```python
import torch

def _softmax(x, axis=-1):
    return torch.softmax(x, dim=axis)
def _gelu(x):
    return torch.nn.functional.gelu(x, approximate="tanh")
def _silu(x):
    return torch.nn.functional.silu(x)
def _sigmoid(x):
    return torch.sigmoid(x)
def _layernorm(x, axis=-1, eps=1e-5):
    m = x.mean(dim=axis, keepdim=True)
    v = x.var(dim=axis, keepdim=True, unbiased=False)
    return (x - m) / torch.sqrt(v + eps)
def _scatter_add(tgt, idx, src, axis=0):
    return tgt.clone().index_add_(axis, idx, src)
def _segment_sum(src, seg, n):
    out = torch.zeros((n,) + src.shape[1:], dtype=src.dtype)
    return out.index_add_(0, seg, src)
def _pad(x, pw):
    flat = tuple(v for pair in reversed(pw) for v in pair)
    return torch.nn.functional.pad(x, flat)

kernel_name = 'recurrent_scan__compressed_kv_cla__glu_gated_geglu__prompt'

def setup_inputs():

    _w = (lambda a: (lambda t: t.to(torch.bfloat16) if t.is_floating_point() else t)(torch.as_tensor(a)))
    def _A_setup():
        B, H, Sq, Sk, D, M = 1, 32, 2048, 2048, 128, 512
        Dc = 4 * D
        return {
            "x": _w((lambda *s: torch.randn(*s, dtype=torch.bfloat16) * 0.05)(B, Sq, M)),
            "c_kv": _w((lambda *s: torch.randn(*s, dtype=torch.bfloat16) * 1.6)(B, Sk, Dc)),
            "w_q": _w((lambda *s: torch.randn(*s, dtype=torch.bfloat16) * 1.6)(M, H, D) * (M ** -0.5)),
            "w_uk": _w((lambda *s: torch.randn(*s, dtype=torch.bfloat16) * 1.6)(Dc, H, D) * (Dc ** -0.5)),
            "w_uv": _w((lambda *s: torch.randn(*s, dtype=torch.bfloat16) * 1.6)(Dc, H, D) * (Dc ** -0.5)),
            "w_o": _w((lambda *s: torch.randn(*s, dtype=torch.bfloat16) * 1.6)(H, D, M) * ((H * D) ** -0.5)),
        }
    _A_in = _A_setup()

    def _B_setup():
        B, S, Dm, Df = 1, 2048, 512, 1792
        return {
            "x": _w((lambda *s: torch.randn(*s, dtype=torch.bfloat16) * 0.05)(B, S, Dm)),
            "w_gate": _w((lambda *s: torch.randn(*s, dtype=torch.bfloat16) * 0.2)(Dm, Df) * (Dm ** -0.5)),
            "w_up": _w((lambda *s: torch.randn(*s, dtype=torch.bfloat16) * 0.2)(Dm, Df) * (Dm ** -0.5)),
            "w_down": _w((lambda *s: torch.randn(*s, dtype=torch.bfloat16) * 0.2)(Df, Dm) * (Df ** -0.5)),
        }
    _B_in = _B_setup()

    return {
        "A_x": _A_in["x"],
        "A_c_kv": _A_in["c_kv"],
        "A_w_q": _A_in["w_q"],
        "A_w_uk": _A_in["w_uk"],
        "A_w_uv": _A_in["w_uv"],
        "A_w_o": _A_in["w_o"],
        "B_x": _B_in["x"],
        "B_w_gate": _B_in["w_gate"],
        "B_w_up": _B_in["w_up"],
        "B_w_down": _B_in["w_down"],
    }

def reference(A_x, A_c_kv, A_w_q, A_w_uk, A_w_uv, A_w_o, B_x, B_w_gate, B_w_up, B_w_down):
    def _A_ref(x, c_kv, w_q, w_uk, w_uv, w_o):
        B, Sq, M = x.shape[0], x.shape[1], x.shape[2]
        Sk = c_kv.shape[1]
        H, D = w_q.shape[1], w_q.shape[2]
        q = torch.einsum("bqm,mhd->bhqd", x, w_q)
        k = torch.einsum("bkc,chd->bhkd", c_kv, w_uk)
        v = torch.einsum("bkc,chd->bhkd", c_kv, w_uv)
        scores = torch.einsum("bhqd,bhkd->bhqk", q, k) * (D ** -0.5)
        off = Sk - Sq
        qi = torch.arange(Sq)[:, None]
        kj = torch.arange(Sk)[None, :]
        cmask = kj <= (qi + off)
        scores = torch.where(cmask[None, None], scores, -1e9)
        p = _softmax(scores, axis=-1)
        ctx = torch.einsum("bhqk,bhkd->bhqd", p, v)
        return torch.einsum("bhqd,hdm->bqm", ctx, w_o)

    def _B_ref(x, w_gate, w_up, w_down):
        g = torch.einsum("bsd,df->bsf", x, w_gate)
        u = torch.einsum("bsd,df->bsf", x, w_up)
        h = _gelu(g) * u
        return torch.einsum("bsf,fd->bsd", h, w_down)

    x = A_x
    xn = _layernorm(x, axis=-1)
    s = _A_ref(xn, A_c_kv, A_w_q, A_w_uk, A_w_uv, A_w_o)
    g = _silu(_B_ref(xn, B_w_gate, B_w_up, B_w_down))
    return x + s * g
```

```asm
; @launch grid=(256,1,1) block=(256,1,1) lds=163840
.amdgcn_target "amdgcn-amd-amdhsa--gfx950"
.text
.globl recurrent_scan__compressed_kv_cla__glu_gated_geglu__prompt_kernel
.p2align 8
.type recurrent_scan__compressed_kv_cla__glu_gated_geglu__prompt_kernel,@function
recurrent_scan__compressed_kv_cla__glu_gated_geglu__prompt_kernel:
    s_cmp_ge_u32 s2, 256
    s_cbranch_scc1 L_end
    s_load_dwordx2 s[8:9], s[0:1], 0
    s_load_dwordx2 s[12:13], s[0:1], 8
    s_load_dwordx2 s[20:21], s[0:1], 24
    s_load_dwordx2 s[52:53], s[0:1], 96
    v_and_b32 v1, 63, v0
    v_lshrrev_b32 v2, 6, v0
    v_lshlrev_b32 v3, 4, v1
    v_readfirstlane_b32 s68, v2
    s_getpc_b64 s[4:5]
    s_lshr_b32 s72, s2, 3
    s_lshl_b32 s72, s72, 11
    v_lshlrev_b32 v16, 3, v2
    v_and_or_b32 v16, v0, 7, v16
    v_lshlrev_b32 v16, 6, v16
    v_add_u32 v16, s72, v16
    v_min_u32 v16, L_end-L_pcref, v16
L_pcref:
    global_load_dword v28, v16, s[4:5]
    s_and_b32 s72, s2, 7
    s_lshl_b32 s72, s72, 2
    s_lshr_b32 s73, s2, 3
    s_and_b32 s73, s73, 3
    s_add_u32 s69, s72, s73
    s_lshr_b32 s70, s2, 5
    s_mul_i32 s72, s73, 4
    s_add_u32 s71, s70, s72
    s_mul_i32 s72, s2, 1
    s_add_u32 s71, s71, s72
    s_and_b32 s71, s71, 7
    s_mul_i32 s72, s73, 0
    s_add_u32 s48, s70, s72
    s_mul_i32 s72, s2, 1
    s_add_u32 s48, s48, s72
    s_and_b32 s48, s48, 3
    s_lshl_b32 s78, s68, 10
    s_lshl_b32 s79, s68, 13
    s_add_u32 s79, s79, 65536
    s_mov_b32 s10, 2097152
    s_mov_b32 s11, 0x20000
    s_mov_b32 s14, 2097152
    s_mov_b32 s15, 0x20000
    s_mov_b32 s22, 4194304
    s_mov_b32 s23, 0x20000
    s_mov_b32 s54, 67108864
    s_mov_b32 s55, 0x20000
    v_lshrrev_b32 v16, 2, v1
    v_lshlrev_b32 v16, 7, v16
    v_and_b32 v17, 3, v1
    v_lshlrev_b32 v17, 3, v17
    v_add_u32 v16, v16, v17
    v_bfe_u32 v17, v1, 3, 2
    v_lshlrev_b32 v17, 5, v17
    v_add_u32 v4, v16, v17
    v_xor_b32 v5, 32, v4
    v_xor_b32 v6, 64, v4
    v_xor_b32 v7, 96, v4
    v_lshrrev_b32 v16, 3, v1
    v_and_b32 v17, 7, v1
    v_and_b32 v18, 6, v16
    v_xor_b32 v17, v17, v18
    v_lshlrev_b32 v30, 4, v17
    s_lshl_b32 s72, s68, 3
    v_add_u32 v18, s72, v16
    v_bfe_u32 v19, v18, 2, 2
    v_lshlrev_b32 v19, 3, v19
    v_lshrrev_b32 v20, 4, v18
    v_lshl_add_u32 v19, v20, 2, v19
    v_and_b32 v20, 3, v18
    v_add_u32 v31, v19, v20
    v_lshl_add_u32 v8, v31, 13, v30
    v_add_u32 v9, 128, v8
    v_add_u32 v10, 262144, v8
    v_add_u32 v11, 262272, v8
    v_and_b32 v17, 7, v1
    v_lshrrev_b32 v18, 1, v16
    v_xor_b32 v17, v17, v18
    v_lshlrev_b32 v17, 4, v17
    v_lshl_add_u32 v12, v16, 10, v17
    v_xor_b32 v13, 64, v12
    v_add_u32 v13, 8192, v13
    v_and_b32 v16, 15, v1
    v_lshrrev_b32 v17, 4, v1
    v_lshrrev_b32 v18, 1, v16
    v_xor_b32 v17, v17, v18
    v_lshlrev_b32 v17, 4, v17
    v_lshl_add_u32 v14, v16, 7, v17
    v_add_u32 v14, s79, v14
    v_xor_b32 v15, 64, v14
    s_lshl_b32 s72, s70, 2
    s_add_u32 s72, s72, s68
    s_lshl_b32 s82, s72, 16
    s_lshl_b32 s83, s69, 19
    s_lshl_b32 s72, s72, 14
    s_add_u32 s83, s83, s72
    s_lshl_b32 s72, s2, 13
    s_lshl_b32 s73, s68, 11
    s_add_u32 s72, s72, s73
    s_add_u32 m0, s78, 0
    s_lshl_b32 s80, s71, 19
    s_lshl_b32 s77, s69, 8
    s_add_u32 s80, s80, s77
    s_waitcnt lgkmcnt(0)
    buffer_load_dwordx4 v[64:67], v3, s[8:11], s72 offen
    buffer_load_dwordx4 v[68:71], v3, s[8:11], s72 offen offset:1024
    buffer_load_dwordx4 v8, s[20:23], s80 offen lds
    s_add_u32 m0, s78, 4096
    s_nop 0
    buffer_load_dwordx4 v9, s[20:23], s80 offen lds
    s_add_u32 m0, s78, 8192
    s_nop 0
    buffer_load_dwordx4 v10, s[20:23], s80 offen lds
    s_add_u32 m0, s78, 12288
    s_nop 0
    buffer_load_dwordx4 v11, s[20:23], s80 offen lds
    s_add_u32 m0, s79, 0
    s_nop 0
    s_add_u32 s81, s71, 0
    s_and_b32 s81, s81, 7
    s_lshl_b32 s81, s81, 7
    s_add_u32 s81, s81, s82
    buffer_load_dwordx4 v12, s[12:15], s81 offen lds
    s_add_u32 m0, s79, 1024
    s_nop 0
    buffer_load_dwordx4 v13, s[12:15], s81 offen lds
    s_add_u32 m0, s79, 2048
    s_nop 0
    s_add_u32 s81, s81, 16384
    buffer_load_dwordx4 v12, s[12:15], s81 offen lds
    s_add_u32 m0, s79, 3072
    s_nop 0
    buffer_load_dwordx4 v13, s[12:15], s81 offen lds
    s_add_u32 m0, s79, 4096
    s_nop 0
    s_add_u32 s81, s81, 16384
    buffer_load_dwordx4 v12, s[12:15], s81 offen lds
    s_add_u32 m0, s79, 5120
    s_nop 0
    buffer_load_dwordx4 v13, s[12:15], s81 offen lds
    s_add_u32 m0, s79, 6144
    s_nop 0
    s_add_u32 s81, s81, 16384
    buffer_load_dwordx4 v12, s[12:15], s81 offen lds
    s_add_u32 m0, s79, 7168
    s_nop 0
    buffer_load_dwordx4 v13, s[12:15], s81 offen lds
    s_add_u32 m0, s78, 16384
    s_nop 0
    s_load_dwordx2 s[16:17], s[0:1], 16
    s_mov_b32 s18, 4194304
    s_mov_b32 s19, 0x20000
    s_load_dwordx2 s[24:25], s[0:1], 32
    s_mov_b32 s26, 4194304
    s_mov_b32 s27, 0x20000
    s_load_dwordx2 s[28:29], s[0:1], 40
    s_mov_b32 s30, 4194304
    s_mov_b32 s31, 0x20000
    s_load_dwordx2 s[32:33], s[0:1], 56
    s_mov_b32 s34, 1835008
    s_mov_b32 s35, 0x20000
    s_load_dwordx2 s[36:37], s[0:1], 64
    s_mov_b32 s38, 1835008
    s_mov_b32 s39, 0x20000
    s_load_dwordx2 s[40:41], s[0:1], 72
    s_mov_b32 s42, 1835008
    s_mov_b32 s43, 0x20000
    s_load_dwordx2 s[44:45], s[0:1], 80
    s_mov_b32 s46, 2097152
    s_mov_b32 s47, 0x20000
    s_mov_b64 s[56:57], s[52:53]
    s_mov_b32 s58, 67108864
    s_mov_b32 s59, 0x20000
    s_mov_b64 s[60:61], s[52:53]
    s_mov_b32 s62, 67108864
    s_mov_b32 s63, 0x20000
    s_mov_b64 s[64:65], s[52:53]
    s_mov_b32 s66, 67108864
    s_mov_b32 s67, 0x20000
    s_add_u32 s6, s52, 11534336
    s_addc_u32 s7, s53, 0
    s_load_dword s3, s[6:7], 0
    s_waitcnt vmcnt(12)
    v_lshlrev_b32 v72, 16, v64
    v_and_b32 v73, 0xffff0000, v64
    v_lshlrev_b32 v74, 16, v65
    v_and_b32 v75, 0xffff0000, v65
    v_lshlrev_b32 v76, 16, v66
    v_and_b32 v77, 0xffff0000, v66
    v_lshlrev_b32 v78, 16, v67
    v_and_b32 v79, 0xffff0000, v67
    v_lshlrev_b32 v80, 16, v68
    v_and_b32 v81, 0xffff0000, v68
    v_lshlrev_b32 v82, 16, v69
    v_and_b32 v83, 0xffff0000, v69
    v_lshlrev_b32 v84, 16, v70
    v_and_b32 v85, 0xffff0000, v70
    v_lshlrev_b32 v86, 16, v71
    v_and_b32 v87, 0xffff0000, v71
    v_pk_add_f32 v[96:97], v[72:73], v[74:75]
    v_pk_add_f32 v[98:99], v[80:81], v[82:83]
    v_pk_add_f32 v[96:97], v[96:97], v[76:77]
    v_pk_add_f32 v[98:99], v[98:99], v[84:85]
    v_pk_add_f32 v[96:97], v[96:97], v[78:79]
    v_pk_add_f32 v[98:99], v[98:99], v[86:87]
    v_add_f32 v88, v96, v97
    v_add_f32 v89, v98, v99
    s_nop 0
    v_add_f32_dpp v88, v88, v88 quad_perm:[1,0,3,2] row_mask:0xf bank_mask:0xf
    v_add_f32_dpp v89, v89, v89 quad_perm:[1,0,3,2] row_mask:0xf bank_mask:0xf
    s_nop 0
    v_add_f32_dpp v88, v88, v88 quad_perm:[2,3,0,1] row_mask:0xf bank_mask:0xf
    v_add_f32_dpp v89, v89, v89 quad_perm:[2,3,0,1] row_mask:0xf bank_mask:0xf
    s_nop 0
    v_add_f32_dpp v88, v88, v88 row_half_mirror row_mask:0xf bank_mask:0xf
    v_add_f32_dpp v89, v89, v89 row_half_mirror row_mask:0xf bank_mask:0xf
    s_lshl_b32 s74, s68, 8
    s_add_u32 s74, s74, s2
    s_lshr_b32 s75, s74, 3
    s_add_u32 s76, s74, s75
    s_and_b32 s76, s76, 7
    s_cmp_lt_u32 s74, 448
    s_cselect_b32 s42, 1835008, 0
    s_cmp_lt_u32 s74, 448
    s_cselect_b32 s66, 67108864, 0
    v_lshrrev_b32 v24, 3, v1
    v_lshl_add_u32 v24, v24, 10, v30
    v_mul_u32_u24 v31, 3584, v31
    v_add_u32 v31, v31, v30
    s_add_u32 s80, s80, 524288
    s_and_b32 s80, s80, 4194303
    buffer_load_dwordx4 v8, s[20:23], s80 offen lds
    s_add_u32 m0, s78, 20480
    s_nop 0
    v_add_f32_dpp v88, v88, v88 row_mirror row_mask:0xf bank_mask:0xf
    v_add_f32_dpp v89, v89, v89 row_mirror row_mask:0xf bank_mask:0xf
    s_nop 0
    v_add_f32_dpp v88, v88, v88 row_bcast:15 row_mask:0xa bank_mask:0xf
    v_add_f32_dpp v89, v89, v89 row_bcast:15 row_mask:0xa bank_mask:0xf
    s_nop 0
    v_add_f32_dpp v88, v88, v88 row_bcast:31 row_mask:0xc bank_mask:0xf
    v_add_f32_dpp v89, v89, v89 row_bcast:31 row_mask:0xc bank_mask:0xf
    s_nop 0
    v_readlane_b32 s72, v88, 63
    v_readlane_b32 s73, v89, 63
    s_nop 1
    v_mov_b32 v92, s72
    v_mov_b32 v93, s73
    v_mul_f32 v92, 0x3b000000, v92
    v_mul_f32 v93, 0x3b000000, v93
    v_pk_add_f32 v[100:101], v[72:73], v[92:93] op_sel_hi:[1,0] neg_lo:[0,1] neg_hi:[0,1]
    v_pk_add_f32 v[108:109], v[80:81], v[92:93] op_sel:[0,1] op_sel_hi:[1,1] neg_lo:[0,1] neg_hi:[0,1]
    v_pk_add_f32 v[102:103], v[74:75], v[92:93] op_sel_hi:[1,0] neg_lo:[0,1] neg_hi:[0,1]
    v_pk_add_f32 v[110:111], v[82:83], v[92:93] op_sel:[0,1] op_sel_hi:[1,1] neg_lo:[0,1] neg_hi:[0,1]
    v_pk_add_f32 v[104:105], v[76:77], v[92:93] op_sel_hi:[1,0] neg_lo:[0,1] neg_hi:[0,1]
    v_pk_add_f32 v[112:113], v[84:85], v[92:93] op_sel:[0,1] op_sel_hi:[1,1] neg_lo:[0,1] neg_hi:[0,1]
    v_pk_add_f32 v[106:107], v[78:79], v[92:93] op_sel_hi:[1,0] neg_lo:[0,1] neg_hi:[0,1]
    v_pk_add_f32 v[114:115], v[86:87], v[92:93] op_sel:[0,1] op_sel_hi:[1,1] neg_lo:[0,1] neg_hi:[0,1]
    v_pk_mul_f32 v[96:97], v[100:101], v[100:101]
    v_pk_mul_f32 v[98:99], v[108:109], v[108:109]
    v_pk_fma_f32 v[96:97], v[102:103], v[102:103], v[96:97]
    v_pk_fma_f32 v[98:99], v[110:111], v[110:111], v[98:99]
    v_pk_fma_f32 v[96:97], v[104:105], v[104:105], v[96:97]
    v_pk_fma_f32 v[98:99], v[112:113], v[112:113], v[98:99]
    v_pk_fma_f32 v[96:97], v[106:107], v[106:107], v[96:97]
    v_pk_fma_f32 v[98:99], v[114:115], v[114:115], v[98:99]
    buffer_load_dwordx4 v9, s[20:23], s80 offen lds
    s_add_u32 m0, s78, 24576
    v_add_f32 v88, v96, v97
    v_add_f32 v89, v98, v99
    s_nop 0
    v_add_f32_dpp v88, v88, v88 quad_perm:[1,0,3,2] row_mask:0xf bank_mask:0xf
    v_add_f32_dpp v89, v89, v89 quad_perm:[1,0,3,2] row_mask:0xf bank_mask:0xf
    s_nop 0
    v_add_f32_dpp v88, v88, v88 quad_perm:[2,3,0,1] row_mask:0xf bank_mask:0xf
    v_add_f32_dpp v89, v89, v89 quad_perm:[2,3,0,1] row_mask:0xf bank_mask:0xf
    s_nop 0
    v_add_f32_dpp v88, v88, v88 row_half_mirror row_mask:0xf bank_mask:0xf
    v_add_f32_dpp v89, v89, v89 row_half_mirror row_mask:0xf bank_mask:0xf
    s_nop 0
    v_add_f32_dpp v88, v88, v88 row_mirror row_mask:0xf bank_mask:0xf
    v_add_f32_dpp v89, v89, v89 row_mirror row_mask:0xf bank_mask:0xf
    s_nop 0
    v_add_f32_dpp v88, v88, v88 row_bcast:15 row_mask:0xa bank_mask:0xf
    v_add_f32_dpp v89, v89, v89 row_bcast:15 row_mask:0xa bank_mask:0xf
    s_nop 0
    v_add_f32_dpp v88, v88, v88 row_bcast:31 row_mask:0xc bank_mask:0xf
    v_add_f32_dpp v89, v89, v89 row_bcast:31 row_mask:0xc bank_mask:0xf
    s_nop 0
    v_readlane_b32 s72, v88, 63
    v_readlane_b32 s73, v89, 63
    s_nop 1
    v_mov_b32 v94, s72
    v_mov_b32 v95, s73
    v_mul_f32 v94, 0x3b000000, v94
    v_mul_f32 v95, 0x3b000000, v95
    v_cvt_pk_bf16_f32 v94, v94, v94
    v_cvt_pk_bf16_f32 v95, v95, v95
    v_lshlrev_b32 v94, 16, v94
    v_lshlrev_b32 v95, 16, v95
    v_add_f32 v94, 0x3727c5ac, v94
    buffer_load_dwordx4 v10, s[20:23], s80 offen lds
    s_add_u32 m0, s78, 28672
    v_add_f32 v95, 0x3727c5ac, v95
    v_cvt_pk_bf16_f32 v94, v94, v94
    v_cvt_pk_bf16_f32 v95, v95, v95
    v_lshlrev_b32 v94, 16, v94
    v_lshlrev_b32 v95, 16, v95
    v_sqrt_f32 v94, v94
    v_sqrt_f32 v95, v95
    v_cvt_pk_bf16_f32 v92, v92, v92
    v_cvt_pk_bf16_f32 v93, v93, v93
    v_lshlrev_b32 v92, 16, v92
    v_lshlrev_b32 v93, 16, v93
    v_cvt_pk_bf16_f32 v94, v94, v94
    v_cvt_pk_bf16_f32 v95, v95, v95
    v_lshlrev_b32 v94, 16, v94
    v_lshlrev_b32 v95, 16, v95
    v_rcp_f32 v94, v94
    v_rcp_f32 v95, v95
    v_pk_add_f32 v[72:73], v[72:73], v[92:93] op_sel_hi:[1,0] neg_lo:[0,1] neg_hi:[0,1]
    v_pk_add_f32 v[74:75], v[74:75], v[92:93] op_sel_hi:[1,0] neg_lo:[0,1] neg_hi:[0,1]
    v_pk_add_f32 v[76:77], v[76:77], v[92:93] op_sel_hi:[1,0] neg_lo:[0,1] neg_hi:[0,1]
    v_pk_add_f32 v[78:79], v[78:79], v[92:93] op_sel_hi:[1,0] neg_lo:[0,1] neg_hi:[0,1]
    v_cvt_pk_bf16_f32 v64, v72, v73
    v_cvt_pk_bf16_f32 v65, v74, v75
    v_cvt_pk_bf16_f32 v66, v76, v77
    v_cvt_pk_bf16_f32 v67, v78, v79
    v_lshlrev_b32 v72, 16, v64
    v_and_b32 v73, 0xffff0000, v64
    v_lshlrev_b32 v74, 16, v65
    v_and_b32 v75, 0xffff0000, v65
    v_lshlrev_b32 v76, 16, v66
    v_and_b32 v77, 0xffff0000, v66
    v_lshlrev_b32 v78, 16, v67
    v_and_b32 v79, 0xffff0000, v67
    buffer_load_dwordx4 v11, s[20:23], s80 offen lds
    s_add_u32 m0, s79, 32768
    v_pk_mul_f32 v[72:73], v[72:73], v[94:95] op_sel_hi:[1,0]
    v_pk_mul_f32 v[74:75], v[74:75], v[94:95] op_sel_hi:[1,0]
    v_pk_mul_f32 v[76:77], v[76:77], v[94:95] op_sel_hi:[1,0]
    v_pk_mul_f32 v[78:79], v[78:79], v[94:95] op_sel_hi:[1,0]
    v_cvt_pk_bf16_f32 v64, v72, v73
    v_cvt_pk_bf16_f32 v65, v74, v75
    v_cvt_pk_bf16_f32 v66, v76, v77
    v_cvt_pk_bf16_f32 v67, v78, v79
    v_pk_add_f32 v[80:81], v[80:81], v[92:93] op_sel:[0,1] op_sel_hi:[1,1] neg_lo:[0,1] neg_hi:[0,1]
    v_pk_add_f32 v[82:83], v[82:83], v[92:93] op_sel:[0,1] op_sel_hi:[1,1] neg_lo:[0,1] neg_hi:[0,1]
    v_pk_add_f32 v[84:85], v[84:85], v[92:93] op_sel:[0,1] op_sel_hi:[1,1] neg_lo:[0,1] neg_hi:[0,1]
    v_pk_add_f32 v[86:87], v[86:87], v[92:93] op_sel:[0,1] op_sel_hi:[1,1] neg_lo:[0,1] neg_hi:[0,1]
    v_cvt_pk_bf16_f32 v68, v80, v81
    v_cvt_pk_bf16_f32 v69, v82, v83
    v_cvt_pk_bf16_f32 v70, v84, v85
    v_cvt_pk_bf16_f32 v71, v86, v87
    v_lshlrev_b32 v80, 16, v68
    v_and_b32 v81, 0xffff0000, v68
    v_lshlrev_b32 v82, 16, v69
    v_and_b32 v83, 0xffff0000, v69
    v_lshlrev_b32 v84, 16, v70
    v_and_b32 v85, 0xffff0000, v70
    v_lshlrev_b32 v86, 16, v71
    v_and_b32 v87, 0xffff0000, v71
    v_pk_mul_f32 v[80:81], v[80:81], v[94:95] op_sel:[0,1] op_sel_hi:[1,1]
    v_pk_mul_f32 v[82:83], v[82:83], v[94:95] op_sel:[0,1] op_sel_hi:[1,1]
    v_pk_mul_f32 v[84:85], v[84:85], v[94:95] op_sel:[0,1] op_sel_hi:[1,1]
    v_pk_mul_f32 v[86:87], v[86:87], v[94:95] op_sel:[0,1] op_sel_hi:[1,1]
    v_cvt_pk_bf16_f32 v68, v80, v81
    v_cvt_pk_bf16_f32 v69, v82, v83
    v_cvt_pk_bf16_f32 v70, v84, v85
    v_cvt_pk_bf16_f32 v71, v86, v87
    s_lshl_b32 s72, s68, 5
    s_add_u32 s72, s72, 49152
    v_lshlrev_b32 v18, 7, v1
    v_add_u32 v18, s72, v18
    ds_write_b128 v18, v[64:67]
    ds_write_b128 v18, v[68:71] offset:16
    s_lshl_b32 s72, s68, 11
    s_add_u32 s72, s72, 49152
    v_add_u32 v18, s72, v3
    v_lshrrev_b32 v19, 5, v1
    v_lshlrev_b32 v19, 12, v19
    v_bfe_u32 v20, v1, 3, 2
    v_lshl_add_u32 v19, v20, 8, v19
    v_and_b32 v20, 7, v1
    v_lshl_add_u32 v19, v20, 4, v19
    s_lshr_b32 s72, s2, 3
    s_lshl_b32 s72, s72, 16
    s_bfe_u32 s73, s2, 0x20001
    s_lshl_b32 s73, s73, 10
    s_add_u32 s72, s72, s73
    s_and_b32 s73, s2, 1
    s_lshl_b32 s73, s73, 7
    s_add_u32 s72, s72, s73
    s_lshl_b32 s73, s68, 14
    s_add_u32 s72, s72, s73
    s_add_u32 s73, s72, 8192
    s_waitcnt vmcnt(4)
    s_waitcnt lgkmcnt(0)
    s_barrier
    s_mul_i32 s3, s3, 0x9e3779b1
    s_add_u32 s3, s3, 0x7f4a7c15
    ds_read_b64_tr_b16 v[32:33], v4 offset:0
    ds_read_b128 a[0:3], v14 offset:0
    ds_read_b128 a[16:19], v15 offset:0
    ds_read_b64_tr_b16 v[34:35], v4 offset:2048
    ds_read_b128 a[4:7], v14 offset:2048
    ds_read_b128 a[20:23], v15 offset:2048
    ds_read_b64_tr_b16 v[36:37], v4 offset:8192
    ds_read_b128 a[8:11], v14 offset:4096
    ds_read_b128 a[24:27], v15 offset:4096
    ds_read_b64_tr_b16 v[38:39], v4 offset:10240
    ds_read_b128 a[12:15], v14 offset:6144
    ds_read_b128 a[28:31], v15 offset:6144
    ds_read_b64_tr_b16 v[40:41], v5 offset:0
    ds_read_b64_tr_b16 v[42:43], v5 offset:2048
    ds_read_b64_tr_b16 v[44:45], v5 offset:8192
    ds_read_b64_tr_b16 v[46:47], v5 offset:10240
    ds_read_b64_tr_b16 v[48:49], v6 offset:0
    ds_read_b64_tr_b16 v[50:51], v6 offset:2048
    ds_read_b64_tr_b16 v[52:53], v6 offset:8192
    s_waitcnt lgkmcnt(7)
    v_mfma_f32_16x16x32_bf16 v[128:131], v[32:35], a[0:3], 0
    ds_read_b64_tr_b16 v[54:55], v6 offset:10240
    s_add_u32 s81, s71, 1
    v_mfma_f32_16x16x32_bf16 v[128:131], v[36:39], a[16:19], v[128:131]
    s_and_b32 s81, s81, 7
    s_lshl_b32 s81, s81, 7
    s_add_u32 s81, s81, s82
    v_mfma_f32_16x16x32_bf16 v[132:135], v[36:39], a[20:23], 0
    ds_read_b64_tr_b16 v[56:57], v7 offset:0
    v_mfma_f32_16x16x32_bf16 v[132:135], v[32:35], a[4:7], v[132:135]
    buffer_load_dwordx4 v12, s[12:15], s81 offen lds
    s_add_u32 m0, s79, 33792
    v_mfma_f32_16x16x32_bf16 v[136:139], v[32:35], a[8:11], 0
    ds_read_b64_tr_b16 v[58:59], v7 offset:2048
    v_mfma_f32_16x16x32_bf16 v[136:139], v[36:39], a[24:27], v[136:139]
    buffer_load_dwordx4 v13, s[12:15], s81 offen lds
    s_add_u32 m0, s79, 34816
    v_mfma_f32_16x16x32_bf16 v[140:143], v[36:39], a[28:31], 0
    ds_read_b64_tr_b16 v[60:61], v7 offset:8192
    s_add_u32 s81, s81, 16384
    v_mfma_f32_16x16x32_bf16 v[140:143], v[32:35], a[12:15], v[140:143]
    s_waitcnt lgkmcnt(7)
    buffer_load_dwordx4 v12, s[12:15], s81 offen lds
    s_add_u32 m0, s79, 35840
    v_mfma_f32_16x16x32_bf16 v[144:147], v[40:43], a[0:3], 0
    ds_read_b64_tr_b16 v[62:63], v7 offset:10240
    v_mfma_f32_16x16x32_bf16 v[144:147], v[44:47], a[16:19], v[144:147]
    buffer_load_dwordx4 v13, s[12:15], s81 offen lds
    s_add_u32 m0, s79, 36864
    v_mfma_f32_16x16x32_bf16 v[148:151], v[44:47], a[20:23], 0
    ds_read_b64_tr_b16 v[32:33], v4 offset:4096
    s_add_u32 s81, s81, 16384
    v_mfma_f32_16x16x32_bf16 v[148:151], v[40:43], a[4:7], v[148:151]
    buffer_load_dwordx4 v12, s[12:15], s81 offen lds
    s_add_u32 m0, s79, 37888
    v_mfma_f32_16x16x32_bf16 v[152:155], v[40:43], a[8:11], 0
    ds_read_b64_tr_b16 v[34:35], v4 offset:6144
    v_mfma_f32_16x16x32_bf16 v[152:155], v[44:47], a[24:27], v[152:155]
    buffer_load_dwordx4 v13, s[12:15], s81 offen lds
    s_add_u32 m0, s79, 38912
    v_mfma_f32_16x16x32_bf16 v[156:159], v[44:47], a[28:31], 0
    ds_read_b64_tr_b16 v[36:37], v4 offset:12288
    s_add_u32 s81, s81, 16384
    v_mfma_f32_16x16x32_bf16 v[156:159], v[40:43], a[12:15], v[156:159]
    s_waitcnt lgkmcnt(7)
    buffer_load_dwordx4 v12, s[12:15], s81 offen lds
    s_add_u32 m0, s79, 39936
    v_mfma_f32_16x16x32_bf16 v[160:163], v[48:51], a[0:3], 0
    ds_read_b64_tr_b16 v[38:39], v4 offset:14336
    v_mfma_f32_16x16x32_bf16 v[160:163], v[52:55], a[16:19], v[160:163]
    buffer_load_dwordx4 v13, s[12:15], s81 offen lds
    s_add_u32 m0, s78, 32768
    v_mfma_f32_16x16x32_bf16 v[164:167], v[52:55], a[20:23], 0
    ds_read_b64_tr_b16 v[40:41], v5 offset:4096
    s_add_u32 s80, s80, 524288
    v_mfma_f32_16x16x32_bf16 v[164:167], v[48:51], a[4:7], v[164:167]
    s_and_b32 s80, s80, 4194303
    buffer_load_dwordx4 v8, s[20:23], s80 offen lds
    s_add_u32 m0, s78, 36864
    v_mfma_f32_16x16x32_bf16 v[168:171], v[48:51], a[8:11], 0
    ds_read_b64_tr_b16 v[42:43], v5 offset:6144
    v_mfma_f32_16x16x32_bf16 v[168:171], v[52:55], a[24:27], v[168:171]
    buffer_load_dwordx4 v9, s[20:23], s80 offen lds
    s_add_u32 m0, s78, 40960
    v_mfma_f32_16x16x32_bf16 v[172:175], v[52:55], a[28:31], 0
    ds_read_b64_tr_b16 v[44:45], v5 offset:12288
    v_mfma_f32_16x16x32_bf16 v[172:175], v[48:51], a[12:15], v[172:175]
    s_waitcnt lgkmcnt(7)
    buffer_load_dwordx4 v10, s[20:23], s80 offen lds
    s_add_u32 m0, s78, 45056
    v_mfma_f32_16x16x32_bf16 v[176:179], v[56:59], a[0:3], 0
    ds_read_b64_tr_b16 v[46:47], v5 offset:14336
    v_mfma_f32_16x16x32_bf16 v[176:179], v[60:63], a[16:19], v[176:179]
    buffer_load_dwordx4 v11, s[20:23], s80 offen lds
    s_add_u32 m0, s79, 0
    v_mfma_f32_16x16x32_bf16 v[180:183], v[60:63], a[20:23], 0
    ds_read_b64_tr_b16 v[48:49], v6 offset:4096
    s_add_u32 s81, s71, 2
    v_mfma_f32_16x16x32_bf16 v[180:183], v[56:59], a[4:7], v[180:183]
    s_and_b32 s81, s81, 7
    s_lshl_b32 s81, s81, 7
    s_add_u32 s81, s81, s82
    v_mfma_f32_16x16x32_bf16 v[184:187], v[56:59], a[8:11], 0
    ds_read_b64_tr_b16 v[50:51], v6 offset:6144
    v_mfma_f32_16x16x32_bf16 v[184:187], v[60:63], a[24:27], v[184:187]
    buffer_load_dwordx4 v12, s[12:15], s81 offen lds
    s_add_u32 m0, s79, 1024
    ds_read_b128 v[64:67], v18
    ds_read_b128 v[68:71], v18 offset:1024
    v_mfma_f32_16x16x32_bf16 v[188:191], v[60:63], a[28:31], 0
    ds_read_b64_tr_b16 v[52:53], v6 offset:12288
    v_mfma_f32_16x16x32_bf16 v[188:191], v[56:59], a[12:15], v[188:191]
    s_waitcnt lgkmcnt(9)
    buffer_load_dwordx4 v13, s[12:15], s81 offen lds
    s_add_u32 m0, s79, 2048
    v_mfma_f32_16x16x32_bf16 v[192:195], v[32:35], a[0:3], 0
    ds_read_b64_tr_b16 v[54:55], v6 offset:14336
    s_add_u32 s81, s81, 16384
    v_mfma_f32_16x16x32_bf16 v[192:195], v[36:39], a[16:19], v[192:195]
    buffer_load_dwordx4 v12, s[12:15], s81 offen lds
    s_add_u32 m0, s79, 3072
    v_mfma_f32_16x16x32_bf16 v[196:199], v[36:39], a[20:23], 0
    ds_read_b64_tr_b16 v[56:57], v7 offset:4096
    v_mfma_f32_16x16x32_bf16 v[196:199], v[32:35], a[4:7], v[196:199]
    buffer_load_dwordx4 v13, s[12:15], s81 offen lds
    s_add_u32 m0, s79, 4096
    v_mfma_f32_16x16x32_bf16 v[200:203], v[32:35], a[8:11], 0
    ds_read_b64_tr_b16 v[58:59], v7 offset:6144
    s_add_u32 s81, s81, 16384
    v_mfma_f32_16x16x32_bf16 v[200:203], v[36:39], a[24:27], v[200:203]
    buffer_load_dwordx4 v12, s[12:15], s81 offen lds
    s_add_u32 m0, s79, 5120
    v_mfma_f32_16x16x32_bf16 v[204:207], v[36:39], a[28:31], 0
    ds_read_b64_tr_b16 v[60:61], v7 offset:12288
    v_mfma_f32_16x16x32_bf16 v[204:207], v[32:35], a[12:15], v[204:207]
    buffer_load_dwordx4 v13, s[12:15], s81 offen lds
    s_add_u32 m0, s79, 6144
    s_waitcnt lgkmcnt(5)
    buffer_store_dwordx4 v[64:67], v19, s[52:55], s72 offen sc1
    v_mfma_f32_16x16x32_bf16 v[208:211], v[40:43], a[0:3], 0
    ds_read_b64_tr_b16 v[62:63], v7 offset:14336
    s_add_u32 s81, s81, 16384
    buffer_load_dwordx4 v12, s[12:15], s81 offen lds
    s_add_u32 m0, s79, 7168
    s_nop 0
    buffer_load_dwordx4 v13, s[12:15], s81 offen lds
    s_add_u32 m0, s78, 49152
    buffer_store_dwordx4 v[68:71], v19, s[52:55], s73 offen sc1
    v_mfma_f32_16x16x32_bf16 v[208:211], v[44:47], a[16:19], v[208:211]
    s_add_u32 s80, s80, 524288
    s_and_b32 s80, s80, 4194303
    v_mfma_f32_16x16x32_bf16 v[212:215], v[44:47], a[20:23], 0
    s_waitcnt vmcnt(14)
    s_barrier
    v_mfma_f32_16x16x32_bf16 v[212:215], v[40:43], a[4:7], v[212:215]
    ds_read_b64_tr_b16 v[32:33], v4 offset:16384
    v_mfma_f32_16x16x32_bf16 v[216:219], v[40:43], a[8:11], 0
    ds_read_b128 a[32:35], v14 offset:32768
    s_sub_u32 s94, 15, s70
    v_mfma_f32_16x16x32_bf16 v[216:219], v[44:47], a[24:27], v[216:219]
    ds_read_b128 a[48:51], v15 offset:32768
    s_cmp_lt_u32 s68, 2
    s_cselect_b32 s95, s94, s70
    v_mfma_f32_16x16x32_bf16 v[220:223], v[44:47], a[28:31], 0
    ds_read_b64_tr_b16 v[34:35], v4 offset:18432
    s_lshl_b32 s95, s95, 1
    v_mfma_f32_16x16x32_bf16 v[220:223], v[40:43], a[12:15], v[220:223]
    s_waitcnt lgkmcnt(8)
    ds_read_b128 a[36:39], v14 offset:34816
    s_and_b32 s96, s68, 1
    v_mfma_f32_16x16x32_bf16 v[224:227], v[48:51], a[0:3], 0
    ds_read_b128 a[52:55], v15 offset:34816
    s_add_u32 s98, s95, s96
    v_mfma_f32_16x16x32_bf16 v[224:227], v[52:55], a[16:19], v[224:227]
    ds_read_b64_tr_b16 v[36:37], v4 offset:24576
    s_lshl_b32 s84, s98, 16
    v_mfma_f32_16x16x32_bf16 v[228:231], v[52:55], a[20:23], 0
    ds_read_b128 a[40:43], v14 offset:36864
    s_mul_i32 s85, s98, 229376
    v_mfma_f32_16x16x32_bf16 v[228:231], v[48:51], a[4:7], v[228:231]
    ds_read_b128 a[56:59], v15 offset:36864
    s_add_u32 s85, s85, 2097152
    v_mfma_f32_16x16x32_bf16 v[232:235], v[48:51], a[8:11], 0
    ds_read_b64_tr_b16 v[38:39], v4 offset:26624
    s_lshl_b32 s100, s69, 14
    v_mfma_f32_16x16x32_bf16 v[232:235], v[52:55], a[24:27], v[232:235]
    ds_read_b128 a[44:47], v14 offset:38912
    s_add_u32 s100, s100, 16777216
    v_mfma_f32_16x16x32_bf16 v[236:239], v[52:55], a[28:31], 0
    ds_read_b128 a[60:63], v15 offset:38912
    s_lshl_b32 s86, s98, 19
    v_mfma_f32_16x16x32_bf16 v[236:239], v[48:51], a[12:15], v[236:239]
    s_waitcnt lgkmcnt(12)
    ds_read_b64_tr_b16 v[40:41], v5 offset:16384
    s_add_u32 s86, s86, s100
    v_mfma_f32_16x16x32_bf16 v[240:243], v[56:59], a[0:3], 0
    ds_read_b64_tr_b16 v[42:43], v5 offset:18432
    s_lshr_b32 s95, s68, 1
    v_mfma_f32_16x16x32_bf16 v[240:243], v[60:63], a[16:19], v[240:243]
    ds_read_b64_tr_b16 v[44:45], v5 offset:24576
    s_xor_b32 s95, s95, s68
    v_mfma_f32_16x16x32_bf16 v[244:247], v[60:63], a[20:23], 0
    ds_read_b64_tr_b16 v[46:47], v5 offset:26624
    s_and_b32 s95, s95, 1
    v_mfma_f32_16x16x32_bf16 v[244:247], v[56:59], a[4:7], v[244:247]
    ds_read_b64_tr_b16 v[48:49], v6 offset:16384
    s_lshl_b32 s94, s94, 1
    v_mfma_f32_16x16x32_bf16 v[248:251], v[56:59], a[8:11], 0
    ds_read_b64_tr_b16 v[50:51], v6 offset:18432
    s_add_u32 s99, s94, s95
    v_mfma_f32_16x16x32_bf16 v[248:251], v[60:63], a[24:27], v[248:251]
    buffer_load_dwordx4 v8, s[20:23], s80 offen lds
    s_add_u32 m0, s78, 53248
    v_mfma_f32_16x16x32_bf16 v[252:255], v[60:63], a[28:31], 0
    ds_read_b64_tr_b16 v[52:53], v6 offset:24576
    s_lshl_b32 s87, s99, 19
    v_mfma_f32_16x16x32_bf16 v[252:255], v[56:59], a[12:15], v[252:255]
    s_waitcnt lgkmcnt(7)
    buffer_load_dwordx4 v9, s[20:23], s80 offen lds
    s_add_u32 m0, s78, 57344
    v_mfma_f32_16x16x32_bf16 v[128:131], v[32:35], a[32:35], v[128:131]
    ds_read_b64_tr_b16 v[54:55], v6 offset:26624
    s_add_u32 s87, s87, s100
    v_mfma_f32_16x16x32_bf16 v[128:131], v[36:39], a[48:51], v[128:131]
    buffer_load_dwordx4 v10, s[20:23], s80 offen lds
    s_add_u32 m0, s78, 61440
    v_mfma_f32_16x16x32_bf16 v[132:135], v[36:39], a[52:55], v[132:135]
    ds_read_b64_tr_b16 v[56:57], v7 offset:16384
    s_lshr_b32 s94, s69, 2
    v_mfma_f32_16x16x32_bf16 v[132:135], v[32:35], a[36:39], v[132:135]
    buffer_load_dwordx4 v11, s[20:23], s80 offen lds
    s_add_u32 m0, s79, 32768
    v_mfma_f32_16x16x32_bf16 v[136:139], v[32:35], a[40:43], v[136:139]
    ds_read_b64_tr_b16 v[58:59], v7 offset:18432
    s_add_u32 s81, s71, 3
    v_mfma_f32_16x16x32_bf16 v[136:139], v[36:39], a[56:59], v[136:139]
    s_and_b32 s81, s81, 7
    s_lshl_b32 s81, s81, 7
    s_add_u32 s81, s81, s82
    v_mfma_f32_16x16x32_bf16 v[140:143], v[36:39], a[60:63], v[140:143]
    ds_read_b64_tr_b16 v[60:61], v7 offset:24576
    s_cmp_lg_u32 s94, s70
    s_cselect_b32 s58, 67108864, 0
    v_mfma_f32_16x16x32_bf16 v[140:143], v[32:35], a[44:47], v[140:143]
    s_waitcnt lgkmcnt(7)
    buffer_load_dwordx4 v12, s[12:15], s81 offen lds
    s_add_u32 m0, s79, 33792
    v_mfma_f32_16x16x32_bf16 v[144:147], v[40:43], a[32:35], v[144:147]
    ds_read_b64_tr_b16 v[62:63], v7 offset:26624
    s_cmp_gt_u32 s94, s70
    s_cselect_b32 s94, 4, 0
    v_mfma_f32_16x16x32_bf16 v[144:147], v[44:47], a[48:51], v[144:147]
    s_sub_u32 s7, s69, s94
    s_lshl_b32 s94, s69, 19
    s_mov_b32 s95, 50331648
    v_mfma_f32_16x16x32_bf16 v[148:151], v[44:47], a[52:55], v[148:151]
    ds_read_b64_tr_b16 v[32:33], v4 offset:20480
    s_cmp_lt_u32 s68, 2
    s_cselect_b32 s95, 33554432, s95
    v_mfma_f32_16x16x32_bf16 v[148:151], v[40:43], a[36:39], v[148:151]
    buffer_load_dwordx4 v13, s[12:15], s81 offen lds
    s_add_u32 m0, s79, 34816
    v_mfma_f32_16x16x32_bf16 v[152:155], v[40:43], a[40:43], v[152:155]
    ds_read_b64_tr_b16 v[34:35], v4 offset:22528
    s_add_u32 s81, s81, 16384
    v_mfma_f32_16x16x32_bf16 v[152:155], v[44:47], a[56:59], v[152:155]
    s_add_u32 s95, s95, s94
    s_add_u32 s93, s95, 516096
    s_and_b32 s94, s68, 1
    v_mfma_f32_16x16x32_bf16 v[156:159], v[44:47], a[60:63], v[156:159]
    ds_read_b64_tr_b16 v[36:37], v4 offset:28672
    s_lshl_b32 s94, s94, 13
    v_mfma_f32_16x16x32_bf16 v[156:159], v[40:43], a[44:47], v[156:159]
    s_waitcnt lgkmcnt(7)
    buffer_load_dwordx4 v12, s[12:15], s81 offen lds
    s_add_u32 m0, s79, 35840
    v_mfma_f32_16x16x32_bf16 v[160:163], v[48:51], a[32:35], v[160:163]
    ds_read_b64_tr_b16 v[38:39], v4 offset:30720
    s_add_u32 s88, s95, s94
    v_mfma_f32_16x16x32_bf16 v[160:163], v[52:55], a[48:51], v[160:163]
    s_lshl_b32 s94, s68, 13
    s_add_u32 s92, s95, s94
    s_add_u32 s92, s92, 524288
    v_mfma_f32_16x16x32_bf16 v[164:167], v[52:55], a[52:55], v[164:167]
    ds_read_b64_tr_b16 v[40:41], v5 offset:20480
    s_min_u32 s89, s92, s93
    v_mfma_f32_16x16x32_bf16 v[164:167], v[48:51], a[36:39], v[164:167]
    buffer_load_dwordx4 v13, s[12:15], s81 offen lds
    s_add_u32 m0, s79, 36864
    v_mfma_f32_16x16x32_bf16 v[168:171], v[48:51], a[40:43], v[168:171]
    ds_read_b64_tr_b16 v[42:43], v5 offset:22528
    s_add_u32 s81, s81, 16384
    v_mfma_f32_16x16x32_bf16 v[168:171], v[52:55], a[56:59], v[168:171]
    s_lshl_b32 s91, s68, 13
    s_add_u32 s90, s91, 65536
    s_xor_b32 s91, s91, 32768
    v_mfma_f32_16x16x32_bf16 v[172:175], v[52:55], a[60:63], v[172:175]
    ds_read_b64_tr_b16 v[44:45], v5 offset:28672
    s_lshl_b32 s97, s70, 1
    v_mfma_f32_16x16x32_bf16 v[172:175], v[48:51], a[44:47], v[172:175]
    s_waitcnt lgkmcnt(7)
    buffer_load_dwordx4 v12, s[12:15], s81 offen lds
    s_add_u32 m0, s79, 37888
    v_mfma_f32_16x16x32_bf16 v[176:179], v[56:59], a[32:35], v[176:179]
    ds_read_b64_tr_b16 v[46:47], v5 offset:30720
    s_add_u32 s97, s97, 2
    v_mfma_f32_16x16x32_bf16 v[176:179], v[60:63], a[48:51], v[176:179]
    s_mul_i32 s94, s68, 57344
    s_mul_i32 s50, s69, 229376
    s_add_u32 s50, s50, s94
    v_mfma_f32_16x16x32_bf16 v[180:183], v[60:63], a[52:55], v[180:183]
    ds_read_b64_tr_b16 v[48:49], v6 offset:20480
    s_add_u32 s50, s50, 2097152
    v_mfma_f32_16x16x32_bf16 v[180:183], v[56:59], a[36:39], v[180:183]
    buffer_load_dwordx4 v13, s[12:15], s81 offen lds
    s_add_u32 m0, s79, 38912
    v_mfma_f32_16x16x32_bf16 v[184:187], v[56:59], a[40:43], v[184:187]
    ds_read_b64_tr_b16 v[50:51], v6 offset:22528
    s_add_u32 s81, s81, 16384
    v_mfma_f32_16x16x32_bf16 v[184:187], v[60:63], a[56:59], v[184:187]
    s_mul_i32 s49, s70, 229376
    s_add_u32 s49, s49, s94
    s_add_u32 s49, s49, 9437184
    v_mfma_f32_16x16x32_bf16 v[188:191], v[60:63], a[60:63], v[188:191]
    ds_read_b64_tr_b16 v[52:53], v6 offset:28672
    s_mov_b32 s51, 0
    v_mfma_f32_16x16x32_bf16 v[188:191], v[56:59], a[44:47], v[188:191]
    s_waitcnt lgkmcnt(7)
    buffer_load_dwordx4 v12, s[12:15], s81 offen lds
    s_add_u32 m0, s79, 39936
    v_mfma_f32_16x16x32_bf16 v[192:195], v[32:35], a[32:35], v[192:195]
    ds_read_b64_tr_b16 v[54:55], v6 offset:30720
    v_mfma_f32_16x16x32_bf16 v[192:195], v[36:39], a[48:51], v[192:195]
    v_mfma_f32_16x16x32_bf16 v[196:199], v[36:39], a[52:55], v[196:199]
    ds_read_b64_tr_b16 v[56:57], v7 offset:20480
    v_mfma_f32_16x16x32_bf16 v[196:199], v[32:35], a[36:39], v[196:199]
    buffer_load_dwordx4 v13, s[12:15], s81 offen lds
    s_add_u32 m0, s78, 0
    v_mfma_f32_16x16x32_bf16 v[200:203], v[32:35], a[40:43], v[200:203]
    ds_read_b64_tr_b16 v[58:59], v7 offset:22528
    v_lshrrev_b32 v29, 2, v1
    v_mfma_f32_16x16x32_bf16 v[200:203], v[36:39], a[56:59], v[200:203]
    v_lshlrev_b32 v29, 7, v29
    v_and_or_b32 v29, v1, 3, v29
    v_mfma_f32_16x16x32_bf16 v[204:207], v[36:39], a[60:63], v[204:207]
    ds_read_b64_tr_b16 v[60:61], v7 offset:28672
    v_lshlrev_b32 v29, 6, v29
    v_mfma_f32_16x16x32_bf16 v[204:207], v[32:35], a[44:47], v[204:207]
    s_waitcnt lgkmcnt(7)
    v_lshlrev_b32 v21, 6, v1
    v_min_u32 v20, 1728, v21
    v_mfma_f32_16x16x32_bf16 v[208:211], v[40:43], a[32:35], v[208:211]
    ds_read_b64_tr_b16 v[62:63], v7 offset:30720
    s_add_u32 s80, s80, 524288
    v_mfma_f32_16x16x32_bf16 v[208:211], v[44:47], a[48:51], v[208:211]
    s_and_b32 s80, s80, 4194303
    v_mfma_f32_16x16x32_bf16 v[212:215], v[44:47], a[52:55], v[212:215]
    s_waitcnt vmcnt(13)
    s_barrier
    v_mfma_f32_16x16x32_bf16 v[212:215], v[40:43], a[36:39], v[212:215]
    ds_read_b64_tr_b16 v[32:33], v4 offset:32768
    v_mfma_f32_16x16x32_bf16 v[216:219], v[40:43], a[40:43], v[216:219]
    ds_read_b128 a[64:67], v14 offset:0
    v_mfma_f32_16x16x32_bf16 v[216:219], v[44:47], a[56:59], v[216:219]
    ds_read_b128 a[80:83], v15 offset:0
    v_mfma_f32_16x16x32_bf16 v[220:223], v[44:47], a[60:63], v[220:223]
    ds_read_b64_tr_b16 v[34:35], v4 offset:34816
    v_mfma_f32_16x16x32_bf16 v[220:223], v[40:43], a[44:47], v[220:223]
    s_waitcnt lgkmcnt(8)
    ds_read_b128 a[68:71], v14 offset:2048
    v_mfma_f32_16x16x32_bf16 v[224:227], v[48:51], a[32:35], v[224:227]
    ds_read_b128 a[84:87], v15 offset:2048
    v_mfma_f32_16x16x32_bf16 v[224:227], v[52:55], a[48:51], v[224:227]
    ds_read_b64_tr_b16 v[36:37], v4 offset:40960
    v_mfma_f32_16x16x32_bf16 v[228:231], v[52:55], a[52:55], v[228:231]
    ds_read_b128 a[72:75], v14 offset:4096
    v_mfma_f32_16x16x32_bf16 v[228:231], v[48:51], a[36:39], v[228:231]
    ds_read_b128 a[88:91], v15 offset:4096
    v_mfma_f32_16x16x32_bf16 v[232:235], v[48:51], a[40:43], v[232:235]
    ds_read_b64_tr_b16 v[38:39], v4 offset:43008
    v_mfma_f32_16x16x32_bf16 v[232:235], v[52:55], a[56:59], v[232:235]
    ds_read_b128 a[76:79], v14 offset:6144
    v_mfma_f32_16x16x32_bf16 v[236:239], v[52:55], a[60:63], v[236:239]
    ds_read_b128 a[92:95], v15 offset:6144
    v_mfma_f32_16x16x32_bf16 v[236:239], v[48:51], a[44:47], v[236:239]
    s_waitcnt lgkmcnt(12)
    ds_read_b64_tr_b16 v[40:41], v5 offset:32768
    v_mfma_f32_16x16x32_bf16 v[240:243], v[56:59], a[32:35], v[240:243]
    ds_read_b64_tr_b16 v[42:43], v5 offset:34816
    v_mfma_f32_16x16x32_bf16 v[240:243], v[60:63], a[48:51], v[240:243]
    ds_read_b64_tr_b16 v[44:45], v5 offset:40960
    v_mfma_f32_16x16x32_bf16 v[244:247], v[60:63], a[52:55], v[244:247]
    ds_read_b64_tr_b16 v[46:47], v5 offset:43008
    v_mfma_f32_16x16x32_bf16 v[244:247], v[56:59], a[36:39], v[244:247]
    ds_read_b64_tr_b16 v[48:49], v6 offset:32768
    v_mfma_f32_16x16x32_bf16 v[248:251], v[56:59], a[40:43], v[248:251]
    ds_read_b64_tr_b16 v[50:51], v6 offset:34816
    v_mfma_f32_16x16x32_bf16 v[248:251], v[60:63], a[56:59], v[248:251]
    buffer_load_dwordx4 v8, s[20:23], s80 offen lds
    s_add_u32 m0, s78, 4096
    v_mfma_f32_16x16x32_bf16 v[252:255], v[60:63], a[60:63], v[252:255]
    ds_read_b64_tr_b16 v[52:53], v6 offset:40960
    v_mfma_f32_16x16x32_bf16 v[252:255], v[56:59], a[44:47], v[252:255]
    s_waitcnt lgkmcnt(7)
    buffer_load_dwordx4 v9, s[20:23], s80 offen lds
    s_add_u32 m0, s78, 8192
    v_mfma_f32_16x16x32_bf16 v[128:131], v[32:35], a[64:67], v[128:131]
    ds_read_b64_tr_b16 v[54:55], v6 offset:43008
    v_mfma_f32_16x16x32_bf16 v[128:131], v[36:39], a[80:83], v[128:131]
    buffer_load_dwordx4 v10, s[20:23], s80 offen lds
    s_add_u32 m0, s78, 12288
    v_mfma_f32_16x16x32_bf16 v[132:135], v[36:39], a[84:87], v[132:135]
    ds_read_b64_tr_b16 v[56:57], v7 offset:32768
    v_mfma_f32_16x16x32_bf16 v[132:135], v[32:35], a[68:71], v[132:135]
    buffer_load_dwordx4 v11, s[20:23], s80 offen lds
    s_add_u32 m0, s79, 0
    v_mfma_f32_16x16x32_bf16 v[136:139], v[32:35], a[72:75], v[136:139]
    ds_read_b64_tr_b16 v[58:59], v7 offset:34816
    s_add_u32 s81, s71, 4
    v_mfma_f32_16x16x32_bf16 v[136:139], v[36:39], a[88:91], v[136:139]
    s_and_b32 s81, s81, 7
    s_lshl_b32 s81, s81, 7
    s_add_u32 s81, s81, s82
    v_mfma_f32_16x16x32_bf16 v[140:143], v[36:39], a[92:95], v[140:143]
    ds_read_b64_tr_b16 v[60:61], v7 offset:40960
    v_mfma_f32_16x16x32_bf16 v[140:143], v[32:35], a[76:79], v[140:143]
    s_waitcnt lgkmcnt(7)
    buffer_load_dwordx4 v12, s[12:15], s81 offen lds
    s_add_u32 m0, s79, 1024
    v_mfma_f32_16x16x32_bf16 v[144:147], v[40:43], a[64:67], v[144:147]
    ds_read_b64_tr_b16 v[62:63], v7 offset:43008
    v_mfma_f32_16x16x32_bf16 v[144:147], v[44:47], a[80:83], v[144:147]
    v_mfma_f32_16x16x32_bf16 v[148:151], v[44:47], a[84:87], v[148:151]
    ds_read_b64_tr_b16 v[32:33], v4 offset:36864
    v_mfma_f32_16x16x32_bf16 v[148:151], v[40:43], a[68:71], v[148:151]
    buffer_load_dwordx4 v13, s[12:15], s81 offen lds
    s_add_u32 m0, s79, 2048
    v_mfma_f32_16x16x32_bf16 v[152:155], v[40:43], a[72:75], v[152:155]
    ds_read_b64_tr_b16 v[34:35], v4 offset:38912
    s_add_u32 s81, s81, 16384
    v_mfma_f32_16x16x32_bf16 v[152:155], v[44:47], a[88:91], v[152:155]
    v_mfma_f32_16x16x32_bf16 v[156:159], v[44:47], a[92:95], v[156:159]
    ds_read_b64_tr_b16 v[36:37], v4 offset:45056
    v_mfma_f32_16x16x32_bf16 v[156:159], v[40:43], a[76:79], v[156:159]
    s_waitcnt lgkmcnt(7)
    buffer_load_dwordx4 v12, s[12:15], s81 offen lds
    s_add_u32 m0, s79, 3072
    v_mfma_f32_16x16x32_bf16 v[160:163], v[48:51], a[64:67], v[160:163]
    ds_read_b64_tr_b16 v[38:39], v4 offset:47104
    v_mfma_f32_16x16x32_bf16 v[160:163], v[52:55], a[80:83], v[160:163]
    v_mfma_f32_16x16x32_bf16 v[164:167], v[52:55], a[84:87], v[164:167]
    ds_read_b64_tr_b16 v[40:41], v5 offset:36864
    v_mfma_f32_16x16x32_bf16 v[164:167], v[48:51], a[68:71], v[164:167]
    buffer_load_dwordx4 v13, s[12:15], s81 offen lds
    s_add_u32 m0, s79, 4096
    v_mfma_f32_16x16x32_bf16 v[168:171], v[48:51], a[72:75], v[168:171]
    ds_read_b64_tr_b16 v[42:43], v5 offset:38912
    s_add_u32 s81, s81, 16384
    v_mfma_f32_16x16x32_bf16 v[168:171], v[52:55], a[88:91], v[168:171]
    v_mfma_f32_16x16x32_bf16 v[172:175], v[52:55], a[92:95], v[172:175]
    ds_read_b64_tr_b16 v[44:45], v5 offset:45056
    s_add_u32 s94, s79, 65536
    v_mfma_f32_16x16x32_bf16 v[172:175], v[48:51], a[76:79], v[172:175]
    s_waitcnt lgkmcnt(7)
    buffer_load_dwordx4 v12, s[12:15], s81 offen lds
    s_add_u32 m0, s79, 5120
    v_mfma_f32_16x16x32_bf16 v[176:179], v[56:59], a[64:67], v[176:179]
    ds_read_b64_tr_b16 v[46:47], v5 offset:47104
    v_add_u32 v25, s94, v4
    v_mfma_f32_16x16x32_bf16 v[176:179], v[60:63], a[80:83], v[176:179]
    v_add_u32 v26, s94, v5
    v_add_u32 v27, s94, v6
    v_mfma_f32_16x16x32_bf16 v[180:183], v[60:63], a[84:87], v[180:183]
    ds_read_b64_tr_b16 v[48:49], v6 offset:36864
    v_add_u32 v28, s94, v7
    v_mfma_f32_16x16x32_bf16 v[180:183], v[56:59], a[68:71], v[180:183]
    buffer_load_dwordx4 v13, s[12:15], s81 offen lds
    s_add_u32 m0, s79, 6144
    v_mfma_f32_16x16x32_bf16 v[184:187], v[56:59], a[72:75], v[184:187]
    ds_read_b64_tr_b16 v[50:51], v6 offset:38912
    s_add_u32 s81, s81, 16384
    v_mfma_f32_16x16x32_bf16 v[184:187], v[60:63], a[88:91], v[184:187]
    s_lshl_b32 s94, s76, 19
    s_lshl_b32 s75, s75, 12
    s_add_u32 s94, s94, s75
    v_mfma_f32_16x16x32_bf16 v[188:191], v[60:63], a[92:95], v[188:191]
    ds_read_b64_tr_b16 v[52:53], v6 offset:45056
    s_add_u32 s94, s94, 12582912
    v_mfma_f32_16x16x32_bf16 v[188:191], v[56:59], a[76:79], v[188:191]
    s_waitcnt lgkmcnt(7)
    buffer_load_dwordx4 v12, s[12:15], s81 offen lds
    s_add_u32 m0, s79, 7168
    v_mfma_f32_16x16x32_bf16 v[192:195], v[32:35], a[64:67], v[192:195]
    ds_read_b64_tr_b16 v[54:55], v6 offset:47104
    s_mul_i32 s95, s76, 229376
    v_mfma_f32_16x16x32_bf16 v[192:195], v[36:39], a[80:83], v[192:195]
    s_add_u32 s95, s95, s75
    s_add_u32 s95, s95, 9437184
    v_mfma_f32_16x16x32_bf16 v[196:199], v[36:39], a[84:87], v[196:199]
    ds_read_b64_tr_b16 v[56:57], v7 offset:36864
    v_mfma_f32_16x16x32_bf16 v[196:199], v[32:35], a[68:71], v[196:199]
    buffer_load_dwordx4 v13, s[12:15], s81 offen lds
    s_add_u32 m0, s78, 16384
    v_mfma_f32_16x16x32_bf16 v[200:203], v[32:35], a[72:75], v[200:203]
    ds_read_b64_tr_b16 v[58:59], v7 offset:38912
    s_add_u32 s80, s80, 524288
    v_mfma_f32_16x16x32_bf16 v[200:203], v[36:39], a[88:91], v[200:203]
    s_and_b32 s80, s80, 4194303
    v_mfma_f32_16x16x32_bf16 v[204:207], v[36:39], a[92:95], v[204:207]
    ds_read_b64_tr_b16 v[60:61], v7 offset:45056
    v_mfma_f32_16x16x32_bf16 v[204:207], v[32:35], a[76:79], v[204:207]
    s_waitcnt lgkmcnt(7)
    v_mfma_f32_16x16x32_bf16 v[208:211], v[40:43], a[64:67], v[208:211]
    ds_read_b64_tr_b16 v[62:63], v7 offset:47104
    v_mfma_f32_16x16x32_bf16 v[208:211], v[44:47], a[80:83], v[208:211]
    v_mfma_f32_16x16x32_bf16 v[212:215], v[44:47], a[84:87], v[212:215]
    s_waitcnt vmcnt(12)
    s_barrier
    s_lshr_b32 s101, s2, 3
    s_lshl_b32 s101, s101, 7
    s_and_b32 s6, s2, 7
    s_lshl_b32 s6, s6, 2
    s_add_u32 s101, s101, s6
    s_add_u32 s101, s101, 11538432
    v_mov_b32 v22, s3
    v_add_u32 v23, s78, v1
    v_min_u32 v23, 1, v23
    v_lshlrev_b32 v23, 30, v23
    buffer_store_dword v22, v23, s[52:55], s101 offen sc1
    v_mfma_f32_16x16x32_bf16 v[212:215], v[40:43], a[68:71], v[212:215]
    ds_read_b64_tr_b16 v[32:33], v4 offset:49152
    v_mfma_f32_16x16x32_bf16 v[216:219], v[40:43], a[72:75], v[216:219]
    ds_read_b128 a[96:99], v14 offset:32768
    v_mfma_f32_16x16x32_bf16 v[216:219], v[44:47], a[88:91], v[216:219]
    ds_read_b128 a[112:115], v15 offset:32768
    v_mfma_f32_16x16x32_bf16 v[220:223], v[44:47], a[92:95], v[220:223]
    ds_read_b64_tr_b16 v[34:35], v4 offset:51200
    v_mfma_f32_16x16x32_bf16 v[220:223], v[40:43], a[76:79], v[220:223]
    s_waitcnt lgkmcnt(8)
    ds_read_b128 a[100:103], v14 offset:34816
    v_mfma_f32_16x16x32_bf16 v[224:227], v[48:51], a[64:67], v[224:227]
    ds_read_b128 a[116:119], v15 offset:34816
    v_mfma_f32_16x16x32_bf16 v[224:227], v[52:55], a[80:83], v[224:227]
    ds_read_b64_tr_b16 v[36:37], v4 offset:57344
    v_mfma_f32_16x16x32_bf16 v[228:231], v[52:55], a[84:87], v[228:231]
    ds_read_b128 a[104:107], v14 offset:36864
    v_mfma_f32_16x16x32_bf16 v[228:231], v[48:51], a[68:71], v[228:231]
    ds_read_b128 a[120:123], v15 offset:36864
    v_mfma_f32_16x16x32_bf16 v[232:235], v[48:51], a[72:75], v[232:235]
    ds_read_b64_tr_b16 v[38:39], v4 offset:59392
    v_mfma_f32_16x16x32_bf16 v[232:235], v[52:55], a[88:91], v[232:235]
    ds_read_b128 a[108:111], v14 offset:38912
    v_mfma_f32_16x16x32_bf16 v[236:239], v[52:55], a[92:95], v[236:239]
    ds_read_b128 a[124:127], v15 offset:38912
    v_mfma_f32_16x16x32_bf16 v[236:239], v[48:51], a[76:79], v[236:239]
    s_waitcnt lgkmcnt(12)
    ds_read_b64_tr_b16 v[40:41], v5 offset:49152
    v_mfma_f32_16x16x32_bf16 v[240:243], v[56:59], a[64:67], v[240:243]
    ds_read_b64_tr_b16 v[42:43], v5 offset:51200
    v_mfma_f32_16x16x32_bf16 v[240:243], v[60:63], a[80:83], v[240:243]
    ds_read_b64_tr_b16 v[44:45], v5 offset:57344
    v_mfma_f32_16x16x32_bf16 v[244:247], v[60:63], a[84:87], v[244:247]
    ds_read_b64_tr_b16 v[46:47], v5 offset:59392
    v_mfma_f32_16x16x32_bf16 v[244:247], v[56:59], a[68:71], v[244:247]
    ds_read_b64_tr_b16 v[48:49], v6 offset:49152
    v_mfma_f32_16x16x32_bf16 v[248:251], v[56:59], a[72:75], v[248:251]
    ds_read_b64_tr_b16 v[50:51], v6 offset:51200
    v_mfma_f32_16x16x32_bf16 v[248:251], v[60:63], a[88:91], v[248:251]
    buffer_load_dwordx4 v8, s[20:23], s80 offen lds
    s_add_u32 m0, s78, 20480
    v_mfma_f32_16x16x32_bf16 v[252:255], v[60:63], a[92:95], v[252:255]
    ds_read_b64_tr_b16 v[52:53], v6 offset:57344
    v_mfma_f32_16x16x32_bf16 v[252:255], v[56:59], a[76:79], v[252:255]
    s_waitcnt lgkmcnt(7)
    buffer_load_dwordx4 v9, s[20:23], s80 offen lds
    s_add_u32 m0, s78, 24576
    v_mfma_f32_16x16x32_bf16 v[128:131], v[32:35], a[96:99], v[128:131]
    ds_read_b64_tr_b16 v[54:55], v6 offset:59392
    v_mfma_f32_16x16x32_bf16 v[128:131], v[36:39], a[112:115], v[128:131]
    buffer_load_dwordx4 v10, s[20:23], s80 offen lds
    s_add_u32 m0, s78, 28672
    v_mfma_f32_16x16x32_bf16 v[132:135], v[36:39], a[116:119], v[132:135]
    ds_read_b64_tr_b16 v[56:57], v7 offset:49152
    v_mfma_f32_16x16x32_bf16 v[132:135], v[32:35], a[100:103], v[132:135]
    buffer_load_dwordx4 v11, s[20:23], s80 offen lds
    s_add_u32 m0, s79, 32768
    v_mfma_f32_16x16x32_bf16 v[136:139], v[32:35], a[104:107], v[136:139]
    ds_read_b64_tr_b16 v[58:59], v7 offset:51200
    s_add_u32 s81, s71, 5
    v_mfma_f32_16x16x32_bf16 v[136:139], v[36:39], a[120:123], v[136:139]
    s_and_b32 s81, s81, 7
    s_lshl_b32 s81, s81, 7
    s_add_u32 s81, s81, s82
    v_mfma_f32_16x16x32_bf16 v[140:143], v[36:39], a[124:127], v[140:143]
    ds_read_b64_tr_b16 v[60:61], v7 offset:57344
    v_mfma_f32_16x16x32_bf16 v[140:143], v[32:35], a[108:111], v[140:143]
    s_waitcnt lgkmcnt(7)
    buffer_load_dwordx4 v12, s[12:15], s81 offen lds
    s_add_u32 m0, s79, 33792
    v_mfma_f32_16x16x32_bf16 v[144:147], v[40:43], a[96:99], v[144:147]
    ds_read_b64_tr_b16 v[62:63], v7 offset:59392
    v_mfma_f32_16x16x32_bf16 v[144:147], v[44:47], a[112:115], v[144:147]
    v_mfma_f32_16x16x32_bf16 v[148:151], v[44:47], a[116:119], v[148:151]
    ds_read_b64_tr_b16 v[32:33], v4 offset:53248
    v_mfma_f32_16x16x32_bf16 v[148:151], v[40:43], a[100:103], v[148:151]
    buffer_load_dwordx4 v13, s[12:15], s81 offen lds
    s_add_u32 m0, s79, 34816
    v_mfma_f32_16x16x32_bf16 v[152:155], v[40:43], a[104:107], v[152:155]
    ds_read_b64_tr_b16 v[34:35], v4 offset:55296
    s_add_u32 s81, s81, 16384
    v_mfma_f32_16x16x32_bf16 v[152:155], v[44:47], a[120:123], v[152:155]
    v_mfma_f32_16x16x32_bf16 v[156:159], v[44:47], a[124:127], v[156:159]
    ds_read_b64_tr_b16 v[36:37], v4 offset:61440
    v_mfma_f32_16x16x32_bf16 v[156:159], v[40:43], a[108:111], v[156:159]
    s_waitcnt lgkmcnt(7)
    buffer_load_dwordx4 v12, s[12:15], s81 offen lds
    s_add_u32 m0, s79, 35840
    v_mfma_f32_16x16x32_bf16 v[160:163], v[48:51], a[96:99], v[160:163]
    ds_read_b64_tr_b16 v[38:39], v4 offset:63488
    v_mfma_f32_16x16x32_bf16 v[160:163], v[52:55], a[112:115], v[160:163]
    v_mfma_f32_16x16x32_bf16 v[164:167], v[52:55], a[116:119], v[164:167]
    ds_read_b64_tr_b16 v[40:41], v5 offset:53248
    v_mfma_f32_16x16x32_bf16 v[164:167], v[48:51], a[100:103], v[164:167]
    buffer_load_dwordx4 v13, s[12:15], s81 offen lds
    s_add_u32 m0, s79, 36864
    v_mfma_f32_16x16x32_bf16 v[168:171], v[48:51], a[104:107], v[168:171]
    ds_read_b64_tr_b16 v[42:43], v5 offset:55296
    s_add_u32 s81, s81, 16384
    v_mfma_f32_16x16x32_bf16 v[168:171], v[52:55], a[120:123], v[168:171]
    v_mfma_f32_16x16x32_bf16 v[172:175], v[52:55], a[124:127], v[172:175]
    ds_read_b64_tr_b16 v[44:45], v5 offset:61440
    v_mfma_f32_16x16x32_bf16 v[172:175], v[48:51], a[108:111], v[172:175]
    s_waitcnt lgkmcnt(7)
    buffer_load_dwordx4 v12, s[12:15], s81 offen lds
    s_add_u32 m0, s79, 37888
    v_mfma_f32_16x16x32_bf16 v[176:179], v[56:59], a[96:99], v[176:179]
    ds_read_b64_tr_b16 v[46:47], v5 offset:63488
    v_mfma_f32_16x16x32_bf16 v[176:179], v[60:63], a[112:115], v[176:179]
    v_mfma_f32_16x16x32_bf16 v[180:183], v[60:63], a[116:119], v[180:183]
    ds_read_b64_tr_b16 v[48:49], v6 offset:53248
    v_mfma_f32_16x16x32_bf16 v[180:183], v[56:59], a[100:103], v[180:183]
    buffer_load_dwordx4 v13, s[12:15], s81 offen lds
    s_add_u32 m0, s79, 38912
    v_mfma_f32_16x16x32_bf16 v[184:187], v[56:59], a[104:107], v[184:187]
    ds_read_b64_tr_b16 v[50:51], v6 offset:55296
    s_add_u32 s81, s81, 16384
    v_mfma_f32_16x16x32_bf16 v[184:187], v[60:63], a[120:123], v[184:187]
    v_mfma_f32_16x16x32_bf16 v[188:191], v[60:63], a[124:127], v[188:191]
    ds_read_b64_tr_b16 v[52:53], v6 offset:61440
    v_mfma_f32_16x16x32_bf16 v[188:191], v[56:59], a[108:111], v[188:191]
    s_waitcnt lgkmcnt(7)
    buffer_load_dwordx4 v12, s[12:15], s81 offen lds
    s_add_u32 m0, s79, 39936
    v_mfma_f32_16x16x32_bf16 v[192:195], v[32:35], a[96:99], v[192:195]
    ds_read_b64_tr_b16 v[54:55], v6 offset:63488
    v_mfma_f32_16x16x32_bf16 v[192:195], v[36:39], a[112:115], v[192:195]
    v_mfma_f32_16x16x32_bf16 v[196:199], v[36:39], a[116:119], v[196:199]
    ds_read_b64_tr_b16 v[56:57], v7 offset:53248
    v_mfma_f32_16x16x32_bf16 v[196:199], v[32:35], a[100:103], v[196:199]
    buffer_load_dwordx4 v13, s[12:15], s81 offen lds
    s_add_u32 m0, s78, 32768
    v_mfma_f32_16x16x32_bf16 v[200:203], v[32:35], a[104:107], v[200:203]
    ds_read_b64_tr_b16 v[58:59], v7 offset:55296
    s_add_u32 s80, s80, 524288
    v_mfma_f32_16x16x32_bf16 v[200:203], v[36:39], a[120:123], v[200:203]
    s_and_b32 s80, s80, 4194303
    v_mfma_f32_16x16x32_bf16 v[204:207], v[36:39], a[124:127], v[204:207]
    ds_read_b64_tr_b16 v[60:61], v7 offset:61440
    v_mfma_f32_16x16x32_bf16 v[204:207], v[32:35], a[108:111], v[204:207]
    s_waitcnt lgkmcnt(7)
    v_mfma_f32_16x16x32_bf16 v[208:211], v[40:43], a[96:99], v[208:211]
    ds_read_b64_tr_b16 v[62:63], v7 offset:63488
    v_mfma_f32_16x16x32_bf16 v[208:211], v[44:47], a[112:115], v[208:211]
    v_mfma_f32_16x16x32_bf16 v[212:215], v[44:47], a[116:119], v[212:215]
    s_waitcnt vmcnt(13)
    s_barrier
    v_mfma_f32_16x16x32_bf16 v[212:215], v[40:43], a[100:103], v[212:215]
    ds_read_b64_tr_b16 v[32:33], v4 offset:0
    v_mfma_f32_16x16x32_bf16 v[216:219], v[40:43], a[104:107], v[216:219]
    ds_read_b128 a[128:131], v14 offset:0
    v_mfma_f32_16x16x32_bf16 v[216:219], v[44:47], a[120:123], v[216:219]
    ds_read_b128 a[144:147], v15 offset:0
    v_mfma_f32_16x16x32_bf16 v[220:223], v[44:47], a[124:127], v[220:223]
    ds_read_b64_tr_b16 v[34:35], v4 offset:2048
    v_mfma_f32_16x16x32_bf16 v[220:223], v[40:43], a[108:111], v[220:223]
    s_waitcnt lgkmcnt(8)
    ds_read_b128 a[132:135], v14 offset:2048
    v_mfma_f32_16x16x32_bf16 v[224:227], v[48:51], a[96:99], v[224:227]
    ds_read_b128 a[148:151], v15 offset:2048
    v_mfma_f32_16x16x32_bf16 v[224:227], v[52:55], a[112:115], v[224:227]
    ds_read_b64_tr_b16 v[36:37], v4 offset:8192
    v_mfma_f32_16x16x32_bf16 v[228:231], v[52:55], a[116:119], v[228:231]
    ds_read_b128 a[136:139], v14 offset:4096
    v_mfma_f32_16x16x32_bf16 v[228:231], v[48:51], a[100:103], v[228:231]
    ds_read_b128 a[152:155], v15 offset:4096
    v_mfma_f32_16x16x32_bf16 v[232:235], v[48:51], a[104:107], v[232:235]
    ds_read_b64_tr_b16 v[38:39], v4 offset:10240
    v_mfma_f32_16x16x32_bf16 v[232:235], v[52:55], a[120:123], v[232:235]
    ds_read_b128 a[140:143], v14 offset:6144
    v_mfma_f32_16x16x32_bf16 v[236:239], v[52:55], a[124:127], v[236:239]
    ds_read_b128 a[156:159], v15 offset:6144
    v_mfma_f32_16x16x32_bf16 v[236:239], v[48:51], a[108:111], v[236:239]
    s_waitcnt lgkmcnt(12)
    ds_read_b64_tr_b16 v[40:41], v5 offset:0
    v_mfma_f32_16x16x32_bf16 v[240:243], v[56:59], a[96:99], v[240:243]
    ds_read_b64_tr_b16 v[42:43], v5 offset:2048
    v_mfma_f32_16x16x32_bf16 v[240:243], v[60:63], a[112:115], v[240:243]
    ds_read_b64_tr_b16 v[44:45], v5 offset:8192
    v_mfma_f32_16x16x32_bf16 v[244:247], v[60:63], a[116:119], v[244:247]
    ds_read_b64_tr_b16 v[46:47], v5 offset:10240
    v_mfma_f32_16x16x32_bf16 v[244:247], v[56:59], a[100:103], v[244:247]
    ds_read_b64_tr_b16 v[48:49], v6 offset:0
    v_mfma_f32_16x16x32_bf16 v[248:251], v[56:59], a[104:107], v[248:251]
    ds_read_b64_tr_b16 v[50:51], v6 offset:2048
    v_mfma_f32_16x16x32_bf16 v[248:251], v[60:63], a[120:123], v[248:251]
    buffer_load_dwordx4 v8, s[20:23], s80 offen lds
    s_add_u32 m0, s78, 36864
    v_mfma_f32_16x16x32_bf16 v[252:255], v[60:63], a[124:127], v[252:255]
    ds_read_b64_tr_b16 v[52:53], v6 offset:8192
    v_mfma_f32_16x16x32_bf16 v[252:255], v[56:59], a[108:111], v[252:255]
    s_waitcnt lgkmcnt(7)
    buffer_load_dwordx4 v9, s[20:23], s80 offen lds
    s_add_u32 m0, s78, 40960
    v_mfma_f32_16x16x32_bf16 v[128:131], v[32:35], a[128:131], v[128:131]
    ds_read_b64_tr_b16 v[54:55], v6 offset:10240
    v_mfma_f32_16x16x32_bf16 v[128:131], v[36:39], a[144:147], v[128:131]
    buffer_load_dwordx4 v10, s[20:23], s80 offen lds
    s_add_u32 m0, s78, 45056
    v_mfma_f32_16x16x32_bf16 v[132:135], v[36:39], a[148:151], v[132:135]
    ds_read_b64_tr_b16 v[56:57], v7 offset:0
    v_mfma_f32_16x16x32_bf16 v[132:135], v[32:35], a[132:135], v[132:135]
    buffer_load_dwordx4 v11, s[20:23], s80 offen lds
    s_add_u32 m0, s79, 0
    v_mfma_f32_16x16x32_bf16 v[136:139], v[32:35], a[136:139], v[136:139]
    ds_read_b64_tr_b16 v[58:59], v7 offset:2048
    s_add_u32 s81, s71, 6
    v_mfma_f32_16x16x32_bf16 v[136:139], v[36:39], a[152:155], v[136:139]
    s_and_b32 s81, s81, 7
    s_lshl_b32 s81, s81, 7
    s_add_u32 s81, s81, s82
    v_mfma_f32_16x16x32_bf16 v[140:143], v[36:39], a[156:159], v[140:143]
    ds_read_b64_tr_b16 v[60:61], v7 offset:8192
    v_mfma_f32_16x16x32_bf16 v[140:143], v[32:35], a[140:143], v[140:143]
    s_waitcnt lgkmcnt(7)
    buffer_load_dwordx4 v12, s[12:15], s81 offen lds
    s_add_u32 m0, s79, 1024
    v_mfma_f32_16x16x32_bf16 v[144:147], v[40:43], a[128:131], v[144:147]
    ds_read_b64_tr_b16 v[62:63], v7 offset:10240
    v_mfma_f32_16x16x32_bf16 v[144:147], v[44:47], a[144:147], v[144:147]
    v_mfma_f32_16x16x32_bf16 v[148:151], v[44:47], a[148:151], v[148:151]
    ds_read_b64_tr_b16 v[32:33], v4 offset:4096
    v_mfma_f32_16x16x32_bf16 v[148:151], v[40:43], a[132:135], v[148:151]
    buffer_load_dwordx4 v13, s[12:15], s81 offen lds
    s_add_u32 m0, s79, 2048
    v_mfma_f32_16x16x32_bf16 v[152:155], v[40:43], a[136:139], v[152:155]
    ds_read_b64_tr_b16 v[34:35], v4 offset:6144
    s_add_u32 s81, s81, 16384
    v_mfma_f32_16x16x32_bf16 v[152:155], v[44:47], a[152:155], v[152:155]
    v_mfma_f32_16x16x32_bf16 v[156:159], v[44:47], a[156:159], v[156:159]
    ds_read_b64_tr_b16 v[36:37], v4 offset:12288
    v_mfma_f32_16x16x32_bf16 v[156:159], v[40:43], a[140:143], v[156:159]
    s_waitcnt lgkmcnt(7)
    buffer_load_dwordx4 v12, s[12:15], s81 offen lds
    s_add_u32 m0, s79, 3072
    v_mfma_f32_16x16x32_bf16 v[160:163], v[48:51], a[128:131], v[160:163]
    ds_read_b64_tr_b16 v[38:39], v4 offset:14336
    v_mfma_f32_16x16x32_bf16 v[160:163], v[52:55], a[144:147], v[160:163]
    v_mfma_f32_16x16x32_bf16 v[164:167], v[52:55], a[148:151], v[164:167]
    ds_read_b64_tr_b16 v[40:41], v5 offset:4096
    v_mfma_f32_16x16x32_bf16 v[164:167], v[48:51], a[132:135], v[164:167]
    buffer_load_dwordx4 v13, s[12:15], s81 offen lds
    s_add_u32 m0, s79, 4096
    v_mfma_f32_16x16x32_bf16 v[168:171], v[48:51], a[136:139], v[168:171]
    ds_read_b64_tr_b16 v[42:43], v5 offset:6144
    s_add_u32 s81, s81, 16384
    v_mfma_f32_16x16x32_bf16 v[168:171], v[52:55], a[152:155], v[168:171]
    v_mfma_f32_16x16x32_bf16 v[172:175], v[52:55], a[156:159], v[172:175]
    ds_read_b64_tr_b16 v[44:45], v5 offset:12288
    v_mfma_f32_16x16x32_bf16 v[172:175], v[48:51], a[140:143], v[172:175]
    s_waitcnt lgkmcnt(7)
    buffer_load_dwordx4 v12, s[12:15], s81 offen lds
    s_add_u32 m0, s79, 5120
    v_mfma_f32_16x16x32_bf16 v[176:179], v[56:59], a[128:131], v[176:179]
    ds_read_b64_tr_b16 v[46:47], v5 offset:14336
    v_mfma_f32_16x16x32_bf16 v[176:179], v[60:63], a[144:147], v[176:179]
    v_mfma_f32_16x16x32_bf16 v[180:183], v[60:63], a[148:151], v[180:183]
    ds_read_b64_tr_b16 v[48:49], v6 offset:4096
    v_mfma_f32_16x16x32_bf16 v[180:183], v[56:59], a[132:135], v[180:183]
    buffer_load_dwordx4 v13, s[12:15], s81 offen lds
    s_add_u32 m0, s79, 6144
    v_mfma_f32_16x16x32_bf16 v[184:187], v[56:59], a[136:139], v[184:187]
    ds_read_b64_tr_b16 v[50:51], v6 offset:6144
    s_add_u32 s81, s81, 16384
    v_mfma_f32_16x16x32_bf16 v[184:187], v[60:63], a[152:155], v[184:187]
    v_mfma_f32_16x16x32_bf16 v[188:191], v[60:63], a[156:159], v[188:191]
    ds_read_b64_tr_b16 v[52:53], v6 offset:12288
    v_mfma_f32_16x16x32_bf16 v[188:191], v[56:59], a[140:143], v[188:191]
    s_waitcnt lgkmcnt(7)
    buffer_load_dwordx4 v12, s[12:15], s81 offen lds
    s_add_u32 m0, s79, 7168
    v_mfma_f32_16x16x32_bf16 v[192:195], v[32:35], a[128:131], v[192:195]
    ds_read_b64_tr_b16 v[54:55], v6 offset:14336
    v_mfma_f32_16x16x32_bf16 v[192:195], v[36:39], a[144:147], v[192:195]
    v_mfma_f32_16x16x32_bf16 v[196:199], v[36:39], a[148:151], v[196:199]
    ds_read_b64_tr_b16 v[56:57], v7 offset:4096
    v_mfma_f32_16x16x32_bf16 v[196:199], v[32:35], a[132:135], v[196:199]
    buffer_load_dwordx4 v13, s[12:15], s81 offen lds
    s_add_u32 m0, s78, 49152
    v_mfma_f32_16x16x32_bf16 v[200:203], v[32:35], a[136:139], v[200:203]
    ds_read_b64_tr_b16 v[58:59], v7 offset:6144
    s_add_u32 s80, s80, 524288
    v_mfma_f32_16x16x32_bf16 v[200:203], v[36:39], a[152:155], v[200:203]
    s_and_b32 s80, s80, 4194303
    v_mfma_f32_16x16x32_bf16 v[204:207], v[36:39], a[156:159], v[204:207]
    ds_read_b64_tr_b16 v[60:61], v7 offset:12288
    v_mfma_f32_16x16x32_bf16 v[204:207], v[32:35], a[140:143], v[204:207]
    s_waitcnt lgkmcnt(7)
    v_mfma_f32_16x16x32_bf16 v[208:211], v[40:43], a[128:131], v[208:211]
    ds_read_b64_tr_b16 v[62:63], v7 offset:14336
    v_mfma_f32_16x16x32_bf16 v[208:211], v[44:47], a[144:147], v[208:211]
    v_mfma_f32_16x16x32_bf16 v[212:215], v[44:47], a[148:151], v[212:215]
    s_waitcnt vmcnt(12)
    s_barrier
    v_mfma_f32_16x16x32_bf16 v[212:215], v[40:43], a[132:135], v[212:215]
    ds_read_b64_tr_b16 v[32:33], v4 offset:16384
    v_mfma_f32_16x16x32_bf16 v[216:219], v[40:43], a[136:139], v[216:219]
    ds_read_b128 a[160:163], v14 offset:32768
    v_mfma_f32_16x16x32_bf16 v[216:219], v[44:47], a[152:155], v[216:219]
    ds_read_b128 a[176:179], v15 offset:32768
    v_mfma_f32_16x16x32_bf16 v[220:223], v[44:47], a[156:159], v[220:223]
    ds_read_b64_tr_b16 v[34:35], v4 offset:18432
    v_mfma_f32_16x16x32_bf16 v[220:223], v[40:43], a[140:143], v[220:223]
    s_waitcnt lgkmcnt(8)
    ds_read_b128 a[164:167], v14 offset:34816
    v_mfma_f32_16x16x32_bf16 v[224:227], v[48:51], a[128:131], v[224:227]
    ds_read_b128 a[180:183], v15 offset:34816
    v_mfma_f32_16x16x32_bf16 v[224:227], v[52:55], a[144:147], v[224:227]
    ds_read_b64_tr_b16 v[36:37], v4 offset:24576
    v_mfma_f32_16x16x32_bf16 v[228:231], v[52:55], a[148:151], v[228:231]
    ds_read_b128 a[168:171], v14 offset:36864
    v_mfma_f32_16x16x32_bf16 v[228:231], v[48:51], a[132:135], v[228:231]
    ds_read_b128 a[184:187], v15 offset:36864
    v_mfma_f32_16x16x32_bf16 v[232:235], v[48:51], a[136:139], v[232:235]
    ds_read_b64_tr_b16 v[38:39], v4 offset:26624
    v_mfma_f32_16x16x32_bf16 v[232:235], v[52:55], a[152:155], v[232:235]
    ds_read_b128 a[172:175], v14 offset:38912
    v_mfma_f32_16x16x32_bf16 v[236:239], v[52:55], a[156:159], v[236:239]
    ds_read_b128 a[188:191], v15 offset:38912
    v_mfma_f32_16x16x32_bf16 v[236:239], v[48:51], a[140:143], v[236:239]
    s_waitcnt lgkmcnt(12)
    ds_read_b64_tr_b16 v[40:41], v5 offset:16384
    v_mfma_f32_16x16x32_bf16 v[240:243], v[56:59], a[128:131], v[240:243]
    ds_read_b64_tr_b16 v[42:43], v5 offset:18432
    v_mfma_f32_16x16x32_bf16 v[240:243], v[60:63], a[144:147], v[240:243]
    ds_read_b64_tr_b16 v[44:45], v5 offset:24576
    v_mfma_f32_16x16x32_bf16 v[244:247], v[60:63], a[148:151], v[244:247]
    ds_read_b64_tr_b16 v[46:47], v5 offset:26624
    v_mfma_f32_16x16x32_bf16 v[244:247], v[56:59], a[132:135], v[244:247]
    ds_read_b64_tr_b16 v[48:49], v6 offset:16384
    v_mfma_f32_16x16x32_bf16 v[248:251], v[56:59], a[136:139], v[248:251]
    ds_read_b64_tr_b16 v[50:51], v6 offset:18432
    v_mfma_f32_16x16x32_bf16 v[248:251], v[60:63], a[152:155], v[248:251]
    buffer_load_dwordx4 v8, s[20:23], s80 offen lds
    s_add_u32 m0, s78, 53248
    v_mfma_f32_16x16x32_bf16 v[252:255], v[60:63], a[156:159], v[252:255]
    ds_read_b64_tr_b16 v[52:53], v6 offset:24576
    v_mfma_f32_16x16x32_bf16 v[252:255], v[56:59], a[140:143], v[252:255]
    s_waitcnt lgkmcnt(7)
    buffer_load_dwordx4 v9, s[20:23], s80 offen lds
    s_add_u32 m0, s78, 57344
    v_mfma_f32_16x16x32_bf16 v[128:131], v[32:35], a[160:163], v[128:131]
    ds_read_b64_tr_b16 v[54:55], v6 offset:26624
    v_mfma_f32_16x16x32_bf16 v[128:131], v[36:39], a[176:179], v[128:131]
    buffer_load_dwordx4 v10, s[20:23], s80 offen lds
    s_add_u32 m0, s78, 61440
    v_mfma_f32_16x16x32_bf16 v[132:135], v[36:39], a[180:183], v[132:135]
    ds_read_b64_tr_b16 v[56:57], v7 offset:16384
    v_mfma_f32_16x16x32_bf16 v[132:135], v[32:35], a[164:167], v[132:135]
    buffer_load_dwordx4 v11, s[20:23], s80 offen lds
    s_add_u32 m0, s79, 32768
    v_mfma_f32_16x16x32_bf16 v[136:139], v[32:35], a[168:171], v[136:139]
    ds_read_b64_tr_b16 v[58:59], v7 offset:18432
    s_add_u32 s81, s71, 7
    v_mfma_f32_16x16x32_bf16 v[136:139], v[36:39], a[184:187], v[136:139]
    s_and_b32 s81, s81, 7
    s_lshl_b32 s81, s81, 7
    s_add_u32 s81, s81, s82
    v_mfma_f32_16x16x32_bf16 v[140:143], v[36:39], a[188:191], v[140:143]
    ds_read_b64_tr_b16 v[60:61], v7 offset:24576
    v_mfma_f32_16x16x32_bf16 v[140:143], v[32:35], a[172:175], v[140:143]
    s_waitcnt lgkmcnt(7)
    buffer_load_dwordx4 v12, s[12:15], s81 offen lds
    s_add_u32 m0, s79, 33792
    v_mfma_f32_16x16x32_bf16 v[144:147], v[40:43], a[160:163], v[144:147]
    ds_read_b64_tr_b16 v[62:63], v7 offset:26624
    v_mfma_f32_16x16x32_bf16 v[144:147], v[44:47], a[176:179], v[144:147]
    v_mfma_f32_16x16x32_bf16 v[148:151], v[44:47], a[180:183], v[148:151]
    ds_read_b64_tr_b16 v[32:33], v4 offset:20480
    v_mfma_f32_16x16x32_bf16 v[148:151], v[40:43], a[164:167], v[148:151]
    buffer_load_dwordx4 v13, s[12:15], s81 offen lds
    s_add_u32 m0, s79, 34816
    v_mfma_f32_16x16x32_bf16 v[152:155], v[40:43], a[168:171], v[152:155]
    ds_read_b64_tr_b16 v[34:35], v4 offset:22528
    s_add_u32 s81, s81, 16384
    v_mfma_f32_16x16x32_bf16 v[152:155], v[44:47], a[184:187], v[152:155]
    v_mfma_f32_16x16x32_bf16 v[156:159], v[44:47], a[188:191], v[156:159]
    ds_read_b64_tr_b16 v[36:37], v4 offset:28672
    v_mfma_f32_16x16x32_bf16 v[156:159], v[40:43], a[172:175], v[156:159]
    s_waitcnt lgkmcnt(7)
    buffer_load_dwordx4 v12, s[12:15], s81 offen lds
    s_add_u32 m0, s79, 35840
    v_mfma_f32_16x16x32_bf16 v[160:163], v[48:51], a[160:163], v[160:163]
    ds_read_b64_tr_b16 v[38:39], v4 offset:30720
    v_mfma_f32_16x16x32_bf16 v[160:163], v[52:55], a[176:179], v[160:163]
    v_mfma_f32_16x16x32_bf16 v[164:167], v[52:55], a[180:183], v[164:167]
    ds_read_b64_tr_b16 v[40:41], v5 offset:20480
    v_mfma_f32_16x16x32_bf16 v[164:167], v[48:51], a[164:167], v[164:167]
    buffer_load_dwordx4 v13, s[12:15], s81 offen lds
    s_add_u32 m0, s79, 36864
    v_mfma_f32_16x16x32_bf16 v[168:171], v[48:51], a[168:171], v[168:171]
    ds_read_b64_tr_b16 v[42:43], v5 offset:22528
    s_add_u32 s81, s81, 16384
    v_mfma_f32_16x16x32_bf16 v[168:171], v[52:55], a[184:187], v[168:171]
    v_mfma_f32_16x16x32_bf16 v[172:175], v[52:55], a[188:191], v[172:175]
    ds_read_b64_tr_b16 v[44:45], v5 offset:28672
    v_mfma_f32_16x16x32_bf16 v[172:175], v[48:51], a[172:175], v[172:175]
    s_waitcnt lgkmcnt(7)
    buffer_load_dwordx4 v12, s[12:15], s81 offen lds
    s_add_u32 m0, s79, 37888
    v_mfma_f32_16x16x32_bf16 v[176:179], v[56:59], a[160:163], v[176:179]
    ds_read_b64_tr_b16 v[46:47], v5 offset:30720
    v_mfma_f32_16x16x32_bf16 v[176:179], v[60:63], a[176:179], v[176:179]
    v_mfma_f32_16x16x32_bf16 v[180:183], v[60:63], a[180:183], v[180:183]
    ds_read_b64_tr_b16 v[48:49], v6 offset:20480
    v_mfma_f32_16x16x32_bf16 v[180:183], v[56:59], a[164:167], v[180:183]
    buffer_load_dwordx4 v13, s[12:15], s81 offen lds
    s_add_u32 m0, s79, 38912
    v_mfma_f32_16x16x32_bf16 v[184:187], v[56:59], a[168:171], v[184:187]
    ds_read_b64_tr_b16 v[50:51], v6 offset:22528
    s_add_u32 s81, s81, 16384
    v_mfma_f32_16x16x32_bf16 v[184:187], v[60:63], a[184:187], v[184:187]
    v_mfma_f32_16x16x32_bf16 v[188:191], v[60:63], a[188:191], v[188:191]
    ds_read_b64_tr_b16 v[52:53], v6 offset:28672
    v_mfma_f32_16x16x32_bf16 v[188:191], v[56:59], a[172:175], v[188:191]
    s_waitcnt lgkmcnt(7)
    buffer_load_dwordx4 v12, s[12:15], s81 offen lds
    s_add_u32 m0, s79, 39936
    v_mfma_f32_16x16x32_bf16 v[192:195], v[32:35], a[160:163], v[192:195]
    ds_read_b64_tr_b16 v[54:55], v6 offset:30720
    v_mfma_f32_16x16x32_bf16 v[192:195], v[36:39], a[176:179], v[192:195]
    v_mfma_f32_16x16x32_bf16 v[196:199], v[36:39], a[180:183], v[196:199]
    ds_read_b64_tr_b16 v[56:57], v7 offset:20480
    v_mfma_f32_16x16x32_bf16 v[196:199], v[32:35], a[164:167], v[196:199]
    buffer_load_dwordx4 v13, s[12:15], s81 offen lds
    s_add_u32 m0, s78, 0
    v_mfma_f32_16x16x32_bf16 v[200:203], v[32:35], a[168:171], v[200:203]
    ds_read_b64_tr_b16 v[58:59], v7 offset:22528
    s_lshl_b32 s80, s71, 19
    v_mfma_f32_16x16x32_bf16 v[200:203], v[36:39], a[184:187], v[200:203]
    s_lshl_b32 s77, s69, 8
    s_add_u32 s80, s80, s77
    v_mfma_f32_16x16x32_bf16 v[204:207], v[36:39], a[188:191], v[204:207]
    ds_read_b64_tr_b16 v[60:61], v7 offset:28672
    v_mfma_f32_16x16x32_bf16 v[204:207], v[32:35], a[172:175], v[204:207]
    s_waitcnt lgkmcnt(7)
    v_mfma_f32_16x16x32_bf16 v[208:211], v[40:43], a[160:163], v[208:211]
    ds_read_b64_tr_b16 v[62:63], v7 offset:30720
    v_mfma_f32_16x16x32_bf16 v[208:211], v[44:47], a[176:179], v[208:211]
    v_mfma_f32_16x16x32_bf16 v[212:215], v[44:47], a[180:183], v[212:215]
    s_waitcnt vmcnt(12)
    s_barrier
    v_mfma_f32_16x16x32_bf16 v[212:215], v[40:43], a[164:167], v[212:215]
    ds_read_b64_tr_b16 v[32:33], v4 offset:32768
    v_mfma_f32_16x16x32_bf16 v[216:219], v[40:43], a[168:171], v[216:219]
    ds_read_b128 a[192:195], v14 offset:0
    v_mfma_f32_16x16x32_bf16 v[216:219], v[44:47], a[184:187], v[216:219]
    ds_read_b128 a[208:211], v15 offset:0
    v_mfma_f32_16x16x32_bf16 v[220:223], v[44:47], a[188:191], v[220:223]
    ds_read_b64_tr_b16 v[34:35], v4 offset:34816
    v_mfma_f32_16x16x32_bf16 v[220:223], v[40:43], a[172:175], v[220:223]
    s_waitcnt lgkmcnt(8)
    ds_read_b128 a[196:199], v14 offset:2048
    v_mfma_f32_16x16x32_bf16 v[224:227], v[48:51], a[160:163], v[224:227]
    ds_read_b128 a[212:215], v15 offset:2048
    v_mfma_f32_16x16x32_bf16 v[224:227], v[52:55], a[176:179], v[224:227]
    ds_read_b64_tr_b16 v[36:37], v4 offset:40960
    v_mfma_f32_16x16x32_bf16 v[228:231], v[52:55], a[180:183], v[228:231]
    ds_read_b128 a[200:203], v14 offset:4096
    v_mfma_f32_16x16x32_bf16 v[228:231], v[48:51], a[164:167], v[228:231]
    ds_read_b128 a[216:219], v15 offset:4096
    v_mfma_f32_16x16x32_bf16 v[232:235], v[48:51], a[168:171], v[232:235]
    ds_read_b64_tr_b16 v[38:39], v4 offset:43008
    v_mfma_f32_16x16x32_bf16 v[232:235], v[52:55], a[184:187], v[232:235]
    ds_read_b128 a[204:207], v14 offset:6144
    v_mfma_f32_16x16x32_bf16 v[236:239], v[52:55], a[188:191], v[236:239]
    ds_read_b128 a[220:223], v15 offset:6144
    v_mfma_f32_16x16x32_bf16 v[236:239], v[48:51], a[172:175], v[236:239]
    s_waitcnt lgkmcnt(12)
    ds_read_b64_tr_b16 v[40:41], v5 offset:32768
    v_mfma_f32_16x16x32_bf16 v[240:243], v[56:59], a[160:163], v[240:243]
    ds_read_b64_tr_b16 v[42:43], v5 offset:34816
    v_mfma_f32_16x16x32_bf16 v[240:243], v[60:63], a[176:179], v[240:243]
    ds_read_b64_tr_b16 v[44:45], v5 offset:40960
    v_mfma_f32_16x16x32_bf16 v[244:247], v[60:63], a[180:183], v[244:247]
    ds_read_b64_tr_b16 v[46:47], v5 offset:43008
    v_mfma_f32_16x16x32_bf16 v[244:247], v[56:59], a[164:167], v[244:247]
    ds_read_b64_tr_b16 v[48:49], v6 offset:32768
    v_mfma_f32_16x16x32_bf16 v[248:251], v[56:59], a[168:171], v[248:251]
    ds_read_b64_tr_b16 v[50:51], v6 offset:34816
    v_mfma_f32_16x16x32_bf16 v[248:251], v[60:63], a[184:187], v[248:251]
    buffer_load_dwordx4 v8, s[24:27], s80 offen lds
    s_add_u32 m0, s78, 4096
    v_mfma_f32_16x16x32_bf16 v[252:255], v[60:63], a[188:191], v[252:255]
    ds_read_b64_tr_b16 v[52:53], v6 offset:40960
    v_mfma_f32_16x16x32_bf16 v[252:255], v[56:59], a[172:175], v[252:255]
    s_waitcnt lgkmcnt(7)
    buffer_load_dwordx4 v9, s[24:27], s80 offen lds
    s_add_u32 m0, s78, 8192
    v_mfma_f32_16x16x32_bf16 v[128:131], v[32:35], a[192:195], v[128:131]
    ds_read_b64_tr_b16 v[54:55], v6 offset:43008
    v_mfma_f32_16x16x32_bf16 v[128:131], v[36:39], a[208:211], v[128:131]
    buffer_load_dwordx4 v10, s[24:27], s80 offen lds
    s_add_u32 m0, s78, 12288
    v_mfma_f32_16x16x32_bf16 v[132:135], v[36:39], a[212:215], v[132:135]
    ds_read_b64_tr_b16 v[56:57], v7 offset:32768
    v_mfma_f32_16x16x32_bf16 v[132:135], v[32:35], a[196:199], v[132:135]
    buffer_load_dwordx4 v11, s[24:27], s80 offen lds
    s_add_u32 m0, s78, 16384
    v_mfma_f32_16x16x32_bf16 v[136:139], v[32:35], a[200:203], v[136:139]
    ds_read_b64_tr_b16 v[58:59], v7 offset:34816
    v_mfma_f32_16x16x32_bf16 v[136:139], v[36:39], a[216:219], v[136:139]
    v_mfma_f32_16x16x32_bf16 v[140:143], v[36:39], a[220:223], v[140:143]
    ds_read_b64_tr_b16 v[60:61], v7 offset:40960
    v_mfma_f32_16x16x32_bf16 v[140:143], v[32:35], a[204:207], v[140:143]
    s_waitcnt lgkmcnt(7)
    v_mfma_f32_16x16x32_bf16 v[144:147], v[40:43], a[192:195], v[144:147]
    ds_read_b64_tr_b16 v[62:63], v7 offset:43008
    v_mfma_f32_16x16x32_bf16 v[144:147], v[44:47], a[208:211], v[144:147]
    v_mfma_f32_16x16x32_bf16 v[148:151], v[44:47], a[212:215], v[148:151]
    ds_read_b64_tr_b16 v[32:33], v4 offset:36864
    s_min_u32 s34, s34, s58
    v_mfma_f32_16x16x32_bf16 v[148:151], v[40:43], a[196:199], v[148:151]
    s_mov_b32 s38, s34
    v_mfma_f32_16x16x32_bf16 v[152:155], v[40:43], a[200:203], v[152:155]
    ds_read_b64_tr_b16 v[34:35], v4 offset:38912
    v_mfma_f32_16x16x32_bf16 v[152:155], v[44:47], a[216:219], v[152:155]
    v_mfma_f32_16x16x32_bf16 v[156:159], v[44:47], a[220:223], v[156:159]
    ds_read_b64_tr_b16 v[36:37], v4 offset:45056
    v_mfma_f32_16x16x32_bf16 v[156:159], v[40:43], a[204:207], v[156:159]
    s_waitcnt lgkmcnt(7)
    v_mfma_f32_16x16x32_bf16 v[160:163], v[48:51], a[192:195], v[160:163]
    ds_read_b64_tr_b16 v[38:39], v4 offset:47104
    v_mfma_f32_16x16x32_bf16 v[160:163], v[52:55], a[208:211], v[160:163]
    v_mfma_f32_16x16x32_bf16 v[164:167], v[52:55], a[212:215], v[164:167]
    ds_read_b64_tr_b16 v[40:41], v5 offset:36864
    v_mfma_f32_16x16x32_bf16 v[164:167], v[48:51], a[196:199], v[164:167]
    v_mfma_f32_16x16x32_bf16 v[168:171], v[48:51], a[200:203], v[168:171]
    ds_read_b64_tr_b16 v[42:43], v5 offset:38912
    v_mfma_f32_16x16x32_bf16 v[168:171], v[52:55], a[216:219], v[168:171]
    v_mfma_f32_16x16x32_bf16 v[172:175], v[52:55], a[220:223], v[172:175]
    ds_read_b64_tr_b16 v[44:45], v5 offset:45056
    v_mfma_f32_16x16x32_bf16 v[172:175], v[48:51], a[204:207], v[172:175]
    s_waitcnt lgkmcnt(7)
    v_mfma_f32_16x16x32_bf16 v[176:179], v[56:59], a[192:195], v[176:179]
    ds_read_b64_tr_b16 v[46:47], v5 offset:47104
    v_mfma_f32_16x16x32_bf16 v[176:179], v[60:63], a[208:211], v[176:179]
    v_mfma_f32_16x16x32_bf16 v[180:183], v[60:63], a[212:215], v[180:183]
    ds_read_b64_tr_b16 v[48:49], v6 offset:36864
    v_mfma_f32_16x16x32_bf16 v[180:183], v[56:59], a[196:199], v[180:183]
    v_mfma_f32_16x16x32_bf16 v[184:187], v[56:59], a[200:203], v[184:187]
    ds_read_b64_tr_b16 v[50:51], v6 offset:38912
    v_mfma_f32_16x16x32_bf16 v[184:187], v[60:63], a[216:219], v[184:187]
    v_mfma_f32_16x16x32_bf16 v[188:191], v[60:63], a[220:223], v[188:191]
    ds_read_b64_tr_b16 v[52:53], v6 offset:45056
    v_mfma_f32_16x16x32_bf16 v[188:191], v[56:59], a[204:207], v[188:191]
    s_waitcnt lgkmcnt(7)
    v_mfma_f32_16x16x32_bf16 v[192:195], v[32:35], a[192:195], v[192:195]
    ds_read_b64_tr_b16 v[54:55], v6 offset:47104
    v_mfma_f32_16x16x32_bf16 v[192:195], v[36:39], a[208:211], v[192:195]
    v_mfma_f32_16x16x32_bf16 v[196:199], v[36:39], a[212:215], v[196:199]
    ds_read_b64_tr_b16 v[56:57], v7 offset:36864
    v_mfma_f32_16x16x32_bf16 v[196:199], v[32:35], a[196:199], v[196:199]
    v_mfma_f32_16x16x32_bf16 v[200:203], v[32:35], a[200:203], v[200:203]
    ds_read_b64_tr_b16 v[58:59], v7 offset:38912
    s_add_u32 s80, s80, 524288
    v_mfma_f32_16x16x32_bf16 v[200:203], v[36:39], a[216:219], v[200:203]
    s_and_b32 s80, s80, 4194303
    v_mfma_f32_16x16x32_bf16 v[204:207], v[36:39], a[220:223], v[204:207]
    ds_read_b64_tr_b16 v[60:61], v7 offset:45056
    v_mfma_f32_16x16x32_bf16 v[204:207], v[32:35], a[204:207], v[204:207]
    s_waitcnt lgkmcnt(7)
    v_mfma_f32_16x16x32_bf16 v[208:211], v[40:43], a[192:195], v[208:211]
    ds_read_b64_tr_b16 v[62:63], v7 offset:47104
    v_mfma_f32_16x16x32_bf16 v[208:211], v[44:47], a[208:211], v[208:211]
    v_mfma_f32_16x16x32_bf16 v[212:215], v[44:47], a[212:215], v[212:215]
    s_waitcnt vmcnt(4)
    s_barrier
    v_mfma_f32_16x16x32_bf16 v[212:215], v[40:43], a[196:199], v[212:215]
    ds_read_b64_tr_b16 v[32:33], v4 offset:49152
    v_mfma_f32_16x16x32_bf16 v[216:219], v[40:43], a[200:203], v[216:219]
    ds_read_b128 a[224:227], v14 offset:32768
    v_mfma_f32_16x16x32_bf16 v[216:219], v[44:47], a[216:219], v[216:219]
    ds_read_b128 a[240:243], v15 offset:32768
    v_mfma_f32_16x16x32_bf16 v[220:223], v[44:47], a[220:223], v[220:223]
    ds_read_b64_tr_b16 v[34:35], v4 offset:51200
    v_mfma_f32_16x16x32_bf16 v[220:223], v[40:43], a[204:207], v[220:223]
    s_waitcnt lgkmcnt(8)
    ds_read_b128 a[228:231], v14 offset:34816
    v_mfma_f32_16x16x32_bf16 v[224:227], v[48:51], a[192:195], v[224:227]
    ds_read_b128 a[244:247], v15 offset:34816
    v_mfma_f32_16x16x32_bf16 v[224:227], v[52:55], a[208:211], v[224:227]
    ds_read_b64_tr_b16 v[36:37], v4 offset:57344
    v_mfma_f32_16x16x32_bf16 v[228:231], v[52:55], a[212:215], v[228:231]
    ds_read_b128 a[232:235], v14 offset:36864
    v_mfma_f32_16x16x32_bf16 v[228:231], v[48:51], a[196:199], v[228:231]
    ds_read_b128 a[248:251], v15 offset:36864
    v_mfma_f32_16x16x32_bf16 v[232:235], v[48:51], a[200:203], v[232:235]
    ds_read_b64_tr_b16 v[38:39], v4 offset:59392
    v_mfma_f32_16x16x32_bf16 v[232:235], v[52:55], a[216:219], v[232:235]
    ds_read_b128 a[236:239], v14 offset:38912
    v_mfma_f32_16x16x32_bf16 v[236:239], v[52:55], a[220:223], v[236:239]
    ds_read_b128 a[252:255], v15 offset:38912
    v_mfma_f32_16x16x32_bf16 v[236:239], v[48:51], a[204:207], v[236:239]
    s_waitcnt lgkmcnt(12)
    ds_read_b64_tr_b16 v[40:41], v5 offset:49152
    v_mfma_f32_16x16x32_bf16 v[240:243], v[56:59], a[192:195], v[240:243]
    ds_read_b64_tr_b16 v[42:43], v5 offset:51200
    v_mfma_f32_16x16x32_bf16 v[240:243], v[60:63], a[208:211], v[240:243]
    ds_read_b64_tr_b16 v[44:45], v5 offset:57344
    v_mfma_f32_16x16x32_bf16 v[244:247], v[60:63], a[212:215], v[244:247]
    ds_read_b64_tr_b16 v[46:47], v5 offset:59392
    v_mfma_f32_16x16x32_bf16 v[244:247], v[56:59], a[196:199], v[244:247]
    ds_read_b64_tr_b16 v[48:49], v6 offset:49152
    v_mfma_f32_16x16x32_bf16 v[248:251], v[56:59], a[200:203], v[248:251]
    ds_read_b64_tr_b16 v[50:51], v6 offset:51200
    v_mfma_f32_16x16x32_bf16 v[248:251], v[60:63], a[216:219], v[248:251]
    buffer_load_dwordx4 v8, s[24:27], s80 offen lds
    s_add_u32 m0, s78, 20480
    v_mfma_f32_16x16x32_bf16 v[252:255], v[60:63], a[220:223], v[252:255]
    ds_read_b64_tr_b16 v[52:53], v6 offset:57344
    v_mfma_f32_16x16x32_bf16 v[252:255], v[56:59], a[204:207], v[252:255]
    s_waitcnt lgkmcnt(7)
    buffer_load_dwordx4 v9, s[24:27], s80 offen lds
    s_add_u32 m0, s78, 24576
    v_mfma_f32_16x16x32_bf16 v[128:131], v[32:35], a[224:227], v[128:131]
    ds_read_b64_tr_b16 v[54:55], v6 offset:59392
    v_mfma_f32_16x16x32_bf16 v[128:131], v[36:39], a[240:243], v[128:131]
    buffer_load_dwordx4 v10, s[24:27], s80 offen lds
    s_add_u32 m0, s78, 28672
    v_mfma_f32_16x16x32_bf16 v[132:135], v[36:39], a[244:247], v[132:135]
    ds_read_b64_tr_b16 v[56:57], v7 offset:49152
    v_mfma_f32_16x16x32_bf16 v[132:135], v[32:35], a[228:231], v[132:135]
    buffer_load_dwordx4 v11, s[24:27], s80 offen lds
    s_add_u32 m0, s78, 65536
    v_mfma_f32_16x16x32_bf16 v[136:139], v[32:35], a[232:235], v[136:139]
    ds_read_b64_tr_b16 v[58:59], v7 offset:51200
    s_add_u32 s73, s48, 0
    v_mfma_f32_16x16x32_bf16 v[136:139], v[36:39], a[248:251], v[136:139]
    s_and_b32 s73, s73, 3
    s_mul_i32 s73, s73, 458752
    s_lshl_b32 s77, s7, 7
    v_mfma_f32_16x16x32_bf16 v[140:143], v[36:39], a[252:255], v[140:143]
    ds_read_b64_tr_b16 v[60:61], v7 offset:57344
    s_add_u32 s73, s73, s77
    v_mfma_f32_16x16x32_bf16 v[140:143], v[32:35], a[236:239], v[140:143]
    s_waitcnt lgkmcnt(7)
    buffer_load_dwordx4 v31, s[32:35], s73 offen lds
    s_add_u32 m0, s78, 69632
    v_mfma_f32_16x16x32_bf16 v[144:147], v[40:43], a[224:227], v[144:147]
    ds_read_b64_tr_b16 v[62:63], v7 offset:59392
    v_mfma_f32_16x16x32_bf16 v[144:147], v[44:47], a[240:243], v[144:147]
    buffer_load_dwordx4 v31, s[36:39], s73 offen lds
    s_add_u32 m0, s78, 73728
    v_mfma_f32_16x16x32_bf16 v[148:151], v[44:47], a[244:247], v[148:151]
    ds_read_b64_tr_b16 v[32:33], v4 offset:53248
    s_add_u32 s73, s73, 114688
    v_mfma_f32_16x16x32_bf16 v[148:151], v[40:43], a[228:231], v[148:151]
    buffer_load_dwordx4 v31, s[32:35], s73 offen lds
    s_add_u32 m0, s78, 77824
    v_mfma_f32_16x16x32_bf16 v[152:155], v[40:43], a[232:235], v[152:155]
    ds_read_b64_tr_b16 v[34:35], v4 offset:55296
    v_cvt_pk_bf16_f32 v64, v128, v129
    v_mfma_f32_16x16x32_bf16 v[152:155], v[44:47], a[248:251], v[152:155]
    buffer_load_dwordx4 v31, s[36:39], s73 offen lds
    s_add_u32 m0, s78, 81920
    v_mfma_f32_16x16x32_bf16 v[156:159], v[44:47], a[252:255], v[156:159]
    ds_read_b64_tr_b16 v[36:37], v4 offset:61440
    s_add_u32 s73, s73, 114688
    v_mfma_f32_16x16x32_bf16 v[156:159], v[40:43], a[236:239], v[156:159]
    s_waitcnt lgkmcnt(7)
    v_cvt_pk_bf16_f32 v65, v130, v131
    v_cvt_pk_bf16_f32 v80, v132, v133
    v_mfma_f32_16x16x32_bf16 v[160:163], v[48:51], a[224:227], v[160:163]
    ds_read_b64_tr_b16 v[38:39], v4 offset:63488
    v_cvt_pk_bf16_f32 v81, v134, v135
    v_mfma_f32_16x16x32_bf16 v[160:163], v[52:55], a[240:243], v[160:163]
    buffer_load_dwordx4 v31, s[32:35], s73 offen lds
    s_add_u32 m0, s78, 86016
    v_mfma_f32_16x16x32_bf16 v[164:167], v[52:55], a[244:247], v[164:167]
    ds_read_b64_tr_b16 v[40:41], v5 offset:53248
    v_cvt_pk_bf16_f32 v96, v136, v137
    v_mfma_f32_16x16x32_bf16 v[164:167], v[48:51], a[228:231], v[164:167]
    buffer_load_dwordx4 v31, s[36:39], s73 offen lds
    s_add_u32 m0, s78, 90112
    v_mfma_f32_16x16x32_bf16 v[168:171], v[48:51], a[232:235], v[168:171]
    ds_read_b64_tr_b16 v[42:43], v5 offset:55296
    s_add_u32 s73, s73, 114688
    v_mfma_f32_16x16x32_bf16 v[168:171], v[52:55], a[248:251], v[168:171]
    v_cvt_pk_bf16_f32 v97, v138, v139
    v_cvt_pk_bf16_f32 v112, v140, v141
    v_mfma_f32_16x16x32_bf16 v[172:175], v[52:55], a[252:255], v[172:175]
    ds_read_b64_tr_b16 v[44:45], v5 offset:61440
    v_cvt_pk_bf16_f32 v113, v142, v143
    v_mfma_f32_16x16x32_bf16 v[172:175], v[48:51], a[236:239], v[172:175]
    s_waitcnt lgkmcnt(7)
    buffer_load_dwordx4 v31, s[32:35], s73 offen lds
    s_add_u32 m0, s78, 94208
    v_mfma_f32_16x16x32_bf16 v[176:179], v[56:59], a[224:227], v[176:179]
    ds_read_b64_tr_b16 v[46:47], v5 offset:63488
    v_cvt_pk_bf16_f32 v66, v144, v145
    v_mfma_f32_16x16x32_bf16 v[176:179], v[60:63], a[240:243], v[176:179]
    buffer_load_dwordx4 v31, s[36:39], s73 offen lds
    s_add_u32 m0, s78, 32768
    v_mfma_f32_16x16x32_bf16 v[180:183], v[60:63], a[244:247], v[180:183]
    ds_read_b64_tr_b16 v[48:49], v6 offset:53248
    v_cvt_pk_bf16_f32 v67, v146, v147
    v_mfma_f32_16x16x32_bf16 v[180:183], v[56:59], a[228:231], v[180:183]
    v_cvt_pk_bf16_f32 v82, v148, v149
    v_cvt_pk_bf16_f32 v83, v150, v151
    v_mfma_f32_16x16x32_bf16 v[184:187], v[56:59], a[232:235], v[184:187]
    ds_read_b64_tr_b16 v[50:51], v6 offset:55296
    v_cvt_pk_bf16_f32 v98, v152, v153
    v_mfma_f32_16x16x32_bf16 v[184:187], v[60:63], a[248:251], v[184:187]
    v_cvt_pk_bf16_f32 v99, v154, v155
    v_cvt_pk_bf16_f32 v114, v156, v157
    v_mfma_f32_16x16x32_bf16 v[188:191], v[60:63], a[252:255], v[188:191]
    ds_read_b64_tr_b16 v[52:53], v6 offset:61440
    v_cvt_pk_bf16_f32 v115, v158, v159
    v_mfma_f32_16x16x32_bf16 v[188:191], v[56:59], a[236:239], v[188:191]
    s_waitcnt lgkmcnt(7)
    v_cvt_pk_bf16_f32 v68, v160, v161
    v_cvt_pk_bf16_f32 v69, v162, v163
    v_mfma_f32_16x16x32_bf16 v[192:195], v[32:35], a[224:227], v[192:195]
    ds_read_b64_tr_b16 v[54:55], v6 offset:63488
    v_cvt_pk_bf16_f32 v84, v164, v165
    v_mfma_f32_16x16x32_bf16 v[192:195], v[36:39], a[240:243], v[192:195]
    v_cvt_pk_bf16_f32 v85, v166, v167
    v_cvt_pk_bf16_f32 v100, v168, v169
    v_mfma_f32_16x16x32_bf16 v[196:199], v[36:39], a[244:247], v[196:199]
    ds_read_b64_tr_b16 v[56:57], v7 offset:53248
    v_cvt_pk_bf16_f32 v101, v170, v171
    v_mfma_f32_16x16x32_bf16 v[196:199], v[32:35], a[228:231], v[196:199]
    v_cvt_pk_bf16_f32 v116, v172, v173
    v_cvt_pk_bf16_f32 v117, v174, v175
    v_mfma_f32_16x16x32_bf16 v[200:203], v[32:35], a[232:235], v[200:203]
    ds_read_b64_tr_b16 v[58:59], v7 offset:55296
    s_add_u32 s80, s80, 524288
    v_mfma_f32_16x16x32_bf16 v[200:203], v[36:39], a[248:251], v[200:203]
    s_and_b32 s80, s80, 4194303
    v_cvt_pk_bf16_f32 v70, v176, v177
    v_cvt_pk_bf16_f32 v71, v178, v179
    v_mfma_f32_16x16x32_bf16 v[204:207], v[36:39], a[252:255], v[204:207]
    ds_read_b64_tr_b16 v[60:61], v7 offset:61440
    v_cvt_pk_bf16_f32 v86, v180, v181
    v_mfma_f32_16x16x32_bf16 v[204:207], v[32:35], a[236:239], v[204:207]
    s_waitcnt lgkmcnt(7)
    v_cvt_pk_bf16_f32 v87, v182, v183
    v_cvt_pk_bf16_f32 v102, v184, v185
    v_mfma_f32_16x16x32_bf16 v[208:211], v[40:43], a[224:227], v[208:211]
    ds_read_b64_tr_b16 v[62:63], v7 offset:63488
    v_cvt_pk_bf16_f32 v103, v186, v187
    v_mfma_f32_16x16x32_bf16 v[208:211], v[44:47], a[240:243], v[208:211]
    v_cvt_pk_bf16_f32 v118, v188, v189
    v_cvt_pk_bf16_f32 v119, v190, v191
    v_mfma_f32_16x16x32_bf16 v[212:215], v[44:47], a[244:247], v[212:215]
    s_waitcnt vmcnt(12)
    s_barrier
    v_mfma_f32_16x16x32_bf16 v[212:215], v[40:43], a[228:231], v[212:215]
    ds_read_b64_tr_b16 v[32:33], v4 offset:0
    v_cvt_pk_bf16_f32 v72, v192, v193
    v_mfma_f32_16x16x32_bf16 v[216:219], v[40:43], a[232:235], v[216:219]
    ds_read_b64_tr_b16 v[34:35], v4 offset:2048
    v_cvt_pk_bf16_f32 v73, v194, v195
    v_mfma_f32_16x16x32_bf16 v[216:219], v[44:47], a[248:251], v[216:219]
    buffer_load_dwordx4 v8, s[24:27], s80 offen lds
    s_add_u32 m0, s78, 36864
    v_mfma_f32_16x16x32_bf16 v[220:223], v[44:47], a[252:255], v[220:223]
    ds_read_b64_tr_b16 v[36:37], v4 offset:8192
    v_cvt_pk_bf16_f32 v88, v196, v197
    v_mfma_f32_16x16x32_bf16 v[220:223], v[40:43], a[236:239], v[220:223]
    s_waitcnt lgkmcnt(7)
    v_cvt_pk_bf16_f32 v89, v198, v199
    v_cvt_pk_bf16_f32 v104, v200, v201
    v_mfma_f32_16x16x32_bf16 v[224:227], v[48:51], a[224:227], v[224:227]
    ds_read_b64_tr_b16 v[38:39], v4 offset:10240
    v_cvt_pk_bf16_f32 v105, v202, v203
    v_mfma_f32_16x16x32_bf16 v[224:227], v[52:55], a[240:243], v[224:227]
    buffer_load_dwordx4 v9, s[24:27], s80 offen lds
    s_add_u32 m0, s78, 40960
    v_mfma_f32_16x16x32_bf16 v[228:231], v[52:55], a[244:247], v[228:231]
    ds_read_b64_tr_b16 v[40:41], v5 offset:0
    v_cvt_pk_bf16_f32 v120, v204, v205
    v_mfma_f32_16x16x32_bf16 v[228:231], v[48:51], a[228:231], v[228:231]
    v_cvt_pk_bf16_f32 v121, v206, v207
    v_cvt_pk_bf16_f32 v74, v208, v209
    v_mfma_f32_16x16x32_bf16 v[232:235], v[48:51], a[232:235], v[232:235]
    ds_read_b64_tr_b16 v[42:43], v5 offset:2048
    v_cvt_pk_bf16_f32 v75, v210, v211
    v_mfma_f32_16x16x32_bf16 v[232:235], v[52:55], a[248:251], v[232:235]
    buffer_load_dwordx4 v10, s[24:27], s80 offen lds
    s_add_u32 m0, s78, 45056
    v_mfma_f32_16x16x32_bf16 v[236:239], v[52:55], a[252:255], v[236:239]
    ds_read_b64_tr_b16 v[44:45], v5 offset:8192
    v_cvt_pk_bf16_f32 v90, v212, v213
    v_mfma_f32_16x16x32_bf16 v[236:239], v[48:51], a[236:239], v[236:239]
    s_waitcnt lgkmcnt(7)
    v_cvt_pk_bf16_f32 v91, v214, v215
    v_cvt_pk_bf16_f32 v106, v216, v217
    v_mfma_f32_16x16x32_bf16 v[240:243], v[56:59], a[224:227], v[240:243]
    ds_read_b64_tr_b16 v[46:47], v5 offset:10240
    v_cvt_pk_bf16_f32 v107, v218, v219
    v_mfma_f32_16x16x32_bf16 v[240:243], v[60:63], a[240:243], v[240:243]
    buffer_load_dwordx4 v11, s[24:27], s80 offen lds
    s_add_u32 m0, s78, 98304
    v_mfma_f32_16x16x32_bf16 v[244:247], v[60:63], a[244:247], v[244:247]
    ds_read_b64_tr_b16 v[48:49], v6 offset:0
    s_add_u32 s73, s48, 1
    v_mfma_f32_16x16x32_bf16 v[244:247], v[56:59], a[228:231], v[244:247]
    s_and_b32 s73, s73, 3
    s_mul_i32 s73, s73, 458752
    s_lshl_b32 s77, s7, 7
    v_mfma_f32_16x16x32_bf16 v[248:251], v[56:59], a[232:235], v[248:251]
    ds_read_b64_tr_b16 v[50:51], v6 offset:2048
    s_add_u32 s73, s73, s77
    v_mfma_f32_16x16x32_bf16 v[248:251], v[60:63], a[248:251], v[248:251]
    v_cvt_pk_bf16_f32 v122, v220, v221
    v_cvt_pk_bf16_f32 v123, v222, v223
    v_mfma_f32_16x16x32_bf16 v[252:255], v[60:63], a[252:255], v[252:255]
    ds_read_b64_tr_b16 v[52:53], v6 offset:8192
    v_cvt_pk_bf16_f32 v76, v224, v225
    v_mfma_f32_16x16x32_bf16 v[252:255], v[56:59], a[236:239], v[252:255]
    s_waitcnt lgkmcnt(7)
    v_cvt_pk_bf16_f32 v77, v226, v227
    v_cvt_pk_bf16_f32 v92, v228, v229
    v_mfma_f32_16x16x32_bf16 v[128:131], a[0:3], v[32:35], 0
    ds_read_b64_tr_b16 v[54:55], v6 offset:10240
    v_cvt_pk_bf16_f32 v93, v230, v231
    v_mfma_f32_16x16x32_bf16 v[128:131], a[16:19], v[36:39], v[128:131]
    v_cvt_pk_bf16_f32 v108, v232, v233
    v_cvt_pk_bf16_f32 v109, v234, v235
    v_mfma_f32_16x16x32_bf16 v[132:135], a[20:23], v[36:39], 0
    ds_read_b64_tr_b16 v[56:57], v7 offset:0
    v_cvt_pk_bf16_f32 v124, v236, v237
    v_mfma_f32_16x16x32_bf16 v[132:135], a[4:7], v[32:35], v[132:135]
    v_cvt_pk_bf16_f32 v125, v238, v239
    v_cvt_pk_bf16_f32 v78, v240, v241
    v_mfma_f32_16x16x32_bf16 v[136:139], a[8:11], v[32:35], 0
    ds_read_b64_tr_b16 v[58:59], v7 offset:2048
    v_cvt_pk_bf16_f32 v79, v242, v243
    v_mfma_f32_16x16x32_bf16 v[136:139], a[24:27], v[36:39], v[136:139]
    buffer_load_dwordx4 v31, s[32:35], s73 offen lds
    s_add_u32 m0, s78, 102400
    v_mfma_f32_16x16x32_bf16 v[140:143], a[28:31], v[36:39], 0
    ds_read_b64_tr_b16 v[60:61], v7 offset:8192
    v_cvt_pk_bf16_f32 v94, v244, v245
    v_mfma_f32_16x16x32_bf16 v[140:143], a[12:15], v[32:35], v[140:143]
    s_waitcnt lgkmcnt(7)
    buffer_load_dwordx4 v31, s[36:39], s73 offen lds
    s_add_u32 m0, s78, 106496
    v_mfma_f32_16x16x32_bf16 v[144:147], a[0:3], v[40:43], 0
    ds_read_b64_tr_b16 v[62:63], v7 offset:10240
    s_add_u32 s73, s73, 114688
    v_mfma_f32_16x16x32_bf16 v[144:147], a[16:19], v[44:47], v[144:147]
    v_cvt_pk_bf16_f32 v95, v246, v247
    v_cvt_pk_bf16_f32 v110, v248, v249
    v_mfma_f32_16x16x32_bf16 v[148:151], a[20:23], v[44:47], 0
    ds_read_b64_tr_b16 v[32:33], v4 offset:4096
    v_cvt_pk_bf16_f32 v111, v250, v251
    v_mfma_f32_16x16x32_bf16 v[148:151], a[4:7], v[40:43], v[148:151]
    buffer_load_dwordx4 v31, s[32:35], s73 offen lds
    s_add_u32 m0, s78, 110592
    v_mfma_f32_16x16x32_bf16 v[152:155], a[8:11], v[40:43], 0
    ds_read_b64_tr_b16 v[34:35], v4 offset:6144
    v_cvt_pk_bf16_f32 v126, v252, v253
    v_mfma_f32_16x16x32_bf16 v[152:155], a[24:27], v[44:47], v[152:155]
    buffer_load_dwordx4 v31, s[36:39], s73 offen lds
    s_add_u32 m0, s78, 114688
    v_mfma_f32_16x16x32_bf16 v[156:159], a[28:31], v[44:47], 0
    ds_read_b64_tr_b16 v[36:37], v4 offset:12288
    s_add_u32 s73, s73, 114688
    v_mfma_f32_16x16x32_bf16 v[156:159], a[12:15], v[40:43], v[156:159]
    s_waitcnt lgkmcnt(7)
    v_cvt_pk_bf16_f32 v127, v254, v255
    v_mfma_f32_16x16x32_bf16 v[160:163], a[0:3], v[48:51], 0
    ds_read_b64_tr_b16 v[38:39], v4 offset:14336
    v_mfma_f32_16x16x32_bf16 v[160:163], a[16:19], v[52:55], v[160:163]
    buffer_load_dwordx4 v31, s[32:35], s73 offen lds
    s_add_u32 m0, s78, 118784
    v_mfma_f32_16x16x32_bf16 v[164:167], a[20:23], v[52:55], 0
    ds_read_b64_tr_b16 v[40:41], v5 offset:4096
    v_mfma_f32_16x16x32_bf16 v[164:167], a[4:7], v[48:51], v[164:167]
    buffer_load_dwordx4 v31, s[36:39], s73 offen lds
    s_add_u32 m0, s78, 122880
    v_mfma_f32_16x16x32_bf16 v[168:171], a[8:11], v[48:51], 0
    ds_read_b64_tr_b16 v[42:43], v5 offset:6144
    s_add_u32 s73, s73, 114688
    v_mfma_f32_16x16x32_bf16 v[168:171], a[24:27], v[52:55], v[168:171]
    v_mfma_f32_16x16x32_bf16 v[172:175], a[28:31], v[52:55], 0
    ds_read_b64_tr_b16 v[44:45], v5 offset:12288
    v_mfma_f32_16x16x32_bf16 v[172:175], a[12:15], v[48:51], v[172:175]
    s_waitcnt lgkmcnt(7)
    buffer_load_dwordx4 v31, s[32:35], s73 offen lds
    s_add_u32 m0, s78, 126976
    v_mfma_f32_16x16x32_bf16 v[176:179], a[0:3], v[56:59], 0
    ds_read_b64_tr_b16 v[46:47], v5 offset:14336
    v_mfma_f32_16x16x32_bf16 v[176:179], a[16:19], v[60:63], v[176:179]
    buffer_load_dwordx4 v31, s[36:39], s73 offen lds
    s_add_u32 m0, s78, 49152
    v_mfma_f32_16x16x32_bf16 v[180:183], a[20:23], v[60:63], 0
    ds_read_b64_tr_b16 v[48:49], v6 offset:4096
    s_lshl_b32 s77, s98, 7
    v_mfma_f32_16x16x32_bf16 v[180:183], a[4:7], v[56:59], v[180:183]
    s_add_u32 s77, s77, 11538432
    v_and_b32 v29, 7, v1
    v_lshlrev_b32 v29, 2, v29
    v_mfma_f32_16x16x32_bf16 v[184:187], a[8:11], v[56:59], 0
    ds_read_b64_tr_b16 v[50:51], v6 offset:6144
    v_add_u32 v29, s77, v29
    v_mfma_f32_16x16x32_bf16 v[184:187], a[24:27], v[60:63], v[184:187]
    buffer_load_dword v0, v29, s[52:55], 0 offen sc1
    v_mfma_f32_16x16x32_bf16 v[188:191], a[28:31], v[60:63], 0
    ds_read_b64_tr_b16 v[52:53], v6 offset:12288
    v_mfma_f32_16x16x32_bf16 v[188:191], a[12:15], v[56:59], v[188:191]
    s_waitcnt lgkmcnt(7)
    v_mfma_f32_16x16x32_bf16 v[192:195], a[0:3], v[32:35], 0
    ds_read_b64_tr_b16 v[54:55], v6 offset:14336
    s_add_u32 s74, s83, 33554432
    v_mfma_f32_16x16x32_bf16 v[192:195], a[16:19], v[36:39], v[192:195]
    v_mfma_f32_16x16x32_bf16 v[196:199], a[20:23], v[36:39], 0
    ds_read_b64_tr_b16 v[56:57], v7 offset:4096
    v_mfma_f32_16x16x32_bf16 v[196:199], a[4:7], v[32:35], v[196:199]
    v_mfma_f32_16x16x32_bf16 v[200:203], a[8:11], v[32:35], 0
    ds_read_b64_tr_b16 v[58:59], v7 offset:6144
    s_add_u32 s80, s80, 524288
    v_mfma_f32_16x16x32_bf16 v[200:203], a[24:27], v[36:39], v[200:203]
    s_and_b32 s80, s80, 4194303
    buffer_store_dwordx4 v[64:67], v3, s[52:55], s74 offen offset:0 sc1
    v_mfma_f32_16x16x32_bf16 v[204:207], a[28:31], v[36:39], 0
    ds_read_b64_tr_b16 v[60:61], v7 offset:12288
    v_mfma_f32_16x16x32_bf16 v[204:207], a[12:15], v[32:35], v[204:207]
    s_waitcnt lgkmcnt(7)
    v_mfma_f32_16x16x32_bf16 v[208:211], a[0:3], v[40:43], 0
    ds_read_b64_tr_b16 v[62:63], v7 offset:14336
    v_mfma_f32_16x16x32_bf16 v[208:211], a[16:19], v[44:47], v[208:211]
    v_mfma_f32_16x16x32_bf16 v[212:215], a[20:23], v[44:47], 0
    s_waitcnt vmcnt(22)
    s_barrier
    v_mfma_f32_16x16x32_bf16 v[212:215], a[4:7], v[40:43], v[212:215]
    ds_read_b64_tr_b16 v[32:33], v4 offset:16384
    v_mfma_f32_16x16x32_bf16 v[216:219], a[8:11], v[40:43], 0
    ds_read_b64_tr_b16 v[34:35], v4 offset:18432
    v_mfma_f32_16x16x32_bf16 v[216:219], a[24:27], v[44:47], v[216:219]
    buffer_load_dwordx4 v8, s[24:27], s80 offen lds
    s_add_u32 m0, s78, 53248
    v_mfma_f32_16x16x32_bf16 v[220:223], a[28:31], v[44:47], 0
    ds_read_b64_tr_b16 v[36:37], v4 offset:24576
    v_mfma_f32_16x16x32_bf16 v[220:223], a[12:15], v[40:43], v[220:223]
    s_waitcnt lgkmcnt(7)
    v_mfma_f32_16x16x32_bf16 v[224:227], a[0:3], v[48:51], 0
    ds_read_b64_tr_b16 v[38:39], v4 offset:26624
    v_mfma_f32_16x16x32_bf16 v[224:227], a[16:19], v[52:55], v[224:227]
    buffer_load_dwordx4 v9, s[24:27], s80 offen lds
    s_add_u32 m0, s78, 57344
    v_mfma_f32_16x16x32_bf16 v[228:231], a[20:23], v[52:55], 0
    ds_read_b64_tr_b16 v[40:41], v5 offset:16384
    v_mfma_f32_16x16x32_bf16 v[228:231], a[4:7], v[48:51], v[228:231]
    v_mfma_f32_16x16x32_bf16 v[232:235], a[8:11], v[48:51], 0
    ds_read_b64_tr_b16 v[42:43], v5 offset:18432
    v_mfma_f32_16x16x32_bf16 v[232:235], a[24:27], v[52:55], v[232:235]
    buffer_load_dwordx4 v10, s[24:27], s80 offen lds
    s_add_u32 m0, s78, 61440
    v_mfma_f32_16x16x32_bf16 v[236:239], a[28:31], v[52:55], 0
    ds_read_b64_tr_b16 v[44:45], v5 offset:24576
    v_mfma_f32_16x16x32_bf16 v[236:239], a[12:15], v[48:51], v[236:239]
    s_waitcnt lgkmcnt(7)
    v_mfma_f32_16x16x32_bf16 v[240:243], a[0:3], v[56:59], 0
    ds_read_b64_tr_b16 v[46:47], v5 offset:26624
    v_mfma_f32_16x16x32_bf16 v[240:243], a[16:19], v[60:63], v[240:243]
    buffer_load_dwordx4 v11, s[24:27], s80 offen lds
    s_add_u32 m0, s78, 0
    v_mfma_f32_16x16x32_bf16 v[244:247], a[20:23], v[60:63], 0
    ds_read_b64_tr_b16 v[48:49], v6 offset:16384
    v_mfma_f32_16x16x32_bf16 v[244:247], a[4:7], v[56:59], v[244:247]
    v_mfma_f32_16x16x32_bf16 v[248:251], a[8:11], v[56:59], 0
    ds_read_b64_tr_b16 v[50:51], v6 offset:18432
    v_mfma_f32_16x16x32_bf16 v[248:251], a[24:27], v[60:63], v[248:251]
    v_mfma_f32_16x16x32_bf16 v[252:255], a[28:31], v[60:63], 0
    ds_read_b64_tr_b16 v[52:53], v6 offset:24576
    v_mfma_f32_16x16x32_bf16 v[252:255], a[12:15], v[56:59], v[252:255]
    s_waitcnt lgkmcnt(7)
    v_mfma_f32_16x16x32_bf16 v[128:131], a[32:35], v[32:35], v[128:131]
    ds_read_b64_tr_b16 v[54:55], v6 offset:26624
    v_mfma_f32_16x16x32_bf16 v[128:131], a[48:51], v[36:39], v[128:131]
    v_mfma_f32_16x16x32_bf16 v[132:135], a[52:55], v[36:39], v[132:135]
    ds_read_b64_tr_b16 v[56:57], v7 offset:16384
    v_mfma_f32_16x16x32_bf16 v[132:135], a[36:39], v[32:35], v[132:135]
    buffer_store_dwordx4 v[68:71], v3, s[52:55], s74 offen offset:1024 sc1
    v_mfma_f32_16x16x32_bf16 v[136:139], a[40:43], v[32:35], v[136:139]
    ds_read_b64_tr_b16 v[58:59], v7 offset:18432
    v_mfma_f32_16x16x32_bf16 v[136:139], a[56:59], v[36:39], v[136:139]
    s_waitcnt vmcnt(6)
    v_cmp_eq_u32 vcc, s3, v0
    s_cmp_eq_u64 vcc, exec
    s_cbranch_scc0 L_spin_xn
L_ok_xn:
    v_mfma_f32_16x16x32_bf16 v[140:143], a[60:63], v[36:39], v[140:143]
    ds_read_b64_tr_b16 v[60:61], v7 offset:24576
    s_add_u32 s81, s48, 0
    v_mfma_f32_16x16x32_bf16 v[140:143], a[44:47], v[32:35], v[140:143]
    s_waitcnt lgkmcnt(7)
    s_and_b32 s81, s81, 3
    s_lshl_b32 s81, s81, 14
    v_mfma_f32_16x16x32_bf16 v[144:147], a[32:35], v[40:43], v[144:147]
    ds_read_b64_tr_b16 v[62:63], v7 offset:26624
    s_add_u32 s81, s81, s84
    v_mfma_f32_16x16x32_bf16 v[144:147], a[48:51], v[44:47], v[144:147]
    buffer_load_dwordx4 a[0:3], v3, s[52:55], s81 offen offset:0 sc1
    v_mfma_f32_16x16x32_bf16 v[148:151], a[52:55], v[44:47], v[148:151]
    ds_read_b64_tr_b16 v[32:33], v4 offset:20480
    v_mfma_f32_16x16x32_bf16 v[148:151], a[36:39], v[40:43], v[148:151]
    v_mfma_f32_16x16x32_bf16 v[152:155], a[40:43], v[40:43], v[152:155]
    ds_read_b64_tr_b16 v[34:35], v4 offset:22528
    v_mfma_f32_16x16x32_bf16 v[152:155], a[56:59], v[44:47], v[152:155]
    buffer_load_dwordx4 a[4:7], v3, s[52:55], s81 offen offset:1024 sc1
    v_mfma_f32_16x16x32_bf16 v[156:159], a[60:63], v[44:47], v[156:159]
    ds_read_b64_tr_b16 v[36:37], v4 offset:28672
    v_mfma_f32_16x16x32_bf16 v[156:159], a[44:47], v[40:43], v[156:159]
    s_waitcnt lgkmcnt(7)
    v_mfma_f32_16x16x32_bf16 v[160:163], a[32:35], v[48:51], v[160:163]
    ds_read_b64_tr_b16 v[38:39], v4 offset:30720
    v_mfma_f32_16x16x32_bf16 v[160:163], a[48:51], v[52:55], v[160:163]
    buffer_load_dwordx4 a[8:11], v3, s[52:55], s81 offen offset:2048 sc1
    v_mfma_f32_16x16x32_bf16 v[164:167], a[52:55], v[52:55], v[164:167]
    ds_read_b64_tr_b16 v[40:41], v5 offset:20480
    v_mfma_f32_16x16x32_bf16 v[164:167], a[36:39], v[48:51], v[164:167]
    v_mfma_f32_16x16x32_bf16 v[168:171], a[40:43], v[48:51], v[168:171]
    ds_read_b64_tr_b16 v[42:43], v5 offset:22528
    v_mfma_f32_16x16x32_bf16 v[168:171], a[56:59], v[52:55], v[168:171]
    buffer_load_dwordx4 a[12:15], v3, s[52:55], s81 offen offset:3072 sc1
    v_mfma_f32_16x16x32_bf16 v[172:175], a[60:63], v[52:55], v[172:175]
    ds_read_b64_tr_b16 v[44:45], v5 offset:28672
    s_add_u32 s81, s81, 4096
    v_mfma_f32_16x16x32_bf16 v[172:175], a[44:47], v[48:51], v[172:175]
    s_waitcnt lgkmcnt(7)
    v_mfma_f32_16x16x32_bf16 v[176:179], a[32:35], v[56:59], v[176:179]
    ds_read_b64_tr_b16 v[46:47], v5 offset:30720
    v_mfma_f32_16x16x32_bf16 v[176:179], a[48:51], v[60:63], v[176:179]
    buffer_load_dwordx4 a[16:19], v3, s[52:55], s81 offen offset:0 sc1
    v_mfma_f32_16x16x32_bf16 v[180:183], a[52:55], v[60:63], v[180:183]
    ds_read_b64_tr_b16 v[48:49], v6 offset:20480
    v_mfma_f32_16x16x32_bf16 v[180:183], a[36:39], v[56:59], v[180:183]
    v_mfma_f32_16x16x32_bf16 v[184:187], a[40:43], v[56:59], v[184:187]
    ds_read_b64_tr_b16 v[50:51], v6 offset:22528
    v_mfma_f32_16x16x32_bf16 v[184:187], a[56:59], v[60:63], v[184:187]
    buffer_load_dwordx4 a[20:23], v3, s[52:55], s81 offen offset:1024 sc1
    v_mfma_f32_16x16x32_bf16 v[188:191], a[60:63], v[60:63], v[188:191]
    ds_read_b64_tr_b16 v[52:53], v6 offset:28672
    v_mfma_f32_16x16x32_bf16 v[188:191], a[44:47], v[56:59], v[188:191]
    s_waitcnt lgkmcnt(7)
    v_mfma_f32_16x16x32_bf16 v[192:195], a[32:35], v[32:35], v[192:195]
    ds_read_b64_tr_b16 v[54:55], v6 offset:30720
    v_mfma_f32_16x16x32_bf16 v[192:195], a[48:51], v[36:39], v[192:195]
    buffer_load_dwordx4 a[24:27], v3, s[52:55], s81 offen offset:2048 sc1
    v_mfma_f32_16x16x32_bf16 v[196:199], a[52:55], v[36:39], v[196:199]
    ds_read_b64_tr_b16 v[56:57], v7 offset:20480
    v_mfma_f32_16x16x32_bf16 v[196:199], a[36:39], v[32:35], v[196:199]
    buffer_store_dwordx4 v[72:75], v3, s[52:55], s74 offen offset:2048 sc1
    v_mfma_f32_16x16x32_bf16 v[200:203], a[40:43], v[32:35], v[200:203]
    ds_read_b64_tr_b16 v[58:59], v7 offset:22528
    v_mfma_f32_16x16x32_bf16 v[200:203], a[56:59], v[36:39], v[200:203]
    buffer_load_dwordx4 a[28:31], v3, s[52:55], s81 offen offset:3072 sc1
    s_add_u32 s80, s80, 524288
    v_mfma_f32_16x16x32_bf16 v[204:207], a[60:63], v[36:39], v[204:207]
    ds_read_b64_tr_b16 v[60:61], v7 offset:28672
    s_and_b32 s80, s80, 4194303
    v_mfma_f32_16x16x32_bf16 v[204:207], a[44:47], v[32:35], v[204:207]
    s_waitcnt lgkmcnt(7)
    v_mfma_f32_16x16x32_bf16 v[208:211], a[32:35], v[40:43], v[208:211]
    ds_read_b64_tr_b16 v[62:63], v7 offset:30720
    v_mfma_f32_16x16x32_bf16 v[208:211], a[48:51], v[44:47], v[208:211]
    v_mfma_f32_16x16x32_bf16 v[212:215], a[52:55], v[44:47], v[212:215]
    s_barrier
    v_mfma_f32_16x16x32_bf16 v[212:215], a[36:39], v[40:43], v[212:215]
    ds_read_b64_tr_b16 v[32:33], v4 offset:32768
    v_mfma_f32_16x16x32_bf16 v[216:219], a[40:43], v[40:43], v[216:219]
    ds_read_b64_tr_b16 v[34:35], v4 offset:34816
    v_mfma_f32_16x16x32_bf16 v[216:219], a[56:59], v[44:47], v[216:219]
    buffer_load_dwordx4 v8, s[24:27], s80 offen lds
    s_add_u32 m0, s78, 4096
    v_mfma_f32_16x16x32_bf16 v[220:223], a[60:63], v[44:47], v[220:223]
    ds_read_b64_tr_b16 v[36:37], v4 offset:40960
    v_mfma_f32_16x16x32_bf16 v[220:223], a[44:47], v[40:43], v[220:223]
    s_waitcnt lgkmcnt(7)
    v_mfma_f32_16x16x32_bf16 v[224:227], a[32:35], v[48:51], v[224:227]
    ds_read_b64_tr_b16 v[38:39], v4 offset:43008
    v_mfma_f32_16x16x32_bf16 v[224:227], a[48:51], v[52:55], v[224:227]
    buffer_load_dwordx4 v9, s[24:27], s80 offen lds
    s_add_u32 m0, s78, 8192
    v_mfma_f32_16x16x32_bf16 v[228:231], a[52:55], v[52:55], v[228:231]
    ds_read_b64_tr_b16 v[40:41], v5 offset:32768
    v_mfma_f32_16x16x32_bf16 v[228:231], a[36:39], v[48:51], v[228:231]
    v_mfma_f32_16x16x32_bf16 v[232:235], a[40:43], v[48:51], v[232:235]
    ds_read_b64_tr_b16 v[42:43], v5 offset:34816
    v_mfma_f32_16x16x32_bf16 v[232:235], a[56:59], v[52:55], v[232:235]
    buffer_load_dwordx4 v10, s[24:27], s80 offen lds
    s_add_u32 m0, s78, 12288
    v_mfma_f32_16x16x32_bf16 v[236:239], a[60:63], v[52:55], v[236:239]
    ds_read_b64_tr_b16 v[44:45], v5 offset:40960
    v_mfma_f32_16x16x32_bf16 v[236:239], a[44:47], v[48:51], v[236:239]
    s_waitcnt lgkmcnt(7)
    v_mfma_f32_16x16x32_bf16 v[240:243], a[32:35], v[56:59], v[240:243]
    ds_read_b64_tr_b16 v[46:47], v5 offset:43008
    v_mfma_f32_16x16x32_bf16 v[240:243], a[48:51], v[60:63], v[240:243]
    buffer_load_dwordx4 v11, s[24:27], s80 offen lds
    s_add_u32 m0, s78, 16384
    v_mfma_f32_16x16x32_bf16 v[244:247], a[52:55], v[60:63], v[244:247]
    ds_read_b64_tr_b16 v[48:49], v6 offset:32768
    v_mfma_f32_16x16x32_bf16 v[244:247], a[36:39], v[56:59], v[244:247]
    v_mfma_f32_16x16x32_bf16 v[248:251], a[40:43], v[56:59], v[248:251]
    ds_read_b64_tr_b16 v[50:51], v6 offset:34816
    v_mfma_f32_16x16x32_bf16 v[248:251], a[56:59], v[60:63], v[248:251]
    v_mfma_f32_16x16x32_bf16 v[252:255], a[60:63], v[60:63], v[252:255]
    ds_read_b64_tr_b16 v[52:53], v6 offset:40960
    v_mfma_f32_16x16x32_bf16 v[252:255], a[44:47], v[56:59], v[252:255]
    s_waitcnt lgkmcnt(7)
    v_mfma_f32_16x16x32_bf16 v[128:131], a[64:67], v[32:35], v[128:131]
    ds_read_b64_tr_b16 v[54:55], v6 offset:43008
    v_mfma_f32_16x16x32_bf16 v[128:131], a[80:83], v[36:39], v[128:131]
    buffer_store_dwordx4 v[76:79], v3, s[52:55], s74 offen offset:3072 sc1
    v_mfma_f32_16x16x32_bf16 v[132:135], a[84:87], v[36:39], v[132:135]
    ds_read_b64_tr_b16 v[56:57], v7 offset:32768
    v_mfma_f32_16x16x32_bf16 v[132:135], a[68:71], v[32:35], v[132:135]
    v_mfma_f32_16x16x32_bf16 v[136:139], a[72:75], v[32:35], v[136:139]
    ds_read_b64_tr_b16 v[58:59], v7 offset:34816
    v_mfma_f32_16x16x32_bf16 v[136:139], a[88:91], v[36:39], v[136:139]
    v_mfma_f32_16x16x32_bf16 v[140:143], a[92:95], v[36:39], v[140:143]
    ds_read_b64_tr_b16 v[60:61], v7 offset:40960
    s_add_u32 s81, s81, 4096
    v_mfma_f32_16x16x32_bf16 v[140:143], a[76:79], v[32:35], v[140:143]
    s_waitcnt lgkmcnt(7)
    v_mfma_f32_16x16x32_bf16 v[144:147], a[64:67], v[40:43], v[144:147]
    ds_read_b64_tr_b16 v[62:63], v7 offset:43008
    v_mfma_f32_16x16x32_bf16 v[144:147], a[80:83], v[44:47], v[144:147]
    buffer_load_dwordx4 a[32:35], v3, s[52:55], s81 offen offset:0 sc1
    v_mfma_f32_16x16x32_bf16 v[148:151], a[84:87], v[44:47], v[148:151]
    ds_read_b64_tr_b16 v[32:33], v4 offset:36864
    v_mfma_f32_16x16x32_bf16 v[148:151], a[68:71], v[40:43], v[148:151]
    v_mfma_f32_16x16x32_bf16 v[152:155], a[72:75], v[40:43], v[152:155]
    ds_read_b64_tr_b16 v[34:35], v4 offset:38912
    v_mfma_f32_16x16x32_bf16 v[152:155], a[88:91], v[44:47], v[152:155]
    buffer_load_dwordx4 a[36:39], v3, s[52:55], s81 offen offset:1024 sc1
    v_mfma_f32_16x16x32_bf16 v[156:159], a[92:95], v[44:47], v[156:159]
    ds_read_b64_tr_b16 v[36:37], v4 offset:45056
    v_mfma_f32_16x16x32_bf16 v[156:159], a[76:79], v[40:43], v[156:159]
    s_waitcnt lgkmcnt(7)
    v_mfma_f32_16x16x32_bf16 v[160:163], a[64:67], v[48:51], v[160:163]
    ds_read_b64_tr_b16 v[38:39], v4 offset:47104
    v_mfma_f32_16x16x32_bf16 v[160:163], a[80:83], v[52:55], v[160:163]
    buffer_load_dwordx4 a[40:43], v3, s[52:55], s81 offen offset:2048 sc1
    v_mfma_f32_16x16x32_bf16 v[164:167], a[84:87], v[52:55], v[164:167]
    ds_read_b64_tr_b16 v[40:41], v5 offset:36864
    v_mfma_f32_16x16x32_bf16 v[164:167], a[68:71], v[48:51], v[164:167]
    v_mfma_f32_16x16x32_bf16 v[168:171], a[72:75], v[48:51], v[168:171]
    ds_read_b64_tr_b16 v[42:43], v5 offset:38912
    v_mfma_f32_16x16x32_bf16 v[168:171], a[88:91], v[52:55], v[168:171]
    buffer_load_dwordx4 a[44:47], v3, s[52:55], s81 offen offset:3072 sc1
    v_mfma_f32_16x16x32_bf16 v[172:175], a[92:95], v[52:55], v[172:175]
    ds_read_b64_tr_b16 v[44:45], v5 offset:45056
    s_add_u32 s81, s81, 4096
    v_mfma_f32_16x16x32_bf16 v[172:175], a[76:79], v[48:51], v[172:175]
    s_waitcnt lgkmcnt(7)
    v_mfma_f32_16x16x32_bf16 v[176:179], a[64:67], v[56:59], v[176:179]
    ds_read_b64_tr_b16 v[46:47], v5 offset:47104
    v_mfma_f32_16x16x32_bf16 v[176:179], a[80:83], v[60:63], v[176:179]
    buffer_load_dwordx4 a[48:51], v3, s[52:55], s81 offen offset:0 sc1
    v_mfma_f32_16x16x32_bf16 v[180:183], a[84:87], v[60:63], v[180:183]
    ds_read_b64_tr_b16 v[48:49], v6 offset:36864
    v_mfma_f32_16x16x32_bf16 v[180:183], a[68:71], v[56:59], v[180:183]
    v_mfma_f32_16x16x32_bf16 v[184:187], a[72:75], v[56:59], v[184:187]
    ds_read_b64_tr_b16 v[50:51], v6 offset:38912
    s_add_u32 s74, s83, 33558528
    v_mfma_f32_16x16x32_bf16 v[184:187], a[88:91], v[60:63], v[184:187]
    buffer_load_dwordx4 a[52:55], v3, s[52:55], s81 offen offset:1024 sc1
    v_mfma_f32_16x16x32_bf16 v[188:191], a[92:95], v[60:63], v[188:191]
    ds_read_b64_tr_b16 v[52:53], v6 offset:45056
    v_mfma_f32_16x16x32_bf16 v[188:191], a[76:79], v[56:59], v[188:191]
    s_waitcnt lgkmcnt(7)
    v_mfma_f32_16x16x32_bf16 v[192:195], a[64:67], v[32:35], v[192:195]
    ds_read_b64_tr_b16 v[54:55], v6 offset:47104
    v_mfma_f32_16x16x32_bf16 v[192:195], a[80:83], v[36:39], v[192:195]
    buffer_load_dwordx4 a[56:59], v3, s[52:55], s81 offen offset:2048 sc1
    v_mfma_f32_16x16x32_bf16 v[196:199], a[84:87], v[36:39], v[196:199]
    ds_read_b64_tr_b16 v[56:57], v7 offset:36864
    v_mfma_f32_16x16x32_bf16 v[196:199], a[68:71], v[32:35], v[196:199]
    buffer_store_dwordx4 v[80:83], v3, s[52:55], s74 offen offset:0 sc1
    v_mfma_f32_16x16x32_bf16 v[200:203], a[72:75], v[32:35], v[200:203]
    ds_read_b64_tr_b16 v[58:59], v7 offset:38912
    v_mfma_f32_16x16x32_bf16 v[200:203], a[88:91], v[36:39], v[200:203]
    buffer_load_dwordx4 a[60:63], v3, s[52:55], s81 offen offset:3072 sc1
    v_add_u32 v12, 65536, v4
    v_mfma_f32_16x16x32_bf16 v[204:207], a[92:95], v[36:39], v[204:207]
    ds_read_b64_tr_b16 v[60:61], v7 offset:45056
    v_add_u32 v13, 65536, v5
    v_mfma_f32_16x16x32_bf16 v[204:207], a[76:79], v[32:35], v[204:207]
    s_waitcnt lgkmcnt(7)
    v_add_u32 v14, 65536, v6
    v_add_u32 v15, 65536, v7
    v_mfma_f32_16x16x32_bf16 v[208:211], a[64:67], v[40:43], v[208:211]
    ds_read_b64_tr_b16 v[62:63], v7 offset:47104
    s_add_u32 s80, s80, 524288
    v_mfma_f32_16x16x32_bf16 v[208:211], a[80:83], v[44:47], v[208:211]
    s_and_b32 s80, s80, 4194303
    v_mfma_f32_16x16x32_bf16 v[212:215], a[84:87], v[44:47], v[212:215]
    s_waitcnt vmcnt(24)
    s_barrier
    v_mfma_f32_16x16x32_bf16 v[212:215], a[68:71], v[40:43], v[212:215]
    ds_read_b64_tr_b16 v[32:33], v4 offset:49152
    v_mfma_f32_16x16x32_bf16 v[216:219], a[72:75], v[40:43], v[216:219]
    ds_read_b64_tr_b16 v[34:35], v4 offset:51200
    v_mfma_f32_16x16x32_bf16 v[216:219], a[88:91], v[44:47], v[216:219]
    buffer_load_dwordx4 v8, s[24:27], s80 offen lds
    s_add_u32 m0, s78, 20480
    v_mfma_f32_16x16x32_bf16 v[220:223], a[92:95], v[44:47], v[220:223]
    ds_read_b64_tr_b16 v[36:37], v4 offset:57344
    v_mfma_f32_16x16x32_bf16 v[220:223], a[76:79], v[40:43], v[220:223]
    s_waitcnt lgkmcnt(7)
    v_mfma_f32_16x16x32_bf16 v[224:227], a[64:67], v[48:51], v[224:227]
    ds_read_b64_tr_b16 v[38:39], v4 offset:59392
    v_mfma_f32_16x16x32_bf16 v[224:227], a[80:83], v[52:55], v[224:227]
    buffer_load_dwordx4 v9, s[24:27], s80 offen lds
    s_add_u32 m0, s78, 24576
    v_mfma_f32_16x16x32_bf16 v[228:231], a[84:87], v[52:55], v[228:231]
    ds_read_b64_tr_b16 v[40:41], v5 offset:49152
    v_mfma_f32_16x16x32_bf16 v[228:231], a[68:71], v[48:51], v[228:231]
    v_mfma_f32_16x16x32_bf16 v[232:235], a[72:75], v[48:51], v[232:235]
    ds_read_b64_tr_b16 v[42:43], v5 offset:51200
    v_mfma_f32_16x16x32_bf16 v[232:235], a[88:91], v[52:55], v[232:235]
    buffer_load_dwordx4 v10, s[24:27], s80 offen lds
    s_add_u32 m0, s78, 28672
    v_mfma_f32_16x16x32_bf16 v[236:239], a[92:95], v[52:55], v[236:239]
    ds_read_b64_tr_b16 v[44:45], v5 offset:57344
    v_mfma_f32_16x16x32_bf16 v[236:239], a[76:79], v[48:51], v[236:239]
    s_waitcnt lgkmcnt(7)
    v_mfma_f32_16x16x32_bf16 v[240:243], a[64:67], v[56:59], v[240:243]
    ds_read_b64_tr_b16 v[46:47], v5 offset:59392
    v_mfma_f32_16x16x32_bf16 v[240:243], a[80:83], v[60:63], v[240:243]
    buffer_load_dwordx4 v11, s[24:27], s80 offen lds
    s_add_u32 m0, s78, 32768
    v_mfma_f32_16x16x32_bf16 v[244:247], a[84:87], v[60:63], v[244:247]
    ds_read_b64_tr_b16 v[48:49], v6 offset:49152
    v_mfma_f32_16x16x32_bf16 v[244:247], a[68:71], v[56:59], v[244:247]
    v_mfma_f32_16x16x32_bf16 v[248:251], a[72:75], v[56:59], v[248:251]
    ds_read_b64_tr_b16 v[50:51], v6 offset:51200
    v_mfma_f32_16x16x32_bf16 v[248:251], a[88:91], v[60:63], v[248:251]
    v_mfma_f32_16x16x32_bf16 v[252:255], a[92:95], v[60:63], v[252:255]
    ds_read_b64_tr_b16 v[52:53], v6 offset:57344
    v_mfma_f32_16x16x32_bf16 v[252:255], a[76:79], v[56:59], v[252:255]
    s_waitcnt lgkmcnt(7)
    buffer_store_dwordx4 v[84:87], v3, s[52:55], s74 offen offset:1024 sc1
    v_mfma_f32_16x16x32_bf16 v[128:131], a[96:99], v[32:35], v[128:131]
    ds_read_b64_tr_b16 v[54:55], v6 offset:59392
    v_mfma_f32_16x16x32_bf16 v[128:131], a[112:115], v[36:39], v[128:131]
    v_mfma_f32_16x16x32_bf16 v[132:135], a[116:119], v[36:39], v[132:135]
    ds_read_b64_tr_b16 v[56:57], v7 offset:49152
    s_add_u32 s81, s48, 1
    v_mfma_f32_16x16x32_bf16 v[132:135], a[100:103], v[32:35], v[132:135]
    s_and_b32 s81, s81, 3
    s_lshl_b32 s81, s81, 14
    s_add_u32 s81, s81, s84
    v_mfma_f32_16x16x32_bf16 v[136:139], a[104:107], v[32:35], v[136:139]
    ds_read_b64_tr_b16 v[58:59], v7 offset:51200
    v_mfma_f32_16x16x32_bf16 v[136:139], a[120:123], v[36:39], v[136:139]
    v_mfma_f32_16x16x32_bf16 v[140:143], a[124:127], v[36:39], v[140:143]
    ds_read_b64_tr_b16 v[60:61], v7 offset:57344
    v_mfma_f32_16x16x32_bf16 v[140:143], a[108:111], v[32:35], v[140:143]
    s_waitcnt lgkmcnt(7)
    v_mfma_f32_16x16x32_bf16 v[144:147], a[96:99], v[40:43], v[144:147]
    ds_read_b64_tr_b16 v[62:63], v7 offset:59392
    v_mfma_f32_16x16x32_bf16 v[144:147], a[112:115], v[44:47], v[144:147]
    buffer_load_dwordx4 a[64:67], v3, s[52:55], s81 offen offset:0 sc1
    v_mfma_f32_16x16x32_bf16 v[148:151], a[116:119], v[44:47], v[148:151]
    ds_read_b64_tr_b16 v[32:33], v4 offset:53248
    v_mfma_f32_16x16x32_bf16 v[148:151], a[100:103], v[40:43], v[148:151]
    v_mfma_f32_16x16x32_bf16 v[152:155], a[104:107], v[40:43], v[152:155]
    ds_read_b64_tr_b16 v[34:35], v4 offset:55296
    v_mfma_f32_16x16x32_bf16 v[152:155], a[120:123], v[44:47], v[152:155]
    buffer_load_dwordx4 a[68:71], v3, s[52:55], s81 offen offset:1024 sc1
    v_mfma_f32_16x16x32_bf16 v[156:159], a[124:127], v[44:47], v[156:159]
    ds_read_b64_tr_b16 v[36:37], v4 offset:61440
    v_mfma_f32_16x16x32_bf16 v[156:159], a[108:111], v[40:43], v[156:159]
    s_waitcnt lgkmcnt(7)
    v_mfma_f32_16x16x32_bf16 v[160:163], a[96:99], v[48:51], v[160:163]
    ds_read_b64_tr_b16 v[38:39], v4 offset:63488
    v_mfma_f32_16x16x32_bf16 v[160:163], a[112:115], v[52:55], v[160:163]
    buffer_load_dwordx4 a[72:75], v3, s[52:55], s81 offen offset:2048 sc1
    v_mfma_f32_16x16x32_bf16 v[164:167], a[116:119], v[52:55], v[164:167]
    ds_read_b64_tr_b16 v[40:41], v5 offset:53248
    v_mfma_f32_16x16x32_bf16 v[164:167], a[100:103], v[48:51], v[164:167]
    v_mfma_f32_16x16x32_bf16 v[168:171], a[104:107], v[48:51], v[168:171]
    ds_read_b64_tr_b16 v[42:43], v5 offset:55296
    v_mfma_f32_16x16x32_bf16 v[168:171], a[120:123], v[52:55], v[168:171]
    buffer_load_dwordx4 a[76:79], v3, s[52:55], s81 offen offset:3072 sc1
    v_mfma_f32_16x16x32_bf16 v[172:175], a[124:127], v[52:55], v[172:175]
    ds_read_b64_tr_b16 v[44:45], v5 offset:61440
    s_add_u32 s81, s81, 4096
    v_mfma_f32_16x16x32_bf16 v[172:175], a[108:111], v[48:51], v[172:175]
    s_waitcnt lgkmcnt(7)
    v_mfma_f32_16x16x32_bf16 v[176:179], a[96:99], v[56:59], v[176:179]
    ds_read_b64_tr_b16 v[46:47], v5 offset:63488
    v_mfma_f32_16x16x32_bf16 v[176:179], a[112:115], v[60:63], v[176:179]
    buffer_load_dwordx4 a[80:83], v3, s[52:55], s81 offen offset:0 sc1
    v_mfma_f32_16x16x32_bf16 v[180:183], a[116:119], v[60:63], v[180:183]
    ds_read_b64_tr_b16 v[48:49], v6 offset:53248
    v_mfma_f32_16x16x32_bf16 v[180:183], a[100:103], v[56:59], v[180:183]
    v_mfma_f32_16x16x32_bf16 v[184:187], a[104:107], v[56:59], v[184:187]
    ds_read_b64_tr_b16 v[50:51], v6 offset:55296
    v_mfma_f32_16x16x32_bf16 v[184:187], a[120:123], v[60:63], v[184:187]
    buffer_load_dwordx4 a[84:87], v3, s[52:55], s81 offen offset:1024 sc1
    v_mfma_f32_16x16x32_bf16 v[188:191], a[124:127], v[60:63], v[188:191]
    ds_read_b64_tr_b16 v[52:53], v6 offset:61440
    v_mfma_f32_16x16x32_bf16 v[188:191], a[108:111], v[56:59], v[188:191]
    s_waitcnt lgkmcnt(7)
    buffer_store_dwordx4 v[88:91], v3, s[52:55], s74 offen offset:2048 sc1
    v_mfma_f32_16x16x32_bf16 v[192:195], a[96:99], v[32:35], v[192:195]
    ds_read_b64_tr_b16 v[54:55], v6 offset:63488
    v_mfma_f32_16x16x32_bf16 v[192:195], a[112:115], v[36:39], v[192:195]
    buffer_load_dwordx4 a[88:91], v3, s[52:55], s81 offen offset:2048 sc1
    v_mfma_f32_16x16x32_bf16 v[196:199], a[116:119], v[36:39], v[196:199]
    ds_read_b64_tr_b16 v[56:57], v7 offset:53248
    v_mfma_f32_16x16x32_bf16 v[196:199], a[100:103], v[32:35], v[196:199]
    v_mfma_f32_16x16x32_bf16 v[200:203], a[104:107], v[32:35], v[200:203]
    ds_read_b64_tr_b16 v[58:59], v7 offset:55296
    v_mfma_f32_16x16x32_bf16 v[200:203], a[120:123], v[36:39], v[200:203]
    buffer_load_dwordx4 a[92:95], v3, s[52:55], s81 offen offset:3072 sc1
    s_add_u32 s80, s80, 524288
    v_mfma_f32_16x16x32_bf16 v[204:207], a[124:127], v[36:39], v[204:207]
    ds_read_b64_tr_b16 v[60:61], v7 offset:61440
    s_and_b32 s80, s80, 4194303
    v_mfma_f32_16x16x32_bf16 v[204:207], a[108:111], v[32:35], v[204:207]
    s_waitcnt lgkmcnt(7)
    v_mfma_f32_16x16x32_bf16 v[208:211], a[96:99], v[40:43], v[208:211]
    ds_read_b64_tr_b16 v[62:63], v7 offset:63488
    v_mfma_f32_16x16x32_bf16 v[208:211], a[112:115], v[44:47], v[208:211]
    v_mfma_f32_16x16x32_bf16 v[212:215], a[116:119], v[44:47], v[212:215]
    s_waitcnt vmcnt(24)
    s_barrier
    v_mfma_f32_16x16x32_bf16 v[212:215], a[100:103], v[40:43], v[212:215]
    ds_read_b64_tr_b16 v[32:33], v4 offset:0
    v_mfma_f32_16x16x32_bf16 v[216:219], a[104:107], v[40:43], v[216:219]
    ds_read_b64_tr_b16 v[34:35], v4 offset:2048
    v_mfma_f32_16x16x32_bf16 v[216:219], a[120:123], v[44:47], v[216:219]
    buffer_load_dwordx4 v8, s[24:27], s80 offen lds
    s_add_u32 m0, s78, 36864
    v_mfma_f32_16x16x32_bf16 v[220:223], a[124:127], v[44:47], v[220:223]
    ds_read_b64_tr_b16 v[36:37], v4 offset:8192
    v_mfma_f32_16x16x32_bf16 v[220:223], a[108:111], v[40:43], v[220:223]
    s_waitcnt lgkmcnt(7)
    v_mfma_f32_16x16x32_bf16 v[224:227], a[96:99], v[48:51], v[224:227]
    ds_read_b64_tr_b16 v[38:39], v4 offset:10240
    v_mfma_f32_16x16x32_bf16 v[224:227], a[112:115], v[52:55], v[224:227]
    buffer_load_dwordx4 v9, s[24:27], s80 offen lds
    s_add_u32 m0, s78, 40960
    v_mfma_f32_16x16x32_bf16 v[228:231], a[116:119], v[52:55], v[228:231]
    ds_read_b64_tr_b16 v[40:41], v5 offset:0
    v_mfma_f32_16x16x32_bf16 v[228:231], a[100:103], v[48:51], v[228:231]
    v_mfma_f32_16x16x32_bf16 v[232:235], a[104:107], v[48:51], v[232:235]
    ds_read_b64_tr_b16 v[42:43], v5 offset:2048
    v_mfma_f32_16x16x32_bf16 v[232:235], a[120:123], v[52:55], v[232:235]
    buffer_load_dwordx4 v10, s[24:27], s80 offen lds
    s_add_u32 m0, s78, 45056
    v_mfma_f32_16x16x32_bf16 v[236:239], a[124:127], v[52:55], v[236:239]
    ds_read_b64_tr_b16 v[44:45], v5 offset:8192
    v_mfma_f32_16x16x32_bf16 v[236:239], a[108:111], v[48:51], v[236:239]
    s_waitcnt lgkmcnt(7)
    v_mfma_f32_16x16x32_bf16 v[240:243], a[96:99], v[56:59], v[240:243]
    ds_read_b64_tr_b16 v[46:47], v5 offset:10240
    v_mfma_f32_16x16x32_bf16 v[240:243], a[112:115], v[60:63], v[240:243]
    buffer_load_dwordx4 v11, s[24:27], s80 offen lds
    s_add_u32 m0, s78, 49152
    v_mfma_f32_16x16x32_bf16 v[244:247], a[116:119], v[60:63], v[244:247]
    ds_read_b64_tr_b16 v[48:49], v6 offset:0
    v_mfma_f32_16x16x32_bf16 v[244:247], a[100:103], v[56:59], v[244:247]
    v_mfma_f32_16x16x32_bf16 v[248:251], a[104:107], v[56:59], v[248:251]
    ds_read_b64_tr_b16 v[50:51], v6 offset:2048
    v_mfma_f32_16x16x32_bf16 v[248:251], a[120:123], v[60:63], v[248:251]
    buffer_store_dwordx4 v[92:95], v3, s[52:55], s74 offen offset:3072 sc1
    v_mfma_f32_16x16x32_bf16 v[252:255], a[124:127], v[60:63], v[252:255]
    ds_read_b64_tr_b16 v[52:53], v6 offset:8192
    v_mfma_f32_16x16x32_bf16 v[252:255], a[108:111], v[56:59], v[252:255]
    s_waitcnt lgkmcnt(7)
    v_mfma_f32_16x16x32_bf16 v[128:131], a[128:131], v[32:35], v[128:131]
    ds_read_b64_tr_b16 v[54:55], v6 offset:10240
    v_mfma_f32_16x16x32_bf16 v[128:131], a[144:147], v[36:39], v[128:131]
    v_mfma_f32_16x16x32_bf16 v[132:135], a[148:151], v[36:39], v[132:135]
    ds_read_b64_tr_b16 v[56:57], v7 offset:0
    v_mfma_f32_16x16x32_bf16 v[132:135], a[132:135], v[32:35], v[132:135]
    v_mfma_f32_16x16x32_bf16 v[136:139], a[136:139], v[32:35], v[136:139]
    ds_read_b64_tr_b16 v[58:59], v7 offset:2048
    v_mfma_f32_16x16x32_bf16 v[136:139], a[152:155], v[36:39], v[136:139]
    v_mfma_f32_16x16x32_bf16 v[140:143], a[156:159], v[36:39], v[140:143]
    ds_read_b64_tr_b16 v[60:61], v7 offset:8192
    s_add_u32 s81, s81, 4096
    v_mfma_f32_16x16x32_bf16 v[140:143], a[140:143], v[32:35], v[140:143]
    s_waitcnt lgkmcnt(7)
    v_mfma_f32_16x16x32_bf16 v[144:147], a[128:131], v[40:43], v[144:147]
    ds_read_b64_tr_b16 v[62:63], v7 offset:10240
    v_mfma_f32_16x16x32_bf16 v[144:147], a[144:147], v[44:47], v[144:147]
    buffer_load_dwordx4 a[96:99], v3, s[52:55], s81 offen offset:0 sc1
    v_mfma_f32_16x16x32_bf16 v[148:151], a[148:151], v[44:47], v[148:151]
    ds_read_b64_tr_b16 v[32:33], v4 offset:4096
    v_mfma_f32_16x16x32_bf16 v[148:151], a[132:135], v[40:43], v[148:151]
    v_mfma_f32_16x16x32_bf16 v[152:155], a[136:139], v[40:43], v[152:155]
    ds_read_b64_tr_b16 v[34:35], v4 offset:6144
    v_mfma_f32_16x16x32_bf16 v[152:155], a[152:155], v[44:47], v[152:155]
    buffer_load_dwordx4 a[100:103], v3, s[52:55], s81 offen offset:1024 sc1
    v_mfma_f32_16x16x32_bf16 v[156:159], a[156:159], v[44:47], v[156:159]
    ds_read_b64_tr_b16 v[36:37], v4 offset:12288
    v_mfma_f32_16x16x32_bf16 v[156:159], a[140:143], v[40:43], v[156:159]
    s_waitcnt lgkmcnt(7)
    v_mfma_f32_16x16x32_bf16 v[160:163], a[128:131], v[48:51], v[160:163]
    ds_read_b64_tr_b16 v[38:39], v4 offset:14336
    v_mfma_f32_16x16x32_bf16 v[160:163], a[144:147], v[52:55], v[160:163]
    buffer_load_dwordx4 a[104:107], v3, s[52:55], s81 offen offset:2048 sc1
    v_mfma_f32_16x16x32_bf16 v[164:167], a[148:151], v[52:55], v[164:167]
    ds_read_b64_tr_b16 v[40:41], v5 offset:4096
    v_mfma_f32_16x16x32_bf16 v[164:167], a[132:135], v[48:51], v[164:167]
    v_mfma_f32_16x16x32_bf16 v[168:171], a[136:139], v[48:51], v[168:171]
    ds_read_b64_tr_b16 v[42:43], v5 offset:6144
    v_mfma_f32_16x16x32_bf16 v[168:171], a[152:155], v[52:55], v[168:171]
    buffer_load_dwordx4 a[108:111], v3, s[52:55], s81 offen offset:3072 sc1
    v_mfma_f32_16x16x32_bf16 v[172:175], a[156:159], v[52:55], v[172:175]
    ds_read_b64_tr_b16 v[44:45], v5 offset:12288
    s_add_u32 s81, s81, 4096
    v_mfma_f32_16x16x32_bf16 v[172:175], a[140:143], v[48:51], v[172:175]
    s_waitcnt lgkmcnt(7)
    v_mfma_f32_16x16x32_bf16 v[176:179], a[128:131], v[56:59], v[176:179]
    ds_read_b64_tr_b16 v[46:47], v5 offset:14336
    s_add_u32 s74, s83, 33562624
    v_mfma_f32_16x16x32_bf16 v[176:179], a[144:147], v[60:63], v[176:179]
    buffer_load_dwordx4 a[112:115], v3, s[52:55], s81 offen offset:0 sc1
    v_mfma_f32_16x16x32_bf16 v[180:183], a[148:151], v[60:63], v[180:183]
    ds_read_b64_tr_b16 v[48:49], v6 offset:4096
    v_mfma_f32_16x16x32_bf16 v[180:183], a[132:135], v[56:59], v[180:183]
    v_mfma_f32_16x16x32_bf16 v[184:187], a[136:139], v[56:59], v[184:187]
    ds_read_b64_tr_b16 v[50:51], v6 offset:6144
    v_mfma_f32_16x16x32_bf16 v[184:187], a[152:155], v[60:63], v[184:187]
    buffer_load_dwordx4 a[116:119], v3, s[52:55], s81 offen offset:1024 sc1
    v_mfma_f32_16x16x32_bf16 v[188:191], a[156:159], v[60:63], v[188:191]
    ds_read_b64_tr_b16 v[52:53], v6 offset:12288
    v_mfma_f32_16x16x32_bf16 v[188:191], a[140:143], v[56:59], v[188:191]
    s_waitcnt lgkmcnt(7)
    buffer_store_dwordx4 v[96:99], v3, s[52:55], s74 offen offset:0 sc1
    v_mfma_f32_16x16x32_bf16 v[192:195], a[128:131], v[32:35], v[192:195]
    ds_read_b64_tr_b16 v[54:55], v6 offset:14336
    v_mfma_f32_16x16x32_bf16 v[192:195], a[144:147], v[36:39], v[192:195]
    buffer_load_dwordx4 a[120:123], v3, s[52:55], s81 offen offset:2048 sc1
    v_mfma_f32_16x16x32_bf16 v[196:199], a[148:151], v[36:39], v[196:199]
    ds_read_b64_tr_b16 v[56:57], v7 offset:4096
    v_mfma_f32_16x16x32_bf16 v[196:199], a[132:135], v[32:35], v[196:199]
    v_mfma_f32_16x16x32_bf16 v[200:203], a[136:139], v[32:35], v[200:203]
    ds_read_b64_tr_b16 v[58:59], v7 offset:6144
    v_mfma_f32_16x16x32_bf16 v[200:203], a[152:155], v[36:39], v[200:203]
    buffer_load_dwordx4 a[124:127], v3, s[52:55], s81 offen offset:3072 sc1
    s_add_u32 s80, s80, 524288
    v_mfma_f32_16x16x32_bf16 v[204:207], a[156:159], v[36:39], v[204:207]
    ds_read_b64_tr_b16 v[60:61], v7 offset:12288
    s_and_b32 s80, s80, 4194303
    v_mfma_f32_16x16x32_bf16 v[204:207], a[140:143], v[32:35], v[204:207]
    s_waitcnt lgkmcnt(7)
    v_mfma_f32_16x16x32_bf16 v[208:211], a[128:131], v[40:43], v[208:211]
    ds_read_b64_tr_b16 v[62:63], v7 offset:14336
    v_mfma_f32_16x16x32_bf16 v[208:211], a[144:147], v[44:47], v[208:211]
    v_mfma_f32_16x16x32_bf16 v[212:215], a[148:151], v[44:47], v[212:215]
    s_waitcnt vmcnt(24)
    s_barrier
    v_mfma_f32_16x16x32_bf16 v[212:215], a[132:135], v[40:43], v[212:215]
    ds_read_b64_tr_b16 v[32:33], v4 offset:16384
    v_mfma_f32_16x16x32_bf16 v[216:219], a[136:139], v[40:43], v[216:219]
    ds_read_b64_tr_b16 v[34:35], v4 offset:18432
    v_mfma_f32_16x16x32_bf16 v[216:219], a[152:155], v[44:47], v[216:219]
    buffer_load_dwordx4 v8, s[24:27], s80 offen lds
    s_add_u32 m0, s78, 53248
    v_mfma_f32_16x16x32_bf16 v[220:223], a[156:159], v[44:47], v[220:223]
    ds_read_b64_tr_b16 v[36:37], v4 offset:24576
    v_mfma_f32_16x16x32_bf16 v[220:223], a[140:143], v[40:43], v[220:223]
    s_waitcnt lgkmcnt(7)
    v_mfma_f32_16x16x32_bf16 v[224:227], a[128:131], v[48:51], v[224:227]
    ds_read_b64_tr_b16 v[38:39], v4 offset:26624
    v_mfma_f32_16x16x32_bf16 v[224:227], a[144:147], v[52:55], v[224:227]
    buffer_load_dwordx4 v9, s[24:27], s80 offen lds
    s_add_u32 m0, s78, 57344
    v_mfma_f32_16x16x32_bf16 v[228:231], a[148:151], v[52:55], v[228:231]
    ds_read_b64_tr_b16 v[40:41], v5 offset:16384
    v_mfma_f32_16x16x32_bf16 v[228:231], a[132:135], v[48:51], v[228:231]
    v_mfma_f32_16x16x32_bf16 v[232:235], a[136:139], v[48:51], v[232:235]
    ds_read_b64_tr_b16 v[42:43], v5 offset:18432
    v_mfma_f32_16x16x32_bf16 v[232:235], a[152:155], v[52:55], v[232:235]
    buffer_load_dwordx4 v10, s[24:27], s80 offen lds
    s_add_u32 m0, s78, 61440
    v_mfma_f32_16x16x32_bf16 v[236:239], a[156:159], v[52:55], v[236:239]
    ds_read_b64_tr_b16 v[44:45], v5 offset:24576
    v_mfma_f32_16x16x32_bf16 v[236:239], a[140:143], v[48:51], v[236:239]
    s_waitcnt lgkmcnt(7)
    v_mfma_f32_16x16x32_bf16 v[240:243], a[128:131], v[56:59], v[240:243]
    ds_read_b64_tr_b16 v[46:47], v5 offset:26624
    v_mfma_f32_16x16x32_bf16 v[240:243], a[144:147], v[60:63], v[240:243]
    buffer_load_dwordx4 v11, s[24:27], s80 offen lds
    s_add_u32 m0, s78, 0
    v_mfma_f32_16x16x32_bf16 v[244:247], a[148:151], v[60:63], v[244:247]
    ds_read_b64_tr_b16 v[48:49], v6 offset:16384
    v_mfma_f32_16x16x32_bf16 v[244:247], a[132:135], v[56:59], v[244:247]
    buffer_store_dwordx4 v[100:103], v3, s[52:55], s74 offen offset:1024 sc1
    v_mfma_f32_16x16x32_bf16 v[248:251], a[136:139], v[56:59], v[248:251]
    ds_read_b64_tr_b16 v[50:51], v6 offset:18432
    v_mfma_f32_16x16x32_bf16 v[248:251], a[152:155], v[60:63], v[248:251]
    v_mfma_f32_16x16x32_bf16 v[252:255], a[156:159], v[60:63], v[252:255]
    ds_read_b64_tr_b16 v[52:53], v6 offset:24576
    v_mfma_f32_16x16x32_bf16 v[252:255], a[140:143], v[56:59], v[252:255]
    s_waitcnt lgkmcnt(7)
    v_mfma_f32_16x16x32_bf16 v[128:131], a[160:163], v[32:35], v[128:131]
    ds_read_b64_tr_b16 v[54:55], v6 offset:26624
    v_mfma_f32_16x16x32_bf16 v[128:131], a[176:179], v[36:39], v[128:131]
    v_mfma_f32_16x16x32_bf16 v[132:135], a[180:183], v[36:39], v[132:135]
    ds_read_b64_tr_b16 v[56:57], v7 offset:16384
    s_add_u32 s81, s48, 2
    v_mfma_f32_16x16x32_bf16 v[132:135], a[164:167], v[32:35], v[132:135]
    s_and_b32 s81, s81, 3
    s_lshl_b32 s81, s81, 14
    s_add_u32 s81, s81, s84
    v_mfma_f32_16x16x32_bf16 v[136:139], a[168:171], v[32:35], v[136:139]
    ds_read_b64_tr_b16 v[58:59], v7 offset:18432
    v_mfma_f32_16x16x32_bf16 v[136:139], a[184:187], v[36:39], v[136:139]
    v_mfma_f32_16x16x32_bf16 v[140:143], a[188:191], v[36:39], v[140:143]
    ds_read_b64_tr_b16 v[60:61], v7 offset:24576
    v_mfma_f32_16x16x32_bf16 v[140:143], a[172:175], v[32:35], v[140:143]
    s_waitcnt lgkmcnt(7)
    v_mfma_f32_16x16x32_bf16 v[144:147], a[160:163], v[40:43], v[144:147]
    ds_read_b64_tr_b16 v[62:63], v7 offset:26624
    v_mfma_f32_16x16x32_bf16 v[144:147], a[176:179], v[44:47], v[144:147]
    buffer_load_dwordx4 a[128:131], v3, s[52:55], s81 offen offset:0 sc1
    v_mfma_f32_16x16x32_bf16 v[148:151], a[180:183], v[44:47], v[148:151]
    ds_read_b64_tr_b16 v[32:33], v4 offset:20480
    v_mfma_f32_16x16x32_bf16 v[148:151], a[164:167], v[40:43], v[148:151]
    v_mfma_f32_16x16x32_bf16 v[152:155], a[168:171], v[40:43], v[152:155]
    ds_read_b64_tr_b16 v[34:35], v4 offset:22528
    v_mfma_f32_16x16x32_bf16 v[152:155], a[184:187], v[44:47], v[152:155]
    buffer_load_dwordx4 a[132:135], v3, s[52:55], s81 offen offset:1024 sc1
    v_mfma_f32_16x16x32_bf16 v[156:159], a[188:191], v[44:47], v[156:159]
    ds_read_b64_tr_b16 v[36:37], v4 offset:28672
    v_mfma_f32_16x16x32_bf16 v[156:159], a[172:175], v[40:43], v[156:159]
    s_waitcnt lgkmcnt(7)
    v_mfma_f32_16x16x32_bf16 v[160:163], a[160:163], v[48:51], v[160:163]
    ds_read_b64_tr_b16 v[38:39], v4 offset:30720
    v_mfma_f32_16x16x32_bf16 v[160:163], a[176:179], v[52:55], v[160:163]
    buffer_load_dwordx4 a[136:139], v3, s[52:55], s81 offen offset:2048 sc1
    v_mfma_f32_16x16x32_bf16 v[164:167], a[180:183], v[52:55], v[164:167]
    ds_read_b64_tr_b16 v[40:41], v5 offset:20480
    v_mfma_f32_16x16x32_bf16 v[164:167], a[164:167], v[48:51], v[164:167]
    v_mfma_f32_16x16x32_bf16 v[168:171], a[168:171], v[48:51], v[168:171]
    ds_read_b64_tr_b16 v[42:43], v5 offset:22528
    v_mfma_f32_16x16x32_bf16 v[168:171], a[184:187], v[52:55], v[168:171]
    buffer_load_dwordx4 a[140:143], v3, s[52:55], s81 offen offset:3072 sc1
    v_mfma_f32_16x16x32_bf16 v[172:175], a[188:191], v[52:55], v[172:175]
    ds_read_b64_tr_b16 v[44:45], v5 offset:28672
    s_add_u32 s81, s81, 4096
    v_mfma_f32_16x16x32_bf16 v[172:175], a[172:175], v[48:51], v[172:175]
    s_waitcnt lgkmcnt(7)
    v_mfma_f32_16x16x32_bf16 v[176:179], a[160:163], v[56:59], v[176:179]
    ds_read_b64_tr_b16 v[46:47], v5 offset:30720
    v_mfma_f32_16x16x32_bf16 v[176:179], a[176:179], v[60:63], v[176:179]
    buffer_load_dwordx4 a[144:147], v3, s[52:55], s81 offen offset:0 sc1
    v_mfma_f32_16x16x32_bf16 v[180:183], a[180:183], v[60:63], v[180:183]
    ds_read_b64_tr_b16 v[48:49], v6 offset:20480
    v_mfma_f32_16x16x32_bf16 v[180:183], a[164:167], v[56:59], v[180:183]
    buffer_store_dwordx4 v[104:107], v3, s[52:55], s74 offen offset:2048 sc1
    v_mfma_f32_16x16x32_bf16 v[184:187], a[168:171], v[56:59], v[184:187]
    ds_read_b64_tr_b16 v[50:51], v6 offset:22528
    v_mfma_f32_16x16x32_bf16 v[184:187], a[184:187], v[60:63], v[184:187]
    buffer_load_dwordx4 a[148:151], v3, s[52:55], s81 offen offset:1024 sc1
    v_mfma_f32_16x16x32_bf16 v[188:191], a[188:191], v[60:63], v[188:191]
    ds_read_b64_tr_b16 v[52:53], v6 offset:28672
    v_mfma_f32_16x16x32_bf16 v[188:191], a[172:175], v[56:59], v[188:191]
    s_waitcnt lgkmcnt(7)
    v_mfma_f32_16x16x32_bf16 v[192:195], a[160:163], v[32:35], v[192:195]
    ds_read_b64_tr_b16 v[54:55], v6 offset:30720
    v_mfma_f32_16x16x32_bf16 v[192:195], a[176:179], v[36:39], v[192:195]
    buffer_load_dwordx4 a[152:155], v3, s[52:55], s81 offen offset:2048 sc1
    v_mfma_f32_16x16x32_bf16 v[196:199], a[180:183], v[36:39], v[196:199]
    ds_read_b64_tr_b16 v[56:57], v7 offset:20480
    v_mfma_f32_16x16x32_bf16 v[196:199], a[164:167], v[32:35], v[196:199]
    v_mfma_f32_16x16x32_bf16 v[200:203], a[168:171], v[32:35], v[200:203]
    ds_read_b64_tr_b16 v[58:59], v7 offset:22528
    v_mfma_f32_16x16x32_bf16 v[200:203], a[184:187], v[36:39], v[200:203]
    buffer_load_dwordx4 a[156:159], v3, s[52:55], s81 offen offset:3072 sc1
    v_mfma_f32_16x16x32_bf16 v[204:207], a[188:191], v[36:39], v[204:207]
    ds_read_b64_tr_b16 v[60:61], v7 offset:28672
    v_mfma_f32_16x16x32_bf16 v[204:207], a[172:175], v[32:35], v[204:207]
    s_waitcnt lgkmcnt(7)
    v_mfma_f32_16x16x32_bf16 v[208:211], a[160:163], v[40:43], v[208:211]
    ds_read_b64_tr_b16 v[62:63], v7 offset:30720
    v_mfma_f32_16x16x32_bf16 v[208:211], a[176:179], v[44:47], v[208:211]
    v_mfma_f32_16x16x32_bf16 v[212:215], a[180:183], v[44:47], v[212:215]
    s_waitcnt vmcnt(24)
    s_barrier
    v_mfma_f32_16x16x32_bf16 v[212:215], a[164:167], v[40:43], v[212:215]
    ds_read_b64_tr_b16 v[32:33], v4 offset:32768
    v_mfma_f32_16x16x32_bf16 v[216:219], a[168:171], v[40:43], v[216:219]
    ds_read_b64_tr_b16 v[34:35], v4 offset:34816
    v_mfma_f32_16x16x32_bf16 v[216:219], a[184:187], v[44:47], v[216:219]
    v_mfma_f32_16x16x32_bf16 v[220:223], a[188:191], v[44:47], v[220:223]
    ds_read_b64_tr_b16 v[36:37], v4 offset:40960
    v_mfma_f32_16x16x32_bf16 v[220:223], a[172:175], v[40:43], v[220:223]
    s_waitcnt lgkmcnt(7)
    v_mfma_f32_16x16x32_bf16 v[224:227], a[160:163], v[48:51], v[224:227]
    ds_read_b64_tr_b16 v[38:39], v4 offset:43008
    v_mfma_f32_16x16x32_bf16 v[224:227], a[176:179], v[52:55], v[224:227]
    v_mfma_f32_16x16x32_bf16 v[228:231], a[180:183], v[52:55], v[228:231]
    ds_read_b64_tr_b16 v[40:41], v5 offset:32768
    v_mfma_f32_16x16x32_bf16 v[228:231], a[164:167], v[48:51], v[228:231]
    v_mfma_f32_16x16x32_bf16 v[232:235], a[168:171], v[48:51], v[232:235]
    ds_read_b64_tr_b16 v[42:43], v5 offset:34816
    v_mfma_f32_16x16x32_bf16 v[232:235], a[184:187], v[52:55], v[232:235]
    v_mfma_f32_16x16x32_bf16 v[236:239], a[188:191], v[52:55], v[236:239]
    ds_read_b64_tr_b16 v[44:45], v5 offset:40960
    v_mfma_f32_16x16x32_bf16 v[236:239], a[172:175], v[48:51], v[236:239]
    s_waitcnt lgkmcnt(7)
    v_mfma_f32_16x16x32_bf16 v[240:243], a[160:163], v[56:59], v[240:243]
    ds_read_b64_tr_b16 v[46:47], v5 offset:43008
    v_mfma_f32_16x16x32_bf16 v[240:243], a[176:179], v[60:63], v[240:243]
    buffer_store_dwordx4 v[108:111], v3, s[52:55], s74 offen offset:3072 sc1
    v_mfma_f32_16x16x32_bf16 v[244:247], a[180:183], v[60:63], v[244:247]
    ds_read_b64_tr_b16 v[48:49], v6 offset:32768
    v_mfma_f32_16x16x32_bf16 v[244:247], a[164:167], v[56:59], v[244:247]
    v_mfma_f32_16x16x32_bf16 v[248:251], a[168:171], v[56:59], v[248:251]
    ds_read_b64_tr_b16 v[50:51], v6 offset:34816
    v_mfma_f32_16x16x32_bf16 v[248:251], a[184:187], v[60:63], v[248:251]
    v_mfma_f32_16x16x32_bf16 v[252:255], a[188:191], v[60:63], v[252:255]
    ds_read_b64_tr_b16 v[52:53], v6 offset:40960
    v_mfma_f32_16x16x32_bf16 v[252:255], a[172:175], v[56:59], v[252:255]
    s_waitcnt lgkmcnt(7)
    v_mfma_f32_16x16x32_bf16 v[128:131], a[192:195], v[32:35], v[128:131]
    ds_read_b64_tr_b16 v[54:55], v6 offset:43008
    v_mfma_f32_16x16x32_bf16 v[128:131], a[208:211], v[36:39], v[128:131]
    v_mfma_f32_16x16x32_bf16 v[132:135], a[212:215], v[36:39], v[132:135]
    ds_read_b64_tr_b16 v[56:57], v7 offset:32768
    v_mfma_f32_16x16x32_bf16 v[132:135], a[196:199], v[32:35], v[132:135]
    v_mfma_f32_16x16x32_bf16 v[136:139], a[200:203], v[32:35], v[136:139]
    ds_read_b64_tr_b16 v[58:59], v7 offset:34816
    v_mfma_f32_16x16x32_bf16 v[136:139], a[216:219], v[36:39], v[136:139]
    v_mfma_f32_16x16x32_bf16 v[140:143], a[220:223], v[36:39], v[140:143]
    ds_read_b64_tr_b16 v[60:61], v7 offset:40960
    s_add_u32 s81, s81, 4096
    v_mfma_f32_16x16x32_bf16 v[140:143], a[204:207], v[32:35], v[140:143]
    s_waitcnt lgkmcnt(7)
    v_mfma_f32_16x16x32_bf16 v[144:147], a[192:195], v[40:43], v[144:147]
    ds_read_b64_tr_b16 v[62:63], v7 offset:43008
    v_mfma_f32_16x16x32_bf16 v[144:147], a[208:211], v[44:47], v[144:147]
    buffer_load_dwordx4 a[160:163], v3, s[52:55], s81 offen offset:0 sc1
    v_mfma_f32_16x16x32_bf16 v[148:151], a[212:215], v[44:47], v[148:151]
    ds_read_b64_tr_b16 v[32:33], v4 offset:36864
    v_mfma_f32_16x16x32_bf16 v[148:151], a[196:199], v[40:43], v[148:151]
    v_mfma_f32_16x16x32_bf16 v[152:155], a[200:203], v[40:43], v[152:155]
    ds_read_b64_tr_b16 v[34:35], v4 offset:38912
    v_mfma_f32_16x16x32_bf16 v[152:155], a[216:219], v[44:47], v[152:155]
    buffer_load_dwordx4 a[164:167], v3, s[52:55], s81 offen offset:1024 sc1
    v_mfma_f32_16x16x32_bf16 v[156:159], a[220:223], v[44:47], v[156:159]
    ds_read_b64_tr_b16 v[36:37], v4 offset:45056
    v_mfma_f32_16x16x32_bf16 v[156:159], a[204:207], v[40:43], v[156:159]
    s_waitcnt lgkmcnt(7)
    v_mfma_f32_16x16x32_bf16 v[160:163], a[192:195], v[48:51], v[160:163]
    ds_read_b64_tr_b16 v[38:39], v4 offset:47104
    v_mfma_f32_16x16x32_bf16 v[160:163], a[208:211], v[52:55], v[160:163]
    buffer_load_dwordx4 a[168:171], v3, s[52:55], s81 offen offset:2048 sc1
    v_mfma_f32_16x16x32_bf16 v[164:167], a[212:215], v[52:55], v[164:167]
    ds_read_b64_tr_b16 v[40:41], v5 offset:36864
    v_mfma_f32_16x16x32_bf16 v[164:167], a[196:199], v[48:51], v[164:167]
    v_mfma_f32_16x16x32_bf16 v[168:171], a[200:203], v[48:51], v[168:171]
    ds_read_b64_tr_b16 v[42:43], v5 offset:38912
    s_add_u32 s74, s83, 33566720
    v_mfma_f32_16x16x32_bf16 v[168:171], a[216:219], v[52:55], v[168:171]
    buffer_load_dwordx4 a[172:175], v3, s[52:55], s81 offen offset:3072 sc1
    v_mfma_f32_16x16x32_bf16 v[172:175], a[220:223], v[52:55], v[172:175]
    ds_read_b64_tr_b16 v[44:45], v5 offset:45056
    s_add_u32 s81, s81, 4096
    v_mfma_f32_16x16x32_bf16 v[172:175], a[204:207], v[48:51], v[172:175]
    s_waitcnt lgkmcnt(7)
    v_mfma_f32_16x16x32_bf16 v[176:179], a[192:195], v[56:59], v[176:179]
    ds_read_b64_tr_b16 v[46:47], v5 offset:47104
    v_mfma_f32_16x16x32_bf16 v[176:179], a[208:211], v[60:63], v[176:179]
    buffer_load_dwordx4 a[176:179], v3, s[52:55], s81 offen offset:0 sc1
    v_mfma_f32_16x16x32_bf16 v[180:183], a[212:215], v[60:63], v[180:183]
    ds_read_b64_tr_b16 v[48:49], v6 offset:36864
    v_mfma_f32_16x16x32_bf16 v[180:183], a[196:199], v[56:59], v[180:183]
    buffer_store_dwordx4 v[112:115], v3, s[52:55], s74 offen offset:0 sc1
    v_mfma_f32_16x16x32_bf16 v[184:187], a[200:203], v[56:59], v[184:187]
    ds_read_b64_tr_b16 v[50:51], v6 offset:38912
    v_mfma_f32_16x16x32_bf16 v[184:187], a[216:219], v[60:63], v[184:187]
    buffer_load_dwordx4 a[180:183], v3, s[52:55], s81 offen offset:1024 sc1
    v_mfma_f32_16x16x32_bf16 v[188:191], a[220:223], v[60:63], v[188:191]
    ds_read_b64_tr_b16 v[52:53], v6 offset:45056
    v_mfma_f32_16x16x32_bf16 v[188:191], a[204:207], v[56:59], v[188:191]
    s_waitcnt lgkmcnt(7)
    v_mfma_f32_16x16x32_bf16 v[192:195], a[192:195], v[32:35], v[192:195]
    ds_read_b64_tr_b16 v[54:55], v6 offset:47104
    v_mfma_f32_16x16x32_bf16 v[192:195], a[208:211], v[36:39], v[192:195]
    buffer_load_dwordx4 a[184:187], v3, s[52:55], s81 offen offset:2048 sc1
    v_mfma_f32_16x16x32_bf16 v[196:199], a[212:215], v[36:39], v[196:199]
    ds_read_b64_tr_b16 v[56:57], v7 offset:36864
    v_mfma_f32_16x16x32_bf16 v[196:199], a[196:199], v[32:35], v[196:199]
    v_mfma_f32_16x16x32_bf16 v[200:203], a[200:203], v[32:35], v[200:203]
    ds_read_b64_tr_b16 v[58:59], v7 offset:38912
    v_mfma_f32_16x16x32_bf16 v[200:203], a[216:219], v[36:39], v[200:203]
    buffer_load_dwordx4 a[188:191], v3, s[52:55], s81 offen offset:3072 sc1
    s_add_u32 s73, s48, 2
    v_mfma_f32_16x16x32_bf16 v[204:207], a[220:223], v[36:39], v[204:207]
    ds_read_b64_tr_b16 v[60:61], v7 offset:45056
    s_and_b32 s73, s73, 3
    v_mfma_f32_16x16x32_bf16 v[204:207], a[204:207], v[32:35], v[204:207]
    s_waitcnt lgkmcnt(7)
    s_mul_i32 s73, s73, 458752
    s_lshl_b32 s77, s7, 7
    v_mfma_f32_16x16x32_bf16 v[208:211], a[192:195], v[40:43], v[208:211]
    ds_read_b64_tr_b16 v[62:63], v7 offset:47104
    s_add_u32 s73, s73, s77
    v_mfma_f32_16x16x32_bf16 v[208:211], a[208:211], v[44:47], v[208:211]
    v_mfma_f32_16x16x32_bf16 v[212:215], a[212:215], v[44:47], v[212:215]
    s_waitcnt vmcnt(20)
    s_barrier
    v_mfma_f32_16x16x32_bf16 v[212:215], a[196:199], v[40:43], v[212:215]
    ds_read_b64_tr_b16 v[32:33], v4 offset:49152
    v_mfma_f32_16x16x32_bf16 v[216:219], a[200:203], v[40:43], v[216:219]
    ds_read_b64_tr_b16 v[34:35], v4 offset:51200
    v_mfma_f32_16x16x32_bf16 v[216:219], a[216:219], v[44:47], v[216:219]
    buffer_load_dwordx4 v31, s[32:35], s73 offen lds
    s_add_u32 m0, s78, 4096
    v_mfma_f32_16x16x32_bf16 v[220:223], a[220:223], v[44:47], v[220:223]
    ds_read_b64_tr_b16 v[36:37], v4 offset:57344
    v_mfma_f32_16x16x32_bf16 v[220:223], a[204:207], v[40:43], v[220:223]
    s_waitcnt lgkmcnt(7)
    buffer_load_dwordx4 v31, s[36:39], s73 offen lds
    s_add_u32 m0, s78, 8192
    v_mfma_f32_16x16x32_bf16 v[224:227], a[192:195], v[48:51], v[224:227]
    ds_read_b64_tr_b16 v[38:39], v4 offset:59392
    s_add_u32 s73, s73, 114688
    v_mfma_f32_16x16x32_bf16 v[224:227], a[208:211], v[52:55], v[224:227]
    v_mfma_f32_16x16x32_bf16 v[228:231], a[212:215], v[52:55], v[228:231]
    ds_read_b64_tr_b16 v[40:41], v5 offset:49152
    v_mfma_f32_16x16x32_bf16 v[228:231], a[196:199], v[48:51], v[228:231]
    buffer_load_dwordx4 v31, s[32:35], s73 offen lds
    s_add_u32 m0, s78, 12288
    v_mfma_f32_16x16x32_bf16 v[232:235], a[200:203], v[48:51], v[232:235]
    ds_read_b64_tr_b16 v[42:43], v5 offset:51200
    v_mfma_f32_16x16x32_bf16 v[232:235], a[216:219], v[52:55], v[232:235]
    buffer_load_dwordx4 v31, s[36:39], s73 offen lds
    s_add_u32 m0, s78, 16384
    v_mfma_f32_16x16x32_bf16 v[236:239], a[220:223], v[52:55], v[236:239]
    ds_read_b64_tr_b16 v[44:45], v5 offset:57344
    s_add_u32 s73, s73, 114688
    v_mfma_f32_16x16x32_bf16 v[236:239], a[204:207], v[48:51], v[236:239]
    s_waitcnt lgkmcnt(7)
    buffer_store_dwordx4 v[116:119], v3, s[52:55], s74 offen offset:1024 sc1
    v_mfma_f32_16x16x32_bf16 v[240:243], a[192:195], v[56:59], v[240:243]
    ds_read_b64_tr_b16 v[46:47], v5 offset:59392
    v_mfma_f32_16x16x32_bf16 v[240:243], a[208:211], v[60:63], v[240:243]
    buffer_load_dwordx4 v31, s[32:35], s73 offen lds
    s_add_u32 m0, s78, 20480
    v_mfma_f32_16x16x32_bf16 v[244:247], a[212:215], v[60:63], v[244:247]
    ds_read_b64_tr_b16 v[48:49], v6 offset:49152
    v_mfma_f32_16x16x32_bf16 v[244:247], a[196:199], v[56:59], v[244:247]
    buffer_load_dwordx4 v31, s[36:39], s73 offen lds
    s_add_u32 m0, s78, 24576
    v_mfma_f32_16x16x32_bf16 v[248:251], a[200:203], v[56:59], v[248:251]
    ds_read_b64_tr_b16 v[50:51], v6 offset:51200
    s_add_u32 s73, s73, 114688
    v_mfma_f32_16x16x32_bf16 v[248:251], a[216:219], v[60:63], v[248:251]
    v_mfma_f32_16x16x32_bf16 v[252:255], a[220:223], v[60:63], v[252:255]
    ds_read_b64_tr_b16 v[52:53], v6 offset:57344
    v_mfma_f32_16x16x32_bf16 v[252:255], a[204:207], v[56:59], v[252:255]
    s_waitcnt lgkmcnt(7)
    buffer_load_dwordx4 v31, s[32:35], s73 offen lds
    s_add_u32 m0, s78, 28672
    v_mfma_f32_16x16x32_bf16 v[128:131], a[224:227], v[32:35], v[128:131]
    ds_read_b64_tr_b16 v[54:55], v6 offset:59392
    v_mfma_f32_16x16x32_bf16 v[128:131], a[240:243], v[36:39], v[128:131]
    buffer_load_dwordx4 v31, s[36:39], s73 offen lds
    s_add_u32 m0, s78, 32768
    v_mfma_f32_16x16x32_bf16 v[132:135], a[244:247], v[36:39], v[132:135]
    ds_read_b64_tr_b16 v[56:57], v7 offset:49152
    s_add_u32 s81, s48, 3
    v_mfma_f32_16x16x32_bf16 v[132:135], a[228:231], v[32:35], v[132:135]
    s_and_b32 s81, s81, 3
    s_lshl_b32 s81, s81, 14
    s_add_u32 s81, s81, s84
    v_mfma_f32_16x16x32_bf16 v[136:139], a[232:235], v[32:35], v[136:139]
    ds_read_b64_tr_b16 v[58:59], v7 offset:51200
    v_mfma_f32_16x16x32_bf16 v[136:139], a[248:251], v[36:39], v[136:139]
    v_mfma_f32_16x16x32_bf16 v[140:143], a[252:255], v[36:39], v[140:143]
    ds_read_b64_tr_b16 v[60:61], v7 offset:57344
    v_mfma_f32_16x16x32_bf16 v[140:143], a[236:239], v[32:35], v[140:143]
    s_waitcnt lgkmcnt(7)
    v_mfma_f32_16x16x32_bf16 v[144:147], a[224:227], v[40:43], v[144:147]
    ds_read_b64_tr_b16 v[62:63], v7 offset:59392
    v_mfma_f32_16x16x32_bf16 v[144:147], a[240:243], v[44:47], v[144:147]
    buffer_load_dwordx4 a[192:195], v3, s[52:55], s81 offen offset:0 sc1
    v_cvt_pk_bf16_f32 v64, v128, v129
    v_mfma_f32_16x16x32_bf16 v[148:151], a[244:247], v[44:47], v[148:151]
    ds_read_b64_tr_b16 v[32:33], v4 offset:53248
    v_cvt_pk_bf16_f32 v65, v130, v131
    v_mfma_f32_16x16x32_bf16 v[148:151], a[228:231], v[40:43], v[148:151]
    v_cvt_pk_bf16_f32 v66, v132, v133
    v_cvt_pk_bf16_f32 v67, v134, v135
    v_mfma_f32_16x16x32_bf16 v[152:155], a[232:235], v[40:43], v[152:155]
    ds_read_b64_tr_b16 v[34:35], v4 offset:55296
    v_mfma_f32_16x16x32_bf16 v[152:155], a[248:251], v[44:47], v[152:155]
    buffer_load_dwordx4 a[196:199], v3, s[52:55], s81 offen offset:1024 sc1
    v_cvt_pk_bf16_f32 v80, v136, v137
    v_mfma_f32_16x16x32_bf16 v[156:159], a[252:255], v[44:47], v[156:159]
    ds_read_b64_tr_b16 v[36:37], v4 offset:61440
    v_cvt_pk_bf16_f32 v81, v138, v139
    v_mfma_f32_16x16x32_bf16 v[156:159], a[236:239], v[40:43], v[156:159]
    s_waitcnt lgkmcnt(7)
    v_cvt_pk_bf16_f32 v82, v140, v141
    v_cvt_pk_bf16_f32 v83, v142, v143
    v_mfma_f32_16x16x32_bf16 v[160:163], a[224:227], v[48:51], v[160:163]
    ds_read_b64_tr_b16 v[38:39], v4 offset:63488
    v_mfma_f32_16x16x32_bf16 v[160:163], a[240:243], v[52:55], v[160:163]
    buffer_load_dwordx4 a[200:203], v3, s[52:55], s81 offen offset:2048 sc1
    v_cvt_pk_bf16_f32 v68, v144, v145
    v_mfma_f32_16x16x32_bf16 v[164:167], a[244:247], v[52:55], v[164:167]
    ds_read_b64_tr_b16 v[40:41], v5 offset:53248
    v_cvt_pk_bf16_f32 v69, v146, v147
    v_mfma_f32_16x16x32_bf16 v[164:167], a[228:231], v[48:51], v[164:167]
    v_cvt_pk_bf16_f32 v70, v148, v149
    v_cvt_pk_bf16_f32 v71, v150, v151
    v_mfma_f32_16x16x32_bf16 v[168:171], a[232:235], v[48:51], v[168:171]
    ds_read_b64_tr_b16 v[42:43], v5 offset:55296
    v_mfma_f32_16x16x32_bf16 v[168:171], a[248:251], v[52:55], v[168:171]
    buffer_load_dwordx4 a[204:207], v3, s[52:55], s81 offen offset:3072 sc1
    v_cvt_pk_bf16_f32 v84, v152, v153
    v_mfma_f32_16x16x32_bf16 v[172:175], a[252:255], v[52:55], v[172:175]
    ds_read_b64_tr_b16 v[44:45], v5 offset:61440
    s_add_u32 s81, s81, 4096
    v_mfma_f32_16x16x32_bf16 v[172:175], a[236:239], v[48:51], v[172:175]
    s_waitcnt lgkmcnt(7)
    v_cvt_pk_bf16_f32 v85, v154, v155
    v_cvt_pk_bf16_f32 v86, v156, v157
    v_mfma_f32_16x16x32_bf16 v[176:179], a[224:227], v[56:59], v[176:179]
    ds_read_b64_tr_b16 v[46:47], v5 offset:63488
    v_cvt_pk_bf16_f32 v87, v158, v159
    v_mfma_f32_16x16x32_bf16 v[176:179], a[240:243], v[60:63], v[176:179]
    buffer_load_dwordx4 a[208:211], v3, s[52:55], s81 offen offset:0 sc1
    v_cvt_pk_bf16_f32 v72, v160, v161
    v_mfma_f32_16x16x32_bf16 v[180:183], a[244:247], v[60:63], v[180:183]
    ds_read_b64_tr_b16 v[48:49], v6 offset:53248
    v_cvt_pk_bf16_f32 v73, v162, v163
    v_mfma_f32_16x16x32_bf16 v[180:183], a[228:231], v[56:59], v[180:183]
    v_cvt_pk_bf16_f32 v74, v164, v165
    v_cvt_pk_bf16_f32 v75, v166, v167
    v_mfma_f32_16x16x32_bf16 v[184:187], a[232:235], v[56:59], v[184:187]
    ds_read_b64_tr_b16 v[50:51], v6 offset:55296
    v_mfma_f32_16x16x32_bf16 v[184:187], a[248:251], v[60:63], v[184:187]
    buffer_load_dwordx4 a[212:215], v3, s[52:55], s81 offen offset:1024 sc1
    v_cvt_pk_bf16_f32 v88, v168, v169
    v_mfma_f32_16x16x32_bf16 v[188:191], a[252:255], v[60:63], v[188:191]
    ds_read_b64_tr_b16 v[52:53], v6 offset:61440
    v_cvt_pk_bf16_f32 v89, v170, v171
    v_mfma_f32_16x16x32_bf16 v[188:191], a[236:239], v[56:59], v[188:191]
    s_waitcnt lgkmcnt(7)
    v_cvt_pk_bf16_f32 v90, v172, v173
    v_cvt_pk_bf16_f32 v91, v174, v175
    v_mfma_f32_16x16x32_bf16 v[192:195], a[224:227], v[32:35], v[192:195]
    ds_read_b64_tr_b16 v[54:55], v6 offset:63488
    v_mfma_f32_16x16x32_bf16 v[192:195], a[240:243], v[36:39], v[192:195]
    buffer_load_dwordx4 a[216:219], v3, s[52:55], s81 offen offset:2048 sc1
    v_cvt_pk_bf16_f32 v76, v176, v177
    v_mfma_f32_16x16x32_bf16 v[196:199], a[244:247], v[36:39], v[196:199]
    ds_read_b64_tr_b16 v[56:57], v7 offset:53248
    v_cvt_pk_bf16_f32 v77, v178, v179
    v_mfma_f32_16x16x32_bf16 v[196:199], a[228:231], v[32:35], v[196:199]
    v_cvt_pk_bf16_f32 v78, v180, v181
    v_cvt_pk_bf16_f32 v79, v182, v183
    v_mfma_f32_16x16x32_bf16 v[200:203], a[232:235], v[32:35], v[200:203]
    ds_read_b64_tr_b16 v[58:59], v7 offset:55296
    v_mfma_f32_16x16x32_bf16 v[200:203], a[248:251], v[36:39], v[200:203]
    buffer_load_dwordx4 a[220:223], v3, s[52:55], s81 offen offset:3072 sc1
    v_cvt_pk_bf16_f32 v92, v184, v185
    v_mfma_f32_16x16x32_bf16 v[204:207], a[252:255], v[36:39], v[204:207]
    ds_read_b64_tr_b16 v[60:61], v7 offset:61440
    v_cvt_pk_bf16_f32 v93, v186, v187
    v_mfma_f32_16x16x32_bf16 v[204:207], a[236:239], v[32:35], v[204:207]
    s_waitcnt lgkmcnt(7)
    v_cvt_pk_bf16_f32 v94, v188, v189
    v_cvt_pk_bf16_f32 v95, v190, v191
    v_mfma_f32_16x16x32_bf16 v[208:211], a[224:227], v[40:43], v[208:211]
    ds_read_b64_tr_b16 v[62:63], v7 offset:63488
    v_mfma_f32_16x16x32_bf16 v[208:211], a[240:243], v[44:47], v[208:211]
    v_mfma_f32_16x16x32_bf16 v[212:215], a[244:247], v[44:47], v[212:215]
    s_barrier
    v_mfma_f32_16x16x32_bf16 v[212:215], a[228:231], v[40:43], v[212:215]
    v_mfma_f32_16x16x32_bf16 v[216:219], a[232:235], v[40:43], v[216:219]
    v_mfma_f32_16x16x32_bf16 v[216:219], a[248:251], v[44:47], v[216:219]
    v_mfma_f32_16x16x32_bf16 v[220:223], a[252:255], v[44:47], v[220:223]
    v_mfma_f32_16x16x32_bf16 v[220:223], a[236:239], v[40:43], v[220:223]
    s_waitcnt lgkmcnt(4)
    v_mfma_f32_16x16x32_bf16 v[224:227], a[224:227], v[48:51], v[224:227]
    ds_read_b64_tr_b16 v[32:33], v12 offset:0
    v_mfma_f32_16x16x32_bf16 v[224:227], a[240:243], v[52:55], v[224:227]
    ds_read_b64_tr_b16 v[34:35], v12 offset:2048
    v_mfma_f32_16x16x32_bf16 v[228:231], a[244:247], v[52:55], v[228:231]
    ds_read_b64_tr_b16 v[36:37], v12 offset:8192
    v_mfma_f32_16x16x32_bf16 v[228:231], a[228:231], v[48:51], v[228:231]
    ds_read_b64_tr_b16 v[38:39], v12 offset:10240
    v_mfma_f32_16x16x32_bf16 v[232:235], a[232:235], v[48:51], v[232:235]
    ds_read_b64_tr_b16 v[40:41], v12 offset:16384
    v_mfma_f32_16x16x32_bf16 v[232:235], a[248:251], v[52:55], v[232:235]
    ds_read_b64_tr_b16 v[42:43], v12 offset:18432
    v_mfma_f32_16x16x32_bf16 v[236:239], a[252:255], v[52:55], v[236:239]
    ds_read_b64_tr_b16 v[44:45], v12 offset:24576
    v_mfma_f32_16x16x32_bf16 v[236:239], a[236:239], v[48:51], v[236:239]
    s_waitcnt lgkmcnt(7)
    ds_read_b64_tr_b16 v[46:47], v12 offset:26624
    v_mfma_f32_16x16x32_bf16 v[240:243], a[224:227], v[56:59], v[240:243]
    v_mfma_f32_16x16x32_bf16 v[240:243], a[240:243], v[60:63], v[240:243]
    v_mfma_f32_16x16x32_bf16 v[244:247], a[244:247], v[60:63], v[244:247]
    v_mfma_f32_16x16x32_bf16 v[244:247], a[228:231], v[56:59], v[244:247]
    v_mfma_f32_16x16x32_bf16 v[248:251], a[232:235], v[56:59], v[248:251]
    v_mfma_f32_16x16x32_bf16 v[248:251], a[248:251], v[60:63], v[248:251]
    v_mfma_f32_16x16x32_bf16 v[252:255], a[252:255], v[60:63], v[252:255]
    v_mfma_f32_16x16x32_bf16 v[252:255], a[236:239], v[56:59], v[252:255]
    s_waitcnt lgkmcnt(0)
    v_mfma_f32_16x16x32_bf16 v[128:131], v[32:35], a[0:3], 0
    ds_read_b64_tr_b16 v[48:49], v13 offset:0
    v_mfma_f32_16x16x32_bf16 v[128:131], v[36:39], a[16:19], v[128:131]
    ds_read_b64_tr_b16 v[50:51], v13 offset:2048
    v_mfma_f32_16x16x32_bf16 v[128:131], v[40:43], a[32:35], v[128:131]
    ds_read_b64_tr_b16 v[52:53], v13 offset:8192
    v_mfma_f32_16x16x32_bf16 v[128:131], v[44:47], a[48:51], v[128:131]
    ds_read_b64_tr_b16 v[54:55], v13 offset:10240
    v_mfma_f32_16x16x32_bf16 v[132:135], v[44:47], a[52:55], 0
    ds_read_b64_tr_b16 v[56:57], v13 offset:16384
    v_mfma_f32_16x16x32_bf16 v[132:135], v[40:43], a[36:39], v[132:135]
    ds_read_b64_tr_b16 v[58:59], v13 offset:18432
    v_mfma_f32_16x16x32_bf16 v[132:135], v[36:39], a[20:23], v[132:135]
    ds_read_b64_tr_b16 v[60:61], v13 offset:24576
    s_add_u32 s81, s81, 4096
    v_mfma_f32_16x16x32_bf16 v[132:135], v[32:35], a[4:7], v[132:135]
    ds_read_b64_tr_b16 v[62:63], v13 offset:26624
    v_mfma_f32_16x16x32_bf16 v[136:139], v[32:35], a[8:11], 0
    buffer_load_dwordx4 a[224:227], v3, s[52:55], s81 offen offset:0 sc1
    v_mfma_f32_16x16x32_bf16 v[136:139], v[36:39], a[24:27], v[136:139]
    buffer_store_dwordx4 v[120:123], v3, s[52:55], s74 offen offset:2048 sc1
    v_mfma_f32_16x16x32_bf16 v[136:139], v[40:43], a[40:43], v[136:139]
    v_mfma_f32_16x16x32_bf16 v[136:139], v[44:47], a[56:59], v[136:139]
    v_mfma_f32_16x16x32_bf16 v[140:143], v[44:47], a[60:63], 0
    buffer_load_dwordx4 a[228:231], v3, s[52:55], s81 offen offset:1024 sc1
    v_mfma_f32_16x16x32_bf16 v[140:143], v[40:43], a[44:47], v[140:143]
    v_mfma_f32_16x16x32_bf16 v[140:143], v[36:39], a[28:31], v[140:143]
    v_mfma_f32_16x16x32_bf16 v[140:143], v[32:35], a[12:15], v[140:143]
    s_waitcnt lgkmcnt(0)
    v_mfma_f32_16x16x32_bf16 v[144:147], v[48:51], a[0:3], 0
    ds_read_b64_tr_b16 v[32:33], v12 offset:4096
    v_mfma_f32_16x16x32_bf16 v[144:147], v[52:55], a[16:19], v[144:147]
    ds_read_b64_tr_b16 v[34:35], v12 offset:6144
    v_mfma_f32_16x16x32_bf16 v[144:147], v[56:59], a[32:35], v[144:147]
    ds_read_b64_tr_b16 v[36:37], v12 offset:12288
    v_mfma_f32_16x16x32_bf16 v[144:147], v[60:63], a[48:51], v[144:147]
    ds_read_b64_tr_b16 v[38:39], v12 offset:14336
    v_mfma_f32_16x16x32_bf16 v[148:151], v[60:63], a[52:55], 0
    ds_read_b64_tr_b16 v[40:41], v12 offset:20480
    v_mfma_f32_16x16x32_bf16 v[148:151], v[56:59], a[36:39], v[148:151]
    ds_read_b64_tr_b16 v[42:43], v12 offset:22528
    v_mfma_f32_16x16x32_bf16 v[148:151], v[52:55], a[20:23], v[148:151]
    ds_read_b64_tr_b16 v[44:45], v12 offset:28672
    v_mfma_f32_16x16x32_bf16 v[148:151], v[48:51], a[4:7], v[148:151]
    ds_read_b64_tr_b16 v[46:47], v12 offset:30720
    v_mfma_f32_16x16x32_bf16 v[152:155], v[48:51], a[8:11], 0
    buffer_load_dwordx4 a[232:235], v3, s[52:55], s81 offen offset:2048 sc1
    v_mfma_f32_16x16x32_bf16 v[152:155], v[52:55], a[24:27], v[152:155]
    buffer_load_dwordx4 a[236:239], v3, s[52:55], s81 offen offset:3072 sc1
    s_add_u32 s81, s81, 4096
    v_mfma_f32_16x16x32_bf16 v[152:155], v[56:59], a[40:43], v[152:155]
    buffer_load_dwordx4 a[240:243], v3, s[52:55], s81 offen offset:0 sc1
    v_mfma_f32_16x16x32_bf16 v[152:155], v[60:63], a[56:59], v[152:155]
    v_mfma_f32_16x16x32_bf16 v[156:159], v[60:63], a[60:63], 0
    buffer_load_dwordx4 a[244:247], v3, s[52:55], s81 offen offset:1024 sc1
    v_mfma_f32_16x16x32_bf16 v[156:159], v[56:59], a[44:47], v[156:159]
    v_mfma_f32_16x16x32_bf16 v[156:159], v[52:55], a[28:31], v[156:159]
    v_mfma_f32_16x16x32_bf16 v[156:159], v[48:51], a[12:15], v[156:159]
    s_waitcnt lgkmcnt(0)
    v_mfma_f32_16x16x32_bf16 v[160:163], v[32:35], a[0:3], 0
    ds_read_b64_tr_b16 v[48:49], v13 offset:4096
    v_mfma_f32_16x16x32_bf16 v[160:163], v[36:39], a[16:19], v[160:163]
    ds_read_b64_tr_b16 v[50:51], v13 offset:6144
    v_mfma_f32_16x16x32_bf16 v[160:163], v[40:43], a[32:35], v[160:163]
    ds_read_b64_tr_b16 v[52:53], v13 offset:12288
    v_mfma_f32_16x16x32_bf16 v[160:163], v[44:47], a[48:51], v[160:163]
    ds_read_b64_tr_b16 v[54:55], v13 offset:14336
    v_mfma_f32_16x16x32_bf16 v[164:167], v[44:47], a[52:55], 0
    ds_read_b64_tr_b16 v[56:57], v13 offset:20480
    v_mfma_f32_16x16x32_bf16 v[164:167], v[40:43], a[36:39], v[164:167]
    ds_read_b64_tr_b16 v[58:59], v13 offset:22528
    v_mfma_f32_16x16x32_bf16 v[164:167], v[36:39], a[20:23], v[164:167]
    ds_read_b64_tr_b16 v[60:61], v13 offset:28672
    buffer_load_dwordx4 a[248:251], v3, s[52:55], s81 offen offset:2048 sc1
    v_mfma_f32_16x16x32_bf16 v[164:167], v[32:35], a[4:7], v[164:167]
    ds_read_b64_tr_b16 v[62:63], v13 offset:30720
    buffer_load_dwordx4 a[252:255], v3, s[52:55], s81 offen offset:3072 sc1
    v_mfma_f32_16x16x32_bf16 v[168:171], v[32:35], a[8:11], 0
    s_add_u32 s73, s48, 3
    s_and_b32 s73, s73, 3
    s_mul_i32 s73, s73, 458752
    v_mfma_f32_16x16x32_bf16 v[168:171], v[36:39], a[24:27], v[168:171]
    s_lshl_b32 s77, s7, 7
    s_add_u32 s73, s73, s77
    buffer_store_dwordx4 v[124:127], v3, s[52:55], s74 offen offset:3072 sc1
    v_mfma_f32_16x16x32_bf16 v[168:171], v[40:43], a[40:43], v[168:171]
    s_barrier
    v_mfma_f32_16x16x32_bf16 v[168:171], v[44:47], a[56:59], v[168:171]
    v_mfma_f32_16x16x32_bf16 v[172:175], v[44:47], a[60:63], 0
    buffer_load_dwordx4 v31, s[32:35], s73 offen lds
    s_add_u32 m0, s78, 36864
    v_mfma_f32_16x16x32_bf16 v[172:175], v[40:43], a[44:47], v[172:175]
    v_mfma_f32_16x16x32_bf16 v[172:175], v[36:39], a[28:31], v[172:175]
    v_mfma_f32_16x16x32_bf16 v[172:175], v[32:35], a[12:15], v[172:175]
    s_waitcnt lgkmcnt(0)
    buffer_load_dwordx4 v31, s[36:39], s73 offen lds
    s_add_u32 m0, s78, 40960
    v_mfma_f32_16x16x32_bf16 v[176:179], v[48:51], a[0:3], 0
    ds_read_b64_tr_b16 v[32:33], v12 offset:32768
    s_add_u32 s73, s73, 114688
    v_mfma_f32_16x16x32_bf16 v[176:179], v[52:55], a[16:19], v[176:179]
    ds_read_b64_tr_b16 v[34:35], v12 offset:34816
    v_mfma_f32_16x16x32_bf16 v[176:179], v[56:59], a[32:35], v[176:179]
    ds_read_b64_tr_b16 v[36:37], v12 offset:40960
    v_mfma_f32_16x16x32_bf16 v[176:179], v[60:63], a[48:51], v[176:179]
    ds_read_b64_tr_b16 v[38:39], v12 offset:43008
    v_mfma_f32_16x16x32_bf16 v[180:183], v[60:63], a[52:55], 0
    ds_read_b64_tr_b16 v[40:41], v12 offset:49152
    v_mfma_f32_16x16x32_bf16 v[180:183], v[56:59], a[36:39], v[180:183]
    ds_read_b64_tr_b16 v[42:43], v12 offset:51200
    v_mfma_f32_16x16x32_bf16 v[180:183], v[52:55], a[20:23], v[180:183]
    ds_read_b64_tr_b16 v[44:45], v12 offset:57344
    v_mfma_f32_16x16x32_bf16 v[180:183], v[48:51], a[4:7], v[180:183]
    ds_read_b64_tr_b16 v[46:47], v12 offset:59392
    v_mfma_f32_16x16x32_bf16 v[184:187], v[48:51], a[8:11], 0
    buffer_load_dwordx4 v31, s[32:35], s73 offen lds
    s_add_u32 m0, s78, 45056
    v_mfma_f32_16x16x32_bf16 v[184:187], v[52:55], a[24:27], v[184:187]
    buffer_load_dwordx4 v31, s[36:39], s73 offen lds
    s_add_u32 m0, s78, 49152
    v_mfma_f32_16x16x32_bf16 v[184:187], v[56:59], a[40:43], v[184:187]
    s_add_u32 s73, s73, 114688
    buffer_load_dwordx4 v31, s[32:35], s73 offen lds
    s_add_u32 m0, s78, 53248
    v_mfma_f32_16x16x32_bf16 v[184:187], v[60:63], a[56:59], v[184:187]
    buffer_load_dwordx4 v31, s[36:39], s73 offen lds
    s_add_u32 m0, s78, 57344
    v_mfma_f32_16x16x32_bf16 v[188:191], v[60:63], a[60:63], 0
    s_add_u32 s73, s73, 114688
    v_mfma_f32_16x16x32_bf16 v[188:191], v[56:59], a[44:47], v[188:191]
    v_mfma_f32_16x16x32_bf16 v[188:191], v[52:55], a[28:31], v[188:191]
    buffer_load_dwordx4 v31, s[32:35], s73 offen lds
    s_add_u32 m0, s78, 61440
    v_mfma_f32_16x16x32_bf16 v[188:191], v[48:51], a[12:15], v[188:191]
    s_waitcnt lgkmcnt(0)
    v_mfma_f32_16x16x32_bf16 v[128:131], v[32:35], a[64:67], v[128:131]
    ds_read_b64_tr_b16 v[48:49], v13 offset:32768
    v_mfma_f32_16x16x32_bf16 v[128:131], v[36:39], a[80:83], v[128:131]
    ds_read_b64_tr_b16 v[50:51], v13 offset:34816
    v_mfma_f32_16x16x32_bf16 v[128:131], v[40:43], a[96:99], v[128:131]
    ds_read_b64_tr_b16 v[52:53], v13 offset:40960
    v_mfma_f32_16x16x32_bf16 v[128:131], v[44:47], a[112:115], v[128:131]
    ds_read_b64_tr_b16 v[54:55], v13 offset:43008
    v_mfma_f32_16x16x32_bf16 v[132:135], v[44:47], a[116:119], v[132:135]
    ds_read_b64_tr_b16 v[56:57], v13 offset:49152
    v_mfma_f32_16x16x32_bf16 v[132:135], v[40:43], a[100:103], v[132:135]
    ds_read_b64_tr_b16 v[58:59], v13 offset:51200
    v_mfma_f32_16x16x32_bf16 v[132:135], v[36:39], a[84:87], v[132:135]
    ds_read_b64_tr_b16 v[60:61], v13 offset:57344
    buffer_load_dwordx4 v31, s[36:39], s73 offen lds
    s_add_u32 m0, s79, 65536
    v_mfma_f32_16x16x32_bf16 v[132:135], v[32:35], a[68:71], v[132:135]
    ds_read_b64_tr_b16 v[62:63], v13 offset:59392
    s_lshl_b32 s100, s76, 7
    s_lshl_b32 s77, s75, 3
    s_add_u32 s100, s100, s77
    v_mfma_f32_16x16x32_bf16 v[136:139], v[32:35], a[72:75], v[136:139]
    buffer_load_dwordx4 v24, s[28:31], s100 offen lds
    s_add_u32 m0, s79, 69632
    v_mfma_f32_16x16x32_bf16 v[136:139], v[36:39], a[88:91], v[136:139]
    v_mfma_f32_16x16x32_bf16 v[136:139], v[40:43], a[104:107], v[136:139]
    v_lshrrev_b32 v30, 4, v1
    v_lshlrev_b32 v30, 2, v30
    v_mfma_f32_16x16x32_bf16 v[136:139], v[44:47], a[120:123], v[136:139]
    buffer_load_dwordx4 v24, s[40:43], s100 offen lds
    s_add_u32 m0, s79, 66560
    v_mfma_f32_16x16x32_bf16 v[140:143], v[44:47], a[124:127], v[140:143]
    s_add_u32 s100, s100, 8192
    v_and_b32 v9, 15, v1
    v_sub_u32 v9, v9, v30
    v_mfma_f32_16x16x32_bf16 v[140:143], v[40:43], a[108:111], v[140:143]
    v_subrev_u32 v10, 1, v9
    v_subrev_u32 v11, 2, v9
    v_mfma_f32_16x16x32_bf16 v[140:143], v[36:39], a[92:95], v[140:143]
    v_subrev_u32 v30, 3, v9
    v_ashrrev_i32 v9, 31, v9
    v_mfma_f32_16x16x32_bf16 v[140:143], v[32:35], a[76:79], v[140:143]
    s_waitcnt lgkmcnt(0)
    v_and_b32 v9, 0xff800000, v9
    v_ashrrev_i32 v10, 31, v10
    v_mfma_f32_16x16x32_bf16 v[144:147], v[48:51], a[64:67], v[144:147]
    ds_read_b64_tr_b16 v[32:33], v12 offset:36864
    v_and_b32 v10, 0xff800000, v10
    v_mfma_f32_16x16x32_bf16 v[144:147], v[52:55], a[80:83], v[144:147]
    ds_read_b64_tr_b16 v[34:35], v12 offset:38912
    v_ashrrev_i32 v11, 31, v11
    v_mfma_f32_16x16x32_bf16 v[144:147], v[56:59], a[96:99], v[144:147]
    ds_read_b64_tr_b16 v[36:37], v12 offset:45056
    v_and_b32 v11, 0xff800000, v11
    v_mfma_f32_16x16x32_bf16 v[144:147], v[60:63], a[112:115], v[144:147]
    ds_read_b64_tr_b16 v[38:39], v12 offset:47104
    v_ashrrev_i32 v30, 31, v30
    v_mfma_f32_16x16x32_bf16 v[148:151], v[60:63], a[116:119], v[148:151]
    ds_read_b64_tr_b16 v[40:41], v12 offset:53248
    s_add_u32 s74, s83, 50331648
    v_mfma_f32_16x16x32_bf16 v[148:151], v[56:59], a[100:103], v[148:151]
    ds_read_b64_tr_b16 v[42:43], v12 offset:55296
    v_and_b32 v30, 0xff800000, v30
    v_mfma_f32_16x16x32_bf16 v[148:151], v[52:55], a[84:87], v[148:151]
    ds_read_b64_tr_b16 v[44:45], v12 offset:61440
    s_lshr_b32 s21, s69, 1
    v_mfma_f32_16x16x32_bf16 v[148:151], v[48:51], a[68:71], v[148:151]
    ds_read_b64_tr_b16 v[46:47], v12 offset:63488
    s_sub_u32 s22, 15, s21
    v_mfma_f32_16x16x32_bf16 v[152:155], v[48:51], a[72:75], v[152:155]
    buffer_load_dwordx4 v24, s[28:31], s100 offen lds
    s_add_u32 m0, s79, 70656
    v_mfma_f32_16x16x32_bf16 v[152:155], v[52:55], a[88:91], v[152:155]
    buffer_load_dwordx4 v24, s[40:43], s100 offen lds
    s_add_u32 m0, s79, 67584
    v_mfma_f32_16x16x32_bf16 v[152:155], v[56:59], a[104:107], v[152:155]
    buffer_store_dwordx4 v[64:67], v3, s[52:55], s74 offen offset:0 sc1
    s_min_u32 s21, s21, s22
    v_mfma_f32_16x16x32_bf16 v[152:155], v[60:63], a[120:123], v[152:155]
    s_lshl_b32 s21, s21, 9
    s_add_u32 s21, s21, 11546624
    v_bfe_u32 v31, v1, 3, 2
    v_mfma_f32_16x16x32_bf16 v[156:159], v[60:63], a[124:127], v[156:159]
    v_lshlrev_b32 v31, 5, v31
    v_and_or_b32 v31, v1, 7, v31
    v_mfma_f32_16x16x32_bf16 v[156:159], v[56:59], a[108:111], v[156:159]
    v_lshlrev_b32 v31, 2, v31
    v_add_u32 v31, s21, v31
    v_mfma_f32_16x16x32_bf16 v[156:159], v[52:55], a[92:95], v[156:159]
    s_lshl_b32 s96, s70, 1
    s_add_u32 s96, s96, s68
    s_sub_u32 s96, s96, 1
    v_mfma_f32_16x16x32_bf16 v[156:159], v[48:51], a[76:79], v[156:159]
    s_waitcnt lgkmcnt(0)
    s_sub_u32 s22, s96, 1
    s_add_u32 s20, s96, 1
    v_mfma_f32_16x16x32_bf16 v[160:163], v[32:35], a[64:67], v[160:163]
    ds_read_b64_tr_b16 v[48:49], v13 offset:36864
    s_cmp_eq_u32 s70, 7
    s_cselect_b32 s21, 16, 99
    v_mfma_f32_16x16x32_bf16 v[160:163], v[36:39], a[80:83], v[160:163]
    ds_read_b64_tr_b16 v[50:51], v13 offset:38912
    s_cmp_eq_u32 s68, 0
    s_cselect_b32 s21, s21, 99
    v_mfma_f32_16x16x32_bf16 v[160:163], v[40:43], a[96:99], v[160:163]
    ds_read_b64_tr_b16 v[52:53], v13 offset:45056
    s_cmp_lt_u32 s68, 2
    s_cselect_b32 s22, s21, s22
    v_mfma_f32_16x16x32_bf16 v[160:163], v[44:47], a[112:115], v[160:163]
    ds_read_b64_tr_b16 v[54:55], v13 offset:47104
    s_cmp_lt_u32 s68, 2
    s_cselect_b32 s20, 99, s20
    v_mfma_f32_16x16x32_bf16 v[164:167], v[44:47], a[116:119], v[164:167]
    ds_read_b64_tr_b16 v[56:57], v13 offset:53248
    s_cmp_lt_u32 s68, 2
    s_cselect_b32 s96, 17, s96
    v_mfma_f32_16x16x32_bf16 v[164:167], v[40:43], a[100:103], v[164:167]
    ds_read_b64_tr_b16 v[58:59], v13 offset:55296
    s_sub_u32 s92, s92, 16384
    v_mfma_f32_16x16x32_bf16 v[164:167], v[36:39], a[84:87], v[164:167]
    ds_read_b64_tr_b16 v[60:61], v13 offset:61440
    s_min_u32 s89, s92, s93
    v_mfma_f32_16x16x32_bf16 v[164:167], v[32:35], a[68:71], v[164:167]
    ds_read_b64_tr_b16 v[62:63], v13 offset:63488
    s_lshr_b32 s21, s2, 3
    v_mfma_f32_16x16x32_bf16 v[168:171], v[32:35], a[72:75], v[168:171]
    s_lshl_b32 s21, s21, 5
    s_and_b32 s23, s2, 7
    s_add_u32 s21, s21, s23
    v_mfma_f32_16x16x32_bf16 v[168:171], v[36:39], a[88:91], v[168:171]
    s_lshl_b32 s21, s21, 2
    s_add_u32 s21, s21, 11546624
    s_sub_u32 s23, 3, s68
    v_mfma_f32_16x16x32_bf16 v[168:171], v[40:43], a[104:107], v[168:171]
    s_waitcnt vmcnt(31)
    s_barrier
    v_mfma_f32_16x16x32_bf16 v[168:171], v[44:47], a[120:123], v[168:171]
    s_lshl_b32 s23, s23, 14
    s_add_u32 s23, s23, 131072
    v_mov_b32 v20, 0xbdd2d3e8
    v_mfma_f32_16x16x32_bf16 v[172:175], v[44:47], a[124:127], v[172:175]
    v_mfma_f32_16x16x32_bf16 v[172:175], v[40:43], a[108:111], v[172:175]
    v_mfma_f32_16x16x32_bf16 v[172:175], v[36:39], a[92:95], v[172:175]
    v_mfma_f32_16x16x32_bf16 v[172:175], v[32:35], a[76:79], v[172:175]
    s_waitcnt lgkmcnt(0)
    v_mfma_f32_16x16x32_bf16 v[176:179], v[48:51], a[64:67], v[176:179]
    ds_read_b64_tr_b16 v[32:33], v4 offset:0
    v_mfma_f32_16x16x32_bf16 v[176:179], v[52:55], a[80:83], v[176:179]
    ds_read_b64_tr_b16 v[34:35], v4 offset:2048
    v_mfma_f32_16x16x32_bf16 v[176:179], v[56:59], a[96:99], v[176:179]
    ds_read_b64_tr_b16 v[36:37], v4 offset:8192
    v_mfma_f32_16x16x32_bf16 v[176:179], v[60:63], a[112:115], v[176:179]
    ds_read_b64_tr_b16 v[38:39], v4 offset:10240
    v_mfma_f32_16x16x32_bf16 v[180:183], v[60:63], a[116:119], v[180:183]
    ds_read_b64_tr_b16 v[40:41], v4 offset:16384
    v_mfma_f32_16x16x32_bf16 v[180:183], v[56:59], a[100:103], v[180:183]
    ds_read_b64_tr_b16 v[42:43], v4 offset:18432
    v_mfma_f32_16x16x32_bf16 v[180:183], v[52:55], a[84:87], v[180:183]
    ds_read_b64_tr_b16 v[44:45], v4 offset:24576
    v_mfma_f32_16x16x32_bf16 v[180:183], v[48:51], a[68:71], v[180:183]
    ds_read_b64_tr_b16 v[46:47], v4 offset:26624
    v_mfma_f32_16x16x32_bf16 v[184:187], v[48:51], a[72:75], v[184:187]
    v_mfma_f32_16x16x32_bf16 v[184:187], v[52:55], a[88:91], v[184:187]
    v_mfma_f32_16x16x32_bf16 v[184:187], v[56:59], a[104:107], v[184:187]
    buffer_store_dwordx4 v[68:71], v3, s[52:55], s74 offen offset:1024 sc1
    v_mfma_f32_16x16x32_bf16 v[184:187], v[60:63], a[120:123], v[184:187]
    v_mfma_f32_16x16x32_bf16 v[188:191], v[60:63], a[124:127], v[188:191]
    v_mfma_f32_16x16x32_bf16 v[188:191], v[56:59], a[108:111], v[188:191]
    v_mfma_f32_16x16x32_bf16 v[188:191], v[52:55], a[92:95], v[188:191]
    v_cvt_pk_bf16_f32 v96, v192, v193
    v_cvt_pk_bf16_f32 v97, v194, v195
    v_mfma_f32_16x16x32_bf16 v[188:191], v[48:51], a[76:79], v[188:191]
    s_waitcnt lgkmcnt(0)
    v_cvt_pk_bf16_f32 v98, v196, v197
    v_cvt_pk_bf16_f32 v99, v198, v199
    v_mfma_f32_16x16x32_bf16 v[128:131], v[32:35], a[128:131], v[128:131]
    ds_read_b64_tr_b16 v[48:49], v5 offset:0
    s_add_u32 s100, s100, 8192
    v_mfma_f32_16x16x32_bf16 v[128:131], v[36:39], a[144:147], v[128:131]
    ds_read_b64_tr_b16 v[50:51], v5 offset:2048
    v_cvt_pk_bf16_f32 v112, v200, v201
    v_mfma_f32_16x16x32_bf16 v[128:131], v[40:43], a[160:163], v[128:131]
    ds_read_b64_tr_b16 v[52:53], v5 offset:8192
    v_cvt_pk_bf16_f32 v113, v202, v203
    v_mfma_f32_16x16x32_bf16 v[128:131], v[44:47], a[176:179], v[128:131]
    ds_read_b64_tr_b16 v[54:55], v5 offset:10240
    v_cvt_pk_bf16_f32 v114, v204, v205
    v_mfma_f32_16x16x32_bf16 v[132:135], v[44:47], a[180:183], v[132:135]
    ds_read_b64_tr_b16 v[56:57], v5 offset:16384
    v_cvt_pk_bf16_f32 v115, v206, v207
    v_mfma_f32_16x16x32_bf16 v[132:135], v[40:43], a[164:167], v[132:135]
    ds_read_b64_tr_b16 v[58:59], v5 offset:18432
    v_cvt_pk_bf16_f32 v100, v208, v209
    v_mfma_f32_16x16x32_bf16 v[132:135], v[36:39], a[148:151], v[132:135]
    ds_read_b64_tr_b16 v[60:61], v5 offset:24576
    v_cvt_pk_bf16_f32 v101, v210, v211
    v_mfma_f32_16x16x32_bf16 v[132:135], v[32:35], a[132:135], v[132:135]
    ds_read_b64_tr_b16 v[62:63], v5 offset:26624
    v_cvt_pk_bf16_f32 v102, v212, v213
    v_mfma_f32_16x16x32_bf16 v[136:139], v[32:35], a[136:139], v[136:139]
    buffer_load_dwordx4 v24, s[28:31], s100 offen lds
    s_add_u32 m0, s79, 71680
    v_mfma_f32_16x16x32_bf16 v[136:139], v[36:39], a[152:155], v[136:139]
    v_cvt_pk_bf16_f32 v103, v214, v215
    v_cvt_pk_bf16_f32 v116, v216, v217
    v_mfma_f32_16x16x32_bf16 v[136:139], v[40:43], a[168:171], v[136:139]
    v_cvt_pk_bf16_f32 v117, v218, v219
    v_cvt_pk_bf16_f32 v118, v220, v221
    v_mfma_f32_16x16x32_bf16 v[136:139], v[44:47], a[184:187], v[136:139]
    buffer_load_dwordx4 v24, s[40:43], s100 offen lds
    s_add_u32 m0, s79, 68608
    v_mfma_f32_16x16x32_bf16 v[140:143], v[44:47], a[188:191], v[140:143]
    s_add_u32 s100, s100, 8192
    v_cvt_pk_bf16_f32 v119, v222, v223
    v_cvt_pk_bf16_f32 v104, v224, v225
    v_mfma_f32_16x16x32_bf16 v[140:143], v[40:43], a[172:175], v[140:143]
    v_cvt_pk_bf16_f32 v105, v226, v227
    v_cvt_pk_bf16_f32 v106, v228, v229
    v_mfma_f32_16x16x32_bf16 v[140:143], v[36:39], a[156:159], v[140:143]
    v_cvt_pk_bf16_f32 v107, v230, v231
    v_cvt_pk_bf16_f32 v120, v232, v233
    v_mfma_f32_16x16x32_bf16 v[140:143], v[32:35], a[140:143], v[140:143]
    s_waitcnt lgkmcnt(0)
    v_cvt_pk_bf16_f32 v121, v234, v235
    v_cvt_pk_bf16_f32 v122, v236, v237
    v_mfma_f32_16x16x32_bf16 v[144:147], v[48:51], a[128:131], v[144:147]
    ds_read_b64_tr_b16 v[32:33], v4 offset:4096
    v_cvt_pk_bf16_f32 v123, v238, v239
    v_mfma_f32_16x16x32_bf16 v[144:147], v[52:55], a[144:147], v[144:147]
    ds_read_b64_tr_b16 v[34:35], v4 offset:6144
    v_cvt_pk_bf16_f32 v108, v240, v241
    v_mfma_f32_16x16x32_bf16 v[144:147], v[56:59], a[160:163], v[144:147]
    ds_read_b64_tr_b16 v[36:37], v4 offset:12288
    v_cvt_pk_bf16_f32 v109, v242, v243
    v_mfma_f32_16x16x32_bf16 v[144:147], v[60:63], a[176:179], v[144:147]
    ds_read_b64_tr_b16 v[38:39], v4 offset:14336
    v_cvt_pk_bf16_f32 v110, v244, v245
    v_mfma_f32_16x16x32_bf16 v[148:151], v[60:63], a[180:183], v[148:151]
    ds_read_b64_tr_b16 v[40:41], v4 offset:20480
    v_cvt_pk_bf16_f32 v111, v246, v247
    v_mfma_f32_16x16x32_bf16 v[148:151], v[56:59], a[164:167], v[148:151]
    ds_read_b64_tr_b16 v[42:43], v4 offset:22528
    v_cvt_pk_bf16_f32 v124, v248, v249
    v_mfma_f32_16x16x32_bf16 v[148:151], v[52:55], a[148:151], v[148:151]
    ds_read_b64_tr_b16 v[44:45], v4 offset:28672
    v_cvt_pk_bf16_f32 v125, v250, v251
    v_mfma_f32_16x16x32_bf16 v[148:151], v[48:51], a[132:135], v[148:151]
    ds_read_b64_tr_b16 v[46:47], v4 offset:30720
    v_cvt_pk_bf16_f32 v126, v252, v253
    v_mfma_f32_16x16x32_bf16 v[152:155], v[48:51], a[136:139], v[152:155]
    buffer_load_dwordx4 v24, s[28:31], s100 offen lds
    s_add_u32 m0, s79, 72704
    v_mfma_f32_16x16x32_bf16 v[152:155], v[52:55], a[152:155], v[152:155]
    buffer_load_dwordx4 v24, s[40:43], s100 offen lds
    s_add_u32 m0, s78, 65536
    v_mfma_f32_16x16x32_bf16 v[152:155], v[56:59], a[168:171], v[152:155]
    v_cvt_pk_bf16_f32 v127, v254, v255
    v_mfma_f32_16x16x32_bf16 v[152:155], v[60:63], a[184:187], v[152:155]
    v_mfma_f32_16x16x32_bf16 v[156:159], v[60:63], a[188:191], v[156:159]
    buffer_store_dwordx4 v[72:75], v3, s[52:55], s74 offen offset:2048 sc1
    v_mfma_f32_16x16x32_bf16 v[156:159], v[56:59], a[172:175], v[156:159]
    v_mfma_f32_16x16x32_bf16 v[156:159], v[52:55], a[156:159], v[156:159]
    v_mfma_f32_16x16x32_bf16 v[156:159], v[48:51], a[140:143], v[156:159]
    s_waitcnt lgkmcnt(0)
    v_mfma_f32_16x16x32_bf16 v[160:163], v[32:35], a[128:131], v[160:163]
    ds_read_b64_tr_b16 v[48:49], v5 offset:4096
    v_mfma_f32_16x16x32_bf16 v[160:163], v[36:39], a[144:147], v[160:163]
    ds_read_b64_tr_b16 v[50:51], v5 offset:6144
    v_mfma_f32_16x16x32_bf16 v[160:163], v[40:43], a[160:163], v[160:163]
    ds_read_b64_tr_b16 v[52:53], v5 offset:12288
    v_mfma_f32_16x16x32_bf16 v[160:163], v[44:47], a[176:179], v[160:163]
    ds_read_b64_tr_b16 v[54:55], v5 offset:14336
    v_mfma_f32_16x16x32_bf16 v[164:167], v[44:47], a[180:183], v[164:167]
    ds_read_b64_tr_b16 v[56:57], v5 offset:20480
    v_mfma_f32_16x16x32_bf16 v[164:167], v[40:43], a[164:167], v[164:167]
    ds_read_b64_tr_b16 v[58:59], v5 offset:22528
    v_mfma_f32_16x16x32_bf16 v[164:167], v[36:39], a[148:151], v[164:167]
    ds_read_b64_tr_b16 v[60:61], v5 offset:28672
    v_mfma_f32_16x16x32_bf16 v[164:167], v[32:35], a[132:135], v[164:167]
    ds_read_b64_tr_b16 v[62:63], v5 offset:30720
    v_mfma_f32_16x16x32_bf16 v[168:171], v[32:35], a[136:139], v[168:171]
    v_mfma_f32_16x16x32_bf16 v[168:171], v[36:39], a[152:155], v[168:171]
    v_mfma_f32_16x16x32_bf16 v[168:171], v[40:43], a[168:171], v[168:171]
    s_waitcnt vmcnt(11)
    s_barrier
    v_mfma_f32_16x16x32_bf16 v[168:171], v[44:47], a[184:187], v[168:171]
    v_mfma_f32_16x16x32_bf16 v[172:175], v[44:47], a[188:191], v[172:175]
    v_mfma_f32_16x16x32_bf16 v[172:175], v[40:43], a[172:175], v[172:175]
    v_mfma_f32_16x16x32_bf16 v[172:175], v[36:39], a[156:159], v[172:175]
    v_mfma_f32_16x16x32_bf16 v[172:175], v[32:35], a[140:143], v[172:175]
    s_waitcnt lgkmcnt(0)
    v_mfma_f32_16x16x32_bf16 v[176:179], v[48:51], a[128:131], v[176:179]
    ds_read_b64_tr_b16 v[32:33], v4 offset:32768
    v_mfma_f32_16x16x32_bf16 v[176:179], v[52:55], a[144:147], v[176:179]
    ds_read_b64_tr_b16 v[34:35], v4 offset:34816
    v_mfma_f32_16x16x32_bf16 v[176:179], v[56:59], a[160:163], v[176:179]
    ds_read_b64_tr_b16 v[36:37], v4 offset:40960
    v_mfma_f32_16x16x32_bf16 v[176:179], v[60:63], a[176:179], v[176:179]
    ds_read_b64_tr_b16 v[38:39], v4 offset:43008
    v_mfma_f32_16x16x32_bf16 v[180:183], v[60:63], a[180:183], v[180:183]
    ds_read_b64_tr_b16 v[40:41], v4 offset:49152
    v_mfma_f32_16x16x32_bf16 v[180:183], v[56:59], a[164:167], v[180:183]
    ds_read_b64_tr_b16 v[42:43], v4 offset:51200
    v_mfma_f32_16x16x32_bf16 v[180:183], v[52:55], a[148:151], v[180:183]
    ds_read_b64_tr_b16 v[44:45], v4 offset:57344
    v_mfma_f32_16x16x32_bf16 v[180:183], v[48:51], a[132:135], v[180:183]
    ds_read_b64_tr_b16 v[46:47], v4 offset:59392
    v_mfma_f32_16x16x32_bf16 v[184:187], v[48:51], a[136:139], v[184:187]
    v_mfma_f32_16x16x32_bf16 v[184:187], v[52:55], a[152:155], v[184:187]
    v_mfma_f32_16x16x32_bf16 v[184:187], v[56:59], a[168:171], v[184:187]
    v_mfma_f32_16x16x32_bf16 v[184:187], v[60:63], a[184:187], v[184:187]
    v_mfma_f32_16x16x32_bf16 v[188:191], v[60:63], a[188:191], v[188:191]
    v_mfma_f32_16x16x32_bf16 v[188:191], v[56:59], a[172:175], v[188:191]
    v_mfma_f32_16x16x32_bf16 v[188:191], v[52:55], a[156:159], v[188:191]
    buffer_store_dwordx4 v[76:79], v3, s[52:55], s74 offen offset:3072 sc1
    v_mfma_f32_16x16x32_bf16 v[188:191], v[48:51], a[140:143], v[188:191]
    s_waitcnt lgkmcnt(0)
    v_mfma_f32_16x16x32_bf16 v[128:131], v[32:35], a[192:195], v[128:131]
    ds_read_b64_tr_b16 v[48:49], v5 offset:32768
    v_mfma_f32_16x16x32_bf16 v[128:131], v[36:39], a[208:211], v[128:131]
    ds_read_b64_tr_b16 v[50:51], v5 offset:34816
    v_mfma_f32_16x16x32_bf16 v[128:131], v[40:43], a[224:227], v[128:131]
    ds_read_b64_tr_b16 v[52:53], v5 offset:40960
    v_mfma_f32_16x16x32_bf16 v[128:131], v[44:47], a[240:243], v[128:131]
    ds_read_b64_tr_b16 v[54:55], v5 offset:43008
    v_mfma_f32_16x16x32_bf16 v[132:135], v[44:47], a[244:247], v[132:135]
    ds_read_b64_tr_b16 v[56:57], v5 offset:49152
    v_mfma_f32_16x16x32_bf16 v[132:135], v[40:43], a[228:231], v[132:135]
    ds_read_b64_tr_b16 v[58:59], v5 offset:51200
    v_mfma_f32_16x16x32_bf16 v[132:135], v[36:39], a[212:215], v[132:135]
    ds_read_b64_tr_b16 v[60:61], v5 offset:57344
    v_mfma_f32_16x16x32_bf16 v[132:135], v[32:35], a[196:199], v[132:135]
    ds_read_b64_tr_b16 v[62:63], v5 offset:59392
    v_mfma_f32_16x16x32_bf16 v[136:139], v[32:35], a[200:203], v[136:139]
    v_mfma_f32_16x16x32_bf16 v[136:139], v[36:39], a[216:219], v[136:139]
    v_mfma_f32_16x16x32_bf16 v[136:139], v[40:43], a[232:235], v[136:139]
    v_mfma_f32_16x16x32_bf16 v[136:139], v[44:47], a[248:251], v[136:139]
    v_mfma_f32_16x16x32_bf16 v[140:143], v[44:47], a[252:255], v[140:143]
    v_mfma_f32_16x16x32_bf16 v[140:143], v[40:43], a[236:239], v[140:143]
    v_mfma_f32_16x16x32_bf16 v[140:143], v[36:39], a[220:223], v[140:143]
    v_mfma_f32_16x16x32_bf16 v[140:143], v[32:35], a[204:207], v[140:143]
    s_waitcnt lgkmcnt(0)
    v_mfma_f32_16x16x32_bf16 v[144:147], v[48:51], a[192:195], v[144:147]
    ds_read_b64_tr_b16 v[32:33], v4 offset:36864
    v_mfma_f32_16x16x32_bf16 v[144:147], v[52:55], a[208:211], v[144:147]
    ds_read_b64_tr_b16 v[34:35], v4 offset:38912
    v_mfma_f32_16x16x32_bf16 v[144:147], v[56:59], a[224:227], v[144:147]
    ds_read_b64_tr_b16 v[36:37], v4 offset:45056
    v_mfma_f32_16x16x32_bf16 v[144:147], v[60:63], a[240:243], v[144:147]
    ds_read_b64_tr_b16 v[38:39], v4 offset:47104
    v_mfma_f32_16x16x32_bf16 v[148:151], v[60:63], a[244:247], v[148:151]
    ds_read_b64_tr_b16 v[40:41], v4 offset:53248
    v_mfma_f32_16x16x32_bf16 v[148:151], v[56:59], a[228:231], v[148:151]
    ds_read_b64_tr_b16 v[42:43], v4 offset:55296
    v_mfma_f32_16x16x32_bf16 v[148:151], v[52:55], a[212:215], v[148:151]
    ds_read_b64_tr_b16 v[44:45], v4 offset:61440
    v_mfma_f32_16x16x32_bf16 v[148:151], v[48:51], a[196:199], v[148:151]
    ds_read_b64_tr_b16 v[46:47], v4 offset:63488
    v_mfma_f32_16x16x32_bf16 v[152:155], v[48:51], a[200:203], v[152:155]
    v_mfma_f32_16x16x32_bf16 v[152:155], v[52:55], a[216:219], v[152:155]
    v_mfma_f32_16x16x32_bf16 v[152:155], v[56:59], a[232:235], v[152:155]
    v_mfma_f32_16x16x32_bf16 v[152:155], v[60:63], a[248:251], v[152:155]
    v_mfma_f32_16x16x32_bf16 v[156:159], v[60:63], a[252:255], v[156:159]
    s_add_u32 s74, s83, 50339840
    v_mfma_f32_16x16x32_bf16 v[156:159], v[56:59], a[236:239], v[156:159]
    v_mfma_f32_16x16x32_bf16 v[156:159], v[52:55], a[220:223], v[156:159]
    v_mfma_f32_16x16x32_bf16 v[156:159], v[48:51], a[204:207], v[156:159]
    s_waitcnt lgkmcnt(0)
    v_mfma_f32_16x16x32_bf16 v[160:163], v[32:35], a[192:195], v[160:163]
    ds_read_b64_tr_b16 v[48:49], v5 offset:36864
    v_mfma_f32_16x16x32_bf16 v[160:163], v[36:39], a[208:211], v[160:163]
    ds_read_b64_tr_b16 v[50:51], v5 offset:38912
    v_mfma_f32_16x16x32_bf16 v[160:163], v[40:43], a[224:227], v[160:163]
    ds_read_b64_tr_b16 v[52:53], v5 offset:45056
    v_mfma_f32_16x16x32_bf16 v[160:163], v[44:47], a[240:243], v[160:163]
    ds_read_b64_tr_b16 v[54:55], v5 offset:47104
    v_mfma_f32_16x16x32_bf16 v[164:167], v[44:47], a[244:247], v[164:167]
    ds_read_b64_tr_b16 v[56:57], v5 offset:53248
    v_mfma_f32_16x16x32_bf16 v[164:167], v[40:43], a[228:231], v[164:167]
    ds_read_b64_tr_b16 v[58:59], v5 offset:55296
    v_mfma_f32_16x16x32_bf16 v[164:167], v[36:39], a[212:215], v[164:167]
    ds_read_b64_tr_b16 v[60:61], v5 offset:61440
    v_mfma_f32_16x16x32_bf16 v[164:167], v[32:35], a[196:199], v[164:167]
    ds_read_b64_tr_b16 v[62:63], v5 offset:63488
    v_mfma_f32_16x16x32_bf16 v[168:171], v[32:35], a[200:203], v[168:171]
    buffer_store_dwordx4 v[80:83], v3, s[52:55], s74 offen offset:0 sc1
    v_mfma_f32_16x16x32_bf16 v[168:171], v[36:39], a[216:219], v[168:171]
    v_mfma_f32_16x16x32_bf16 v[168:171], v[40:43], a[232:235], v[168:171]
    v_mfma_f32_16x16x32_bf16 v[168:171], v[44:47], a[248:251], v[168:171]
    v_mfma_f32_16x16x32_bf16 v[172:175], v[44:47], a[252:255], v[172:175]
    v_mfma_f32_16x16x32_bf16 v[172:175], v[40:43], a[236:239], v[172:175]
    v_mfma_f32_16x16x32_bf16 v[172:175], v[36:39], a[220:223], v[172:175]
    v_mfma_f32_16x16x32_bf16 v[172:175], v[32:35], a[204:207], v[172:175]
    s_waitcnt lgkmcnt(0)
    v_mfma_f32_16x16x32_bf16 v[176:179], v[48:51], a[192:195], v[176:179]
    ds_read_b64_tr_b16 v[32:33], v14 offset:0
    v_mfma_f32_16x16x32_bf16 v[176:179], v[52:55], a[208:211], v[176:179]
    ds_read_b64_tr_b16 v[34:35], v14 offset:2048
    v_mfma_f32_16x16x32_bf16 v[176:179], v[56:59], a[224:227], v[176:179]
    ds_read_b64_tr_b16 v[36:37], v14 offset:8192
    v_mfma_f32_16x16x32_bf16 v[176:179], v[60:63], a[240:243], v[176:179]
    ds_read_b64_tr_b16 v[38:39], v14 offset:10240
    v_mfma_f32_16x16x32_bf16 v[180:183], v[60:63], a[244:247], v[180:183]
    ds_read_b64_tr_b16 v[40:41], v14 offset:16384
    v_mfma_f32_16x16x32_bf16 v[180:183], v[56:59], a[228:231], v[180:183]
    ds_read_b64_tr_b16 v[42:43], v14 offset:18432
    v_mfma_f32_16x16x32_bf16 v[180:183], v[52:55], a[212:215], v[180:183]
    ds_read_b64_tr_b16 v[44:45], v14 offset:24576
    v_mfma_f32_16x16x32_bf16 v[180:183], v[48:51], a[196:199], v[180:183]
    ds_read_b64_tr_b16 v[46:47], v14 offset:26624
    v_mfma_f32_16x16x32_bf16 v[184:187], v[48:51], a[200:203], v[184:187]
    v_mfma_f32_16x16x32_bf16 v[184:187], v[52:55], a[216:219], v[184:187]
    v_mfma_f32_16x16x32_bf16 v[184:187], v[56:59], a[232:235], v[184:187]
    v_mfma_f32_16x16x32_bf16 v[184:187], v[60:63], a[248:251], v[184:187]
    s_lshl_b32 s72, s7, 13
    s_add_u32 s72, s72, 0
    s_add_u32 s72, s72, s85
    v_mfma_f32_16x16x32_bf16 v[188:191], v[60:63], a[252:255], v[188:191]
    v_mul_f32 v16, v128, v128
    v_mul_f32 v17, v129, v129
    v_mfma_f32_16x16x32_bf16 v[188:191], v[56:59], a[236:239], v[188:191]
    v_mul_f32 v18, v130, v130
    v_mul_f32 v19, v131, v131
    v_mfma_f32_16x16x32_bf16 v[188:191], v[52:55], a[220:223], v[188:191]
    v_mul_f32 v160, v128, v160
    v_mul_f32 v161, v129, v161
    v_mfma_f32_16x16x32_bf16 v[188:191], v[48:51], a[204:207], v[188:191]
    s_waitcnt lgkmcnt(0)
    v_mul_f32 v162, v130, v162
    v_mul_f32 v163, v131, v163
    v_mfma_f32_16x16x32_bf16 v[192:195], v[32:35], a[0:3], 0
    ds_read_b64_tr_b16 v[48:49], v15 offset:0
    v_fmaak_f32 v16, v16, v20, 0xc0135761
    v_mfma_f32_16x16x32_bf16 v[192:195], v[36:39], a[16:19], v[192:195]
    ds_read_b64_tr_b16 v[50:51], v15 offset:2048
    v_fmaak_f32 v17, v17, v20, 0xc0135761
    v_mfma_f32_16x16x32_bf16 v[192:195], v[40:43], a[32:35], v[192:195]
    ds_read_b64_tr_b16 v[52:53], v15 offset:8192
    v_fmaak_f32 v18, v18, v20, 0xc0135761
    v_mfma_f32_16x16x32_bf16 v[192:195], v[44:47], a[48:51], v[192:195]
    ds_read_b64_tr_b16 v[54:55], v15 offset:10240
    v_fmaak_f32 v19, v19, v20, 0xc0135761
    v_mfma_f32_16x16x32_bf16 v[196:199], v[44:47], a[52:55], 0
    ds_read_b64_tr_b16 v[56:57], v15 offset:16384
    v_mul_f32 v128, v128, v16
    v_mfma_f32_16x16x32_bf16 v[196:199], v[40:43], a[36:39], v[196:199]
    ds_read_b64_tr_b16 v[58:59], v15 offset:18432
    v_mul_f32 v129, v129, v17
    v_mfma_f32_16x16x32_bf16 v[196:199], v[36:39], a[20:23], v[196:199]
    ds_read_b64_tr_b16 v[60:61], v15 offset:24576
    v_mul_f32 v130, v130, v18
    v_mfma_f32_16x16x32_bf16 v[196:199], v[32:35], a[4:7], v[196:199]
    ds_read_b64_tr_b16 v[62:63], v15 offset:26624
    v_mul_f32 v131, v131, v19
    v_mfma_f32_16x16x32_bf16 v[200:203], v[32:35], a[8:11], 0
    buffer_store_dwordx4 v[84:87], v3, s[52:55], s74 offen offset:1024 sc1
    v_mul_f32 v16, v144, v144
    v_mfma_f32_16x16x32_bf16 v[200:203], v[36:39], a[24:27], v[200:203]
    v_exp_f32 v128, v128
    v_mfma_f32_16x16x32_bf16 v[200:203], v[40:43], a[40:43], v[200:203]
    v_exp_f32 v129, v129
    v_mfma_f32_16x16x32_bf16 v[200:203], v[44:47], a[56:59], v[200:203]
    v_exp_f32 v130, v130
    v_mfma_f32_16x16x32_bf16 v[204:207], v[44:47], a[60:63], 0
    v_exp_f32 v131, v131
    v_mfma_f32_16x16x32_bf16 v[204:207], v[40:43], a[44:47], v[204:207]
    v_add_f32 v128, 1.0, v128
    v_add_f32 v129, 1.0, v129
    v_mfma_f32_16x16x32_bf16 v[204:207], v[36:39], a[28:31], v[204:207]
    v_add_f32 v130, 1.0, v130
    v_add_f32 v131, 1.0, v131
    v_mfma_f32_16x16x32_bf16 v[204:207], v[32:35], a[12:15], v[204:207]
    s_waitcnt lgkmcnt(0)
    v_rcp_f32 v128, v128
    v_mfma_f32_16x16x32_bf16 v[208:211], v[48:51], a[0:3], 0
    ds_read_b64_tr_b16 v[32:33], v14 offset:4096
    v_mul_f32 v160, v160, v128
    v_mfma_f32_16x16x32_bf16 v[208:211], v[52:55], a[16:19], v[208:211]
    ds_read_b64_tr_b16 v[34:35], v14 offset:6144
    v_mul_f32 v17, v145, v145
    v_mfma_f32_16x16x32_bf16 v[208:211], v[56:59], a[32:35], v[208:211]
    ds_read_b64_tr_b16 v[36:37], v14 offset:12288
    v_mul_f32 v18, v146, v146
    v_mfma_f32_16x16x32_bf16 v[208:211], v[60:63], a[48:51], v[208:211]
    ds_read_b64_tr_b16 v[38:39], v14 offset:14336
    v_mul_f32 v19, v147, v147
    v_mfma_f32_16x16x32_bf16 v[212:215], v[60:63], a[52:55], 0
    ds_read_b64_tr_b16 v[40:41], v14 offset:20480
    v_mul_f32 v176, v144, v176
    v_mfma_f32_16x16x32_bf16 v[212:215], v[56:59], a[36:39], v[212:215]
    ds_read_b64_tr_b16 v[42:43], v14 offset:22528
    v_mul_f32 v177, v145, v177
    v_mfma_f32_16x16x32_bf16 v[212:215], v[52:55], a[20:23], v[212:215]
    ds_read_b64_tr_b16 v[44:45], v14 offset:28672
    v_mul_f32 v178, v146, v178
    v_mfma_f32_16x16x32_bf16 v[212:215], v[48:51], a[4:7], v[212:215]
    ds_read_b64_tr_b16 v[46:47], v14 offset:30720
    v_mul_f32 v179, v147, v179
    v_mfma_f32_16x16x32_bf16 v[216:219], v[48:51], a[8:11], 0
    v_rcp_f32 v129, v129
    v_mfma_f32_16x16x32_bf16 v[216:219], v[52:55], a[24:27], v[216:219]
    v_rcp_f32 v130, v130
    v_mfma_f32_16x16x32_bf16 v[216:219], v[56:59], a[40:43], v[216:219]
    v_rcp_f32 v131, v131
    v_mfma_f32_16x16x32_bf16 v[216:219], v[60:63], a[56:59], v[216:219]
    v_mul_f32 v161, v161, v129
    v_mul_f32 v162, v162, v130
    v_mfma_f32_16x16x32_bf16 v[220:223], v[60:63], a[60:63], 0
    v_mul_f32 v163, v163, v131
    v_cvt_pk_bf16_f32 v128, v160, v161
    v_mfma_f32_16x16x32_bf16 v[220:223], v[56:59], a[44:47], v[220:223]
    v_cvt_pk_bf16_f32 v129, v162, v163
    v_fmaak_f32 v16, v16, v20, 0xc0135761
    v_mfma_f32_16x16x32_bf16 v[220:223], v[52:55], a[28:31], v[220:223]
    v_fmaak_f32 v17, v17, v20, 0xc0135761
    v_fmaak_f32 v18, v18, v20, 0xc0135761
    v_mfma_f32_16x16x32_bf16 v[220:223], v[48:51], a[12:15], v[220:223]
    s_waitcnt lgkmcnt(0)
    v_fmaak_f32 v19, v19, v20, 0xc0135761
    v_mul_f32 v144, v144, v16
    v_mfma_f32_16x16x32_bf16 v[224:227], v[32:35], a[0:3], 0
    ds_read_b64_tr_b16 v[48:49], v15 offset:4096
    v_mul_f32 v145, v145, v17
    v_mfma_f32_16x16x32_bf16 v[224:227], v[36:39], a[16:19], v[224:227]
    ds_read_b64_tr_b16 v[50:51], v15 offset:6144
    v_mul_f32 v146, v146, v18
    v_mfma_f32_16x16x32_bf16 v[224:227], v[40:43], a[32:35], v[224:227]
    ds_read_b64_tr_b16 v[52:53], v15 offset:12288
    v_mul_f32 v147, v147, v19
    v_mfma_f32_16x16x32_bf16 v[224:227], v[44:47], a[48:51], v[224:227]
    ds_read_b64_tr_b16 v[54:55], v15 offset:14336
    v_mul_f32 v16, v132, v132
    v_mfma_f32_16x16x32_bf16 v[228:231], v[44:47], a[52:55], 0
    ds_read_b64_tr_b16 v[56:57], v15 offset:20480
    v_mul_f32 v17, v133, v133
    v_mfma_f32_16x16x32_bf16 v[228:231], v[40:43], a[36:39], v[228:231]
    ds_read_b64_tr_b16 v[58:59], v15 offset:22528
    v_mul_f32 v18, v134, v134
    v_mfma_f32_16x16x32_bf16 v[228:231], v[36:39], a[20:23], v[228:231]
    ds_read_b64_tr_b16 v[60:61], v15 offset:28672
    v_mul_f32 v19, v135, v135
    v_mfma_f32_16x16x32_bf16 v[228:231], v[32:35], a[4:7], v[228:231]
    ds_read_b64_tr_b16 v[62:63], v15 offset:30720
    v_mul_f32 v164, v132, v164
    v_mfma_f32_16x16x32_bf16 v[232:235], v[32:35], a[8:11], 0
    s_waitcnt vmcnt(4)
    ds_read_b64_tr_b16 v[64:65], v25 offset:0
    ds_read_b64_tr_b16 v[66:67], v25 offset:2048
    v_mfma_f32_16x16x32_bf16 v[232:235], v[36:39], a[24:27], v[232:235]
    buffer_store_dwordx4 v[88:91], v3, s[52:55], s74 offen offset:2048 sc1
    v_mul_f32 v165, v133, v165
    v_mfma_f32_16x16x32_bf16 v[232:235], v[40:43], a[40:43], v[232:235]
    v_exp_f32 v144, v144
    v_mfma_f32_16x16x32_bf16 v[232:235], v[44:47], a[56:59], v[232:235]
    v_exp_f32 v145, v145
    v_mfma_f32_16x16x32_bf16 v[236:239], v[44:47], a[60:63], 0
    v_exp_f32 v146, v146
    v_mfma_f32_16x16x32_bf16 v[236:239], v[40:43], a[44:47], v[236:239]
    v_exp_f32 v147, v147
    v_mfma_f32_16x16x32_bf16 v[236:239], v[36:39], a[28:31], v[236:239]
    v_add_f32 v144, 1.0, v144
    v_add_f32 v145, 1.0, v145
    v_mfma_f32_16x16x32_bf16 v[236:239], v[32:35], a[12:15], v[236:239]
    s_waitcnt lgkmcnt(2)
    v_add_f32 v146, 1.0, v146
    v_add_f32 v147, 1.0, v147
    v_mfma_f32_16x16x32_bf16 v[240:243], v[48:51], a[0:3], 0
    ds_read_b64_tr_b16 v[32:33], v14 offset:32768
    v_mul_f32 v166, v134, v166
    v_mfma_f32_16x16x32_bf16 v[240:243], v[52:55], a[16:19], v[240:243]
    ds_read_b64_tr_b16 v[34:35], v14 offset:34816
    v_mul_f32 v167, v135, v167
    v_mfma_f32_16x16x32_bf16 v[240:243], v[56:59], a[32:35], v[240:243]
    ds_read_b64_tr_b16 v[36:37], v14 offset:40960
    v_fmaak_f32 v16, v16, v20, 0xc0135761
    v_mfma_f32_16x16x32_bf16 v[240:243], v[60:63], a[48:51], v[240:243]
    ds_read_b64_tr_b16 v[38:39], v14 offset:43008
    v_fmaak_f32 v17, v17, v20, 0xc0135761
    v_mfma_f32_16x16x32_bf16 v[244:247], v[60:63], a[52:55], 0
    ds_read_b64_tr_b16 v[40:41], v14 offset:49152
    v_fmaak_f32 v18, v18, v20, 0xc0135761
    v_mfma_f32_16x16x32_bf16 v[244:247], v[56:59], a[36:39], v[244:247]
    ds_read_b64_tr_b16 v[42:43], v14 offset:51200
    v_fmaak_f32 v19, v19, v20, 0xc0135761
    v_mfma_f32_16x16x32_bf16 v[244:247], v[52:55], a[20:23], v[244:247]
    ds_read_b64_tr_b16 v[44:45], v14 offset:57344
    v_mul_f32 v132, v132, v16
    v_mfma_f32_16x16x32_bf16 v[244:247], v[48:51], a[4:7], v[244:247]
    ds_read_b64_tr_b16 v[46:47], v14 offset:59392
    v_mul_f32 v133, v133, v17
    v_mfma_f32_16x16x32_bf16 v[248:251], v[48:51], a[8:11], 0
    s_waitcnt lgkmcnt(8)
    buffer_store_dwordx4 v[64:67], v3, s[52:55], s94 offen offset:0 sc1
    v_mul_f32 v134, v134, v18
    v_mfma_f32_16x16x32_bf16 v[248:251], v[52:55], a[24:27], v[248:251]
    v_rcp_f32 v144, v144
    v_mfma_f32_16x16x32_bf16 v[248:251], v[56:59], a[40:43], v[248:251]
    v_rcp_f32 v145, v145
    v_mfma_f32_16x16x32_bf16 v[248:251], v[60:63], a[56:59], v[248:251]
    v_rcp_f32 v146, v146
    v_mfma_f32_16x16x32_bf16 v[252:255], v[60:63], a[60:63], 0
    v_rcp_f32 v147, v147
    v_mfma_f32_16x16x32_bf16 v[252:255], v[56:59], a[44:47], v[252:255]
    v_mul_f32 v176, v176, v144
    v_mul_f32 v177, v177, v145
    v_mfma_f32_16x16x32_bf16 v[252:255], v[52:55], a[28:31], v[252:255]
    v_mul_f32 v178, v178, v146
    v_mul_f32 v179, v179, v147
    v_mfma_f32_16x16x32_bf16 v[252:255], v[48:51], a[12:15], v[252:255]
    s_waitcnt lgkmcnt(0)
    v_cvt_pk_bf16_f32 v130, v176, v177
    v_cvt_pk_bf16_f32 v131, v178, v179
    v_mfma_f32_16x16x32_bf16 v[192:195], v[32:35], a[64:67], v[192:195]
    ds_read_b64_tr_b16 v[48:49], v15 offset:32768
    v_mul_f32 v135, v135, v19
    v_mfma_f32_16x16x32_bf16 v[192:195], v[36:39], a[80:83], v[192:195]
    ds_read_b64_tr_b16 v[50:51], v15 offset:34816
    v_mul_f32 v16, v148, v148
    v_mfma_f32_16x16x32_bf16 v[192:195], v[40:43], a[96:99], v[192:195]
    ds_read_b64_tr_b16 v[52:53], v15 offset:40960
    v_mul_f32 v17, v149, v149
    v_mfma_f32_16x16x32_bf16 v[192:195], v[44:47], a[112:115], v[192:195]
    ds_read_b64_tr_b16 v[54:55], v15 offset:43008
    v_mul_f32 v18, v150, v150
    v_mfma_f32_16x16x32_bf16 v[196:199], v[44:47], a[116:119], v[196:199]
    ds_read_b64_tr_b16 v[56:57], v15 offset:49152
    v_mul_f32 v19, v151, v151
    v_mfma_f32_16x16x32_bf16 v[196:199], v[40:43], a[100:103], v[196:199]
    ds_read_b64_tr_b16 v[58:59], v15 offset:51200
    v_mul_f32 v180, v148, v180
    v_mfma_f32_16x16x32_bf16 v[196:199], v[36:39], a[84:87], v[196:199]
    ds_read_b64_tr_b16 v[60:61], v15 offset:57344
    v_mul_f32 v181, v149, v181
    v_mfma_f32_16x16x32_bf16 v[196:199], v[32:35], a[68:71], v[196:199]
    ds_read_b64_tr_b16 v[62:63], v15 offset:59392
    v_mul_f32 v182, v150, v182
    v_mfma_f32_16x16x32_bf16 v[200:203], v[32:35], a[72:75], v[200:203]
    ds_read_b64_tr_b16 v[68:69], v26 offset:0
    ds_read_b64_tr_b16 v[70:71], v26 offset:2048
    v_mfma_f32_16x16x32_bf16 v[200:203], v[36:39], a[88:91], v[200:203]
    buffer_store_dwordx4 v[92:95], v3, s[52:55], s74 offen offset:3072 sc1
    v_mul_f32 v183, v151, v183
    v_mfma_f32_16x16x32_bf16 v[200:203], v[40:43], a[104:107], v[200:203]
    buffer_store_dwordx4 v[128:131], v3, s[56:59], s72 offen offset:0 sc1
    v_fmaak_f32 v16, v16, v20, 0xc0135761
    v_mfma_f32_16x16x32_bf16 v[200:203], v[44:47], a[120:123], v[200:203]
    v_exp_f32 v132, v132
    v_mfma_f32_16x16x32_bf16 v[204:207], v[44:47], a[124:127], v[204:207]
    v_exp_f32 v133, v133
    v_mfma_f32_16x16x32_bf16 v[204:207], v[40:43], a[108:111], v[204:207]
    v_exp_f32 v134, v134
    v_mfma_f32_16x16x32_bf16 v[204:207], v[36:39], a[92:95], v[204:207]
    v_exp_f32 v135, v135
    v_mfma_f32_16x16x32_bf16 v[204:207], v[32:35], a[76:79], v[204:207]
    s_waitcnt lgkmcnt(2)
    v_add_f32 v132, 1.0, v132
    v_add_f32 v133, 1.0, v133
    v_mfma_f32_16x16x32_bf16 v[208:211], v[48:51], a[64:67], v[208:211]
    ds_read_b64_tr_b16 v[32:33], v14 offset:36864
    v_add_f32 v134, 1.0, v134
    v_mfma_f32_16x16x32_bf16 v[208:211], v[52:55], a[80:83], v[208:211]
    ds_read_b64_tr_b16 v[34:35], v14 offset:38912
    v_add_f32 v135, 1.0, v135
    v_mfma_f32_16x16x32_bf16 v[208:211], v[56:59], a[96:99], v[208:211]
    ds_read_b64_tr_b16 v[36:37], v14 offset:45056
    v_fmaak_f32 v17, v17, v20, 0xc0135761
    v_mfma_f32_16x16x32_bf16 v[208:211], v[60:63], a[112:115], v[208:211]
    ds_read_b64_tr_b16 v[38:39], v14 offset:47104
    v_fmaak_f32 v18, v18, v20, 0xc0135761
    v_mfma_f32_16x16x32_bf16 v[212:215], v[60:63], a[116:119], v[212:215]
    ds_read_b64_tr_b16 v[40:41], v14 offset:53248
    v_fmaak_f32 v19, v19, v20, 0xc0135761
    v_mfma_f32_16x16x32_bf16 v[212:215], v[56:59], a[100:103], v[212:215]
    ds_read_b64_tr_b16 v[42:43], v14 offset:55296
    v_mul_f32 v148, v148, v16
    v_mfma_f32_16x16x32_bf16 v[212:215], v[52:55], a[84:87], v[212:215]
    ds_read_b64_tr_b16 v[44:45], v14 offset:61440
    v_mul_f32 v149, v149, v17
    v_mfma_f32_16x16x32_bf16 v[212:215], v[48:51], a[68:71], v[212:215]
    ds_read_b64_tr_b16 v[46:47], v14 offset:63488
    v_mul_f32 v150, v150, v18
    v_mfma_f32_16x16x32_bf16 v[216:219], v[48:51], a[72:75], v[216:219]
    s_waitcnt lgkmcnt(8)
    buffer_store_dwordx4 v[68:71], v3, s[52:55], s94 offen offset:1024 sc1
    v_mul_f32 v151, v151, v19
    v_mfma_f32_16x16x32_bf16 v[216:219], v[52:55], a[88:91], v[216:219]
    v_rcp_f32 v132, v132
    v_mfma_f32_16x16x32_bf16 v[216:219], v[56:59], a[104:107], v[216:219]
    v_rcp_f32 v133, v133
    v_mfma_f32_16x16x32_bf16 v[216:219], v[60:63], a[120:123], v[216:219]
    v_rcp_f32 v134, v134
    v_mfma_f32_16x16x32_bf16 v[220:223], v[60:63], a[124:127], v[220:223]
    v_rcp_f32 v135, v135
    v_mfma_f32_16x16x32_bf16 v[220:223], v[56:59], a[108:111], v[220:223]
    v_mul_f32 v164, v164, v132
    v_mul_f32 v165, v165, v133
    v_mfma_f32_16x16x32_bf16 v[220:223], v[52:55], a[92:95], v[220:223]
    v_mul_f32 v166, v166, v134
    v_mul_f32 v167, v167, v135
    v_mfma_f32_16x16x32_bf16 v[220:223], v[48:51], a[76:79], v[220:223]
    s_waitcnt lgkmcnt(0)
    v_cvt_pk_bf16_f32 v132, v164, v165
    v_cvt_pk_bf16_f32 v133, v166, v167
    v_mfma_f32_16x16x32_bf16 v[224:227], v[32:35], a[64:67], v[224:227]
    ds_read_b64_tr_b16 v[48:49], v15 offset:36864
    v_mul_f32 v16, v136, v136
    v_mfma_f32_16x16x32_bf16 v[224:227], v[36:39], a[80:83], v[224:227]
    ds_read_b64_tr_b16 v[50:51], v15 offset:38912
    v_mul_f32 v17, v137, v137
    v_mfma_f32_16x16x32_bf16 v[224:227], v[40:43], a[96:99], v[224:227]
    ds_read_b64_tr_b16 v[52:53], v15 offset:45056
    s_add_u32 s80, s48, 0
    v_mfma_f32_16x16x32_bf16 v[224:227], v[44:47], a[112:115], v[224:227]
    ds_read_b64_tr_b16 v[54:55], v15 offset:47104
    s_and_b32 s80, s80, 3
    v_mfma_f32_16x16x32_bf16 v[228:231], v[44:47], a[116:119], v[228:231]
    ds_read_b64_tr_b16 v[56:57], v15 offset:53248
    s_lshl_b32 s80, s80, 20
    v_mfma_f32_16x16x32_bf16 v[228:231], v[40:43], a[100:103], v[228:231]
    ds_read_b64_tr_b16 v[58:59], v15 offset:55296
    s_lshl_b32 s77, s69, 8
    v_mfma_f32_16x16x32_bf16 v[228:231], v[36:39], a[84:87], v[228:231]
    ds_read_b64_tr_b16 v[60:61], v15 offset:61440
    s_add_u32 s80, s80, s77
    v_mfma_f32_16x16x32_bf16 v[228:231], v[32:35], a[68:71], v[228:231]
    ds_read_b64_tr_b16 v[62:63], v15 offset:63488
    s_add_u32 s74, s83, 50335744
    v_mfma_f32_16x16x32_bf16 v[232:235], v[32:35], a[72:75], v[232:235]
    ds_read_b64_tr_b16 v[64:65], v27 offset:0
    ds_read_b64_tr_b16 v[66:67], v27 offset:2048
    v_mfma_f32_16x16x32_bf16 v[232:235], v[36:39], a[88:91], v[232:235]
    buffer_store_dwordx4 v[96:99], v3, s[52:55], s74 offen offset:0 sc1
    v_mul_f32 v18, v138, v138
    v_mfma_f32_16x16x32_bf16 v[232:235], v[40:43], a[104:107], v[232:235]
    s_barrier
    v_mfma_f32_16x16x32_bf16 v[232:235], v[44:47], a[120:123], v[232:235]
    v_exp_f32 v148, v148
    v_mfma_f32_16x16x32_bf16 v[236:239], v[44:47], a[124:127], v[236:239]
    buffer_load_dwordx4 v8, s[16:19], s80 offen lds
    s_add_u32 m0, s78, 69632
    v_mfma_f32_16x16x32_bf16 v[236:239], v[40:43], a[108:111], v[236:239]
    v_exp_f32 v149, v149
    v_mfma_f32_16x16x32_bf16 v[236:239], v[36:39], a[92:95], v[236:239]
    s_add_u32 s80, s80, 262144
    v_exp_f32 v150, v150
    v_mfma_f32_16x16x32_bf16 v[236:239], v[32:35], a[76:79], v[236:239]
    s_waitcnt lgkmcnt(2)
    v_exp_f32 v151, v151
    v_mfma_f32_16x16x32_bf16 v[240:243], v[48:51], a[64:67], v[240:243]
    ds_read_b64_tr_b16 v[32:33], v6 offset:0
    v_add_f32 v148, 1.0, v148
    v_mfma_f32_16x16x32_bf16 v[240:243], v[52:55], a[80:83], v[240:243]
    ds_read_b64_tr_b16 v[34:35], v6 offset:2048
    v_add_f32 v149, 1.0, v149
    v_mfma_f32_16x16x32_bf16 v[240:243], v[56:59], a[96:99], v[240:243]
    ds_read_b64_tr_b16 v[36:37], v6 offset:8192
    v_add_f32 v150, 1.0, v150
    v_mfma_f32_16x16x32_bf16 v[240:243], v[60:63], a[112:115], v[240:243]
    ds_read_b64_tr_b16 v[38:39], v6 offset:10240
    v_add_f32 v151, 1.0, v151
    v_mfma_f32_16x16x32_bf16 v[244:247], v[60:63], a[116:119], v[244:247]
    ds_read_b64_tr_b16 v[40:41], v6 offset:16384
    v_mul_f32 v19, v139, v139
    v_mfma_f32_16x16x32_bf16 v[244:247], v[56:59], a[100:103], v[244:247]
    ds_read_b64_tr_b16 v[42:43], v6 offset:18432
    v_mul_f32 v168, v136, v168
    v_mfma_f32_16x16x32_bf16 v[244:247], v[52:55], a[84:87], v[244:247]
    ds_read_b64_tr_b16 v[44:45], v6 offset:24576
    v_mul_f32 v169, v137, v169
    v_mfma_f32_16x16x32_bf16 v[244:247], v[48:51], a[68:71], v[244:247]
    ds_read_b64_tr_b16 v[46:47], v6 offset:26624
    v_mul_f32 v170, v138, v170
    v_mfma_f32_16x16x32_bf16 v[248:251], v[48:51], a[72:75], v[248:251]
    buffer_load_dwordx4 v8, s[16:19], s80 offen lds
    s_add_u32 m0, s78, 73728
    v_mfma_f32_16x16x32_bf16 v[248:251], v[52:55], a[88:91], v[248:251]
    s_add_u32 s80, s80, 262144
    buffer_load_dwordx4 v8, s[16:19], s80 offen lds
    s_add_u32 m0, s78, 77824
    v_mfma_f32_16x16x32_bf16 v[248:251], v[56:59], a[104:107], v[248:251]
    s_add_u32 s80, s80, 262144
    buffer_load_dwordx4 v8, s[16:19], s80 offen lds
    s_add_u32 m0, s78, 81920
    v_mfma_f32_16x16x32_bf16 v[248:251], v[60:63], a[120:123], v[248:251]
    s_waitcnt lgkmcnt(8)
    buffer_store_dwordx4 v[64:67], v3, s[52:55], s94 offen offset:2048 sc1
    v_mul_f32 v171, v139, v171
    v_mfma_f32_16x16x32_bf16 v[252:255], v[60:63], a[124:127], v[252:255]
    v_rcp_f32 v148, v148
    v_mfma_f32_16x16x32_bf16 v[252:255], v[56:59], a[108:111], v[252:255]
    v_rcp_f32 v149, v149
    v_mfma_f32_16x16x32_bf16 v[252:255], v[52:55], a[92:95], v[252:255]
    v_rcp_f32 v150, v150
    v_mfma_f32_16x16x32_bf16 v[252:255], v[48:51], a[76:79], v[252:255]
    s_waitcnt lgkmcnt(0)
    v_rcp_f32 v151, v151
    v_mfma_f32_16x16x32_bf16 v[192:195], v[32:35], a[128:131], v[192:195]
    ds_read_b64_tr_b16 v[48:49], v7 offset:0
    v_mul_f32 v180, v180, v148
    v_mfma_f32_16x16x32_bf16 v[192:195], v[36:39], a[144:147], v[192:195]
    ds_read_b64_tr_b16 v[50:51], v7 offset:2048
    v_mul_f32 v181, v181, v149
    v_mfma_f32_16x16x32_bf16 v[192:195], v[40:43], a[160:163], v[192:195]
    ds_read_b64_tr_b16 v[52:53], v7 offset:8192
    v_mul_f32 v182, v182, v150
    v_mfma_f32_16x16x32_bf16 v[192:195], v[44:47], a[176:179], v[192:195]
    ds_read_b64_tr_b16 v[54:55], v7 offset:10240
    v_mul_f32 v183, v183, v151
    v_mfma_f32_16x16x32_bf16 v[196:199], v[44:47], a[180:183], v[196:199]
    ds_read_b64_tr_b16 v[56:57], v7 offset:16384
    v_cvt_pk_bf16_f32 v134, v180, v181
    v_mfma_f32_16x16x32_bf16 v[196:199], v[40:43], a[164:167], v[196:199]
    ds_read_b64_tr_b16 v[58:59], v7 offset:18432
    v_cvt_pk_bf16_f32 v135, v182, v183
    v_mfma_f32_16x16x32_bf16 v[196:199], v[36:39], a[148:151], v[196:199]
    ds_read_b64_tr_b16 v[60:61], v7 offset:24576
    v_fmaak_f32 v16, v16, v20, 0xc0135761
    v_mfma_f32_16x16x32_bf16 v[196:199], v[32:35], a[132:135], v[196:199]
    ds_read_b64_tr_b16 v[62:63], v7 offset:26624
    v_fmaak_f32 v17, v17, v20, 0xc0135761
    v_mfma_f32_16x16x32_bf16 v[200:203], v[32:35], a[136:139], v[200:203]
    ds_read_b64_tr_b16 v[68:69], v28 offset:0
    ds_read_b64_tr_b16 v[70:71], v28 offset:2048
    v_mfma_f32_16x16x32_bf16 v[200:203], v[36:39], a[152:155], v[200:203]
    buffer_store_dwordx4 v[132:135], v3, s[56:59], s72 offen offset:1024 sc1
    v_fmaak_f32 v18, v18, v20, 0xc0135761
    v_mfma_f32_16x16x32_bf16 v[200:203], v[40:43], a[168:171], v[200:203]
    buffer_store_dwordx4 v[100:103], v3, s[52:55], s74 offen offset:1024 sc1
    v_fmaak_f32 v19, v19, v20, 0xc0135761
    v_mfma_f32_16x16x32_bf16 v[200:203], v[44:47], a[184:187], v[200:203]
    v_mul_f32 v136, v136, v16
    v_mul_f32 v137, v137, v17
    v_mfma_f32_16x16x32_bf16 v[204:207], v[44:47], a[188:191], v[204:207]
    v_mul_f32 v138, v138, v18
    v_mul_f32 v139, v139, v19
    v_mfma_f32_16x16x32_bf16 v[204:207], v[40:43], a[172:175], v[204:207]
    v_exp_f32 v136, v136
    v_mfma_f32_16x16x32_bf16 v[204:207], v[36:39], a[156:159], v[204:207]
    v_exp_f32 v137, v137
    v_mfma_f32_16x16x32_bf16 v[204:207], v[32:35], a[140:143], v[204:207]
    s_waitcnt lgkmcnt(2)
    v_exp_f32 v138, v138
    v_mfma_f32_16x16x32_bf16 v[208:211], v[48:51], a[128:131], v[208:211]
    ds_read_b64_tr_b16 v[32:33], v6 offset:4096
    v_add_f32 v136, 1.0, v136
    v_mfma_f32_16x16x32_bf16 v[208:211], v[52:55], a[144:147], v[208:211]
    ds_read_b64_tr_b16 v[34:35], v6 offset:6144
    v_add_f32 v137, 1.0, v137
    v_mfma_f32_16x16x32_bf16 v[208:211], v[56:59], a[160:163], v[208:211]
    ds_read_b64_tr_b16 v[36:37], v6 offset:12288
    v_add_f32 v138, 1.0, v138
    v_mfma_f32_16x16x32_bf16 v[208:211], v[60:63], a[176:179], v[208:211]
    ds_read_b64_tr_b16 v[38:39], v6 offset:14336
    v_mul_f32 v16, v152, v152
    v_mfma_f32_16x16x32_bf16 v[212:215], v[60:63], a[180:183], v[212:215]
    ds_read_b64_tr_b16 v[40:41], v6 offset:20480
    v_mul_f32 v17, v153, v153
    v_mfma_f32_16x16x32_bf16 v[212:215], v[56:59], a[164:167], v[212:215]
    ds_read_b64_tr_b16 v[42:43], v6 offset:22528
    v_mul_f32 v18, v154, v154
    v_mfma_f32_16x16x32_bf16 v[212:215], v[52:55], a[148:151], v[212:215]
    ds_read_b64_tr_b16 v[44:45], v6 offset:28672
    v_mul_f32 v19, v155, v155
    v_mfma_f32_16x16x32_bf16 v[212:215], v[48:51], a[132:135], v[212:215]
    ds_read_b64_tr_b16 v[46:47], v6 offset:30720
    v_mul_f32 v184, v152, v184
    v_mfma_f32_16x16x32_bf16 v[216:219], v[48:51], a[136:139], v[216:219]
    s_waitcnt lgkmcnt(8)
    buffer_store_dwordx4 v[68:71], v3, s[52:55], s94 offen offset:3072 sc1
    v_mul_f32 v185, v153, v185
    v_mfma_f32_16x16x32_bf16 v[216:219], v[52:55], a[152:155], v[216:219]
    v_exp_f32 v139, v139
    v_mfma_f32_16x16x32_bf16 v[216:219], v[56:59], a[168:171], v[216:219]
    v_add_f32 v139, 1.0, v139
    v_mul_f32 v186, v154, v186
    v_mfma_f32_16x16x32_bf16 v[216:219], v[60:63], a[184:187], v[216:219]
    v_rcp_f32 v136, v136
    v_mfma_f32_16x16x32_bf16 v[220:223], v[60:63], a[188:191], v[220:223]
    v_rcp_f32 v137, v137
    v_mfma_f32_16x16x32_bf16 v[220:223], v[56:59], a[172:175], v[220:223]
    v_rcp_f32 v138, v138
    v_mfma_f32_16x16x32_bf16 v[220:223], v[52:55], a[156:159], v[220:223]
    v_rcp_f32 v139, v139
    v_mfma_f32_16x16x32_bf16 v[220:223], v[48:51], a[140:143], v[220:223]
    s_waitcnt lgkmcnt(0)
    v_mul_f32 v168, v168, v136
    v_mul_f32 v169, v169, v137
    v_mfma_f32_16x16x32_bf16 v[224:227], v[32:35], a[128:131], v[224:227]
    ds_read_b64_tr_b16 v[48:49], v7 offset:4096
    v_mul_f32 v170, v170, v138
    v_mfma_f32_16x16x32_bf16 v[224:227], v[36:39], a[144:147], v[224:227]
    ds_read_b64_tr_b16 v[50:51], v7 offset:6144
    v_mul_f32 v171, v171, v139
    v_mfma_f32_16x16x32_bf16 v[224:227], v[40:43], a[160:163], v[224:227]
    ds_read_b64_tr_b16 v[52:53], v7 offset:12288
    s_add_u32 s80, s48, 1
    v_mfma_f32_16x16x32_bf16 v[224:227], v[44:47], a[176:179], v[224:227]
    ds_read_b64_tr_b16 v[54:55], v7 offset:14336
    s_and_b32 s80, s80, 3
    v_mfma_f32_16x16x32_bf16 v[228:231], v[44:47], a[180:183], v[228:231]
    ds_read_b64_tr_b16 v[56:57], v7 offset:20480
    s_lshl_b32 s80, s80, 20
    v_mfma_f32_16x16x32_bf16 v[228:231], v[40:43], a[164:167], v[228:231]
    ds_read_b64_tr_b16 v[58:59], v7 offset:22528
    s_lshl_b32 s77, s69, 8
    v_mfma_f32_16x16x32_bf16 v[228:231], v[36:39], a[148:151], v[228:231]
    ds_read_b64_tr_b16 v[60:61], v7 offset:28672
    s_add_u32 s80, s80, s77
    v_mfma_f32_16x16x32_bf16 v[228:231], v[32:35], a[132:135], v[228:231]
    ds_read_b64_tr_b16 v[62:63], v7 offset:30720
    v_cvt_pk_bf16_f32 v136, v168, v169
    v_mfma_f32_16x16x32_bf16 v[232:235], v[32:35], a[136:139], v[232:235]
    ds_read_b64_tr_b16 v[64:65], v25 offset:4096
    ds_read_b64_tr_b16 v[66:67], v25 offset:6144
    v_mfma_f32_16x16x32_bf16 v[232:235], v[36:39], a[152:155], v[232:235]
    v_cvt_pk_bf16_f32 v137, v170, v171
    v_mul_f32 v187, v155, v187
    v_mfma_f32_16x16x32_bf16 v[232:235], v[40:43], a[168:171], v[232:235]
    s_barrier
    v_mfma_f32_16x16x32_bf16 v[232:235], v[44:47], a[184:187], v[232:235]
    v_fmaak_f32 v16, v16, v20, 0xc0135761
    v_fmaak_f32 v17, v17, v20, 0xc0135761
    v_mfma_f32_16x16x32_bf16 v[236:239], v[44:47], a[188:191], v[236:239]
    buffer_load_dwordx4 v8, s[16:19], s80 offen lds
    s_add_u32 m0, s78, 86016
    v_mfma_f32_16x16x32_bf16 v[236:239], v[40:43], a[172:175], v[236:239]
    buffer_store_dwordx4 v[104:107], v3, s[52:55], s74 offen offset:2048 sc1
    v_fmaak_f32 v18, v18, v20, 0xc0135761
    v_mfma_f32_16x16x32_bf16 v[236:239], v[36:39], a[156:159], v[236:239]
    s_add_u32 s80, s80, 262144
    v_fmaak_f32 v19, v19, v20, 0xc0135761
    v_mul_f32 v152, v152, v16
    v_mfma_f32_16x16x32_bf16 v[236:239], v[32:35], a[140:143], v[236:239]
    s_waitcnt lgkmcnt(2)
    v_mul_f32 v153, v153, v17
    v_mul_f32 v154, v154, v18
    v_mfma_f32_16x16x32_bf16 v[240:243], v[48:51], a[128:131], v[240:243]
    ds_read_b64_tr_b16 v[32:33], v6 offset:32768
    v_mul_f32 v155, v155, v19
    v_mfma_f32_16x16x32_bf16 v[240:243], v[52:55], a[144:147], v[240:243]
    ds_read_b64_tr_b16 v[34:35], v6 offset:34816
    v_mul_f32 v16, v140, v140
    v_mfma_f32_16x16x32_bf16 v[240:243], v[56:59], a[160:163], v[240:243]
    ds_read_b64_tr_b16 v[36:37], v6 offset:40960
    v_mul_f32 v17, v141, v141
    v_mfma_f32_16x16x32_bf16 v[240:243], v[60:63], a[176:179], v[240:243]
    ds_read_b64_tr_b16 v[38:39], v6 offset:43008
    v_mul_f32 v18, v142, v142
    v_mfma_f32_16x16x32_bf16 v[244:247], v[60:63], a[180:183], v[244:247]
    ds_read_b64_tr_b16 v[40:41], v6 offset:49152
    v_mul_f32 v19, v143, v143
    v_mfma_f32_16x16x32_bf16 v[244:247], v[56:59], a[164:167], v[244:247]
    ds_read_b64_tr_b16 v[42:43], v6 offset:51200
    v_mul_f32 v172, v140, v172
    v_mfma_f32_16x16x32_bf16 v[244:247], v[52:55], a[148:151], v[244:247]
    ds_read_b64_tr_b16 v[44:45], v6 offset:57344
    v_mul_f32 v173, v141, v173
    v_mfma_f32_16x16x32_bf16 v[244:247], v[48:51], a[132:135], v[244:247]
    ds_read_b64_tr_b16 v[46:47], v6 offset:59392
    v_mul_f32 v174, v142, v174
    v_mfma_f32_16x16x32_bf16 v[248:251], v[48:51], a[136:139], v[248:251]
    buffer_load_dwordx4 v8, s[16:19], s80 offen lds
    s_add_u32 m0, s78, 90112
    v_mfma_f32_16x16x32_bf16 v[248:251], v[52:55], a[152:155], v[248:251]
    s_add_u32 s80, s80, 262144
    buffer_load_dwordx4 v8, s[16:19], s80 offen lds
    s_add_u32 m0, s78, 94208
    v_mfma_f32_16x16x32_bf16 v[248:251], v[56:59], a[168:171], v[248:251]
    s_add_u32 s80, s80, 262144
    buffer_load_dwordx4 v8, s[16:19], s80 offen lds
    s_add_u32 m0, s78, 98304
    v_mfma_f32_16x16x32_bf16 v[248:251], v[60:63], a[184:187], v[248:251]
    s_waitcnt lgkmcnt(8)
    buffer_store_dwordx4 v[64:67], v3, s[64:67], s95 offen offset:0 sc1
    v_mul_f32 v175, v143, v175
    v_mfma_f32_16x16x32_bf16 v[252:255], v[60:63], a[188:191], v[252:255]
    v_exp_f32 v152, v152
    v_mfma_f32_16x16x32_bf16 v[252:255], v[56:59], a[172:175], v[252:255]
    v_exp_f32 v153, v153
    v_mfma_f32_16x16x32_bf16 v[252:255], v[52:55], a[156:159], v[252:255]
    v_exp_f32 v154, v154
    v_mfma_f32_16x16x32_bf16 v[252:255], v[48:51], a[140:143], v[252:255]
    s_waitcnt lgkmcnt(0)
    v_exp_f32 v155, v155
    v_mfma_f32_16x16x32_bf16 v[192:195], v[32:35], a[192:195], v[192:195]
    ds_read_b64_tr_b16 v[48:49], v7 offset:32768
    v_add_f32 v152, 1.0, v152
    v_mfma_f32_16x16x32_bf16 v[192:195], v[36:39], a[208:211], v[192:195]
    ds_read_b64_tr_b16 v[50:51], v7 offset:34816
    v_add_f32 v153, 1.0, v153
    v_mfma_f32_16x16x32_bf16 v[192:195], v[40:43], a[224:227], v[192:195]
    ds_read_b64_tr_b16 v[52:53], v7 offset:40960
    v_add_f32 v154, 1.0, v154
    v_mfma_f32_16x16x32_bf16 v[192:195], v[44:47], a[240:243], v[192:195]
    ds_read_b64_tr_b16 v[54:55], v7 offset:43008
    v_add_f32 v155, 1.0, v155
    v_mfma_f32_16x16x32_bf16 v[196:199], v[44:47], a[244:247], v[196:199]
    ds_read_b64_tr_b16 v[56:57], v7 offset:49152
    v_fmaak_f32 v16, v16, v20, 0xc0135761
    v_mfma_f32_16x16x32_bf16 v[196:199], v[40:43], a[228:231], v[196:199]
    ds_read_b64_tr_b16 v[58:59], v7 offset:51200
    v_fmaak_f32 v17, v17, v20, 0xc0135761
    v_mfma_f32_16x16x32_bf16 v[196:199], v[36:39], a[212:215], v[196:199]
    ds_read_b64_tr_b16 v[60:61], v7 offset:57344
    v_fmaak_f32 v18, v18, v20, 0xc0135761
    v_mfma_f32_16x16x32_bf16 v[196:199], v[32:35], a[196:199], v[196:199]
    ds_read_b64_tr_b16 v[62:63], v7 offset:59392
    v_fmaak_f32 v19, v19, v20, 0xc0135761
    v_mfma_f32_16x16x32_bf16 v[200:203], v[32:35], a[200:203], v[200:203]
    ds_read_b64_tr_b16 v[68:69], v26 offset:4096
    ds_read_b64_tr_b16 v[70:71], v26 offset:6144
    v_mfma_f32_16x16x32_bf16 v[200:203], v[36:39], a[216:219], v[200:203]
    v_rcp_f32 v152, v152
    v_mfma_f32_16x16x32_bf16 v[200:203], v[40:43], a[232:235], v[200:203]
    v_rcp_f32 v153, v153
    v_mfma_f32_16x16x32_bf16 v[200:203], v[44:47], a[248:251], v[200:203]
    v_rcp_f32 v154, v154
    v_mfma_f32_16x16x32_bf16 v[204:207], v[44:47], a[252:255], v[204:207]
    v_rcp_f32 v155, v155
    v_mfma_f32_16x16x32_bf16 v[204:207], v[40:43], a[236:239], v[204:207]
    v_mul_f32 v184, v184, v152
    v_mul_f32 v185, v185, v153
    v_mfma_f32_16x16x32_bf16 v[204:207], v[36:39], a[220:223], v[204:207]
    buffer_store_dwordx4 v[108:111], v3, s[52:55], s74 offen offset:3072 sc1
    v_mul_f32 v186, v186, v154
    v_mfma_f32_16x16x32_bf16 v[204:207], v[32:35], a[204:207], v[204:207]
    s_waitcnt lgkmcnt(2)
    v_mul_f32 v187, v187, v155
    v_cvt_pk_bf16_f32 v138, v184, v185
    v_mfma_f32_16x16x32_bf16 v[208:211], v[48:51], a[192:195], v[208:211]
    ds_read_b64_tr_b16 v[32:33], v6 offset:36864
    v_cvt_pk_bf16_f32 v139, v186, v187
    v_mfma_f32_16x16x32_bf16 v[208:211], v[52:55], a[208:211], v[208:211]
    ds_read_b64_tr_b16 v[34:35], v6 offset:38912
    v_mul_f32 v140, v140, v16
    v_mfma_f32_16x16x32_bf16 v[208:211], v[56:59], a[224:227], v[208:211]
    ds_read_b64_tr_b16 v[36:37], v6 offset:45056
    v_mul_f32 v141, v141, v17
    v_mfma_f32_16x16x32_bf16 v[208:211], v[60:63], a[240:243], v[208:211]
    ds_read_b64_tr_b16 v[38:39], v6 offset:47104
    v_mul_f32 v142, v142, v18
    v_mfma_f32_16x16x32_bf16 v[212:215], v[60:63], a[244:247], v[212:215]
    ds_read_b64_tr_b16 v[40:41], v6 offset:53248
    v_mul_f32 v143, v143, v19
    v_mfma_f32_16x16x32_bf16 v[212:215], v[56:59], a[228:231], v[212:215]
    ds_read_b64_tr_b16 v[42:43], v6 offset:55296
    v_mul_f32 v16, v156, v156
    v_mfma_f32_16x16x32_bf16 v[212:215], v[52:55], a[212:215], v[212:215]
    ds_read_b64_tr_b16 v[44:45], v6 offset:61440
    v_mul_f32 v17, v157, v157
    v_mfma_f32_16x16x32_bf16 v[212:215], v[48:51], a[196:199], v[212:215]
    ds_read_b64_tr_b16 v[46:47], v6 offset:63488
    v_mul_f32 v18, v158, v158
    v_mfma_f32_16x16x32_bf16 v[216:219], v[48:51], a[200:203], v[216:219]
    s_waitcnt lgkmcnt(8)
    buffer_store_dwordx4 v[68:71], v3, s[64:67], s95 offen offset:1024 sc1
    v_mul_f32 v19, v159, v159
    v_mfma_f32_16x16x32_bf16 v[216:219], v[52:55], a[216:219], v[216:219]
    buffer_store_dwordx4 v[136:139], v3, s[56:59], s72 offen offset:2048 sc1
    v_mul_f32 v188, v156, v188
    v_mfma_f32_16x16x32_bf16 v[216:219], v[56:59], a[232:235], v[216:219]
    v_exp_f32 v140, v140
    v_mfma_f32_16x16x32_bf16 v[216:219], v[60:63], a[248:251], v[216:219]
    v_exp_f32 v141, v141
    v_mfma_f32_16x16x32_bf16 v[220:223], v[60:63], a[252:255], v[220:223]
    v_exp_f32 v142, v142
    v_mfma_f32_16x16x32_bf16 v[220:223], v[56:59], a[236:239], v[220:223]
    v_exp_f32 v143, v143
    v_mfma_f32_16x16x32_bf16 v[220:223], v[52:55], a[220:223], v[220:223]
    v_add_f32 v140, 1.0, v140
    v_add_f32 v141, 1.0, v141
    v_mfma_f32_16x16x32_bf16 v[220:223], v[48:51], a[204:207], v[220:223]
    s_waitcnt lgkmcnt(0)
    v_add_f32 v142, 1.0, v142
    v_add_f32 v143, 1.0, v143
    v_mfma_f32_16x16x32_bf16 v[224:227], v[32:35], a[192:195], v[224:227]
    ds_read_b64_tr_b16 v[48:49], v7 offset:36864
    v_mul_f32 v189, v157, v189
    v_mfma_f32_16x16x32_bf16 v[224:227], v[36:39], a[208:211], v[224:227]
    ds_read_b64_tr_b16 v[50:51], v7 offset:38912
    v_mul_f32 v190, v158, v190
    v_mfma_f32_16x16x32_bf16 v[224:227], v[40:43], a[224:227], v[224:227]
    ds_read_b64_tr_b16 v[52:53], v7 offset:45056
    s_add_u32 s80, s48, 2
    v_mfma_f32_16x16x32_bf16 v[224:227], v[44:47], a[240:243], v[224:227]
    ds_read_b64_tr_b16 v[54:55], v7 offset:47104
    s_and_b32 s80, s80, 3
    v_mfma_f32_16x16x32_bf16 v[228:231], v[44:47], a[244:247], v[228:231]
    ds_read_b64_tr_b16 v[56:57], v7 offset:53248
    s_lshl_b32 s80, s80, 20
    v_mfma_f32_16x16x32_bf16 v[228:231], v[40:43], a[228:231], v[228:231]
    ds_read_b64_tr_b16 v[58:59], v7 offset:55296
    s_lshl_b32 s77, s69, 8
    v_mfma_f32_16x16x32_bf16 v[228:231], v[36:39], a[212:215], v[228:231]
    ds_read_b64_tr_b16 v[60:61], v7 offset:61440
    s_add_u32 s80, s80, s77
    v_mfma_f32_16x16x32_bf16 v[228:231], v[32:35], a[196:199], v[228:231]
    ds_read_b64_tr_b16 v[62:63], v7 offset:63488
    v_mul_f32 v191, v159, v191
    v_mfma_f32_16x16x32_bf16 v[232:235], v[32:35], a[200:203], v[232:235]
    ds_read_b64_tr_b16 v[64:65], v27 offset:4096
    ds_read_b64_tr_b16 v[66:67], v27 offset:6144
    v_mfma_f32_16x16x32_bf16 v[232:235], v[36:39], a[216:219], v[232:235]
    v_rcp_f32 v140, v140
    v_mfma_f32_16x16x32_bf16 v[232:235], v[40:43], a[232:235], v[232:235]
    s_waitcnt vmcnt(13)
    s_barrier
    v_mfma_f32_16x16x32_bf16 v[232:235], v[44:47], a[248:251], v[232:235]
    v_rcp_f32 v141, v141
    v_mfma_f32_16x16x32_bf16 v[236:239], v[44:47], a[252:255], v[236:239]
    buffer_load_dwordx4 v8, s[16:19], s80 offen lds
    s_add_u32 m0, s78, 102400
    v_mfma_f32_16x16x32_bf16 v[236:239], v[40:43], a[236:239], v[236:239]
    s_add_u32 s74, s83, 50343936
    v_rcp_f32 v142, v142
    v_mfma_f32_16x16x32_bf16 v[236:239], v[36:39], a[220:223], v[236:239]
    s_add_u32 s80, s80, 262144
    v_rcp_f32 v143, v143
    v_mfma_f32_16x16x32_bf16 v[236:239], v[32:35], a[204:207], v[236:239]
    s_waitcnt lgkmcnt(2)
    v_mul_f32 v172, v172, v140
    v_mul_f32 v173, v173, v141
    v_mfma_f32_16x16x32_bf16 v[240:243], v[48:51], a[192:195], v[240:243]
    ds_read_b64_tr_b16 v[32:33], v12 offset:0
    v_mul_f32 v174, v174, v142
    v_mfma_f32_16x16x32_bf16 v[240:243], v[52:55], a[208:211], v[240:243]
    ds_read_b64_tr_b16 v[34:35], v12 offset:2048
    v_mul_f32 v175, v175, v143
    v_mfma_f32_16x16x32_bf16 v[240:243], v[56:59], a[224:227], v[240:243]
    ds_read_b64_tr_b16 v[36:37], v12 offset:4096
    v_cvt_pk_bf16_f32 v140, v172, v173
    v_mfma_f32_16x16x32_bf16 v[240:243], v[60:63], a[240:243], v[240:243]
    ds_read_b64_tr_b16 v[38:39], v12 offset:6144
    v_cvt_pk_bf16_f32 v141, v174, v175
    v_mfma_f32_16x16x32_bf16 v[244:247], v[60:63], a[244:247], v[244:247]
    ds_read_b64_tr_b16 v[40:41], v12 offset:8192
    v_fmaak_f32 v16, v16, v20, 0xc0135761
    v_mfma_f32_16x16x32_bf16 v[244:247], v[56:59], a[228:231], v[244:247]
    ds_read_b64_tr_b16 v[42:43], v12 offset:10240
    v_fmaak_f32 v17, v17, v20, 0xc0135761
    v_mfma_f32_16x16x32_bf16 v[244:247], v[52:55], a[212:215], v[244:247]
    ds_read_b64_tr_b16 v[44:45], v12 offset:12288
    v_fmaak_f32 v18, v18, v20, 0xc0135761
    v_mfma_f32_16x16x32_bf16 v[244:247], v[48:51], a[196:199], v[244:247]
    ds_read_b64_tr_b16 v[46:47], v12 offset:14336
    v_fmaak_f32 v19, v19, v20, 0xc0135761
    v_mfma_f32_16x16x32_bf16 v[248:251], v[48:51], a[200:203], v[248:251]
    buffer_load_dwordx4 v8, s[16:19], s80 offen lds
    s_add_u32 m0, s78, 106496
    v_mfma_f32_16x16x32_bf16 v[248:251], v[52:55], a[216:219], v[248:251]
    s_add_u32 s80, s80, 262144
    buffer_load_dwordx4 v8, s[16:19], s80 offen lds
    s_add_u32 m0, s78, 110592
    v_mfma_f32_16x16x32_bf16 v[248:251], v[56:59], a[232:235], v[248:251]
    s_add_u32 s80, s80, 262144
    buffer_load_dwordx4 v8, s[16:19], s80 offen lds
    s_add_u32 m0, s78, 114688
    v_mfma_f32_16x16x32_bf16 v[248:251], v[60:63], a[248:251], v[248:251]
    s_waitcnt lgkmcnt(8)
    buffer_store_dwordx4 v[64:67], v3, s[64:67], s95 offen offset:2048 sc1
    v_mul_f32 v156, v156, v16
    v_mfma_f32_16x16x32_bf16 v[252:255], v[60:63], a[252:255], v[252:255]
    buffer_store_dwordx4 v[112:115], v3, s[52:55], s74 offen offset:0 sc1
    v_mul_f32 v157, v157, v17
    v_mfma_f32_16x16x32_bf16 v[252:255], v[56:59], a[236:239], v[252:255]
    v_mul_f32 v158, v158, v18
    v_mul_f32 v159, v159, v19
    v_mfma_f32_16x16x32_bf16 v[252:255], v[52:55], a[220:223], v[252:255]
    v_exp_f32 v156, v156
    v_mfma_f32_16x16x32_bf16 v[252:255], v[48:51], a[204:207], v[252:255]
    v_exp_f32 v157, v157
    v_exp_f32 v158, v158
    v_exp_f32 v159, v159
    v_add_f32 v156, 1.0, v156
    v_add_f32 v157, 1.0, v157
    v_add_f32 v158, 1.0, v158
    v_add_f32 v159, 1.0, v159
    v_rcp_f32 v156, v156
    v_rcp_f32 v157, v157
    v_rcp_f32 v158, v158
    v_rcp_f32 v159, v159
    v_mul_f32 v188, v188, v156
    v_mul_f32 v189, v189, v157
    v_mul_f32 v190, v190, v158
    v_mul_f32 v191, v191, v159
    v_cvt_pk_bf16_f32 v142, v188, v189
    v_cvt_pk_bf16_f32 v143, v190, v191
    buffer_store_dwordx4 v[140:143], v3, s[56:59], s72 offen offset:3072 sc1
    s_waitcnt lgkmcnt(0)
    v_mfma_f32_16x16x32_bf16 v[128:131], v[32:35], a[0:3], 0
    ds_read_b64_tr_b16 v[48:49], v13 offset:0
    s_lshl_b32 s72, s7, 13
    v_mfma_f32_16x16x32_bf16 v[128:131], v[36:39], a[16:19], v[128:131]
    ds_read_b64_tr_b16 v[50:51], v13 offset:2048
    s_add_u32 s72, s72, 4096
    v_mfma_f32_16x16x32_bf16 v[128:131], v[40:43], a[32:35], v[128:131]
    ds_read_b64_tr_b16 v[52:53], v13 offset:4096
    s_add_u32 s72, s72, s85
    v_mfma_f32_16x16x32_bf16 v[128:131], v[44:47], a[48:51], v[128:131]
    ds_read_b64_tr_b16 v[54:55], v13 offset:6144
    v_mul_f32 v16, v192, v192
    v_mfma_f32_16x16x32_bf16 v[132:135], v[44:47], a[52:55], 0
    ds_read_b64_tr_b16 v[56:57], v13 offset:8192
    v_mul_f32 v17, v193, v193
    v_mfma_f32_16x16x32_bf16 v[132:135], v[40:43], a[36:39], v[132:135]
    ds_read_b64_tr_b16 v[58:59], v13 offset:10240
    v_mul_f32 v18, v194, v194
    v_mfma_f32_16x16x32_bf16 v[132:135], v[36:39], a[20:23], v[132:135]
    ds_read_b64_tr_b16 v[60:61], v13 offset:12288
    v_mul_f32 v19, v195, v195
    v_mfma_f32_16x16x32_bf16 v[132:135], v[32:35], a[4:7], v[132:135]
    ds_read_b64_tr_b16 v[62:63], v13 offset:14336
    v_mul_f32 v224, v192, v224
    v_mfma_f32_16x16x32_bf16 v[136:139], v[32:35], a[8:11], 0
    ds_read_b64_tr_b16 v[68:69], v28 offset:4096
    ds_read_b64_tr_b16 v[70:71], v28 offset:6144
    v_mfma_f32_16x16x32_bf16 v[136:139], v[36:39], a[24:27], v[136:139]
    v_mul_f32 v225, v193, v225
    v_mul_f32 v226, v194, v226
    v_mfma_f32_16x16x32_bf16 v[136:139], v[40:43], a[40:43], v[136:139]
    v_mul_f32 v227, v195, v227
    v_fmaak_f32 v16, v16, v20, 0xc0135761
    v_mfma_f32_16x16x32_bf16 v[136:139], v[44:47], a[56:59], v[136:139]
    v_fmaak_f32 v17, v17, v20, 0xc0135761
    v_fmaak_f32 v18, v18, v20, 0xc0135761
    v_mfma_f32_16x16x32_bf16 v[140:143], v[44:47], a[60:63], 0
    v_fmaak_f32 v19, v19, v20, 0xc0135761
    v_mul_f32 v192, v192, v16
    v_mfma_f32_16x16x32_bf16 v[140:143], v[40:43], a[44:47], v[140:143]
    v_mul_f32 v193, v193, v17
    v_mul_f32 v194, v194, v18
    v_mfma_f32_16x16x32_bf16 v[140:143], v[36:39], a[28:31], v[140:143]
    v_mul_f32 v195, v195, v19
    v_mul_f32 v16, v208, v208
    v_mfma_f32_16x16x32_bf16 v[140:143], v[32:35], a[12:15], v[140:143]
    s_waitcnt lgkmcnt(2)
    v_exp_f32 v192, v192
    v_mfma_f32_16x16x32_bf16 v[144:147], v[48:51], a[0:3], 0
    ds_read_b64_tr_b16 v[32:33], v14 offset:0
    v_add_f32 v192, 1.0, v192
    v_mfma_f32_16x16x32_bf16 v[144:147], v[52:55], a[16:19], v[144:147]
    ds_read_b64_tr_b16 v[34:35], v14 offset:2048
    v_mul_f32 v17, v209, v209
    v_mfma_f32_16x16x32_bf16 v[144:147], v[56:59], a[32:35], v[144:147]
    ds_read_b64_tr_b16 v[36:37], v14 offset:4096
    v_mul_f32 v18, v210, v210
    v_mfma_f32_16x16x32_bf16 v[144:147], v[60:63], a[48:51], v[144:147]
    ds_read_b64_tr_b16 v[38:39], v14 offset:6144
    v_mul_f32 v19, v211, v211
    v_mfma_f32_16x16x32_bf16 v[148:151], v[60:63], a[52:55], 0
    ds_read_b64_tr_b16 v[40:41], v14 offset:8192
    v_mul_f32 v240, v208, v240
    v_mfma_f32_16x16x32_bf16 v[148:151], v[56:59], a[36:39], v[148:151]
    ds_read_b64_tr_b16 v[42:43], v14 offset:10240
    v_mul_f32 v241, v209, v241
    v_mfma_f32_16x16x32_bf16 v[148:151], v[52:55], a[20:23], v[148:151]
    ds_read_b64_tr_b16 v[44:45], v14 offset:12288
    v_mul_f32 v242, v210, v242
    v_mfma_f32_16x16x32_bf16 v[148:151], v[48:51], a[4:7], v[148:151]
    ds_read_b64_tr_b16 v[46:47], v14 offset:14336
    v_mul_f32 v243, v211, v243
    v_mfma_f32_16x16x32_bf16 v[152:155], v[48:51], a[8:11], 0
    s_waitcnt lgkmcnt(8)
    buffer_store_dwordx4 v[68:71], v3, s[64:67], s95 offen offset:3072 sc1
    v_fmaak_f32 v16, v16, v20, 0xc0135761
    v_mfma_f32_16x16x32_bf16 v[152:155], v[52:55], a[24:27], v[152:155]
    buffer_store_dwordx4 v[116:119], v3, s[52:55], s74 offen offset:1024 sc1
    v_fmaak_f32 v17, v17, v20, 0xc0135761
    v_mfma_f32_16x16x32_bf16 v[152:155], v[56:59], a[40:43], v[152:155]
    v_exp_f32 v193, v193
    v_mfma_f32_16x16x32_bf16 v[152:155], v[60:63], a[56:59], v[152:155]
    v_exp_f32 v194, v194
    v_mfma_f32_16x16x32_bf16 v[156:159], v[60:63], a[60:63], 0
    v_exp_f32 v195, v195
    v_mfma_f32_16x16x32_bf16 v[156:159], v[56:59], a[44:47], v[156:159]
    v_add_f32 v193, 1.0, v193
    v_add_f32 v194, 1.0, v194
    v_mfma_f32_16x16x32_bf16 v[156:159], v[52:55], a[28:31], v[156:159]
    v_add_f32 v195, 1.0, v195
    v_fmaak_f32 v18, v18, v20, 0xc0135761
    v_mfma_f32_16x16x32_bf16 v[156:159], v[48:51], a[12:15], v[156:159]
    s_waitcnt lgkmcnt(0)
    v_rcp_f32 v192, v192
    v_mfma_f32_16x16x32_bf16 v[160:163], v[32:35], a[0:3], 0
    ds_read_b64_tr_b16 v[48:49], v15 offset:0
    v_mul_f32 v224, v224, v192
    v_mfma_f32_16x16x32_bf16 v[160:163], v[36:39], a[16:19], v[160:163]
    ds_read_b64_tr_b16 v[50:51], v15 offset:2048
    v_fmaak_f32 v19, v19, v20, 0xc0135761
    v_mfma_f32_16x16x32_bf16 v[160:163], v[40:43], a[32:35], v[160:163]
    ds_read_b64_tr_b16 v[52:53], v15 offset:4096
    s_add_u32 s80, s48, 3
    v_mfma_f32_16x16x32_bf16 v[160:163], v[44:47], a[48:51], v[160:163]
    ds_read_b64_tr_b16 v[54:55], v15 offset:6144
    s_and_b32 s80, s80, 3
    v_mfma_f32_16x16x32_bf16 v[164:167], v[44:47], a[52:55], 0
    ds_read_b64_tr_b16 v[56:57], v15 offset:8192
    s_lshl_b32 s80, s80, 20
    v_mfma_f32_16x16x32_bf16 v[164:167], v[40:43], a[36:39], v[164:167]
    ds_read_b64_tr_b16 v[58:59], v15 offset:10240
    s_lshl_b32 s77, s69, 8
    v_mfma_f32_16x16x32_bf16 v[164:167], v[36:39], a[20:23], v[164:167]
    ds_read_b64_tr_b16 v[60:61], v15 offset:12288
    s_add_u32 s80, s80, s77
    v_mfma_f32_16x16x32_bf16 v[164:167], v[32:35], a[4:7], v[164:167]
    ds_read_b64_tr_b16 v[62:63], v15 offset:14336
    v_mul_f32 v208, v208, v16
    v_mfma_f32_16x16x32_bf16 v[168:171], v[32:35], a[8:11], 0
    v_rcp_f32 v193, v193
    v_mfma_f32_16x16x32_bf16 v[168:171], v[36:39], a[24:27], v[168:171]
    v_rcp_f32 v194, v194
    v_mfma_f32_16x16x32_bf16 v[168:171], v[40:43], a[40:43], v[168:171]
    s_waitcnt vmcnt(13)
    s_barrier
    v_mfma_f32_16x16x32_bf16 v[168:171], v[44:47], a[56:59], v[168:171]
    v_rcp_f32 v195, v195
    v_mfma_f32_16x16x32_bf16 v[172:175], v[44:47], a[60:63], 0
    buffer_load_dwordx4 v8, s[16:19], s80 offen lds
    s_add_u32 m0, s78, 118784
    v_mfma_f32_16x16x32_bf16 v[172:175], v[40:43], a[44:47], v[172:175]
    v_mul_f32 v225, v225, v193
    v_mul_f32 v226, v226, v194
    v_mfma_f32_16x16x32_bf16 v[172:175], v[36:39], a[28:31], v[172:175]
    s_add_u32 s80, s80, 262144
    v_mul_f32 v227, v227, v195
    v_cvt_pk_bf16_f32 v192, v224, v225
    v_mfma_f32_16x16x32_bf16 v[172:175], v[32:35], a[12:15], v[172:175]
    s_waitcnt lgkmcnt(0)
    v_cvt_pk_bf16_f32 v193, v226, v227
    v_mul_f32 v209, v209, v17
    v_mfma_f32_16x16x32_bf16 v[176:179], v[48:51], a[0:3], 0
    ds_read_b64_tr_b16 v[32:33], v12 offset:16384
    v_mul_f32 v210, v210, v18
    v_mfma_f32_16x16x32_bf16 v[176:179], v[52:55], a[16:19], v[176:179]
    ds_read_b64_tr_b16 v[34:35], v12 offset:18432
    v_mul_f32 v211, v211, v19
    v_mfma_f32_16x16x32_bf16 v[176:179], v[56:59], a[32:35], v[176:179]
    ds_read_b64_tr_b16 v[36:37], v12 offset:20480
    v_mul_f32 v16, v196, v196
    v_mfma_f32_16x16x32_bf16 v[176:179], v[60:63], a[48:51], v[176:179]
    ds_read_b64_tr_b16 v[38:39], v12 offset:22528
    v_mul_f32 v17, v197, v197
    v_mfma_f32_16x16x32_bf16 v[180:183], v[60:63], a[52:55], 0
    ds_read_b64_tr_b16 v[40:41], v12 offset:24576
    v_mul_f32 v18, v198, v198
    v_mfma_f32_16x16x32_bf16 v[180:183], v[56:59], a[36:39], v[180:183]
    ds_read_b64_tr_b16 v[42:43], v12 offset:26624
    v_mul_f32 v19, v199, v199
    v_mfma_f32_16x16x32_bf16 v[180:183], v[52:55], a[20:23], v[180:183]
    ds_read_b64_tr_b16 v[44:45], v12 offset:28672
    v_mul_f32 v228, v196, v228
    v_mfma_f32_16x16x32_bf16 v[180:183], v[48:51], a[4:7], v[180:183]
    ds_read_b64_tr_b16 v[46:47], v12 offset:30720
    v_mul_f32 v229, v197, v229
    v_mfma_f32_16x16x32_bf16 v[184:187], v[48:51], a[8:11], 0
    buffer_load_dwordx4 v8, s[16:19], s80 offen lds
    s_add_u32 m0, s78, 122880
    v_mfma_f32_16x16x32_bf16 v[184:187], v[52:55], a[24:27], v[184:187]
    s_add_u32 s80, s80, 262144
    buffer_load_dwordx4 v8, s[16:19], s80 offen lds
    s_add_u32 m0, s78, 126976
    v_mfma_f32_16x16x32_bf16 v[184:187], v[56:59], a[40:43], v[184:187]
    s_add_u32 s80, s80, 262144
    buffer_load_dwordx4 v8, s[16:19], s80 offen lds
    s_add_u32 m0, s78, 0
    v_mfma_f32_16x16x32_bf16 v[184:187], v[60:63], a[56:59], v[184:187]
    buffer_store_dwordx4 v[120:123], v3, s[52:55], s74 offen offset:2048 sc1
    v_mul_f32 v230, v198, v230
    v_mfma_f32_16x16x32_bf16 v[188:191], v[60:63], a[60:63], 0
    v_exp_f32 v208, v208
    v_mfma_f32_16x16x32_bf16 v[188:191], v[56:59], a[44:47], v[188:191]
    v_exp_f32 v209, v209
    v_mfma_f32_16x16x32_bf16 v[188:191], v[52:55], a[28:31], v[188:191]
    v_exp_f32 v210, v210
    v_mfma_f32_16x16x32_bf16 v[188:191], v[48:51], a[12:15], v[188:191]
    s_waitcnt lgkmcnt(0)
    v_exp_f32 v211, v211
    v_mfma_f32_16x16x32_bf16 v[128:131], v[32:35], a[64:67], v[128:131]
    ds_read_b64_tr_b16 v[48:49], v13 offset:16384
    v_add_f32 v208, 1.0, v208
    v_mfma_f32_16x16x32_bf16 v[128:131], v[36:39], a[80:83], v[128:131]
    ds_read_b64_tr_b16 v[50:51], v13 offset:18432
    v_add_f32 v209, 1.0, v209
    v_mfma_f32_16x16x32_bf16 v[128:131], v[40:43], a[96:99], v[128:131]
    ds_read_b64_tr_b16 v[52:53], v13 offset:20480
    v_add_f32 v210, 1.0, v210
    v_mfma_f32_16x16x32_bf16 v[128:131], v[44:47], a[112:115], v[128:131]
    ds_read_b64_tr_b16 v[54:55], v13 offset:22528
    v_add_f32 v211, 1.0, v211
    v_mfma_f32_16x16x32_bf16 v[132:135], v[44:47], a[116:119], v[132:135]
    ds_read_b64_tr_b16 v[56:57], v13 offset:24576
    v_mul_f32 v231, v199, v231
    v_mfma_f32_16x16x32_bf16 v[132:135], v[40:43], a[100:103], v[132:135]
    ds_read_b64_tr_b16 v[58:59], v13 offset:26624
    v_fmaak_f32 v16, v16, v20, 0xc0135761
    v_mfma_f32_16x16x32_bf16 v[132:135], v[36:39], a[84:87], v[132:135]
    ds_read_b64_tr_b16 v[60:61], v13 offset:28672
    v_fmaak_f32 v17, v17, v20, 0xc0135761
    v_mfma_f32_16x16x32_bf16 v[132:135], v[32:35], a[68:71], v[132:135]
    ds_read_b64_tr_b16 v[62:63], v13 offset:30720
    v_fmaak_f32 v18, v18, v20, 0xc0135761
    v_mfma_f32_16x16x32_bf16 v[136:139], v[32:35], a[72:75], v[136:139]
    v_rcp_f32 v208, v208
    v_mfma_f32_16x16x32_bf16 v[136:139], v[36:39], a[88:91], v[136:139]
    v_rcp_f32 v209, v209
    v_mfma_f32_16x16x32_bf16 v[136:139], v[40:43], a[104:107], v[136:139]
    v_rcp_f32 v210, v210
    v_mfma_f32_16x16x32_bf16 v[136:139], v[44:47], a[120:123], v[136:139]
    v_rcp_f32 v211, v211
    v_mfma_f32_16x16x32_bf16 v[140:143], v[44:47], a[124:127], v[140:143]
    v_mul_f32 v240, v240, v208
    v_mul_f32 v241, v241, v209
    v_mfma_f32_16x16x32_bf16 v[140:143], v[40:43], a[108:111], v[140:143]
    v_mul_f32 v242, v242, v210
    v_mul_f32 v243, v243, v211
    v_mfma_f32_16x16x32_bf16 v[140:143], v[36:39], a[92:95], v[140:143]
    v_cvt_pk_bf16_f32 v194, v240, v241
    v_cvt_pk_bf16_f32 v195, v242, v243
    v_mfma_f32_16x16x32_bf16 v[140:143], v[32:35], a[76:79], v[140:143]
    s_waitcnt lgkmcnt(0)
    buffer_store_dwordx4 v[192:195], v3, s[56:59], s72 offen offset:0 sc1
    v_fmaak_f32 v19, v19, v20, 0xc0135761
    v_mfma_f32_16x16x32_bf16 v[144:147], v[48:51], a[64:67], v[144:147]
    ds_read_b64_tr_b16 v[32:33], v14 offset:16384
    v_mul_f32 v196, v196, v16
    v_mfma_f32_16x16x32_bf16 v[144:147], v[52:55], a[80:83], v[144:147]
    ds_read_b64_tr_b16 v[34:35], v14 offset:18432
    v_mul_f32 v197, v197, v17
    v_mfma_f32_16x16x32_bf16 v[144:147], v[56:59], a[96:99], v[144:147]
    ds_read_b64_tr_b16 v[36:37], v14 offset:20480
    v_mul_f32 v198, v198, v18
    v_mfma_f32_16x16x32_bf16 v[144:147], v[60:63], a[112:115], v[144:147]
    ds_read_b64_tr_b16 v[38:39], v14 offset:22528
    v_mul_f32 v199, v199, v19
    v_mfma_f32_16x16x32_bf16 v[148:151], v[60:63], a[116:119], v[148:151]
    ds_read_b64_tr_b16 v[40:41], v14 offset:24576
    v_mul_f32 v16, v212, v212
    v_mfma_f32_16x16x32_bf16 v[148:151], v[56:59], a[100:103], v[148:151]
    ds_read_b64_tr_b16 v[42:43], v14 offset:26624
    v_mul_f32 v17, v213, v213
    v_mfma_f32_16x16x32_bf16 v[148:151], v[52:55], a[84:87], v[148:151]
    ds_read_b64_tr_b16 v[44:45], v14 offset:28672
    v_mul_f32 v18, v214, v214
    v_mfma_f32_16x16x32_bf16 v[148:151], v[48:51], a[68:71], v[148:151]
    ds_read_b64_tr_b16 v[46:47], v14 offset:30720
    v_mul_f32 v19, v215, v215
    v_mfma_f32_16x16x32_bf16 v[152:155], v[48:51], a[72:75], v[152:155]
    buffer_store_dwordx4 v[124:127], v3, s[52:55], s74 offen offset:3072 sc1
    v_mul_f32 v244, v212, v244
    v_mfma_f32_16x16x32_bf16 v[152:155], v[52:55], a[88:91], v[152:155]
    v_exp_f32 v196, v196
    v_mfma_f32_16x16x32_bf16 v[152:155], v[56:59], a[104:107], v[152:155]
    v_exp_f32 v197, v197
    v_mfma_f32_16x16x32_bf16 v[152:155], v[60:63], a[120:123], v[152:155]
    v_exp_f32 v198, v198
    v_mfma_f32_16x16x32_bf16 v[156:159], v[60:63], a[124:127], v[156:159]
    v_exp_f32 v199, v199
    v_mfma_f32_16x16x32_bf16 v[156:159], v[56:59], a[108:111], v[156:159]
    v_add_f32 v196, 1.0, v196
    v_add_f32 v197, 1.0, v197
    v_mfma_f32_16x16x32_bf16 v[156:159], v[52:55], a[92:95], v[156:159]
    v_add_f32 v198, 1.0, v198
    v_add_f32 v199, 1.0, v199
    v_mfma_f32_16x16x32_bf16 v[156:159], v[48:51], a[76:79], v[156:159]
    s_waitcnt lgkmcnt(0)
    v_rcp_f32 v196, v196
    v_mfma_f32_16x16x32_bf16 v[160:163], v[32:35], a[64:67], v[160:163]
    ds_read_b64_tr_b16 v[48:49], v15 offset:16384
    v_mul_f32 v228, v228, v196
    v_mfma_f32_16x16x32_bf16 v[160:163], v[36:39], a[80:83], v[160:163]
    ds_read_b64_tr_b16 v[50:51], v15 offset:18432
    v_mul_f32 v245, v213, v245
    v_mfma_f32_16x16x32_bf16 v[160:163], v[40:43], a[96:99], v[160:163]
    ds_read_b64_tr_b16 v[52:53], v15 offset:20480
    s_add_u32 s80, s48, 0
    v_mfma_f32_16x16x32_bf16 v[160:163], v[44:47], a[112:115], v[160:163]
    ds_read_b64_tr_b16 v[54:55], v15 offset:22528
    s_and_b32 s80, s80, 3
    v_mfma_f32_16x16x32_bf16 v[164:167], v[44:47], a[116:119], v[164:167]
    ds_read_b64_tr_b16 v[56:57], v15 offset:24576
    s_lshl_b32 s80, s80, 20
    v_mfma_f32_16x16x32_bf16 v[164:167], v[40:43], a[100:103], v[164:167]
    ds_read_b64_tr_b16 v[58:59], v15 offset:26624
    s_lshl_b32 s77, s69, 8
    v_mfma_f32_16x16x32_bf16 v[164:167], v[36:39], a[84:87], v[164:167]
    ds_read_b64_tr_b16 v[60:61], v15 offset:28672
    s_add_u32 s80, s80, s77
    v_mfma_f32_16x16x32_bf16 v[164:167], v[32:35], a[68:71], v[164:167]
    ds_read_b64_tr_b16 v[62:63], v15 offset:30720
    s_add_u32 s80, s80, 128
    v_mfma_f32_16x16x32_bf16 v[168:171], v[32:35], a[72:75], v[168:171]
    v_rcp_f32 v197, v197
    v_mfma_f32_16x16x32_bf16 v[168:171], v[36:39], a[88:91], v[168:171]
    v_rcp_f32 v198, v198
    v_mfma_f32_16x16x32_bf16 v[168:171], v[40:43], a[104:107], v[168:171]
    s_waitcnt vmcnt(12)
    s_barrier
    v_mfma_f32_16x16x32_bf16 v[168:171], v[44:47], a[120:123], v[168:171]
    v_rcp_f32 v199, v199
    v_mfma_f32_16x16x32_bf16 v[172:175], v[44:47], a[124:127], v[172:175]
    buffer_load_dwordx4 v8, s[16:19], s80 offen lds
    s_add_u32 m0, s78, 4096
    v_mfma_f32_16x16x32_bf16 v[172:175], v[40:43], a[108:111], v[172:175]
    v_mul_f32 v229, v229, v197
    v_mul_f32 v230, v230, v198
    v_mfma_f32_16x16x32_bf16 v[172:175], v[36:39], a[92:95], v[172:175]
    s_add_u32 s80, s80, 262144
    v_mul_f32 v231, v231, v199
    v_cvt_pk_bf16_f32 v196, v228, v229
    v_mfma_f32_16x16x32_bf16 v[172:175], v[32:35], a[76:79], v[172:175]
    s_waitcnt lgkmcnt(0)
    v_cvt_pk_bf16_f32 v197, v230, v231
    v_mul_f32 v246, v214, v246
    v_mfma_f32_16x16x32_bf16 v[176:179], v[48:51], a[64:67], v[176:179]
    ds_read_b64_tr_b16 v[32:33], v12 offset:32768
    v_mul_f32 v247, v215, v247
    v_mfma_f32_16x16x32_bf16 v[176:179], v[52:55], a[80:83], v[176:179]
    ds_read_b64_tr_b16 v[34:35], v12 offset:34816
    v_fmaak_f32 v16, v16, v20, 0xc0135761
    v_mfma_f32_16x16x32_bf16 v[176:179], v[56:59], a[96:99], v[176:179]
    ds_read_b64_tr_b16 v[36:37], v12 offset:36864
    v_fmaak_f32 v17, v17, v20, 0xc0135761
    v_mfma_f32_16x16x32_bf16 v[176:179], v[60:63], a[112:115], v[176:179]
    ds_read_b64_tr_b16 v[38:39], v12 offset:38912
    v_fmaak_f32 v18, v18, v20, 0xc0135761
    v_mfma_f32_16x16x32_bf16 v[180:183], v[60:63], a[116:119], v[180:183]
    ds_read_b64_tr_b16 v[40:41], v12 offset:40960
    v_fmaak_f32 v19, v19, v20, 0xc0135761
    v_mfma_f32_16x16x32_bf16 v[180:183], v[56:59], a[100:103], v[180:183]
    ds_read_b64_tr_b16 v[42:43], v12 offset:43008
    v_mul_f32 v212, v212, v16
    v_mfma_f32_16x16x32_bf16 v[180:183], v[52:55], a[84:87], v[180:183]
    ds_read_b64_tr_b16 v[44:45], v12 offset:45056
    v_mul_f32 v213, v213, v17
    v_mfma_f32_16x16x32_bf16 v[180:183], v[48:51], a[68:71], v[180:183]
    ds_read_b64_tr_b16 v[46:47], v12 offset:47104
    v_mul_f32 v214, v214, v18
    v_mfma_f32_16x16x32_bf16 v[184:187], v[48:51], a[72:75], v[184:187]
    buffer_load_dwordx4 v8, s[16:19], s80 offen lds
    s_add_u32 m0, s78, 8192
    v_mfma_f32_16x16x32_bf16 v[184:187], v[52:55], a[88:91], v[184:187]
    s_add_u32 s80, s80, 262144
    buffer_load_dwordx4 v8, s[16:19], s80 offen lds
    s_add_u32 m0, s78, 12288
    v_mfma_f32_16x16x32_bf16 v[184:187], v[56:59], a[104:107], v[184:187]
    s_add_u32 s80, s80, 262144
    buffer_load_dwordx4 v8, s[16:19], s80 offen lds
    s_add_u32 m0, s78, 16384
    v_mfma_f32_16x16x32_bf16 v[184:187], v[60:63], a[120:123], v[184:187]
    v_mul_f32 v215, v215, v19
    v_mul_f32 v16, v200, v200
    v_mfma_f32_16x16x32_bf16 v[188:191], v[60:63], a[124:127], v[188:191]
    v_exp_f32 v212, v212
    v_mfma_f32_16x16x32_bf16 v[188:191], v[56:59], a[108:111], v[188:191]
    v_exp_f32 v213, v213
    v_mfma_f32_16x16x32_bf16 v[188:191], v[52:55], a[92:95], v[188:191]
    v_exp_f32 v214, v214
    v_mfma_f32_16x16x32_bf16 v[188:191], v[48:51], a[76:79], v[188:191]
    s_waitcnt lgkmcnt(0)
    v_exp_f32 v215, v215
    v_mfma_f32_16x16x32_bf16 v[128:131], v[32:35], a[128:131], v[128:131]
    ds_read_b64_tr_b16 v[48:49], v13 offset:32768
    v_add_f32 v212, 1.0, v212
    v_mfma_f32_16x16x32_bf16 v[128:131], v[36:39], a[144:147], v[128:131]
    ds_read_b64_tr_b16 v[50:51], v13 offset:34816
    v_add_f32 v213, 1.0, v213
    v_mfma_f32_16x16x32_bf16 v[128:131], v[40:43], a[160:163], v[128:131]
    ds_read_b64_tr_b16 v[52:53], v13 offset:36864
    v_add_f32 v214, 1.0, v214
    v_mfma_f32_16x16x32_bf16 v[128:131], v[44:47], a[176:179], v[128:131]
    ds_read_b64_tr_b16 v[54:55], v13 offset:38912
    v_add_f32 v215, 1.0, v215
    v_mfma_f32_16x16x32_bf16 v[132:135], v[44:47], a[180:183], v[132:135]
    ds_read_b64_tr_b16 v[56:57], v13 offset:40960
    v_mul_f32 v17, v201, v201
    v_mfma_f32_16x16x32_bf16 v[132:135], v[40:43], a[164:167], v[132:135]
    ds_read_b64_tr_b16 v[58:59], v13 offset:43008
    v_mul_f32 v18, v202, v202
    v_mfma_f32_16x16x32_bf16 v[132:135], v[36:39], a[148:151], v[132:135]
    ds_read_b64_tr_b16 v[60:61], v13 offset:45056
    v_mul_f32 v19, v203, v203
    v_mfma_f32_16x16x32_bf16 v[132:135], v[32:35], a[132:135], v[132:135]
    ds_read_b64_tr_b16 v[62:63], v13 offset:47104
    v_mul_f32 v232, v200, v232
    v_mfma_f32_16x16x32_bf16 v[136:139], v[32:35], a[136:139], v[136:139]
    v_rcp_f32 v212, v212
    v_mfma_f32_16x16x32_bf16 v[136:139], v[36:39], a[152:155], v[136:139]
    v_rcp_f32 v213, v213
    v_mfma_f32_16x16x32_bf16 v[136:139], v[40:43], a[168:171], v[136:139]
    v_rcp_f32 v214, v214
    v_mfma_f32_16x16x32_bf16 v[136:139], v[44:47], a[184:187], v[136:139]
    v_rcp_f32 v215, v215
    v_mfma_f32_16x16x32_bf16 v[140:143], v[44:47], a[188:191], v[140:143]
    v_mul_f32 v244, v244, v212
    v_mul_f32 v245, v245, v213
    v_mfma_f32_16x16x32_bf16 v[140:143], v[40:43], a[172:175], v[140:143]
    v_mul_f32 v246, v246, v214
    v_mul_f32 v247, v247, v215
    v_mfma_f32_16x16x32_bf16 v[140:143], v[36:39], a[156:159], v[140:143]
    v_cvt_pk_bf16_f32 v198, v244, v245
    v_cvt_pk_bf16_f32 v199, v246, v247
    v_mfma_f32_16x16x32_bf16 v[140:143], v[32:35], a[140:143], v[140:143]
    s_waitcnt lgkmcnt(0)
    buffer_store_dwordx4 v[196:199], v3, s[56:59], s72 offen offset:1024 sc1
    v_mul_f32 v233, v201, v233
    v_mfma_f32_16x16x32_bf16 v[144:147], v[48:51], a[128:131], v[144:147]
    ds_read_b64_tr_b16 v[32:33], v14 offset:32768
    v_mul_f32 v234, v202, v234
    v_mfma_f32_16x16x32_bf16 v[144:147], v[52:55], a[144:147], v[144:147]
    ds_read_b64_tr_b16 v[34:35], v14 offset:34816
    v_mul_f32 v235, v203, v235
    v_mfma_f32_16x16x32_bf16 v[144:147], v[56:59], a[160:163], v[144:147]
    ds_read_b64_tr_b16 v[36:37], v14 offset:36864
    v_fmaak_f32 v16, v16, v20, 0xc0135761
    v_mfma_f32_16x16x32_bf16 v[144:147], v[60:63], a[176:179], v[144:147]
    ds_read_b64_tr_b16 v[38:39], v14 offset:38912
    v_fmaak_f32 v17, v17, v20, 0xc0135761
    v_mfma_f32_16x16x32_bf16 v[148:151], v[60:63], a[180:183], v[148:151]
    ds_read_b64_tr_b16 v[40:41], v14 offset:40960
    v_fmaak_f32 v18, v18, v20, 0xc0135761
    v_mfma_f32_16x16x32_bf16 v[148:151], v[56:59], a[164:167], v[148:151]
    ds_read_b64_tr_b16 v[42:43], v14 offset:43008
    v_fmaak_f32 v19, v19, v20, 0xc0135761
    v_mfma_f32_16x16x32_bf16 v[148:151], v[52:55], a[148:151], v[148:151]
    ds_read_b64_tr_b16 v[44:45], v14 offset:45056
    v_mul_f32 v200, v200, v16
    v_mfma_f32_16x16x32_bf16 v[148:151], v[48:51], a[132:135], v[148:151]
    ds_read_b64_tr_b16 v[46:47], v14 offset:47104
    v_mul_f32 v201, v201, v17
    v_mfma_f32_16x16x32_bf16 v[152:155], v[48:51], a[136:139], v[152:155]
    v_mul_f32 v202, v202, v18
    v_mul_f32 v203, v203, v19
    v_mfma_f32_16x16x32_bf16 v[152:155], v[52:55], a[152:155], v[152:155]
    v_exp_f32 v200, v200
    v_mfma_f32_16x16x32_bf16 v[152:155], v[56:59], a[168:171], v[152:155]
    v_exp_f32 v201, v201
    v_mfma_f32_16x16x32_bf16 v[152:155], v[60:63], a[184:187], v[152:155]
    v_exp_f32 v202, v202
    v_mfma_f32_16x16x32_bf16 v[156:159], v[60:63], a[188:191], v[156:159]
    v_exp_f32 v203, v203
    v_mfma_f32_16x16x32_bf16 v[156:159], v[56:59], a[172:175], v[156:159]
    v_add_f32 v200, 1.0, v200
    v_add_f32 v201, 1.0, v201
    v_mfma_f32_16x16x32_bf16 v[156:159], v[52:55], a[156:159], v[156:159]
    v_add_f32 v202, 1.0, v202
    v_add_f32 v203, 1.0, v203
    v_mfma_f32_16x16x32_bf16 v[156:159], v[48:51], a[140:143], v[156:159]
    s_waitcnt lgkmcnt(0)
    v_rcp_f32 v200, v200
    v_mfma_f32_16x16x32_bf16 v[160:163], v[32:35], a[128:131], v[160:163]
    ds_read_b64_tr_b16 v[48:49], v15 offset:32768
    v_mul_f32 v232, v232, v200
    v_mfma_f32_16x16x32_bf16 v[160:163], v[36:39], a[144:147], v[160:163]
    ds_read_b64_tr_b16 v[50:51], v15 offset:34816
    v_mul_f32 v16, v216, v216
    v_mfma_f32_16x16x32_bf16 v[160:163], v[40:43], a[160:163], v[160:163]
    ds_read_b64_tr_b16 v[52:53], v15 offset:36864
    s_add_u32 s80, s48, 1
    v_mfma_f32_16x16x32_bf16 v[160:163], v[44:47], a[176:179], v[160:163]
    ds_read_b64_tr_b16 v[54:55], v15 offset:38912
    s_and_b32 s80, s80, 3
    v_mfma_f32_16x16x32_bf16 v[164:167], v[44:47], a[180:183], v[164:167]
    ds_read_b64_tr_b16 v[56:57], v15 offset:40960
    s_lshl_b32 s80, s80, 20
    v_mfma_f32_16x16x32_bf16 v[164:167], v[40:43], a[164:167], v[164:167]
    ds_read_b64_tr_b16 v[58:59], v15 offset:43008
    s_lshl_b32 s77, s69, 8
    v_mfma_f32_16x16x32_bf16 v[164:167], v[36:39], a[148:151], v[164:167]
    ds_read_b64_tr_b16 v[60:61], v15 offset:45056
    s_add_u32 s80, s80, s77
    v_mfma_f32_16x16x32_bf16 v[164:167], v[32:35], a[132:135], v[164:167]
    ds_read_b64_tr_b16 v[62:63], v15 offset:47104
    s_add_u32 s80, s80, 128
    v_mfma_f32_16x16x32_bf16 v[168:171], v[32:35], a[136:139], v[168:171]
    v_rcp_f32 v201, v201
    v_mfma_f32_16x16x32_bf16 v[168:171], v[36:39], a[152:155], v[168:171]
    v_rcp_f32 v202, v202
    v_mfma_f32_16x16x32_bf16 v[168:171], v[40:43], a[168:171], v[168:171]
    s_waitcnt vmcnt(5)
    s_barrier
    s_and_b32 s101, s2, 31
    s_lshl_b32 s101, s101, 7
    s_lshl_b32 s6, s70, 2
    s_add_u32 s101, s101, s6
    s_add_u32 s101, s101, 11542528
    v_mov_b32 v22, s3
    v_add_u32 v23, s78, v1
    v_min_u32 v23, 1, v23
    v_lshlrev_b32 v23, 30, v23
    buffer_store_dword v22, v23, s[52:55], s101 offen sc1
    v_mfma_f32_16x16x32_bf16 v[168:171], v[44:47], a[184:187], v[168:171]
    v_rcp_f32 v203, v203
    v_mfma_f32_16x16x32_bf16 v[172:175], v[44:47], a[188:191], v[172:175]
    buffer_load_dwordx4 v8, s[16:19], s80 offen lds
    s_add_u32 m0, s78, 20480
    v_mfma_f32_16x16x32_bf16 v[172:175], v[40:43], a[172:175], v[172:175]
    v_mul_f32 v233, v233, v201
    v_mul_f32 v234, v234, v202
    v_mfma_f32_16x16x32_bf16 v[172:175], v[36:39], a[156:159], v[172:175]
    s_add_u32 s80, s80, 262144
    v_mul_f32 v235, v235, v203
    v_cvt_pk_bf16_f32 v200, v232, v233
    v_mfma_f32_16x16x32_bf16 v[172:175], v[32:35], a[140:143], v[172:175]
    s_waitcnt lgkmcnt(0)
    v_cvt_pk_bf16_f32 v201, v234, v235
    v_mul_f32 v17, v217, v217
    v_mfma_f32_16x16x32_bf16 v[176:179], v[48:51], a[128:131], v[176:179]
    ds_read_b64_tr_b16 v[32:33], v12 offset:49152
    v_mul_f32 v18, v218, v218
    v_mfma_f32_16x16x32_bf16 v[176:179], v[52:55], a[144:147], v[176:179]
    ds_read_b64_tr_b16 v[34:35], v12 offset:51200
    v_mul_f32 v19, v219, v219
    v_mfma_f32_16x16x32_bf16 v[176:179], v[56:59], a[160:163], v[176:179]
    ds_read_b64_tr_b16 v[36:37], v12 offset:53248
    v_mul_f32 v248, v216, v248
    v_mfma_f32_16x16x32_bf16 v[176:179], v[60:63], a[176:179], v[176:179]
    ds_read_b64_tr_b16 v[38:39], v12 offset:55296
    v_mul_f32 v249, v217, v249
    v_mfma_f32_16x16x32_bf16 v[180:183], v[60:63], a[180:183], v[180:183]
    ds_read_b64_tr_b16 v[40:41], v12 offset:57344
    v_mul_f32 v250, v218, v250
    v_mfma_f32_16x16x32_bf16 v[180:183], v[56:59], a[164:167], v[180:183]
    ds_read_b64_tr_b16 v[42:43], v12 offset:59392
    v_mul_f32 v251, v219, v251
    v_mfma_f32_16x16x32_bf16 v[180:183], v[52:55], a[148:151], v[180:183]
    ds_read_b64_tr_b16 v[44:45], v12 offset:61440
    v_fmaak_f32 v16, v16, v20, 0xc0135761
    v_mfma_f32_16x16x32_bf16 v[180:183], v[48:51], a[132:135], v[180:183]
    ds_read_b64_tr_b16 v[46:47], v12 offset:63488
    v_fmaak_f32 v17, v17, v20, 0xc0135761
    v_mfma_f32_16x16x32_bf16 v[184:187], v[48:51], a[136:139], v[184:187]
    buffer_load_dwordx4 v8, s[16:19], s80 offen lds
    s_add_u32 m0, s78, 24576
    v_mfma_f32_16x16x32_bf16 v[184:187], v[52:55], a[152:155], v[184:187]
    s_add_u32 s80, s80, 262144
    buffer_load_dwordx4 v8, s[16:19], s80 offen lds
    s_add_u32 m0, s78, 28672
    v_mfma_f32_16x16x32_bf16 v[184:187], v[56:59], a[168:171], v[184:187]
    s_add_u32 s80, s80, 262144
    buffer_load_dwordx4 v8, s[16:19], s80 offen lds
    s_add_u32 m0, s78, 32768
    v_mfma_f32_16x16x32_bf16 v[184:187], v[60:63], a[184:187], v[184:187]
    v_fmaak_f32 v18, v18, v20, 0xc0135761
    v_fmaak_f32 v19, v19, v20, 0xc0135761
    v_mfma_f32_16x16x32_bf16 v[188:191], v[60:63], a[188:191], v[188:191]
    v_mul_f32 v216, v216, v16
    v_mul_f32 v217, v217, v17
    v_mfma_f32_16x16x32_bf16 v[188:191], v[56:59], a[172:175], v[188:191]
    v_mul_f32 v218, v218, v18
    v_mul_f32 v219, v219, v19
    v_mfma_f32_16x16x32_bf16 v[188:191], v[52:55], a[156:159], v[188:191]
    v_exp_f32 v216, v216
    v_mfma_f32_16x16x32_bf16 v[188:191], v[48:51], a[140:143], v[188:191]
    s_waitcnt lgkmcnt(0)
    v_exp_f32 v217, v217
    v_mfma_f32_16x16x32_bf16 v[128:131], v[32:35], a[192:195], v[128:131]
    ds_read_b64_tr_b16 v[48:49], v13 offset:49152
    v_add_f32 v216, 1.0, v216
    v_mfma_f32_16x16x32_bf16 v[128:131], v[36:39], a[208:211], v[128:131]
    ds_read_b64_tr_b16 v[50:51], v13 offset:51200
    v_add_f32 v217, 1.0, v217
    v_mfma_f32_16x16x32_bf16 v[128:131], v[40:43], a[224:227], v[128:131]
    ds_read_b64_tr_b16 v[52:53], v13 offset:53248
    v_mul_f32 v16, v204, v204
    v_mfma_f32_16x16x32_bf16 v[128:131], v[44:47], a[240:243], v[128:131]
    ds_read_b64_tr_b16 v[54:55], v13 offset:55296
    v_mul_f32 v17, v205, v205
    v_mfma_f32_16x16x32_bf16 v[132:135], v[44:47], a[244:247], v[132:135]
    ds_read_b64_tr_b16 v[56:57], v13 offset:57344
    s_and_b32 s77, s2, 31
    v_mfma_f32_16x16x32_bf16 v[132:135], v[40:43], a[228:231], v[132:135]
    ds_read_b64_tr_b16 v[58:59], v13 offset:59392
    s_lshl_b32 s77, s77, 7
    v_mfma_f32_16x16x32_bf16 v[132:135], v[36:39], a[212:215], v[132:135]
    ds_read_b64_tr_b16 v[60:61], v13 offset:61440
    s_add_u32 s77, s77, 11542528
    v_mfma_f32_16x16x32_bf16 v[132:135], v[32:35], a[196:199], v[132:135]
    ds_read_b64_tr_b16 v[62:63], v13 offset:63488
    v_and_b32 v29, 7, v1
    v_mfma_f32_16x16x32_bf16 v[136:139], v[32:35], a[200:203], v[136:139]
    v_lshlrev_b32 v29, 2, v29
    v_add_u32 v29, s77, v29
    v_mfma_f32_16x16x32_bf16 v[136:139], v[36:39], a[216:219], v[136:139]
    v_exp_f32 v218, v218
    v_mfma_f32_16x16x32_bf16 v[136:139], v[40:43], a[232:235], v[136:139]
    v_exp_f32 v219, v219
    v_mfma_f32_16x16x32_bf16 v[136:139], v[44:47], a[248:251], v[136:139]
    v_add_f32 v218, 1.0, v218
    v_add_f32 v219, 1.0, v219
    v_mfma_f32_16x16x32_bf16 v[140:143], v[44:47], a[252:255], v[140:143]
    v_rcp_f32 v216, v216
    v_mfma_f32_16x16x32_bf16 v[140:143], v[40:43], a[236:239], v[140:143]
    v_rcp_f32 v217, v217
    v_mfma_f32_16x16x32_bf16 v[140:143], v[36:39], a[220:223], v[140:143]
    v_rcp_f32 v218, v218
    v_mfma_f32_16x16x32_bf16 v[140:143], v[32:35], a[204:207], v[140:143]
    s_waitcnt lgkmcnt(0)
    v_rcp_f32 v219, v219
    v_mfma_f32_16x16x32_bf16 v[144:147], v[48:51], a[192:195], v[144:147]
    ds_read_b64_tr_b16 v[32:33], v14 offset:49152
    v_mul_f32 v248, v248, v216
    v_mfma_f32_16x16x32_bf16 v[144:147], v[52:55], a[208:211], v[144:147]
    ds_read_b64_tr_b16 v[34:35], v14 offset:51200
    v_mul_f32 v249, v249, v217
    v_mfma_f32_16x16x32_bf16 v[144:147], v[56:59], a[224:227], v[144:147]
    ds_read_b64_tr_b16 v[36:37], v14 offset:53248
    v_mul_f32 v250, v250, v218
    v_mfma_f32_16x16x32_bf16 v[144:147], v[60:63], a[240:243], v[144:147]
    ds_read_b64_tr_b16 v[38:39], v14 offset:55296
    v_mul_f32 v251, v251, v219
    v_mfma_f32_16x16x32_bf16 v[148:151], v[60:63], a[244:247], v[148:151]
    ds_read_b64_tr_b16 v[40:41], v14 offset:57344
    v_cvt_pk_bf16_f32 v202, v248, v249
    v_mfma_f32_16x16x32_bf16 v[148:151], v[56:59], a[228:231], v[148:151]
    ds_read_b64_tr_b16 v[42:43], v14 offset:59392
    v_cvt_pk_bf16_f32 v203, v250, v251
    v_mfma_f32_16x16x32_bf16 v[148:151], v[52:55], a[212:215], v[148:151]
    ds_read_b64_tr_b16 v[44:45], v14 offset:61440
    v_mul_f32 v18, v206, v206
    v_mfma_f32_16x16x32_bf16 v[148:151], v[48:51], a[196:199], v[148:151]
    ds_read_b64_tr_b16 v[46:47], v14 offset:63488
    v_mul_f32 v19, v207, v207
    v_mfma_f32_16x16x32_bf16 v[152:155], v[48:51], a[200:203], v[152:155]
    buffer_store_dwordx4 v[200:203], v3, s[56:59], s72 offen offset:2048 sc1
    v_mul_f32 v236, v204, v236
    v_mfma_f32_16x16x32_bf16 v[152:155], v[52:55], a[216:219], v[152:155]
    v_mul_f32 v237, v205, v237
    v_mul_f32 v238, v206, v238
    v_mfma_f32_16x16x32_bf16 v[152:155], v[56:59], a[232:235], v[152:155]
    v_mul_f32 v239, v207, v239
    v_fmaak_f32 v16, v16, v20, 0xc0135761
    v_mfma_f32_16x16x32_bf16 v[152:155], v[60:63], a[248:251], v[152:155]
    v_fmaak_f32 v17, v17, v20, 0xc0135761
    v_fmaak_f32 v18, v18, v20, 0xc0135761
    v_mfma_f32_16x16x32_bf16 v[156:159], v[60:63], a[252:255], v[156:159]
    v_fmaak_f32 v19, v19, v20, 0xc0135761
    v_mul_f32 v204, v204, v16
    v_mfma_f32_16x16x32_bf16 v[156:159], v[56:59], a[236:239], v[156:159]
    v_mul_f32 v205, v205, v17
    v_mul_f32 v206, v206, v18
    v_mfma_f32_16x16x32_bf16 v[156:159], v[52:55], a[220:223], v[156:159]
    v_mul_f32 v207, v207, v19
    v_mul_f32 v16, v220, v220
    v_mfma_f32_16x16x32_bf16 v[156:159], v[48:51], a[204:207], v[156:159]
    s_waitcnt lgkmcnt(0)
    v_exp_f32 v204, v204
    v_mfma_f32_16x16x32_bf16 v[160:163], v[32:35], a[192:195], v[160:163]
    ds_read_b64_tr_b16 v[48:49], v15 offset:49152
    v_add_f32 v204, 1.0, v204
    v_mfma_f32_16x16x32_bf16 v[160:163], v[36:39], a[208:211], v[160:163]
    ds_read_b64_tr_b16 v[50:51], v15 offset:51200
    v_mul_f32 v17, v221, v221
    v_mfma_f32_16x16x32_bf16 v[160:163], v[40:43], a[224:227], v[160:163]
    ds_read_b64_tr_b16 v[52:53], v15 offset:53248
    s_add_u32 s80, s48, 2
    v_mfma_f32_16x16x32_bf16 v[160:163], v[44:47], a[240:243], v[160:163]
    ds_read_b64_tr_b16 v[54:55], v15 offset:55296
    s_and_b32 s80, s80, 3
    v_mfma_f32_16x16x32_bf16 v[164:167], v[44:47], a[244:247], v[164:167]
    ds_read_b64_tr_b16 v[56:57], v15 offset:57344
    s_lshl_b32 s80, s80, 20
    v_mfma_f32_16x16x32_bf16 v[164:167], v[40:43], a[228:231], v[164:167]
    ds_read_b64_tr_b16 v[58:59], v15 offset:59392
    s_lshl_b32 s77, s69, 8
    v_mfma_f32_16x16x32_bf16 v[164:167], v[36:39], a[212:215], v[164:167]
    ds_read_b64_tr_b16 v[60:61], v15 offset:61440
    s_add_u32 s80, s80, s77
    v_mfma_f32_16x16x32_bf16 v[164:167], v[32:35], a[196:199], v[164:167]
    ds_read_b64_tr_b16 v[62:63], v15 offset:63488
    s_add_u32 s80, s80, 128
    v_mfma_f32_16x16x32_bf16 v[168:171], v[32:35], a[200:203], v[168:171]
    v_exp_f32 v205, v205
    v_mfma_f32_16x16x32_bf16 v[168:171], v[36:39], a[216:219], v[168:171]
    v_exp_f32 v206, v206
    v_mfma_f32_16x16x32_bf16 v[168:171], v[40:43], a[232:235], v[168:171]
    s_waitcnt vmcnt(7)
    s_barrier
    v_mfma_f32_16x16x32_bf16 v[168:171], v[44:47], a[248:251], v[168:171]
    v_exp_f32 v207, v207
    v_mfma_f32_16x16x32_bf16 v[172:175], v[44:47], a[252:255], v[172:175]
    buffer_load_dwordx4 v8, s[16:19], s80 offen lds
    s_add_u32 m0, s78, 36864
    v_mfma_f32_16x16x32_bf16 v[172:175], v[40:43], a[236:239], v[172:175]
    v_add_f32 v205, 1.0, v205
    v_add_f32 v206, 1.0, v206
    v_mfma_f32_16x16x32_bf16 v[172:175], v[36:39], a[220:223], v[172:175]
    s_add_u32 s80, s80, 262144
    v_add_f32 v207, 1.0, v207
    v_mul_f32 v18, v222, v222
    v_mfma_f32_16x16x32_bf16 v[172:175], v[32:35], a[204:207], v[172:175]
    s_waitcnt lgkmcnt(0)
    v_rcp_f32 v204, v204
    v_mfma_f32_16x16x32_bf16 v[176:179], v[48:51], a[192:195], v[176:179]
    ds_read_b64_tr_b16 v[32:33], v4 offset:0
    v_mul_f32 v236, v236, v204
    v_mfma_f32_16x16x32_bf16 v[176:179], v[52:55], a[208:211], v[176:179]
    ds_read_b64_tr_b16 v[34:35], v4 offset:2048
    v_mul_f32 v19, v223, v223
    v_mfma_f32_16x16x32_bf16 v[176:179], v[56:59], a[224:227], v[176:179]
    ds_read_b64_tr_b16 v[36:37], v4 offset:4096
    v_mul_f32 v252, v220, v252
    v_mfma_f32_16x16x32_bf16 v[176:179], v[60:63], a[240:243], v[176:179]
    ds_read_b64_tr_b16 v[38:39], v4 offset:6144
    v_mul_f32 v253, v221, v253
    v_mfma_f32_16x16x32_bf16 v[180:183], v[60:63], a[244:247], v[180:183]
    ds_read_b64_tr_b16 v[40:41], v4 offset:8192
    v_mul_f32 v254, v222, v254
    v_mfma_f32_16x16x32_bf16 v[180:183], v[56:59], a[228:231], v[180:183]
    ds_read_b64_tr_b16 v[42:43], v4 offset:10240
    v_mul_f32 v255, v223, v255
    v_mfma_f32_16x16x32_bf16 v[180:183], v[52:55], a[212:215], v[180:183]
    ds_read_b64_tr_b16 v[44:45], v4 offset:12288
    v_fmaak_f32 v16, v16, v20, 0xc0135761
    v_mfma_f32_16x16x32_bf16 v[180:183], v[48:51], a[196:199], v[180:183]
    ds_read_b64_tr_b16 v[46:47], v4 offset:14336
    v_fmaak_f32 v17, v17, v20, 0xc0135761
    v_mfma_f32_16x16x32_bf16 v[184:187], v[48:51], a[200:203], v[184:187]
    buffer_load_dwordx4 v8, s[16:19], s80 offen lds
    s_add_u32 m0, s78, 40960
    v_mfma_f32_16x16x32_bf16 v[184:187], v[52:55], a[216:219], v[184:187]
    s_add_u32 s80, s80, 262144
    buffer_load_dwordx4 v8, s[16:19], s80 offen lds
    s_add_u32 m0, s78, 45056
    v_mfma_f32_16x16x32_bf16 v[184:187], v[56:59], a[232:235], v[184:187]
    s_add_u32 s80, s80, 262144
    buffer_load_dwordx4 v8, s[16:19], s80 offen lds
    s_add_u32 m0, s78, 49152
    v_mfma_f32_16x16x32_bf16 v[184:187], v[60:63], a[248:251], v[184:187]
    v_rcp_f32 v205, v205
    v_mfma_f32_16x16x32_bf16 v[188:191], v[60:63], a[252:255], v[188:191]
    v_rcp_f32 v206, v206
    v_mfma_f32_16x16x32_bf16 v[188:191], v[56:59], a[236:239], v[188:191]
    v_rcp_f32 v207, v207
    v_mfma_f32_16x16x32_bf16 v[188:191], v[52:55], a[220:223], v[188:191]
    v_mul_f32 v237, v237, v205
    v_mul_f32 v238, v238, v206
    v_mfma_f32_16x16x32_bf16 v[188:191], v[48:51], a[204:207], v[188:191]
    v_mul_f32 v239, v239, v207
    v_cvt_pk_bf16_f32 v204, v236, v237
    v_cvt_pk_bf16_f32 v205, v238, v239
    v_fmaak_f32 v18, v18, v20, 0xc0135761
    v_fmaak_f32 v19, v19, v20, 0xc0135761
    v_mul_f32 v220, v220, v16
    v_mul_f32 v221, v221, v17
    v_mul_f32 v222, v222, v18
    v_mul_f32 v223, v223, v19
    v_exp_f32 v220, v220
    v_exp_f32 v221, v221
    v_exp_f32 v222, v222
    v_exp_f32 v223, v223
    v_add_f32 v220, 1.0, v220
    v_add_f32 v221, 1.0, v221
    v_add_f32 v222, 1.0, v222
    v_add_f32 v223, 1.0, v223
    v_rcp_f32 v220, v220
    v_rcp_f32 v221, v221
    v_rcp_f32 v222, v222
    v_rcp_f32 v223, v223
    v_mul_f32 v252, v252, v220
    v_mul_f32 v253, v253, v221
    v_mul_f32 v254, v254, v222
    v_mul_f32 v255, v255, v223
    v_cvt_pk_bf16_f32 v206, v252, v253
    v_cvt_pk_bf16_f32 v207, v254, v255
    buffer_store_dwordx4 v[204:207], v3, s[56:59], s72 offen offset:3072 sc1
    s_waitcnt lgkmcnt(0)
    v_mfma_f32_16x16x32_bf16 v[192:195], v[32:35], a[0:3], 0
    ds_read_b64_tr_b16 v[48:49], v5 offset:0
    s_lshl_b32 s72, s68, 14
    v_mfma_f32_16x16x32_bf16 v[192:195], v[36:39], a[16:19], v[192:195]
    ds_read_b64_tr_b16 v[50:51], v5 offset:2048
    s_add_u32 s72, s72, 131072
    v_mfma_f32_16x16x32_bf16 v[192:195], v[40:43], a[32:35], v[192:195]
    ds_read_b64_tr_b16 v[52:53], v5 offset:4096
    v_mov_b32 v13, s3
    v_mfma_f32_16x16x32_bf16 v[192:195], v[44:47], a[48:51], v[192:195]
    ds_read_b64_tr_b16 v[54:55], v5 offset:6144
    v_add_u32 v12, s78, v1
    v_mfma_f32_16x16x32_bf16 v[196:199], v[44:47], a[52:55], 0
    ds_read_b64_tr_b16 v[56:57], v5 offset:8192
    v_min_u32 v12, 1, v12
    v_mfma_f32_16x16x32_bf16 v[196:199], v[40:43], a[36:39], v[196:199]
    ds_read_b64_tr_b16 v[58:59], v5 offset:10240
    v_lshlrev_b32 v12, 30, v12
    v_mfma_f32_16x16x32_bf16 v[196:199], v[36:39], a[20:23], v[196:199]
    ds_read_b64_tr_b16 v[60:61], v5 offset:12288
    v_add_u32 v12, s21, v12
    v_mfma_f32_16x16x32_bf16 v[196:199], v[32:35], a[4:7], v[196:199]
    ds_read_b64_tr_b16 v[62:63], v5 offset:14336
    v_add_u32 v14, s23, v3
    v_mfma_f32_16x16x32_bf16 v[200:203], v[32:35], a[8:11], 0
    v_and_b32 v15, 3, v1
    v_subrev_u32 v15, 1, v15
    v_mfma_f32_16x16x32_bf16 v[200:203], v[36:39], a[24:27], v[200:203]
    v_ashrrev_i32 v15, 31, v15
    v_and_b32 v15, 0x3f803f80, v15
    v_mfma_f32_16x16x32_bf16 v[200:203], v[40:43], a[40:43], v[200:203]
    s_mov_b32 s74, 1
    s_lshr_b32 s25, s68, 1
    s_add_u32 s97, s97, s25
    v_mfma_f32_16x16x32_bf16 v[200:203], v[44:47], a[56:59], v[200:203]
    s_add_u32 s25, s25, 14
    s_mov_b32 s94, -1
    s_mov_b32 s58, 0
    v_mfma_f32_16x16x32_bf16 v[204:207], v[44:47], a[60:63], 0
    v_add_u32 v21, s72, v3
    v_mul_f32 v128, 0x3e0293ee, v128
    v_mfma_f32_16x16x32_bf16 v[204:207], v[40:43], a[44:47], v[204:207]
    v_mul_f32 v144, 0x3e0293ee, v144
    v_mul_f32 v129, 0x3e0293ee, v129
    v_mfma_f32_16x16x32_bf16 v[204:207], v[36:39], a[28:31], v[204:207]
    v_mul_f32 v145, 0x3e0293ee, v145
    v_mul_f32 v130, 0x3e0293ee, v130
    v_mfma_f32_16x16x32_bf16 v[204:207], v[32:35], a[12:15], v[204:207]
    s_waitcnt lgkmcnt(0)
    v_mul_f32 v146, 0x3e0293ee, v146
    v_mul_f32 v131, 0x3e0293ee, v131
    v_mfma_f32_16x16x32_bf16 v[208:211], v[48:51], a[0:3], 0
    ds_read_b64_tr_b16 v[32:33], v6 offset:0
    v_mul_f32 v147, 0x3e0293ee, v147
    v_mfma_f32_16x16x32_bf16 v[208:211], v[52:55], a[16:19], v[208:211]
    ds_read_b64_tr_b16 v[34:35], v6 offset:2048
    v_cvt_pk_bf16_f32 v128, v128, v129
    v_mfma_f32_16x16x32_bf16 v[208:211], v[56:59], a[32:35], v[208:211]
    ds_read_b64_tr_b16 v[36:37], v6 offset:4096
    v_cvt_pk_bf16_f32 v129, v130, v131
    v_mfma_f32_16x16x32_bf16 v[208:211], v[60:63], a[48:51], v[208:211]
    ds_read_b64_tr_b16 v[38:39], v6 offset:6144
    v_cvt_pk_bf16_f32 v130, v144, v145
    v_mfma_f32_16x16x32_bf16 v[212:215], v[60:63], a[52:55], 0
    ds_read_b64_tr_b16 v[40:41], v6 offset:8192
    v_cvt_pk_bf16_f32 v131, v146, v147
    v_mfma_f32_16x16x32_bf16 v[212:215], v[56:59], a[36:39], v[212:215]
    ds_read_b64_tr_b16 v[42:43], v6 offset:10240
    v_mfma_f32_16x16x32_bf16 v[212:215], v[52:55], a[20:23], v[212:215]
    ds_read_b64_tr_b16 v[44:45], v6 offset:12288
    v_mfma_f32_16x16x32_bf16 v[212:215], v[48:51], a[4:7], v[212:215]
    ds_read_b64_tr_b16 v[46:47], v6 offset:14336
    v_mfma_f32_16x16x32_bf16 v[216:219], v[48:51], a[8:11], 0
    ds_write_b128 v21, v[128:131] offset:0
    v_mul_f32 v132, 0x3e0293ee, v132
    v_mfma_f32_16x16x32_bf16 v[216:219], v[52:55], a[24:27], v[216:219]
    v_mul_f32 v148, 0x3e0293ee, v148
    v_mul_f32 v133, 0x3e0293ee, v133
    v_mfma_f32_16x16x32_bf16 v[216:219], v[56:59], a[40:43], v[216:219]
    buffer_load_dword v0, v29, s[52:55], 0 offen sc1
    v_mul_f32 v149, 0x3e0293ee, v149
    v_mfma_f32_16x16x32_bf16 v[216:219], v[60:63], a[56:59], v[216:219]
    v_mul_f32 v134, 0x3e0293ee, v134
    v_mul_f32 v150, 0x3e0293ee, v150
    v_mfma_f32_16x16x32_bf16 v[220:223], v[60:63], a[60:63], 0
    v_mul_f32 v135, 0x3e0293ee, v135
    v_mul_f32 v151, 0x3e0293ee, v151
    v_mfma_f32_16x16x32_bf16 v[220:223], v[56:59], a[44:47], v[220:223]
    v_cvt_pk_bf16_f32 v132, v132, v133
    v_cvt_pk_bf16_f32 v133, v134, v135
    v_mfma_f32_16x16x32_bf16 v[220:223], v[52:55], a[28:31], v[220:223]
    v_cvt_pk_bf16_f32 v134, v148, v149
    v_cvt_pk_bf16_f32 v135, v150, v151
    v_mfma_f32_16x16x32_bf16 v[220:223], v[48:51], a[12:15], v[220:223]
    s_waitcnt lgkmcnt(1)
    ds_write_b128 v21, v[132:135] offset:4096
    v_mul_f32 v136, 0x3e0293ee, v136
    v_mfma_f32_16x16x32_bf16 v[224:227], v[32:35], a[0:3], 0
    ds_read_b64_tr_b16 v[48:49], v7 offset:0
    v_mul_f32 v152, 0x3e0293ee, v152
    v_mfma_f32_16x16x32_bf16 v[224:227], v[36:39], a[16:19], v[224:227]
    ds_read_b64_tr_b16 v[50:51], v7 offset:2048
    v_mul_f32 v137, 0x3e0293ee, v137
    v_mfma_f32_16x16x32_bf16 v[224:227], v[40:43], a[32:35], v[224:227]
    ds_read_b64_tr_b16 v[52:53], v7 offset:4096
    s_add_u32 s80, s48, 3
    v_mfma_f32_16x16x32_bf16 v[224:227], v[44:47], a[48:51], v[224:227]
    ds_read_b64_tr_b16 v[54:55], v7 offset:6144
    s_and_b32 s80, s80, 3
    v_mfma_f32_16x16x32_bf16 v[228:231], v[44:47], a[52:55], 0
    ds_read_b64_tr_b16 v[56:57], v7 offset:8192
    s_lshl_b32 s80, s80, 20
    v_mfma_f32_16x16x32_bf16 v[228:231], v[40:43], a[36:39], v[228:231]
    ds_read_b64_tr_b16 v[58:59], v7 offset:10240
    s_lshl_b32 s77, s69, 8
    v_mfma_f32_16x16x32_bf16 v[228:231], v[36:39], a[20:23], v[228:231]
    ds_read_b64_tr_b16 v[60:61], v7 offset:12288
    s_add_u32 s80, s80, s77
    v_mfma_f32_16x16x32_bf16 v[228:231], v[32:35], a[4:7], v[228:231]
    ds_read_b64_tr_b16 v[62:63], v7 offset:14336
    s_add_u32 s80, s80, 128
    v_mfma_f32_16x16x32_bf16 v[232:235], v[32:35], a[8:11], 0
    v_mul_f32 v153, 0x3e0293ee, v153
    v_mul_f32 v138, 0x3e0293ee, v138
    v_mfma_f32_16x16x32_bf16 v[232:235], v[36:39], a[24:27], v[232:235]
    v_mul_f32 v154, 0x3e0293ee, v154
    v_mul_f32 v139, 0x3e0293ee, v139
    v_mfma_f32_16x16x32_bf16 v[232:235], v[40:43], a[40:43], v[232:235]
    s_waitcnt vmcnt(7)
    s_barrier
    v_mfma_f32_16x16x32_bf16 v[232:235], v[44:47], a[56:59], v[232:235]
    v_mul_f32 v155, 0x3e0293ee, v155
    v_cvt_pk_bf16_f32 v136, v136, v137
    v_mfma_f32_16x16x32_bf16 v[236:239], v[44:47], a[60:63], 0
    buffer_load_dwordx4 v8, s[16:19], s80 offen lds
    s_add_u32 m0, s78, 53248
    v_mfma_f32_16x16x32_bf16 v[236:239], v[40:43], a[44:47], v[236:239]
    v_cvt_pk_bf16_f32 v137, v138, v139
    v_cvt_pk_bf16_f32 v138, v152, v153
    v_mfma_f32_16x16x32_bf16 v[236:239], v[36:39], a[28:31], v[236:239]
    s_add_u32 s80, s80, 262144
    v_cvt_pk_bf16_f32 v139, v154, v155
    v_mfma_f32_16x16x32_bf16 v[236:239], v[32:35], a[12:15], v[236:239]
    s_waitcnt lgkmcnt(0)
    ds_write_b128 v21, v[136:139] offset:8192
    v_mul_f32 v140, 0x3e0293ee, v140
    v_mfma_f32_16x16x32_bf16 v[240:243], v[48:51], a[0:3], 0
    ds_read_b64_tr_b16 v[32:33], v4 offset:16384
    v_mul_f32 v156, 0x3e0293ee, v156
    v_mfma_f32_16x16x32_bf16 v[240:243], v[52:55], a[16:19], v[240:243]
    ds_read_b64_tr_b16 v[34:35], v4 offset:18432
    v_mul_f32 v141, 0x3e0293ee, v141
    v_mfma_f32_16x16x32_bf16 v[240:243], v[56:59], a[32:35], v[240:243]
    ds_read_b64_tr_b16 v[36:37], v4 offset:20480
    v_mul_f32 v157, 0x3e0293ee, v157
    v_mfma_f32_16x16x32_bf16 v[240:243], v[60:63], a[48:51], v[240:243]
    ds_read_b64_tr_b16 v[38:39], v4 offset:22528
    v_mul_f32 v142, 0x3e0293ee, v142
    v_mfma_f32_16x16x32_bf16 v[244:247], v[60:63], a[52:55], 0
    ds_read_b64_tr_b16 v[40:41], v4 offset:24576
    v_mul_f32 v158, 0x3e0293ee, v158
    v_mfma_f32_16x16x32_bf16 v[244:247], v[56:59], a[36:39], v[244:247]
    ds_read_b64_tr_b16 v[42:43], v4 offset:26624
    v_mul_f32 v143, 0x3e0293ee, v143
    v_mfma_f32_16x16x32_bf16 v[244:247], v[52:55], a[20:23], v[244:247]
    ds_read_b64_tr_b16 v[44:45], v4 offset:28672
    v_mul_f32 v159, 0x3e0293ee, v159
    v_mfma_f32_16x16x32_bf16 v[244:247], v[48:51], a[4:7], v[244:247]
    ds_read_b64_tr_b16 v[46:47], v4 offset:30720
    v_cvt_pk_bf16_f32 v140, v140, v141
    v_mfma_f32_16x16x32_bf16 v[248:251], v[48:51], a[8:11], 0
    buffer_load_dwordx4 v8, s[16:19], s80 offen lds
    s_add_u32 m0, s78, 57344
    v_mfma_f32_16x16x32_bf16 v[248:251], v[52:55], a[24:27], v[248:251]
    s_add_u32 s80, s80, 262144
    buffer_load_dwordx4 v8, s[16:19], s80 offen lds
    s_add_u32 m0, s78, 61440
    v_mfma_f32_16x16x32_bf16 v[248:251], v[56:59], a[40:43], v[248:251]
    s_add_u32 s80, s80, 262144
    buffer_load_dwordx4 v8, s[16:19], s80 offen lds
    s_add_u32 m0, s90, 0
    v_mfma_f32_16x16x32_bf16 v[248:251], v[60:63], a[56:59], v[248:251]
    v_cvt_pk_bf16_f32 v141, v142, v143
    v_cvt_pk_bf16_f32 v142, v156, v157
    v_mfma_f32_16x16x32_bf16 v[252:255], v[60:63], a[60:63], 0
    v_cvt_pk_bf16_f32 v143, v158, v159
    v_mfma_f32_16x16x32_bf16 v[252:255], v[56:59], a[44:47], v[252:255]
    ds_write_b128 v21, v[140:143] offset:12288
    v_mul_f32 v160, 0x3e0293ee, v160
    v_mfma_f32_16x16x32_bf16 v[252:255], v[52:55], a[28:31], v[252:255]
    v_mul_f32 v176, 0x3e0293ee, v176
    v_mul_f32 v161, 0x3e0293ee, v161
    v_mfma_f32_16x16x32_bf16 v[252:255], v[48:51], a[12:15], v[252:255]
    s_waitcnt lgkmcnt(1)
    v_mul_f32 v177, 0x3e0293ee, v177
    v_mul_f32 v162, 0x3e0293ee, v162
    v_mfma_f32_16x16x32_bf16 v[192:195], v[32:35], a[64:67], v[192:195]
    ds_read_b64_tr_b16 v[48:49], v5 offset:16384
    v_mul_f32 v178, 0x3e0293ee, v178
    v_mfma_f32_16x16x32_bf16 v[192:195], v[36:39], a[80:83], v[192:195]
    ds_read_b64_tr_b16 v[50:51], v5 offset:18432
    v_mul_f32 v163, 0x3e0293ee, v163
    v_mfma_f32_16x16x32_bf16 v[192:195], v[40:43], a[96:99], v[192:195]
    ds_read_b64_tr_b16 v[52:53], v5 offset:20480
    v_mul_f32 v179, 0x3e0293ee, v179
    v_mfma_f32_16x16x32_bf16 v[192:195], v[44:47], a[112:115], v[192:195]
    ds_read_b64_tr_b16 v[54:55], v5 offset:22528
    v_cvt_pk_bf16_f32 v160, v160, v161
    v_mfma_f32_16x16x32_bf16 v[196:199], v[44:47], a[116:119], v[196:199]
    ds_read_b64_tr_b16 v[56:57], v5 offset:24576
    v_cvt_pk_bf16_f32 v161, v162, v163
    v_mfma_f32_16x16x32_bf16 v[196:199], v[40:43], a[100:103], v[196:199]
    ds_read_b64_tr_b16 v[58:59], v5 offset:26624
    v_cvt_pk_bf16_f32 v162, v176, v177
    v_mfma_f32_16x16x32_bf16 v[196:199], v[36:39], a[84:87], v[196:199]
    ds_read_b64_tr_b16 v[60:61], v5 offset:28672
    v_cvt_pk_bf16_f32 v163, v178, v179
    v_mfma_f32_16x16x32_bf16 v[196:199], v[32:35], a[68:71], v[196:199]
    ds_read_b64_tr_b16 v[62:63], v5 offset:30720
    s_waitcnt vmcnt(4)
    v_cmp_eq_u32 vcc, s3, v0
    s_cmp_eq_u64 vcc, exec
    s_cbranch_scc0 L_spin_kv
L_ok_kv:
    v_mfma_f32_16x16x32_bf16 v[200:203], v[32:35], a[72:75], v[200:203]
    s_cmp_lt_u32 s68, 2
    s_cselect_b32 s62, 67108864, 0
    buffer_load_dwordx4 v3, s[60:63], s88 offen offset:0 sc1 lds
    s_add_u32 m0, s90, 0
    v_mfma_f32_16x16x32_bf16 v[200:203], v[36:39], a[88:91], v[200:203]
    ds_write_b128 v21, v[160:163] offset:1024
    v_mul_f32 v164, 0x3e0293ee, v164
    v_mfma_f32_16x16x32_bf16 v[200:203], v[40:43], a[104:107], v[200:203]
    v_mul_f32 v180, 0x3e0293ee, v180
    v_mul_f32 v165, 0x3e0293ee, v165
    v_mfma_f32_16x16x32_bf16 v[200:203], v[44:47], a[120:123], v[200:203]
    v_mul_f32 v181, 0x3e0293ee, v181
    v_mul_f32 v166, 0x3e0293ee, v166
    v_mfma_f32_16x16x32_bf16 v[204:207], v[44:47], a[124:127], v[204:207]
    v_mul_f32 v182, 0x3e0293ee, v182
    v_mul_f32 v167, 0x3e0293ee, v167
    v_mfma_f32_16x16x32_bf16 v[204:207], v[40:43], a[108:111], v[204:207]
    v_mul_f32 v183, 0x3e0293ee, v183
    v_cvt_pk_bf16_f32 v164, v164, v165
    v_mfma_f32_16x16x32_bf16 v[204:207], v[36:39], a[92:95], v[204:207]
    buffer_load_dwordx4 v3, s[60:63], s88 offen offset:1024 sc1 lds
    s_add_u32 m0, s90, 0
    v_mfma_f32_16x16x32_bf16 v[204:207], v[32:35], a[76:79], v[204:207]
    s_waitcnt lgkmcnt(1)
    v_cvt_pk_bf16_f32 v165, v166, v167
    v_cvt_pk_bf16_f32 v166, v180, v181
    v_mfma_f32_16x16x32_bf16 v[208:211], v[48:51], a[64:67], v[208:211]
    ds_read_b64_tr_b16 v[32:33], v6 offset:16384
    v_cvt_pk_bf16_f32 v167, v182, v183
    v_mfma_f32_16x16x32_bf16 v[208:211], v[52:55], a[80:83], v[208:211]
    ds_read_b64_tr_b16 v[34:35], v6 offset:18432
    v_mfma_f32_16x16x32_bf16 v[208:211], v[56:59], a[96:99], v[208:211]
    ds_read_b64_tr_b16 v[36:37], v6 offset:20480
    v_mfma_f32_16x16x32_bf16 v[208:211], v[60:63], a[112:115], v[208:211]
    ds_read_b64_tr_b16 v[38:39], v6 offset:22528
    v_mfma_f32_16x16x32_bf16 v[212:215], v[60:63], a[116:119], v[212:215]
    ds_read_b64_tr_b16 v[40:41], v6 offset:24576
    v_mfma_f32_16x16x32_bf16 v[212:215], v[56:59], a[100:103], v[212:215]
    ds_read_b64_tr_b16 v[42:43], v6 offset:26624
    v_mfma_f32_16x16x32_bf16 v[212:215], v[52:55], a[84:87], v[212:215]
    ds_read_b64_tr_b16 v[44:45], v6 offset:28672
    v_mfma_f32_16x16x32_bf16 v[212:215], v[48:51], a[68:71], v[212:215]
    ds_read_b64_tr_b16 v[46:47], v6 offset:30720
    v_mfma_f32_16x16x32_bf16 v[216:219], v[48:51], a[72:75], v[216:219]
    buffer_load_dwordx4 v3, s[60:63], s88 offen offset:2048 sc1 lds
    s_add_u32 m0, s90, 0
    v_mfma_f32_16x16x32_bf16 v[216:219], v[52:55], a[88:91], v[216:219]
    ds_write_b128 v21, v[164:167] offset:5120
    v_mul_f32 v168, 0x3e0293ee, v168
    v_mfma_f32_16x16x32_bf16 v[216:219], v[56:59], a[104:107], v[216:219]
    buffer_load_dwordx4 v3, s[60:63], s88 offen offset:3072 sc1 lds
    s_add_u32 m0, s90, 4096
    v_mfma_f32_16x16x32_bf16 v[216:219], v[60:63], a[120:123], v[216:219]
    s_add_u32 s76, s88, 4096
    v_mul_f32 v184, 0x3e0293ee, v184
    v_mul_f32 v169, 0x3e0293ee, v169
    v_mfma_f32_16x16x32_bf16 v[220:223], v[60:63], a[124:127], v[220:223]
    v_mul_f32 v185, 0x3e0293ee, v185
    v_mul_f32 v170, 0x3e0293ee, v170
    v_mfma_f32_16x16x32_bf16 v[220:223], v[56:59], a[108:111], v[220:223]
    v_mul_f32 v186, 0x3e0293ee, v186
    v_mul_f32 v171, 0x3e0293ee, v171
    v_mfma_f32_16x16x32_bf16 v[220:223], v[52:55], a[92:95], v[220:223]
    v_mul_f32 v187, 0x3e0293ee, v187
    v_cvt_pk_bf16_f32 v168, v168, v169
    v_mfma_f32_16x16x32_bf16 v[220:223], v[48:51], a[76:79], v[220:223]
    s_waitcnt lgkmcnt(1)
    v_cvt_pk_bf16_f32 v169, v170, v171
    v_cvt_pk_bf16_f32 v170, v184, v185
    v_mfma_f32_16x16x32_bf16 v[224:227], v[32:35], a[64:67], v[224:227]
    ds_read_b64_tr_b16 v[48:49], v7 offset:16384
    v_cvt_pk_bf16_f32 v171, v186, v187
    v_mfma_f32_16x16x32_bf16 v[224:227], v[36:39], a[80:83], v[224:227]
    ds_read_b64_tr_b16 v[50:51], v7 offset:18432
    v_mfma_f32_16x16x32_bf16 v[224:227], v[40:43], a[96:99], v[224:227]
    ds_read_b64_tr_b16 v[52:53], v7 offset:20480
    v_mfma_f32_16x16x32_bf16 v[224:227], v[44:47], a[112:115], v[224:227]
    ds_read_b64_tr_b16 v[54:55], v7 offset:22528
    v_mfma_f32_16x16x32_bf16 v[228:231], v[44:47], a[116:119], v[228:231]
    ds_read_b64_tr_b16 v[56:57], v7 offset:24576
    v_mfma_f32_16x16x32_bf16 v[228:231], v[40:43], a[100:103], v[228:231]
    ds_read_b64_tr_b16 v[58:59], v7 offset:26624
    v_mfma_f32_16x16x32_bf16 v[228:231], v[36:39], a[84:87], v[228:231]
    ds_read_b64_tr_b16 v[60:61], v7 offset:28672
    v_mfma_f32_16x16x32_bf16 v[228:231], v[32:35], a[68:71], v[228:231]
    ds_read_b64_tr_b16 v[62:63], v7 offset:30720
    v_mfma_f32_16x16x32_bf16 v[232:235], v[32:35], a[72:75], v[232:235]
    buffer_load_dwordx4 v3, s[60:63], s76 offen offset:0 sc1 lds
    s_add_u32 m0, s90, 4096
    v_mfma_f32_16x16x32_bf16 v[232:235], v[36:39], a[88:91], v[232:235]
    buffer_load_dwordx4 v3, s[60:63], s76 offen offset:1024 sc1 lds
    s_add_u32 m0, s90, 4096
    v_mfma_f32_16x16x32_bf16 v[232:235], v[40:43], a[104:107], v[232:235]
    s_barrier
    v_mfma_f32_16x16x32_bf16 v[232:235], v[44:47], a[120:123], v[232:235]
    ds_write_b128 v21, v[168:171] offset:9216
    v_mul_f32 v172, 0x3e0293ee, v172
    v_mfma_f32_16x16x32_bf16 v[236:239], v[44:47], a[124:127], v[236:239]
    buffer_load_dwordx4 v3, s[60:63], s76 offen offset:2048 sc1 lds
    s_add_u32 m0, s90, 4096
    v_mfma_f32_16x16x32_bf16 v[236:239], v[40:43], a[108:111], v[236:239]
    v_mul_f32 v188, 0x3e0293ee, v188
    v_mul_f32 v173, 0x3e0293ee, v173
    v_mfma_f32_16x16x32_bf16 v[236:239], v[36:39], a[92:95], v[236:239]
    v_mul_f32 v189, 0x3e0293ee, v189
    v_mul_f32 v174, 0x3e0293ee, v174
    v_mfma_f32_16x16x32_bf16 v[236:239], v[32:35], a[76:79], v[236:239]
    s_waitcnt lgkmcnt(1)
    v_mul_f32 v190, 0x3e0293ee, v190
    v_mul_f32 v175, 0x3e0293ee, v175
    v_mfma_f32_16x16x32_bf16 v[240:243], v[48:51], a[64:67], v[240:243]
    ds_read_b64_tr_b16 v[32:33], v4 offset:32768
    v_mul_f32 v191, 0x3e0293ee, v191
    v_mfma_f32_16x16x32_bf16 v[240:243], v[52:55], a[80:83], v[240:243]
    ds_read_b64_tr_b16 v[34:35], v4 offset:34816
    v_cvt_pk_bf16_f32 v172, v172, v173
    v_mfma_f32_16x16x32_bf16 v[240:243], v[56:59], a[96:99], v[240:243]
    ds_read_b64_tr_b16 v[36:37], v4 offset:36864
    v_cvt_pk_bf16_f32 v173, v174, v175
    v_mfma_f32_16x16x32_bf16 v[240:243], v[60:63], a[112:115], v[240:243]
    ds_read_b64_tr_b16 v[38:39], v4 offset:38912
    v_cvt_pk_bf16_f32 v174, v188, v189
    v_mfma_f32_16x16x32_bf16 v[244:247], v[60:63], a[116:119], v[244:247]
    ds_read_b64_tr_b16 v[40:41], v4 offset:40960
    v_cvt_pk_bf16_f32 v175, v190, v191
    v_mfma_f32_16x16x32_bf16 v[244:247], v[56:59], a[100:103], v[244:247]
    ds_read_b64_tr_b16 v[42:43], v4 offset:43008
    v_mfma_f32_16x16x32_bf16 v[244:247], v[52:55], a[84:87], v[244:247]
    ds_read_b64_tr_b16 v[44:45], v4 offset:45056
    v_mfma_f32_16x16x32_bf16 v[244:247], v[48:51], a[68:71], v[244:247]
    ds_read_b64_tr_b16 v[46:47], v4 offset:47104
    v_mfma_f32_16x16x32_bf16 v[248:251], v[48:51], a[72:75], v[248:251]
    buffer_load_dwordx4 v3, s[60:63], s76 offen offset:3072 sc1 lds
    s_add_u32 m0, s90, 32768
    v_mfma_f32_16x16x32_bf16 v[248:251], v[52:55], a[88:91], v[248:251]
    s_cmp_ge_u32 s68, 2
    s_cselect_b32 s76, 0, 2
    s_lshl_b32 s76, s76, 13
    s_add_u32 s88, s88, s76
    v_mfma_f32_16x16x32_bf16 v[248:251], v[56:59], a[104:107], v[248:251]
    s_mov_b32 s62, 67108864
    ds_write_b128 v21, v[172:175] offset:13312
    v_accvgpr_write_b32 a0, v128
    v_mfma_f32_16x16x32_bf16 v[248:251], v[60:63], a[120:123], v[248:251]
    v_accvgpr_write_b32 a1, v129
    v_accvgpr_write_b32 a2, v130
    v_mfma_f32_16x16x32_bf16 v[252:255], v[60:63], a[124:127], v[252:255]
    v_accvgpr_write_b32 a3, v131
    v_accvgpr_write_b32 a16, v132
    v_mfma_f32_16x16x32_bf16 v[252:255], v[56:59], a[108:111], v[252:255]
    v_accvgpr_write_b32 a17, v133
    v_accvgpr_write_b32 a18, v134
    v_mfma_f32_16x16x32_bf16 v[252:255], v[52:55], a[92:95], v[252:255]
    v_accvgpr_write_b32 a19, v135
    v_accvgpr_write_b32 a32, v136
    v_mfma_f32_16x16x32_bf16 v[252:255], v[48:51], a[76:79], v[252:255]
    s_waitcnt lgkmcnt(1)
    v_accvgpr_write_b32 a33, v137
    v_accvgpr_write_b32 a34, v138
    v_mfma_f32_16x16x32_bf16 v[192:195], v[32:35], a[128:131], v[192:195]
    ds_read_b64_tr_b16 v[48:49], v5 offset:32768
    v_accvgpr_write_b32 a35, v139
    v_mfma_f32_16x16x32_bf16 v[192:195], v[36:39], a[144:147], v[192:195]
    ds_read_b64_tr_b16 v[50:51], v5 offset:34816
    v_accvgpr_write_b32 a48, v140
    v_mfma_f32_16x16x32_bf16 v[192:195], v[40:43], a[160:163], v[192:195]
    ds_read_b64_tr_b16 v[52:53], v5 offset:36864
    v_accvgpr_write_b32 a49, v141
    v_mfma_f32_16x16x32_bf16 v[192:195], v[44:47], a[176:179], v[192:195]
    ds_read_b64_tr_b16 v[54:55], v5 offset:38912
    v_accvgpr_write_b32 a50, v142
    v_mfma_f32_16x16x32_bf16 v[196:199], v[44:47], a[180:183], v[196:199]
    ds_read_b64_tr_b16 v[56:57], v5 offset:40960
    v_accvgpr_write_b32 a51, v143
    v_mfma_f32_16x16x32_bf16 v[196:199], v[40:43], a[164:167], v[196:199]
    ds_read_b64_tr_b16 v[58:59], v5 offset:43008
    v_accvgpr_write_b32 a4, v160
    v_mfma_f32_16x16x32_bf16 v[196:199], v[36:39], a[148:151], v[196:199]
    ds_read_b64_tr_b16 v[60:61], v5 offset:45056
    v_accvgpr_write_b32 a5, v161
    v_mfma_f32_16x16x32_bf16 v[196:199], v[32:35], a[132:135], v[196:199]
    ds_read_b64_tr_b16 v[62:63], v5 offset:47104
    v_accvgpr_write_b32 a6, v162
    v_mfma_f32_16x16x32_bf16 v[200:203], v[32:35], a[136:139], v[200:203]
    buffer_load_dwordx4 v3, s[60:63], s88 offen offset:0 sc1 lds
    s_add_u32 m0, s90, 32768
    v_mfma_f32_16x16x32_bf16 v[200:203], v[36:39], a[152:155], v[200:203]
    v_accvgpr_write_b32 a7, v163
    v_accvgpr_write_b32 a20, v164
    v_mfma_f32_16x16x32_bf16 v[200:203], v[40:43], a[168:171], v[200:203]
    v_accvgpr_write_b32 a21, v165
    v_accvgpr_write_b32 a22, v166
    v_mfma_f32_16x16x32_bf16 v[200:203], v[44:47], a[184:187], v[200:203]
    v_accvgpr_write_b32 a23, v167
    v_accvgpr_write_b32 a36, v168
    v_mfma_f32_16x16x32_bf16 v[204:207], v[44:47], a[188:191], v[204:207]
    v_accvgpr_write_b32 a37, v169
    v_accvgpr_write_b32 a38, v170
    v_mfma_f32_16x16x32_bf16 v[204:207], v[40:43], a[172:175], v[204:207]
    v_accvgpr_write_b32 a39, v171
    v_accvgpr_write_b32 a52, v172
    v_mfma_f32_16x16x32_bf16 v[204:207], v[36:39], a[156:159], v[204:207]
    buffer_load_dwordx4 v3, s[60:63], s88 offen offset:1024 sc1 lds
    s_add_u32 m0, s90, 32768
    v_mfma_f32_16x16x32_bf16 v[204:207], v[32:35], a[140:143], v[204:207]
    s_waitcnt lgkmcnt(0)
    v_accvgpr_write_b32 a53, v173
    v_accvgpr_write_b32 a54, v174
    v_mfma_f32_16x16x32_bf16 v[208:211], v[48:51], a[128:131], v[208:211]
    ds_read_b64_tr_b16 v[32:33], v6 offset:32768
    v_accvgpr_write_b32 a55, v175
    v_mfma_f32_16x16x32_bf16 v[208:211], v[52:55], a[144:147], v[208:211]
    ds_read_b64_tr_b16 v[34:35], v6 offset:34816
    v_mfma_f32_16x16x32_bf16 v[208:211], v[56:59], a[160:163], v[208:211]
    ds_read_b64_tr_b16 v[36:37], v6 offset:36864
    v_mfma_f32_16x16x32_bf16 v[208:211], v[60:63], a[176:179], v[208:211]
    ds_read_b64_tr_b16 v[38:39], v6 offset:38912
    v_mfma_f32_16x16x32_bf16 v[212:215], v[60:63], a[180:183], v[212:215]
    ds_read_b64_tr_b16 v[40:41], v6 offset:40960
    v_mfma_f32_16x16x32_bf16 v[212:215], v[56:59], a[164:167], v[212:215]
    ds_read_b64_tr_b16 v[42:43], v6 offset:43008
    v_mfma_f32_16x16x32_bf16 v[212:215], v[52:55], a[148:151], v[212:215]
    ds_read_b64_tr_b16 v[44:45], v6 offset:45056
    v_mfma_f32_16x16x32_bf16 v[212:215], v[48:51], a[132:135], v[212:215]
    ds_read_b64_tr_b16 v[46:47], v6 offset:47104
    v_mfma_f32_16x16x32_bf16 v[216:219], v[48:51], a[136:139], v[216:219]
    buffer_load_dwordx4 v3, s[60:63], s88 offen offset:2048 sc1 lds
    s_add_u32 m0, s90, 32768
    v_mfma_f32_16x16x32_bf16 v[216:219], v[52:55], a[152:155], v[216:219]
    v_mfma_f32_16x16x32_bf16 v[216:219], v[56:59], a[168:171], v[216:219]
    buffer_load_dwordx4 v3, s[60:63], s88 offen offset:3072 sc1 lds
    s_add_u32 m0, s90, 36864
    v_mfma_f32_16x16x32_bf16 v[216:219], v[60:63], a[184:187], v[216:219]
    s_add_u32 s76, s88, 4096
    v_mfma_f32_16x16x32_bf16 v[220:223], v[60:63], a[188:191], v[220:223]
    v_mfma_f32_16x16x32_bf16 v[220:223], v[56:59], a[172:175], v[220:223]
    v_mfma_f32_16x16x32_bf16 v[220:223], v[52:55], a[156:159], v[220:223]
    v_mfma_f32_16x16x32_bf16 v[220:223], v[48:51], a[140:143], v[220:223]
    s_waitcnt lgkmcnt(0)
    v_mfma_f32_16x16x32_bf16 v[224:227], v[32:35], a[128:131], v[224:227]
    ds_read_b64_tr_b16 v[48:49], v7 offset:32768
    v_mfma_f32_16x16x32_bf16 v[224:227], v[36:39], a[144:147], v[224:227]
    ds_read_b64_tr_b16 v[50:51], v7 offset:34816
    v_mfma_f32_16x16x32_bf16 v[224:227], v[40:43], a[160:163], v[224:227]
    ds_read_b64_tr_b16 v[52:53], v7 offset:36864
    v_mfma_f32_16x16x32_bf16 v[224:227], v[44:47], a[176:179], v[224:227]
    ds_read_b64_tr_b16 v[54:55], v7 offset:38912
    v_mfma_f32_16x16x32_bf16 v[228:231], v[44:47], a[180:183], v[228:231]
    ds_read_b64_tr_b16 v[56:57], v7 offset:40960
    v_mfma_f32_16x16x32_bf16 v[228:231], v[40:43], a[164:167], v[228:231]
    ds_read_b64_tr_b16 v[58:59], v7 offset:43008
    v_mfma_f32_16x16x32_bf16 v[228:231], v[36:39], a[148:151], v[228:231]
    ds_read_b64_tr_b16 v[60:61], v7 offset:45056
    v_mfma_f32_16x16x32_bf16 v[228:231], v[32:35], a[132:135], v[228:231]
    ds_read_b64_tr_b16 v[62:63], v7 offset:47104
    v_mfma_f32_16x16x32_bf16 v[232:235], v[32:35], a[136:139], v[232:235]
    buffer_load_dwordx4 v3, s[60:63], s76 offen offset:0 sc1 lds
    s_add_u32 m0, s90, 36864
    v_mfma_f32_16x16x32_bf16 v[232:235], v[36:39], a[152:155], v[232:235]
    buffer_load_dwordx4 v3, s[60:63], s76 offen offset:1024 sc1 lds
    s_add_u32 m0, s90, 36864
    v_mfma_f32_16x16x32_bf16 v[232:235], v[40:43], a[168:171], v[232:235]
    s_waitcnt vmcnt(14)
    s_barrier
    v_mfma_f32_16x16x32_bf16 v[232:235], v[44:47], a[184:187], v[232:235]
    v_mfma_f32_16x16x32_bf16 v[236:239], v[44:47], a[188:191], v[236:239]
    buffer_load_dwordx4 v3, s[60:63], s76 offen offset:2048 sc1 lds
    s_add_u32 m0, s90, 36864
    v_mfma_f32_16x16x32_bf16 v[236:239], v[40:43], a[172:175], v[236:239]
    v_mfma_f32_16x16x32_bf16 v[236:239], v[36:39], a[156:159], v[236:239]
    v_mfma_f32_16x16x32_bf16 v[236:239], v[32:35], a[140:143], v[236:239]
    s_waitcnt lgkmcnt(0)
    v_mfma_f32_16x16x32_bf16 v[240:243], v[48:51], a[128:131], v[240:243]
    ds_read_b64_tr_b16 v[32:33], v4 offset:49152
    v_mfma_f32_16x16x32_bf16 v[240:243], v[52:55], a[144:147], v[240:243]
    ds_read_b64_tr_b16 v[34:35], v4 offset:51200
    v_mfma_f32_16x16x32_bf16 v[240:243], v[56:59], a[160:163], v[240:243]
    ds_read_b64_tr_b16 v[36:37], v4 offset:53248
    v_mfma_f32_16x16x32_bf16 v[240:243], v[60:63], a[176:179], v[240:243]
    ds_read_b64_tr_b16 v[38:39], v4 offset:55296
    v_mfma_f32_16x16x32_bf16 v[244:247], v[60:63], a[180:183], v[244:247]
    ds_read_b64_tr_b16 v[40:41], v4 offset:57344
    v_mfma_f32_16x16x32_bf16 v[244:247], v[56:59], a[164:167], v[244:247]
    ds_read_b64_tr_b16 v[42:43], v4 offset:59392
    v_mfma_f32_16x16x32_bf16 v[244:247], v[52:55], a[148:151], v[244:247]
    ds_read_b64_tr_b16 v[44:45], v4 offset:61440
    v_mfma_f32_16x16x32_bf16 v[244:247], v[48:51], a[132:135], v[244:247]
    ds_read_b64_tr_b16 v[46:47], v4 offset:63488
    v_mfma_f32_16x16x32_bf16 v[248:251], v[48:51], a[136:139], v[248:251]
    buffer_load_dwordx4 v3, s[60:63], s76 offen offset:3072 sc1 lds
    v_mfma_f32_16x16x32_bf16 v[248:251], v[52:55], a[152:155], v[248:251]
    s_add_u32 s88, s88, 16384
    v_mfma_f32_16x16x32_bf16 v[248:251], v[56:59], a[168:171], v[248:251]
    v_mfma_f32_16x16x32_bf16 v[248:251], v[60:63], a[184:187], v[248:251]
    v_mfma_f32_16x16x32_bf16 v[252:255], v[60:63], a[188:191], v[252:255]
    v_mfma_f32_16x16x32_bf16 v[252:255], v[56:59], a[172:175], v[252:255]
    v_mfma_f32_16x16x32_bf16 v[252:255], v[52:55], a[156:159], v[252:255]
    v_mfma_f32_16x16x32_bf16 v[252:255], v[48:51], a[140:143], v[252:255]
    s_waitcnt lgkmcnt(0)
    v_mfma_f32_16x16x32_bf16 v[192:195], v[32:35], a[192:195], v[192:195]
    ds_read_b64_tr_b16 v[48:49], v5 offset:49152
    v_mfma_f32_16x16x32_bf16 v[192:195], v[36:39], a[208:211], v[192:195]
    ds_read_b64_tr_b16 v[50:51], v5 offset:51200
    v_mfma_f32_16x16x32_bf16 v[192:195], v[40:43], a[224:227], v[192:195]
    ds_read_b64_tr_b16 v[52:53], v5 offset:53248
    v_mfma_f32_16x16x32_bf16 v[192:195], v[44:47], a[240:243], v[192:195]
    ds_read_b64_tr_b16 v[54:55], v5 offset:55296
    v_mfma_f32_16x16x32_bf16 v[196:199], v[44:47], a[244:247], v[196:199]
    ds_read_b64_tr_b16 v[56:57], v5 offset:57344
    v_accvgpr_write_b32 a128, 0
    v_mfma_f32_16x16x32_bf16 v[196:199], v[40:43], a[228:231], v[196:199]
    ds_read_b64_tr_b16 v[58:59], v5 offset:59392
    v_accvgpr_write_b32 a129, 0
    v_mfma_f32_16x16x32_bf16 v[196:199], v[36:39], a[212:215], v[196:199]
    ds_read_b64_tr_b16 v[60:61], v5 offset:61440
    v_accvgpr_write_b32 a130, 0
    v_mfma_f32_16x16x32_bf16 v[196:199], v[32:35], a[196:199], v[196:199]
    ds_read_b64_tr_b16 v[62:63], v5 offset:63488
    v_accvgpr_write_b32 a131, 0
    v_mfma_f32_16x16x32_bf16 v[200:203], v[32:35], a[200:203], v[200:203]
    v_accvgpr_write_b32 a132, 0
    v_accvgpr_write_b32 a133, 0
    v_mfma_f32_16x16x32_bf16 v[200:203], v[36:39], a[216:219], v[200:203]
    v_accvgpr_write_b32 a134, 0
    v_accvgpr_write_b32 a135, 0
    v_mfma_f32_16x16x32_bf16 v[200:203], v[40:43], a[232:235], v[200:203]
    v_accvgpr_write_b32 a136, 0
    v_accvgpr_write_b32 a137, 0
    v_mfma_f32_16x16x32_bf16 v[200:203], v[44:47], a[248:251], v[200:203]
    v_accvgpr_write_b32 a138, 0
    v_accvgpr_write_b32 a139, 0
    v_mfma_f32_16x16x32_bf16 v[204:207], v[44:47], a[252:255], v[204:207]
    v_accvgpr_write_b32 a140, 0
    v_accvgpr_write_b32 a141, 0
    v_mfma_f32_16x16x32_bf16 v[204:207], v[40:43], a[236:239], v[204:207]
    v_accvgpr_write_b32 a142, 0
    v_accvgpr_write_b32 a143, 0
    v_mfma_f32_16x16x32_bf16 v[204:207], v[36:39], a[220:223], v[204:207]
    v_accvgpr_write_b32 a144, 0
    v_accvgpr_write_b32 a145, 0
    v_mfma_f32_16x16x32_bf16 v[204:207], v[32:35], a[204:207], v[204:207]
    s_waitcnt lgkmcnt(0)
    v_accvgpr_write_b32 a146, 0
    v_accvgpr_write_b32 a147, 0
    v_mfma_f32_16x16x32_bf16 v[208:211], v[48:51], a[192:195], v[208:211]
    ds_read_b64_tr_b16 v[32:33], v6 offset:49152
    v_accvgpr_write_b32 a148, 0
    v_mfma_f32_16x16x32_bf16 v[208:211], v[52:55], a[208:211], v[208:211]
    ds_read_b64_tr_b16 v[34:35], v6 offset:51200
    v_accvgpr_write_b32 a149, 0
    v_mfma_f32_16x16x32_bf16 v[208:211], v[56:59], a[224:227], v[208:211]
    ds_read_b64_tr_b16 v[36:37], v6 offset:53248
    v_accvgpr_write_b32 a150, 0
    v_mfma_f32_16x16x32_bf16 v[208:211], v[60:63], a[240:243], v[208:211]
    ds_read_b64_tr_b16 v[38:39], v6 offset:55296
    v_accvgpr_write_b32 a151, 0
    v_mfma_f32_16x16x32_bf16 v[212:215], v[60:63], a[244:247], v[212:215]
    ds_read_b64_tr_b16 v[40:41], v6 offset:57344
    v_accvgpr_write_b32 a152, 0
    v_mfma_f32_16x16x32_bf16 v[212:215], v[56:59], a[228:231], v[212:215]
    ds_read_b64_tr_b16 v[42:43], v6 offset:59392
    v_accvgpr_write_b32 a153, 0
    v_mfma_f32_16x16x32_bf16 v[212:215], v[52:55], a[212:215], v[212:215]
    ds_read_b64_tr_b16 v[44:45], v6 offset:61440
    v_accvgpr_write_b32 a154, 0
    v_mfma_f32_16x16x32_bf16 v[212:215], v[48:51], a[196:199], v[212:215]
    ds_read_b64_tr_b16 v[46:47], v6 offset:63488
    v_accvgpr_write_b32 a155, 0
    v_mfma_f32_16x16x32_bf16 v[216:219], v[48:51], a[200:203], v[216:219]
    v_accvgpr_write_b32 a156, 0
    v_accvgpr_write_b32 a157, 0
    v_mfma_f32_16x16x32_bf16 v[216:219], v[52:55], a[216:219], v[216:219]
    v_accvgpr_write_b32 a158, 0
    v_accvgpr_write_b32 a159, 0
    v_mfma_f32_16x16x32_bf16 v[216:219], v[56:59], a[232:235], v[216:219]
    v_accvgpr_write_b32 a160, 0
    v_accvgpr_write_b32 a161, 0
    v_mfma_f32_16x16x32_bf16 v[216:219], v[60:63], a[248:251], v[216:219]
    v_accvgpr_write_b32 a162, 0
    v_accvgpr_write_b32 a163, 0
    v_mfma_f32_16x16x32_bf16 v[220:223], v[60:63], a[252:255], v[220:223]
    v_accvgpr_write_b32 a164, 0
    v_accvgpr_write_b32 a165, 0
    v_mfma_f32_16x16x32_bf16 v[220:223], v[56:59], a[236:239], v[220:223]
    v_accvgpr_write_b32 a166, 0
    v_accvgpr_write_b32 a167, 0
    v_mfma_f32_16x16x32_bf16 v[220:223], v[52:55], a[220:223], v[220:223]
    v_accvgpr_write_b32 a168, 0
    v_accvgpr_write_b32 a169, 0
    v_mfma_f32_16x16x32_bf16 v[220:223], v[48:51], a[204:207], v[220:223]
    s_waitcnt lgkmcnt(0)
    v_accvgpr_write_b32 a170, 0
    v_accvgpr_write_b32 a171, 0
    v_mfma_f32_16x16x32_bf16 v[224:227], v[32:35], a[192:195], v[224:227]
    ds_read_b64_tr_b16 v[48:49], v7 offset:49152
    v_accvgpr_write_b32 a172, 0
    v_mfma_f32_16x16x32_bf16 v[224:227], v[36:39], a[208:211], v[224:227]
    ds_read_b64_tr_b16 v[50:51], v7 offset:51200
    v_accvgpr_write_b32 a173, 0
    v_mfma_f32_16x16x32_bf16 v[224:227], v[40:43], a[224:227], v[224:227]
    ds_read_b64_tr_b16 v[52:53], v7 offset:53248
    v_accvgpr_write_b32 a174, 0
    v_mfma_f32_16x16x32_bf16 v[224:227], v[44:47], a[240:243], v[224:227]
    ds_read_b64_tr_b16 v[54:55], v7 offset:55296
    v_accvgpr_write_b32 a175, 0
    v_mfma_f32_16x16x32_bf16 v[228:231], v[44:47], a[244:247], v[228:231]
    ds_read_b64_tr_b16 v[56:57], v7 offset:57344
    v_accvgpr_write_b32 a176, 0
    v_mfma_f32_16x16x32_bf16 v[228:231], v[40:43], a[228:231], v[228:231]
    ds_read_b64_tr_b16 v[58:59], v7 offset:59392
    v_accvgpr_write_b32 a177, 0
    v_mfma_f32_16x16x32_bf16 v[228:231], v[36:39], a[212:215], v[228:231]
    ds_read_b64_tr_b16 v[60:61], v7 offset:61440
    v_accvgpr_write_b32 a178, 0
    v_mfma_f32_16x16x32_bf16 v[228:231], v[32:35], a[196:199], v[228:231]
    ds_read_b64_tr_b16 v[62:63], v7 offset:63488
    v_accvgpr_write_b32 a179, 0
    v_mfma_f32_16x16x32_bf16 v[232:235], v[32:35], a[200:203], v[232:235]
    v_accvgpr_write_b32 a180, 0
    v_accvgpr_write_b32 a181, 0
    v_mfma_f32_16x16x32_bf16 v[232:235], v[36:39], a[216:219], v[232:235]
    v_accvgpr_write_b32 a182, 0
    v_accvgpr_write_b32 a183, 0
    v_mfma_f32_16x16x32_bf16 v[232:235], v[40:43], a[232:235], v[232:235]
    v_accvgpr_write_b32 a184, 0
    v_accvgpr_write_b32 a185, 0
    v_mfma_f32_16x16x32_bf16 v[232:235], v[44:47], a[248:251], v[232:235]
    v_accvgpr_write_b32 a186, 0
    v_accvgpr_write_b32 a187, 0
    v_mfma_f32_16x16x32_bf16 v[236:239], v[44:47], a[252:255], v[236:239]
    v_accvgpr_write_b32 a188, 0
    v_accvgpr_write_b32 a189, 0
    v_mfma_f32_16x16x32_bf16 v[236:239], v[40:43], a[236:239], v[236:239]
    v_accvgpr_write_b32 a190, 0
    v_accvgpr_write_b32 a191, 0
    v_mfma_f32_16x16x32_bf16 v[236:239], v[36:39], a[220:223], v[236:239]
    v_mul_f32 v192, 0x3e0293ee, v192
    v_mul_f32 v208, 0x3e0293ee, v208
    v_mfma_f32_16x16x32_bf16 v[236:239], v[32:35], a[204:207], v[236:239]
    s_waitcnt lgkmcnt(0)
    v_mul_f32 v193, 0x3e0293ee, v193
    v_mul_f32 v209, 0x3e0293ee, v209
    v_mfma_f32_16x16x32_bf16 v[240:243], v[48:51], a[192:195], v[240:243]
    v_mul_f32 v194, 0x3e0293ee, v194
    v_mul_f32 v210, 0x3e0293ee, v210
    v_mfma_f32_16x16x32_bf16 v[240:243], v[52:55], a[208:211], v[240:243]
    v_mul_f32 v195, 0x3e0293ee, v195
    v_mul_f32 v211, 0x3e0293ee, v211
    v_mfma_f32_16x16x32_bf16 v[240:243], v[56:59], a[224:227], v[240:243]
    v_cvt_pk_bf16_f32 v192, v192, v193
    v_cvt_pk_bf16_f32 v193, v194, v195
    v_mfma_f32_16x16x32_bf16 v[240:243], v[60:63], a[240:243], v[240:243]
    v_cvt_pk_bf16_f32 v194, v208, v209
    v_cvt_pk_bf16_f32 v195, v210, v211
    v_mfma_f32_16x16x32_bf16 v[244:247], v[60:63], a[244:247], v[244:247]
    ds_write_b128 v21, v[192:195] offset:2048
    v_mul_f32 v196, 0x3e0293ee, v196
    v_mfma_f32_16x16x32_bf16 v[244:247], v[56:59], a[228:231], v[244:247]
    v_mul_f32 v212, 0x3e0293ee, v212
    v_mul_f32 v197, 0x3e0293ee, v197
    v_mfma_f32_16x16x32_bf16 v[244:247], v[52:55], a[212:215], v[244:247]
    v_mul_f32 v213, 0x3e0293ee, v213
    v_mul_f32 v198, 0x3e0293ee, v198
    v_mfma_f32_16x16x32_bf16 v[244:247], v[48:51], a[196:199], v[244:247]
    v_mul_f32 v214, 0x3e0293ee, v214
    v_mul_f32 v199, 0x3e0293ee, v199
    v_mfma_f32_16x16x32_bf16 v[248:251], v[48:51], a[200:203], v[248:251]
    v_mul_f32 v215, 0x3e0293ee, v215
    v_cvt_pk_bf16_f32 v196, v196, v197
    v_mfma_f32_16x16x32_bf16 v[248:251], v[52:55], a[216:219], v[248:251]
    v_cvt_pk_bf16_f32 v197, v198, v199
    v_cvt_pk_bf16_f32 v198, v212, v213
    v_mfma_f32_16x16x32_bf16 v[248:251], v[56:59], a[232:235], v[248:251]
    v_cvt_pk_bf16_f32 v199, v214, v215
    v_mfma_f32_16x16x32_bf16 v[248:251], v[60:63], a[248:251], v[248:251]
    ds_write_b128 v21, v[196:199] offset:6144
    v_mul_f32 v200, 0x3e0293ee, v200
    v_mfma_f32_16x16x32_bf16 v[252:255], v[60:63], a[252:255], v[252:255]
    v_mul_f32 v216, 0x3e0293ee, v216
    v_mul_f32 v201, 0x3e0293ee, v201
    v_mfma_f32_16x16x32_bf16 v[252:255], v[56:59], a[236:239], v[252:255]
    v_mul_f32 v217, 0x3e0293ee, v217
    v_mul_f32 v202, 0x3e0293ee, v202
    v_mfma_f32_16x16x32_bf16 v[252:255], v[52:55], a[220:223], v[252:255]
    v_mul_f32 v218, 0x3e0293ee, v218
    v_mul_f32 v203, 0x3e0293ee, v203
    v_mfma_f32_16x16x32_bf16 v[252:255], v[48:51], a[204:207], v[252:255]
    v_mul_f32 v219, 0x3e0293ee, v219
    v_cvt_pk_bf16_f32 v200, v200, v201
    s_nop 7
    v_cvt_pk_bf16_f32 v201, v202, v203
    v_cvt_pk_bf16_f32 v202, v216, v217
    v_cvt_pk_bf16_f32 v203, v218, v219
    ds_write_b128 v21, v[200:203] offset:10240
    v_mul_f32 v204, 0x3e0293ee, v204
    v_mul_f32 v220, 0x3e0293ee, v220
    v_mul_f32 v205, 0x3e0293ee, v205
    v_mul_f32 v221, 0x3e0293ee, v221
    v_mul_f32 v206, 0x3e0293ee, v206
    v_mul_f32 v222, 0x3e0293ee, v222
    v_mul_f32 v207, 0x3e0293ee, v207
    v_mul_f32 v223, 0x3e0293ee, v223
    v_cvt_pk_bf16_f32 v204, v204, v205
    v_cvt_pk_bf16_f32 v205, v206, v207
    v_cvt_pk_bf16_f32 v206, v220, v221
    v_cvt_pk_bf16_f32 v207, v222, v223
    ds_write_b128 v21, v[204:207] offset:14336
    v_mul_f32 v224, 0x3e0293ee, v224
    v_mul_f32 v240, 0x3e0293ee, v240
    v_mul_f32 v225, 0x3e0293ee, v225
    v_mul_f32 v241, 0x3e0293ee, v241
    v_mul_f32 v226, 0x3e0293ee, v226
    v_mul_f32 v242, 0x3e0293ee, v242
    v_mul_f32 v227, 0x3e0293ee, v227
    v_mul_f32 v243, 0x3e0293ee, v243
    v_cvt_pk_bf16_f32 v224, v224, v225
    v_cvt_pk_bf16_f32 v225, v226, v227
    v_cvt_pk_bf16_f32 v226, v240, v241
    v_cvt_pk_bf16_f32 v227, v242, v243
    ds_write_b128 v21, v[224:227] offset:3072
    v_mul_f32 v228, 0x3e0293ee, v228
    v_mul_f32 v244, 0x3e0293ee, v244
    v_mul_f32 v229, 0x3e0293ee, v229
    v_mul_f32 v245, 0x3e0293ee, v245
    v_mul_f32 v230, 0x3e0293ee, v230
    v_mul_f32 v246, 0x3e0293ee, v246
    v_mul_f32 v231, 0x3e0293ee, v231
    v_mul_f32 v247, 0x3e0293ee, v247
    v_cvt_pk_bf16_f32 v228, v228, v229
    v_cvt_pk_bf16_f32 v229, v230, v231
    v_cvt_pk_bf16_f32 v230, v244, v245
    v_cvt_pk_bf16_f32 v231, v246, v247
    ds_write_b128 v21, v[228:231] offset:7168
    v_mul_f32 v232, 0x3e0293ee, v232
    v_mul_f32 v248, 0x3e0293ee, v248
    v_mul_f32 v233, 0x3e0293ee, v233
    v_mul_f32 v249, 0x3e0293ee, v249
    v_mul_f32 v234, 0x3e0293ee, v234
    v_mul_f32 v250, 0x3e0293ee, v250
    v_mul_f32 v235, 0x3e0293ee, v235
    v_mul_f32 v251, 0x3e0293ee, v251
    v_cvt_pk_bf16_f32 v232, v232, v233
    v_cvt_pk_bf16_f32 v233, v234, v235
    v_cvt_pk_bf16_f32 v234, v248, v249
    v_cvt_pk_bf16_f32 v235, v250, v251
    ds_write_b128 v21, v[232:235] offset:11264
    v_mul_f32 v236, 0x3e0293ee, v236
    v_mul_f32 v252, 0x3e0293ee, v252
    v_mul_f32 v237, 0x3e0293ee, v237
    v_mul_f32 v253, 0x3e0293ee, v253
    v_mul_f32 v238, 0x3e0293ee, v238
    v_mul_f32 v254, 0x3e0293ee, v254
    v_mul_f32 v239, 0x3e0293ee, v239
    v_mul_f32 v255, 0x3e0293ee, v255
    v_cvt_pk_bf16_f32 v236, v236, v237
    v_cvt_pk_bf16_f32 v237, v238, v239
    v_cvt_pk_bf16_f32 v238, v252, v253
    v_cvt_pk_bf16_f32 v239, v254, v255
    ds_write_b128 v21, v[236:239] offset:15360
    v_accvgpr_write_b32 a8, v192
    v_accvgpr_write_b32 a9, v193
    v_accvgpr_write_b32 a10, v194
    v_accvgpr_write_b32 a11, v195
    v_accvgpr_write_b32 a24, v196
    v_accvgpr_write_b32 a25, v197
    v_accvgpr_write_b32 a26, v198
    v_accvgpr_write_b32 a27, v199
    v_accvgpr_write_b32 a40, v200
    v_accvgpr_write_b32 a41, v201
    v_accvgpr_write_b32 a42, v202
    v_accvgpr_write_b32 a43, v203
    v_accvgpr_write_b32 a56, v204
    v_accvgpr_write_b32 a57, v205
    v_accvgpr_write_b32 a58, v206
    v_accvgpr_write_b32 a59, v207
    v_accvgpr_write_b32 a12, v224
    v_accvgpr_write_b32 a13, v225
    v_accvgpr_write_b32 a14, v226
    v_accvgpr_write_b32 a15, v227
    v_accvgpr_write_b32 a28, v228
    v_accvgpr_write_b32 a29, v229
    v_accvgpr_write_b32 a30, v230
    v_accvgpr_write_b32 a31, v231
    v_accvgpr_write_b32 a44, v232
    v_accvgpr_write_b32 a45, v233
    v_accvgpr_write_b32 a46, v234
    v_accvgpr_write_b32 a47, v235
    v_accvgpr_write_b32 a60, v236
    v_accvgpr_write_b32 a61, v237
    v_accvgpr_write_b32 a62, v238
    v_accvgpr_write_b32 a63, v239
    v_add_u32 v4, 65536, v3
    s_waitcnt vmcnt(8) lgkmcnt(0)
    s_barrier
    ds_read_b128 a[64:67], v4 offset:0
    ds_read_b128 a[68:71], v4 offset:1024
    ds_read_b128 a[72:75], v4 offset:2048
    ds_read_b128 a[76:79], v4 offset:3072
    ds_read_b128 a[80:83], v4 offset:4096
    ds_read_b128 a[84:87], v4 offset:5120
    ds_read_b128 a[88:91], v4 offset:6144
    ds_read_b128 a[92:95], v4 offset:7168
    buffer_store_dword v13, v12, s[52:55], 0 offen sc1
    s_add_u32 s94, s94, 1
    s_cmp_eq_u32 s94, s22
    s_cselect_b32 s21, -1, 0
    s_cmp_eq_u32 s94, s20
    s_cselect_b32 s21, -1, s21
    v_and_b32 v16, s21, v9
    v_and_b32 v17, s21, v10
    v_and_b32 v18, s21, v11
    v_and_b32 v19, s21, v30
    s_and_b32 s21, s21, 0xff800000
    v_mov_b32 v20, s21
    v_mov_b32 v21, s21
    v_mov_b32 v22, s21
    v_mov_b32 v23, s21
    s_xor_b32 s90, s90, 32768
    s_waitcnt lgkmcnt(4)
    v_mfma_f32_16x16x32_bf16 v[64:67], a[64:67], a[0:3], v[16:19]
    ds_read_b128 a[96:99], v4 offset:8192
    v_mfma_f32_16x16x32_bf16 v[64:67], a[68:71], a[4:7], v[64:67]
    v_accvgpr_write_b32 a215, 0
    v_accvgpr_write_b32 a211, v15
    v_mfma_f32_16x16x32_bf16 v[64:67], a[72:75], a[8:11], v[64:67]
    ds_read_b128 a[100:103], v4 offset:9216
    v_mfma_f32_16x16x32_bf16 v[64:67], a[76:79], a[12:15], v[64:67]
    v_accvgpr_write_b32 a214, 0
    v_accvgpr_write_b32 a210, v15
    v_mfma_f32_16x16x32_bf16 v[68:71], a[76:79], a[28:31], 0
    ds_read_b128 a[104:107], v4 offset:10240
    v_mfma_f32_16x16x32_bf16 v[68:71], a[72:75], a[24:27], v[68:71]
    v_accvgpr_write_b32 a213, 0
    v_accvgpr_write_b32 a209, v15
    v_mfma_f32_16x16x32_bf16 v[68:71], a[68:71], a[20:23], v[68:71]
    ds_read_b128 a[108:111], v4 offset:11264
    v_mfma_f32_16x16x32_bf16 v[68:71], a[64:67], a[16:19], v[68:71]
    v_accvgpr_write_b32 a212, 0
    v_accvgpr_write_b32 a208, v15
    v_mfma_f32_16x16x32_bf16 v[72:75], a[64:67], a[32:35], 0
    ds_read_b128 a[112:115], v4 offset:12288
    v_mfma_f32_16x16x32_bf16 v[72:75], a[68:71], a[36:39], v[72:75]
    v_exp_f32 v64, v64
    v_mfma_f32_16x16x32_bf16 v[72:75], a[72:75], a[40:43], v[72:75]
    ds_read_b128 a[116:119], v4 offset:13312
    v_mfma_f32_16x16x32_bf16 v[72:75], a[76:79], a[44:47], v[72:75]
    v_exp_f32 v65, v65
    v_mfma_f32_16x16x32_bf16 v[76:79], a[76:79], a[60:63], 0
    ds_read_b128 a[120:123], v4 offset:14336
    v_mfma_f32_16x16x32_bf16 v[76:79], a[72:75], a[56:59], v[76:79]
    v_exp_f32 v66, v66
    v_mfma_f32_16x16x32_bf16 v[76:79], a[68:71], a[52:55], v[76:79]
    ds_read_b128 a[124:127], v4 offset:15360
    v_mfma_f32_16x16x32_bf16 v[76:79], a[64:67], a[48:51], v[76:79]
    s_waitcnt lgkmcnt(8)
    v_exp_f32 v67, v67
    v_mfma_f32_16x16x32_bf16 v[80:83], a[80:83], a[0:3], v[20:23]
    v_exp_f32 v68, v68
    v_mfma_f32_16x16x32_bf16 v[80:83], a[84:87], a[4:7], v[80:83]
    v_exp_f32 v69, v69
    v_mfma_f32_16x16x32_bf16 v[80:83], a[88:91], a[8:11], v[80:83]
    s_mov_b32 s73, 0x30000
    v_mfma_f32_16x16x32_bf16 v[80:83], a[92:95], a[12:15], v[80:83]
    v_exp_f32 v70, v70
    v_mfma_f32_16x16x32_bf16 v[84:87], a[92:95], a[28:31], v[16:19]
    v_exp_f32 v71, v71
    v_mfma_f32_16x16x32_bf16 v[84:87], a[88:91], a[24:27], v[84:87]
    v_exp_f32 v72, v72
    v_mfma_f32_16x16x32_bf16 v[84:87], a[84:87], a[20:23], v[84:87]
    v_exp_f32 v73, v73
    v_mfma_f32_16x16x32_bf16 v[84:87], a[80:83], a[16:19], v[84:87]
    v_exp_f32 v74, v74
    v_mfma_f32_16x16x32_bf16 v[88:91], a[80:83], a[32:35], 0
    s_cmp_le_u32 s94, 15
    s_cselect_b32 s72, 32768, s73
    v_mfma_f32_16x16x32_bf16 v[88:91], a[84:87], a[36:39], v[88:91]
    v_exp_f32 v75, v75
    v_mfma_f32_16x16x32_bf16 v[88:91], a[88:91], a[40:43], v[88:91]
    v_exp_f32 v76, v76
    v_mfma_f32_16x16x32_bf16 v[88:91], a[92:95], a[44:47], v[88:91]
    v_exp_f32 v77, v77
    v_mfma_f32_16x16x32_bf16 v[92:95], a[92:95], a[60:63], 0
    v_exp_f32 v78, v78
    v_mfma_f32_16x16x32_bf16 v[92:95], a[88:91], a[56:59], v[92:95]
    v_exp_f32 v79, v79
    v_mfma_f32_16x16x32_bf16 v[92:95], a[84:87], a[52:55], v[92:95]
    s_cmp_le_u32 s94, s25
    s_cselect_b32 s62, 67108864, 0
    v_mfma_f32_16x16x32_bf16 v[92:95], a[80:83], a[48:51], v[92:95]
    s_waitcnt lgkmcnt(4)
    v_exp_f32 v80, v80
    v_mfma_f32_16x16x32_bf16 v[96:99], a[96:99], a[0:3], v[20:23]
    v_exp_f32 v81, v81
    v_mfma_f32_16x16x32_bf16 v[96:99], a[100:103], a[4:7], v[96:99]
    v_exp_f32 v82, v82
    v_mfma_f32_16x16x32_bf16 v[96:99], a[104:107], a[8:11], v[96:99]
    v_exp_f32 v83, v83
    v_mfma_f32_16x16x32_bf16 v[96:99], a[108:111], a[12:15], v[96:99]
    v_exp_f32 v84, v84
    v_mfma_f32_16x16x32_bf16 v[100:103], a[108:111], a[28:31], v[20:23]
    s_add_u32 s75, s94, 2
    s_xor_b32 s91, s91, s72
    v_mfma_f32_16x16x32_bf16 v[100:103], a[104:107], a[24:27], v[100:103]
    v_exp_f32 v85, v85
    v_mfma_f32_16x16x32_bf16 v[100:103], a[100:103], a[20:23], v[100:103]
    v_exp_f32 v86, v86
    v_mfma_f32_16x16x32_bf16 v[100:103], a[96:99], a[16:19], v[100:103]
    v_exp_f32 v87, v87
    v_mfma_f32_16x16x32_bf16 v[104:107], a[96:99], a[32:35], v[16:19]
    v_exp_f32 v88, v88
    v_mfma_f32_16x16x32_bf16 v[104:107], a[100:103], a[36:39], v[104:107]
    v_exp_f32 v89, v89
    v_mfma_f32_16x16x32_bf16 v[104:107], a[104:107], a[40:43], v[104:107]
    s_cmp_ge_u32 s75, s97
    s_cselect_b32 s66, s62, 0
    v_mfma_f32_16x16x32_bf16 v[104:107], a[108:111], a[44:47], v[104:107]
    v_exp_f32 v90, v90
    v_mfma_f32_16x16x32_bf16 v[108:111], a[108:111], a[60:63], 0
    v_exp_f32 v91, v91
    v_mfma_f32_16x16x32_bf16 v[108:111], a[104:107], a[56:59], v[108:111]
    v_exp_f32 v92, v92
    v_mfma_f32_16x16x32_bf16 v[108:111], a[100:103], a[52:55], v[108:111]
    v_exp_f32 v93, v93
    v_mfma_f32_16x16x32_bf16 v[108:111], a[96:99], a[48:51], v[108:111]
    s_waitcnt lgkmcnt(0)
    v_exp_f32 v94, v94
    v_mfma_f32_16x16x32_bf16 v[112:115], a[112:115], a[0:3], v[20:23]
    s_xor_b32 s90, s90, s72
    s_mov_b32 m0, s90
    v_mfma_f32_16x16x32_bf16 v[112:115], a[116:119], a[4:7], v[112:115]
    v_exp_f32 v95, v95
    v_mfma_f32_16x16x32_bf16 v[112:115], a[120:123], a[8:11], v[112:115]
    v_exp_f32 v96, v96
    v_mfma_f32_16x16x32_bf16 v[112:115], a[124:127], a[12:15], v[112:115]
    v_exp_f32 v97, v97
    v_mfma_f32_16x16x32_bf16 v[116:119], a[124:127], a[28:31], v[20:23]
    v_exp_f32 v98, v98
    v_mfma_f32_16x16x32_bf16 v[116:119], a[120:123], a[24:27], v[116:119]
    v_exp_f32 v99, v99
    v_mfma_f32_16x16x32_bf16 v[116:119], a[116:119], a[20:23], v[116:119]
    v_xor_b32 v4, 32768, v4
    v_mfma_f32_16x16x32_bf16 v[116:119], a[112:115], a[16:19], v[116:119]
    v_exp_f32 v100, v100
    v_mfma_f32_16x16x32_bf16 v[120:123], a[112:115], a[32:35], v[20:23]
    v_exp_f32 v101, v101
    v_mfma_f32_16x16x32_bf16 v[120:123], a[116:119], a[36:39], v[120:123]
    v_exp_f32 v102, v102
    v_mfma_f32_16x16x32_bf16 v[120:123], a[120:123], a[40:43], v[120:123]
    v_exp_f32 v103, v103
    v_mfma_f32_16x16x32_bf16 v[120:123], a[124:127], a[44:47], v[120:123]
    v_exp_f32 v104, v104
    v_mfma_f32_16x16x32_bf16 v[124:127], a[124:127], a[60:63], v[16:19]
    v_exp_f32 v105, v105
    v_mfma_f32_16x16x32_bf16 v[124:127], a[120:123], a[56:59], v[124:127]
    v_exp_f32 v106, v106
    v_mfma_f32_16x16x32_bf16 v[124:127], a[116:119], a[52:55], v[124:127]
    v_exp_f32 v107, v107
    v_mfma_f32_16x16x32_bf16 v[124:127], a[112:115], a[48:51], v[124:127]
    s_waitcnt vmcnt(0) lgkmcnt(0)
    s_barrier
    v_mfma_f32_16x16x32_bf16 v[128:131], a[212:215], a[212:215], 0
    buffer_load_dwordx4 v3, s[60:63], s88 offen offset:0 sc1 lds
    v_mfma_f32_16x16x32_bf16 v[132:135], a[212:215], a[212:215], 0
    v_exp_f32 v108, v108
    v_mfma_f32_16x16x32_bf16 v[136:139], a[212:215], a[212:215], 0
    ds_read_b128 a[64:67], v4 offset:0
    v_mfma_f32_16x16x32_bf16 v[140:143], a[212:215], a[212:215], 0
    v_exp_f32 v109, v109
    v_mfma_f32_16x16x32_bf16 v[156:159], a[212:215], a[212:215], 0
    buffer_load_dwordx4 v3, s[60:63], s88 offen offset:1024 sc1 lds
    v_mfma_f32_16x16x32_bf16 v[152:155], a[212:215], a[212:215], 0
    v_exp_f32 v110, v110
    v_mfma_f32_16x16x32_bf16 v[148:151], a[212:215], a[212:215], 0
    ds_read_b128 a[68:71], v4 offset:1024
    v_mfma_f32_16x16x32_bf16 v[144:147], a[212:215], a[212:215], 0
    v_exp_f32 v111, v111
    v_mfma_f32_16x16x32_bf16 v[160:163], a[212:215], a[212:215], 0
    buffer_load_dwordx4 v3, s[60:63], s88 offen offset:2048 sc1 lds
    v_mfma_f32_16x16x32_bf16 v[164:167], a[212:215], a[212:215], 0
    v_exp_f32 v112, v112
    v_mfma_f32_16x16x32_bf16 v[168:171], a[212:215], a[212:215], 0
    ds_read_b128 a[72:75], v4 offset:2048
    v_mfma_f32_16x16x32_bf16 v[172:175], a[212:215], a[212:215], 0
    v_exp_f32 v113, v113
    v_mfma_f32_16x16x32_bf16 v[188:191], a[212:215], a[212:215], 0
    buffer_load_dwordx4 v3, s[60:63], s88 offen offset:3072 sc1 lds
    s_add_u32 m0, s90, 4096
    s_add_u32 s76, s88, 4096
    v_mfma_f32_16x16x32_bf16 v[184:187], a[212:215], a[212:215], 0
    v_exp_f32 v114, v114
    v_mfma_f32_16x16x32_bf16 v[180:183], a[212:215], a[212:215], 0
    ds_read_b128 a[76:79], v4 offset:3072
    v_mfma_f32_16x16x32_bf16 v[176:179], a[212:215], a[212:215], 0
    v_exp_f32 v115, v115
    v_mfma_f32_16x16x32_bf16 v[192:195], a[212:215], a[212:215], 0
    buffer_load_dwordx4 v3, s[60:63], s76 offen offset:0 sc1 lds
    v_mfma_f32_16x16x32_bf16 v[196:199], a[212:215], a[212:215], 0
    v_exp_f32 v116, v116
    v_mfma_f32_16x16x32_bf16 v[200:203], a[212:215], a[212:215], 0
    ds_read_b128 a[80:83], v4 offset:4096
    v_mfma_f32_16x16x32_bf16 v[204:207], a[212:215], a[212:215], 0
    v_exp_f32 v117, v117
    v_mfma_f32_16x16x32_bf16 v[220:223], a[212:215], a[212:215], 0
    buffer_load_dwordx4 v3, s[60:63], s76 offen offset:1024 sc1 lds
    v_mfma_f32_16x16x32_bf16 v[216:219], a[212:215], a[212:215], 0
    v_exp_f32 v118, v118
    v_mfma_f32_16x16x32_bf16 v[212:215], a[212:215], a[212:215], 0
    ds_read_b128 a[84:87], v4 offset:5120
    v_mfma_f32_16x16x32_bf16 v[208:211], a[212:215], a[212:215], 0
    v_exp_f32 v119, v119
    v_mfma_f32_16x16x32_bf16 v[224:227], a[212:215], a[212:215], 0
    buffer_load_dwordx4 v3, s[60:63], s76 offen offset:2048 sc1 lds
    v_mfma_f32_16x16x32_bf16 v[228:231], a[212:215], a[212:215], 0
    v_exp_f32 v120, v120
    v_mfma_f32_16x16x32_bf16 v[232:235], a[212:215], a[212:215], 0
    ds_read_b128 a[88:91], v4 offset:6144
    v_mfma_f32_16x16x32_bf16 v[236:239], a[212:215], a[212:215], 0
    v_exp_f32 v121, v121
    v_mfma_f32_16x16x32_bf16 v[252:255], a[212:215], a[212:215], 0
    buffer_load_dwordx4 v3, s[60:63], s76 offen offset:3072 sc1 lds
    s_mov_b32 m0, s91
    s_add_u32 s88, s88, 16384
    v_mfma_f32_16x16x32_bf16 v[248:251], a[212:215], a[212:215], 0
    v_exp_f32 v122, v122
    v_mfma_f32_16x16x32_bf16 v[244:247], a[212:215], a[212:215], 0
    ds_read_b128 a[92:95], v4 offset:7168
    v_mfma_f32_16x16x32_bf16 v[240:243], a[212:215], a[212:215], 0
    v_exp_f32 v123, v123
    v_mfma_f32_16x16x32_bf16 a[192:195], a[212:215], a[212:215], 0
    buffer_load_dwordx4 v3, s[64:67], s89 offen offset:0 sc1 lds
    v_mfma_f32_16x16x32_bf16 a[196:199], a[212:215], a[212:215], 0
    buffer_load_dwordx4 v3, s[64:67], s89 offen offset:1024 sc1 lds
    v_mfma_f32_16x16x32_bf16 a[200:203], a[212:215], a[212:215], 0
    buffer_load_dwordx4 v3, s[64:67], s89 offen offset:2048 sc1 lds
    v_mfma_f32_16x16x32_bf16 a[204:207], a[212:215], a[212:215], 0
    buffer_load_dwordx4 v3, s[64:67], s89 offen offset:3072 sc1 lds
    s_add_u32 m0, s91, 4096
    s_add_u32 s76, s89, 4096
    v_exp_f32 v124, v124
    v_exp_f32 v125, v125
    v_exp_f32 v126, v126
    v_exp_f32 v127, v127
    s_add_u32 s94, s94, 1
    s_cmp_eq_u32 s94, s22
    s_cselect_b32 s21, -1, 0
    s_cmp_eq_u32 s94, s20
    s_cselect_b32 s21, -1, s21
    v_and_b32 v16, s21, v9
    v_and_b32 v17, s21, v10
    v_and_b32 v18, s21, v11
    v_and_b32 v19, s21, v30
    s_and_b32 s21, s21, 0xff800000
    v_mov_b32 v20, s21
    v_mov_b32 v21, s21
    v_mov_b32 v22, s21
    v_mov_b32 v23, s21
    v_cvt_pk_bf16_f32 v32, v64, v65
    v_cvt_pk_bf16_f32 v33, v66, v67
    s_waitcnt lgkmcnt(4)
    s_branch L_special
.p2align 6
L_body:
    v_mfma_f32_16x16x32_bf16 v[64:67], a[64:67], a[0:3], v[16:19]
    ds_read_b128 a[96:99], v4 offset:8192
    v_cvt_pk_bf16_f32 v36, v68, v69
    v_mfma_f32_16x16x32_bf16 v[64:67], a[68:71], a[4:7], v[64:67]
    v_cvt_pk_bf16_f32 v37, v70, v71
    v_cvt_pk_bf16_f32 v41, v74, v75
    v_mfma_f32_16x16x32_bf16 v[64:67], a[72:75], a[8:11], v[64:67]
    buffer_load_dwordx4 v3, s[64:67], s76 offen offset:0 sc1 lds
    v_mfma_f32_16x16x32_bf16 v[64:67], a[76:79], a[12:15], v[64:67]
    v_cvt_pk_bf16_f32 v45, v78, v79
    v_cvt_pk_bf16_f32 v35, v82, v83
    v_mfma_f32_16x16x32_bf16 v[68:71], a[76:79], a[28:31], 0
    ds_read_b128 a[100:103], v4 offset:9216
    v_cvt_pk_bf16_f32 v40, v72, v73
    v_mfma_f32_16x16x32_bf16 v[68:71], a[72:75], a[24:27], v[68:71]
    v_cvt_pk_bf16_f32 v39, v86, v87
    v_cvt_pk_bf16_f32 v43, v90, v91
    v_mfma_f32_16x16x32_bf16 v[68:71], a[68:71], a[20:23], v[68:71]
    buffer_load_dwordx4 v3, s[64:67], s76 offen offset:1024 sc1 lds
    v_mfma_f32_16x16x32_bf16 v[68:71], a[64:67], a[16:19], v[68:71]
    v_cvt_pk_bf16_f32 v47, v94, v95
    v_cvt_pk_bf16_f32 v49, v98, v99
    v_mfma_f32_16x16x32_bf16 v[72:75], a[64:67], a[32:35], 0
    ds_read_b128 a[104:107], v4 offset:10240
    v_cvt_pk_bf16_f32 v44, v76, v77
    v_mfma_f32_16x16x32_bf16 v[72:75], a[68:71], a[36:39], v[72:75]
    v_cvt_pk_bf16_f32 v53, v102, v103
    v_cvt_pk_bf16_f32 v57, v106, v107
    v_mfma_f32_16x16x32_bf16 v[72:75], a[72:75], a[40:43], v[72:75]
    buffer_load_dwordx4 v3, s[64:67], s76 offen offset:2048 sc1 lds
    v_mfma_f32_16x16x32_bf16 v[72:75], a[76:79], a[44:47], v[72:75]
    v_cvt_pk_bf16_f32 v61, v110, v111
    v_cvt_pk_bf16_f32 v51, v114, v115
    v_mfma_f32_16x16x32_bf16 v[76:79], a[76:79], a[60:63], 0
    ds_read_b128 a[108:111], v4 offset:11264
    v_cvt_pk_bf16_f32 v34, v80, v81
    v_mfma_f32_16x16x32_bf16 v[76:79], a[72:75], a[56:59], v[76:79]
    v_cvt_pk_bf16_f32 v55, v118, v119
    v_cvt_pk_bf16_f32 v59, v122, v123
    v_mfma_f32_16x16x32_bf16 v[76:79], a[68:71], a[52:55], v[76:79]
    buffer_load_dwordx4 v3, s[64:67], s76 offen offset:3072 sc1 lds
    s_sub_u32 s92, s92, 16384
    v_mfma_f32_16x16x32_bf16 v[76:79], a[64:67], a[48:51], v[76:79]
    s_waitcnt lgkmcnt(4)
    v_cvt_pk_bf16_f32 v63, v126, v127
    v_mfma_f32_16x16x32_bf16 v[80:83], a[80:83], a[0:3], v[20:23]
    s_min_u32 s89, s92, s93
    ds_read_b128 a[112:115], v4 offset:12288
    v_cvt_pk_bf16_f32 v38, v84, v85
    v_mfma_f32_16x16x32_bf16 v[80:83], a[84:87], a[4:7], v[80:83]
    v_exp_f32 v64, v64
    v_mfma_f32_16x16x32_bf16 v[80:83], a[88:91], a[8:11], v[80:83]
    buffer_load_dwordx4 a[224:227], v3, s[56:59], s49 offen offset:0 sc1
    v_mfma_f32_16x16x32_bf16 v[80:83], a[92:95], a[12:15], v[80:83]
    v_exp_f32 v65, v65
    v_mfma_f32_16x16x32_bf16 v[84:87], a[92:95], a[28:31], v[16:19]
    ds_read_b128 a[116:119], v4 offset:13312
    v_cvt_pk_bf16_f32 v42, v88, v89
    v_mfma_f32_16x16x32_bf16 v[84:87], a[88:91], a[24:27], v[84:87]
    v_exp_f32 v66, v66
    v_mfma_f32_16x16x32_bf16 v[84:87], a[84:87], a[20:23], v[84:87]
    buffer_load_dwordx4 a[228:231], v3, s[56:59], s49 offen offset:1024 sc1
    v_mfma_f32_16x16x32_bf16 v[84:87], a[80:83], a[16:19], v[84:87]
    v_exp_f32 v67, v67
    v_mfma_f32_16x16x32_bf16 v[88:91], a[80:83], a[32:35], 0
    ds_read_b128 a[120:123], v4 offset:14336
    v_cvt_pk_bf16_f32 v46, v92, v93
    v_mfma_f32_16x16x32_bf16 v[88:91], a[84:87], a[36:39], v[88:91]
    v_exp_f32 v68, v68
    v_mfma_f32_16x16x32_bf16 v[88:91], a[88:91], a[40:43], v[88:91]
    buffer_load_dwordx4 a[232:235], v3, s[56:59], s49 offen offset:2048 sc1
    v_mfma_f32_16x16x32_bf16 v[88:91], a[92:95], a[44:47], v[88:91]
    v_exp_f32 v69, v69
    v_mfma_f32_16x16x32_bf16 v[92:95], a[92:95], a[60:63], 0
    ds_read_b128 a[124:127], v4 offset:15360
    v_cvt_pk_bf16_f32 v48, v96, v97
    v_mfma_f32_16x16x32_bf16 v[92:95], a[88:91], a[56:59], v[92:95]
    v_exp_f32 v70, v70
    v_mfma_f32_16x16x32_bf16 v[92:95], a[84:87], a[52:55], v[92:95]
    buffer_load_dwordx4 a[236:239], v3, s[56:59], s49 offen offset:3072 sc1
    s_add_u32 s49, s49, s51
    v_mfma_f32_16x16x32_bf16 v[92:95], a[80:83], a[48:51], v[92:95]
    s_waitcnt lgkmcnt(4)
    v_exp_f32 v71, v71
    v_mfma_f32_16x16x32_bf16 v[96:99], a[96:99], a[0:3], v[20:23]
    ds_read_b128 a[64:67], v4 offset:16384
    v_cvt_pk_bf16_f32 v52, v100, v101
    v_mfma_f32_16x16x32_bf16 v[96:99], a[100:103], a[4:7], v[96:99]
    v_exp_f32 v72, v72
    v_mfma_f32_16x16x32_bf16 v[96:99], a[104:107], a[8:11], v[96:99]
    buffer_load_dwordx4 a[240:243], v3, s[56:59], s50 offen offset:0 sc1
    v_mfma_f32_16x16x32_bf16 v[96:99], a[108:111], a[12:15], v[96:99]
    v_exp_f32 v73, v73
    v_mfma_f32_16x16x32_bf16 v[100:103], a[108:111], a[28:31], v[20:23]
    ds_read_b128 a[68:71], v4 offset:24576
    v_cvt_pk_bf16_f32 v56, v104, v105
    v_mfma_f32_16x16x32_bf16 v[100:103], a[104:107], a[24:27], v[100:103]
    v_exp_f32 v74, v74
    v_mfma_f32_16x16x32_bf16 v[100:103], a[100:103], a[20:23], v[100:103]
    buffer_load_dwordx4 a[244:247], v3, s[56:59], s50 offen offset:1024 sc1
    v_mfma_f32_16x16x32_bf16 v[100:103], a[96:99], a[16:19], v[100:103]
    v_exp_f32 v75, v75
    v_mfma_f32_16x16x32_bf16 v[104:107], a[96:99], a[32:35], v[16:19]
    ds_read_b128 a[72:75], v4 offset:17408
    v_cvt_pk_bf16_f32 v60, v108, v109
    v_mfma_f32_16x16x32_bf16 v[104:107], a[100:103], a[36:39], v[104:107]
    v_exp_f32 v76, v76
    v_mfma_f32_16x16x32_bf16 v[104:107], a[104:107], a[40:43], v[104:107]
    buffer_load_dwordx4 a[248:251], v3, s[56:59], s50 offen offset:2048 sc1
    v_mfma_f32_16x16x32_bf16 v[104:107], a[108:111], a[44:47], v[104:107]
    v_exp_f32 v77, v77
    v_mfma_f32_16x16x32_bf16 v[108:111], a[108:111], a[60:63], 0
    ds_read_b128 a[76:79], v4 offset:25600
    v_cvt_pk_bf16_f32 v50, v112, v113
    v_mfma_f32_16x16x32_bf16 v[108:111], a[104:107], a[56:59], v[108:111]
    v_exp_f32 v78, v78
    v_mfma_f32_16x16x32_bf16 v[108:111], a[100:103], a[52:55], v[108:111]
    buffer_load_dwordx4 a[252:255], v3, s[56:59], s50 offen offset:3072 sc1
    s_add_u32 s50, s50, s51
    v_mfma_f32_16x16x32_bf16 v[108:111], a[96:99], a[48:51], v[108:111]
    s_waitcnt lgkmcnt(4)
    v_exp_f32 v79, v79
    v_mfma_f32_16x16x32_bf16 v[112:115], a[112:115], a[0:3], v[20:23]
    ds_read_b128 a[80:83], v4 offset:18432
    v_cvt_pk_bf16_f32 v54, v116, v117
    v_mfma_f32_16x16x32_bf16 v[112:115], a[116:119], a[4:7], v[112:115]
    v_exp_f32 v80, v80
    v_mfma_f32_16x16x32_bf16 v[112:115], a[120:123], a[8:11], v[112:115]
    v_mfma_f32_16x16x32_bf16 v[112:115], a[124:127], a[12:15], v[112:115]
    v_exp_f32 v81, v81
    v_mfma_f32_16x16x32_bf16 v[116:119], a[124:127], a[28:31], v[20:23]
    ds_read_b128 a[84:87], v4 offset:26624
    v_cvt_pk_bf16_f32 v58, v120, v121
    v_mfma_f32_16x16x32_bf16 v[116:119], a[120:123], a[24:27], v[116:119]
    v_exp_f32 v82, v82
    v_mfma_f32_16x16x32_bf16 v[116:119], a[116:119], a[20:23], v[116:119]
    v_mfma_f32_16x16x32_bf16 v[116:119], a[112:115], a[16:19], v[116:119]
    v_exp_f32 v83, v83
    v_mfma_f32_16x16x32_bf16 v[120:123], a[112:115], a[32:35], v[20:23]
    ds_read_b128 a[88:91], v4 offset:19456
    v_cvt_pk_bf16_f32 v62, v124, v125
    v_mfma_f32_16x16x32_bf16 v[120:123], a[116:119], a[36:39], v[120:123]
    v_exp_f32 v84, v84
    v_mfma_f32_16x16x32_bf16 v[120:123], a[120:123], a[40:43], v[120:123]
    buffer_load_dword v0, v31, s[52:55], 0 offen sc1
    v_mfma_f32_16x16x32_bf16 v[120:123], a[124:127], a[44:47], v[120:123]
    v_exp_f32 v85, v85
    v_mfma_f32_16x16x32_bf16 v[124:127], a[124:127], a[60:63], v[16:19]
    ds_read_b128 a[92:95], v4 offset:27648
    v_mfma_f32_16x16x32_bf16 v[124:127], a[120:123], a[56:59], v[124:127]
    v_exp_f32 v86, v86
    v_mfma_f32_16x16x32_bf16 v[124:127], a[116:119], a[52:55], v[124:127]
    s_mov_b32 s73, 0x30000
    v_mfma_f32_16x16x32_bf16 v[124:127], a[112:115], a[48:51], v[124:127]
    s_waitcnt lgkmcnt(4)
    v_exp_f32 v87, v87
    v_mfma_f32_16x16x32_bf16 v[128:131], a[64:67], v[32:35], v[128:131]
    ds_read_b128 a[96:99], v4 offset:20480
    v_mfma_f32_16x16x32_bf16 v[128:131], a[68:71], v[48:51], v[128:131]
    v_exp_f32 v88, v88
    v_mfma_f32_16x16x32_bf16 v[132:135], a[68:71], v[52:55], v[132:135]
    ds_read_b128 a[100:103], v4 offset:28672
    v_mfma_f32_16x16x32_bf16 v[132:135], a[64:67], v[36:39], v[132:135]
    v_exp_f32 v89, v89
    v_mfma_f32_16x16x32_bf16 v[136:139], a[64:67], v[40:43], v[136:139]
    ds_read_b128 a[104:107], v4 offset:21504
    v_mfma_f32_16x16x32_bf16 v[136:139], a[68:71], v[56:59], v[136:139]
    v_exp_f32 v90, v90
    v_mfma_f32_16x16x32_bf16 v[140:143], a[68:71], v[60:63], v[140:143]
    ds_read_b128 a[108:111], v4 offset:29696
    v_mfma_f32_16x16x32_bf16 v[140:143], a[64:67], v[44:47], v[140:143]
    v_exp_f32 v91, v91
    v_mfma_f32_16x16x32_bf16 v[156:159], a[72:75], v[44:47], v[156:159]
    ds_read_b128 a[112:115], v4 offset:22528
    v_mfma_f32_16x16x32_bf16 v[156:159], a[76:79], v[60:63], v[156:159]
    v_exp_f32 v92, v92
    v_mfma_f32_16x16x32_bf16 v[152:155], a[76:79], v[56:59], v[152:155]
    ds_read_b128 a[116:119], v4 offset:30720
    v_mfma_f32_16x16x32_bf16 v[152:155], a[72:75], v[40:43], v[152:155]
    v_exp_f32 v93, v93
    v_mfma_f32_16x16x32_bf16 v[148:151], a[72:75], v[36:39], v[148:151]
    ds_read_b128 a[120:123], v4 offset:23552
    v_mfma_f32_16x16x32_bf16 v[148:151], a[76:79], v[52:55], v[148:151]
    v_exp_f32 v94, v94
    v_mfma_f32_16x16x32_bf16 v[144:147], a[76:79], v[48:51], v[144:147]
    ds_read_b128 a[124:127], v4 offset:31744
    v_mfma_f32_16x16x32_bf16 v[144:147], a[72:75], v[32:35], v[144:147]
    s_waitcnt lgkmcnt(8)
    v_exp_f32 v95, v95
    v_mfma_f32_16x16x32_bf16 v[160:163], a[80:83], v[32:35], v[160:163]
    s_cmp_le_u32 s94, 15
    s_cselect_b32 s72, 32768, s73
    v_mfma_f32_16x16x32_bf16 v[160:163], a[84:87], v[48:51], v[160:163]
    v_exp_f32 v96, v96
    v_mfma_f32_16x16x32_bf16 v[164:167], a[84:87], v[52:55], v[164:167]
    s_cmp_le_u32 s94, s25
    s_cselect_b32 s62, 67108864, 0
    v_mfma_f32_16x16x32_bf16 v[164:167], a[80:83], v[36:39], v[164:167]
    v_exp_f32 v97, v97
    v_mfma_f32_16x16x32_bf16 v[168:171], a[80:83], v[40:43], v[168:171]
    s_add_u32 s75, s94, 2
    s_xor_b32 s91, s91, s72
    v_mfma_f32_16x16x32_bf16 v[168:171], a[84:87], v[56:59], v[168:171]
    v_exp_f32 v98, v98
    v_mfma_f32_16x16x32_bf16 v[172:175], a[84:87], v[60:63], v[172:175]
    s_cmp_ge_u32 s75, s97
    s_cselect_b32 s66, s62, 0
    v_mfma_f32_16x16x32_bf16 v[172:175], a[80:83], v[44:47], v[172:175]
    v_exp_f32 v99, v99
    v_mfma_f32_16x16x32_bf16 v[188:191], a[88:91], v[44:47], v[188:191]
    s_xor_b32 s90, s90, s72
    s_mov_b32 m0, s90
    v_mfma_f32_16x16x32_bf16 v[188:191], a[92:95], v[60:63], v[188:191]
    v_exp_f32 v100, v100
    v_mfma_f32_16x16x32_bf16 v[184:187], a[92:95], v[56:59], v[184:187]
    v_xor_b32 v4, 32768, v4
    s_add_u32 s94, s94, 1
    v_mfma_f32_16x16x32_bf16 v[184:187], a[88:91], v[40:43], v[184:187]
    v_exp_f32 v101, v101
    v_mfma_f32_16x16x32_bf16 v[180:183], a[88:91], v[36:39], v[180:183]
    s_cmp_eq_u32 s94, s22
    s_cselect_b32 s21, -1, 0
    v_mfma_f32_16x16x32_bf16 v[180:183], a[92:95], v[52:55], v[180:183]
    v_exp_f32 v102, v102
    v_mfma_f32_16x16x32_bf16 v[176:179], a[92:95], v[48:51], v[176:179]
    s_cmp_eq_u32 s94, s20
    s_cselect_b32 s21, -1, s21
    v_mfma_f32_16x16x32_bf16 v[176:179], a[88:91], v[32:35], v[176:179]
    s_waitcnt vmcnt(0) lgkmcnt(0)
    s_barrier
    v_mfma_f32_16x16x32_bf16 v[192:195], a[96:99], v[32:35], v[192:195]
    v_exp_f32 v103, v103
    v_mfma_f32_16x16x32_bf16 v[192:195], a[100:103], v[48:51], v[192:195]
    v_exp_f32 v104, v104
    v_mfma_f32_16x16x32_bf16 v[196:199], a[100:103], v[52:55], v[196:199]
    buffer_load_dwordx4 v3, s[60:63], s88 offen offset:0 sc1 lds
    v_mfma_f32_16x16x32_bf16 v[196:199], a[96:99], v[36:39], v[196:199]
    v_exp_f32 v105, v105
    v_mfma_f32_16x16x32_bf16 v[200:203], a[96:99], v[40:43], v[200:203]
    ds_read_b128 a[64:67], v4 offset:0
    v_mfma_f32_16x16x32_bf16 v[200:203], a[100:103], v[56:59], v[200:203]
    v_exp_f32 v106, v106
    v_mfma_f32_16x16x32_bf16 v[204:207], a[100:103], v[60:63], v[204:207]
    buffer_load_dwordx4 v3, s[60:63], s88 offen offset:1024 sc1 lds
    v_mfma_f32_16x16x32_bf16 v[204:207], a[96:99], v[44:47], v[204:207]
    v_exp_f32 v107, v107
    v_mfma_f32_16x16x32_bf16 v[220:223], a[104:107], v[44:47], v[220:223]
    ds_read_b128 a[68:71], v4 offset:1024
    v_mfma_f32_16x16x32_bf16 v[220:223], a[108:111], v[60:63], v[220:223]
    v_exp_f32 v108, v108
    v_mfma_f32_16x16x32_bf16 v[216:219], a[108:111], v[56:59], v[216:219]
    buffer_load_dwordx4 v3, s[60:63], s88 offen offset:2048 sc1 lds
    v_mfma_f32_16x16x32_bf16 v[216:219], a[104:107], v[40:43], v[216:219]
    v_exp_f32 v109, v109
    v_mfma_f32_16x16x32_bf16 v[212:215], a[104:107], v[36:39], v[212:215]
    ds_read_b128 a[72:75], v4 offset:2048
    v_mfma_f32_16x16x32_bf16 v[212:215], a[108:111], v[52:55], v[212:215]
    v_exp_f32 v110, v110
    v_mfma_f32_16x16x32_bf16 v[208:211], a[108:111], v[48:51], v[208:211]
    buffer_load_dwordx4 v3, s[60:63], s88 offen offset:3072 sc1 lds
    s_add_u32 m0, s90, 4096
    v_mfma_f32_16x16x32_bf16 v[208:211], a[104:107], v[32:35], v[208:211]
    s_add_u32 s76, s88, 4096
    v_exp_f32 v111, v111
    v_mfma_f32_16x16x32_bf16 v[224:227], a[112:115], v[32:35], v[224:227]
    ds_read_b128 a[76:79], v4 offset:3072
    v_mfma_f32_16x16x32_bf16 v[224:227], a[116:119], v[48:51], v[224:227]
    v_exp_f32 v112, v112
    v_mfma_f32_16x16x32_bf16 v[228:231], a[116:119], v[52:55], v[228:231]
    buffer_load_dwordx4 v3, s[60:63], s76 offen offset:0 sc1 lds
    v_mfma_f32_16x16x32_bf16 v[228:231], a[112:115], v[36:39], v[228:231]
    v_exp_f32 v113, v113
    v_mfma_f32_16x16x32_bf16 v[232:235], a[112:115], v[40:43], v[232:235]
    ds_read_b128 a[80:83], v4 offset:4096
    v_mfma_f32_16x16x32_bf16 v[232:235], a[116:119], v[56:59], v[232:235]
    v_exp_f32 v114, v114
    v_mfma_f32_16x16x32_bf16 v[236:239], a[116:119], v[60:63], v[236:239]
    buffer_load_dwordx4 v3, s[60:63], s76 offen offset:1024 sc1 lds
    v_mfma_f32_16x16x32_bf16 v[236:239], a[112:115], v[44:47], v[236:239]
    v_exp_f32 v115, v115
    v_mfma_f32_16x16x32_bf16 v[252:255], a[120:123], v[44:47], v[252:255]
    ds_read_b128 a[84:87], v4 offset:5120
    v_mfma_f32_16x16x32_bf16 v[252:255], a[124:127], v[60:63], v[252:255]
    v_exp_f32 v116, v116
    v_mfma_f32_16x16x32_bf16 v[248:251], a[124:127], v[56:59], v[248:251]
    buffer_load_dwordx4 v3, s[60:63], s76 offen offset:2048 sc1 lds
    v_mfma_f32_16x16x32_bf16 v[248:251], a[120:123], v[40:43], v[248:251]
    v_exp_f32 v117, v117
    v_mfma_f32_16x16x32_bf16 v[244:247], a[120:123], v[36:39], v[244:247]
    ds_read_b128 a[88:91], v4 offset:6144
    v_mfma_f32_16x16x32_bf16 v[244:247], a[124:127], v[52:55], v[244:247]
    v_exp_f32 v118, v118
    v_mfma_f32_16x16x32_bf16 v[240:243], a[124:127], v[48:51], v[240:243]
    buffer_load_dwordx4 v3, s[60:63], s76 offen offset:3072 sc1 lds
    s_mov_b32 m0, s91
    v_mfma_f32_16x16x32_bf16 v[240:243], a[120:123], v[32:35], v[240:243]
    s_add_u32 s88, s88, 16384
    v_exp_f32 v119, v119
    v_mfma_f32_16x16x32_bf16 a[192:195], a[208:211], v[32:35], a[192:195]
    ds_read_b128 a[92:95], v4 offset:7168
    v_mfma_f32_16x16x32_bf16 a[192:195], a[208:211], v[48:51], a[192:195]
    v_exp_f32 v120, v120
    v_mfma_f32_16x16x32_bf16 a[196:199], a[208:211], v[36:39], a[196:199]
    buffer_load_dwordx4 v3, s[64:67], s89 offen offset:0 sc1 lds
    v_mfma_f32_16x16x32_bf16 a[196:199], a[208:211], v[52:55], a[196:199]
    v_exp_f32 v121, v121
    v_mfma_f32_16x16x32_bf16 a[200:203], a[208:211], v[40:43], a[200:203]
    v_and_b32 v16, s21, v9
    v_and_b32 v17, s21, v10
    v_mfma_f32_16x16x32_bf16 a[200:203], a[208:211], v[56:59], a[200:203]
    v_exp_f32 v122, v122
    v_mfma_f32_16x16x32_bf16 a[204:207], a[208:211], v[44:47], a[204:207]
    buffer_load_dwordx4 v3, s[64:67], s89 offen offset:1024 sc1 lds
    v_mfma_f32_16x16x32_bf16 a[204:207], a[208:211], v[60:63], a[204:207]
    v_exp_f32 v123, v123
    v_mfma_f32_16x16x32_bf16 a[128:131], a[224:227], a[240:243], a[128:131]
    v_and_b32 v18, s21, v11
    v_and_b32 v19, s21, v30
    v_mfma_f32_16x16x32_bf16 a[132:135], a[224:227], a[244:247], a[132:135]
    v_exp_f32 v124, v124
    v_mfma_f32_16x16x32_bf16 a[136:139], a[224:227], a[248:251], a[136:139]
    buffer_load_dwordx4 v3, s[64:67], s89 offen offset:2048 sc1 lds
    v_mfma_f32_16x16x32_bf16 a[140:143], a[224:227], a[252:255], a[140:143]
    v_exp_f32 v125, v125
    v_mfma_f32_16x16x32_bf16 a[156:159], a[228:231], a[252:255], a[156:159]
    s_and_b32 s21, s21, 0xff800000
    v_mov_b32 v20, s21
    v_mov_b32 v21, s21
    v_mfma_f32_16x16x32_bf16 a[152:155], a[228:231], a[248:251], a[152:155]
    v_exp_f32 v126, v126
    v_mfma_f32_16x16x32_bf16 a[148:151], a[228:231], a[244:247], a[148:151]
    buffer_load_dwordx4 v3, s[64:67], s89 offen offset:3072 sc1 lds
    s_add_u32 m0, s91, 4096
    v_mfma_f32_16x16x32_bf16 a[144:147], a[228:231], a[240:243], a[144:147]
    s_add_u32 s76, s89, 4096
    v_exp_f32 v127, v127
    v_mfma_f32_16x16x32_bf16 a[160:163], a[232:235], a[240:243], a[160:163]
    v_mov_b32 v22, s21
    v_mov_b32 v23, s21
    v_mfma_f32_16x16x32_bf16 a[164:167], a[232:235], a[244:247], a[164:167]
    v_mfma_f32_16x16x32_bf16 a[168:171], a[232:235], a[248:251], a[168:171]
    v_cvt_pk_bf16_f32 v32, v64, v65
    v_cvt_pk_bf16_f32 v33, v66, v67
    v_mfma_f32_16x16x32_bf16 a[172:175], a[232:235], a[252:255], a[172:175]
    v_mfma_f32_16x16x32_bf16 a[188:191], a[236:239], a[252:255], a[188:191]
    v_mfma_f32_16x16x32_bf16 a[184:187], a[236:239], a[248:251], a[184:187]
    v_mfma_f32_16x16x32_bf16 a[180:183], a[236:239], a[244:247], a[180:183]
    s_cmp_eq_u32 s94, s74
    v_mfma_f32_16x16x32_bf16 a[176:179], a[236:239], a[240:243], a[176:179]
    s_waitcnt lgkmcnt(4)
    s_cbranch_scc0 L_body
L_special:
    s_cmp_lt_u32 s94, 3
    s_cselect_b32 s74, 3, 17
    s_min_u32 s74, s74, s96
    s_cmp_eq_u32 s94, 3
    s_cbranch_scc0 L_late
    v_cmp_eq_u32 vcc, s3, v0
    s_cmp_eq_u64 vcc, exec
    s_cbranch_scc0 L_spin_b
L_ok_b:
    s_mov_b32 s58, 67108864
    s_mov_b32 s51, 4096
L_late:
    s_cmp_eq_u32 s94, s20
    s_cbranch_scc1 L_first
    s_cmp_eq_u32 s94, s96
    s_cbranch_scc0 L_body
    s_cmp_eq_u32 s94, 17
    s_cbranch_scc0 L_trans
L_final:
    s_lshl_b32 s72, s68, 17
    s_lshl_b32 s81, s69, 19
    s_add_u32 s81, s81, s72
    s_add_u32 s81, s81, 16777216
    s_lshl_b32 s80, s70, 19
    s_add_u32 s80, s80, s72
    s_add_u32 s80, s80, 12582912
    s_mov_b32 s82, s80
    s_mov_b32 s83, s81
    s_mul_i32 s72, s2, 0
    s_and_b32 s72, s72, 131071
    s_add_u32 s80, s80, s72
    s_add_u32 s81, s81, s72
    s_and_b32 s72, s68, 1
    s_lshl_b32 s72, s72, 14
    s_lshr_b32 s73, s68, 1
    s_lshl_b32 s73, s73, 16
    s_add_u32 s72, s72, s73
    v_add_u32 v16, s72, v3
    v_xor_b32 v17, 81920, v16
    s_add_u32 s72, s78, 147456
    v_add_u32 v18, s72, v3
    v_xor_b32 v19, 3072, v18
    s_cmp_ge_u32 s68, 2
    s_cbranch_scc1 L_mergeB
    s_waitcnt lgkmcnt(0)
    ds_read_b128 a[64:67], v4 offset:20480
    ds_read_b128 a[68:71], v4 offset:28672
    ds_read_b128 a[72:75], v4 offset:21504
    ds_read_b128 a[76:79], v4 offset:29696
    ds_read_b128 a[80:83], v4 offset:22528
    ds_read_b128 a[84:87], v4 offset:30720
    ds_read_b128 a[88:91], v4 offset:23552
    ds_read_b128 a[92:95], v4 offset:31744
    v_cvt_pk_bf16_f32 v36, v68, v69
    v_cvt_pk_bf16_f32 v37, v70, v71
    v_cvt_pk_bf16_f32 v40, v72, v73
    v_cvt_pk_bf16_f32 v41, v74, v75
    v_cvt_pk_bf16_f32 v44, v76, v77
    v_cvt_pk_bf16_f32 v45, v78, v79
    v_cvt_pk_bf16_f32 v34, v80, v81
    v_cvt_pk_bf16_f32 v35, v82, v83
    v_cvt_pk_bf16_f32 v38, v84, v85
    v_cvt_pk_bf16_f32 v39, v86, v87
    v_cvt_pk_bf16_f32 v42, v88, v89
    v_cvt_pk_bf16_f32 v43, v90, v91
    v_cvt_pk_bf16_f32 v46, v92, v93
    v_cvt_pk_bf16_f32 v47, v94, v95
    v_cvt_pk_bf16_f32 v48, v96, v97
    v_cvt_pk_bf16_f32 v49, v98, v99
    v_cvt_pk_bf16_f32 v52, v100, v101
    v_cvt_pk_bf16_f32 v53, v102, v103
    v_cvt_pk_bf16_f32 v56, v104, v105
    v_cvt_pk_bf16_f32 v57, v106, v107
    v_cvt_pk_bf16_f32 v60, v108, v109
    v_cvt_pk_bf16_f32 v61, v110, v111
    v_cvt_pk_bf16_f32 v50, v112, v113
    v_cvt_pk_bf16_f32 v51, v114, v115
    v_cvt_pk_bf16_f32 v54, v116, v117
    v_cvt_pk_bf16_f32 v55, v118, v119
    v_cvt_pk_bf16_f32 v58, v120, v121
    v_cvt_pk_bf16_f32 v59, v122, v123
    v_cvt_pk_bf16_f32 v62, v124, v125
    v_cvt_pk_bf16_f32 v63, v126, v127
    ds_read_b128 a[96:99], v4 offset:16384
    ds_read_b128 a[100:103], v4 offset:24576
    ds_read_b128 a[104:107], v4 offset:17408
    ds_read_b128 a[108:111], v4 offset:25600
    ds_read_b128 a[112:115], v4 offset:18432
    ds_read_b128 a[116:119], v4 offset:26624
    ds_read_b128 a[120:123], v4 offset:19456
    ds_read_b128 a[124:127], v4 offset:27648
    v_mfma_f32_16x16x32_bf16 a[192:195], a[208:211], v[32:35], a[192:195]
    buffer_load_dwordx4 a[224:227], v3, s[52:55], s80 offen offset:0 sc1
    v_mfma_f32_16x16x32_bf16 a[192:195], a[208:211], v[48:51], a[192:195]
    v_mfma_f32_16x16x32_bf16 a[196:199], a[208:211], v[36:39], a[196:199]
    buffer_load_dwordx4 a[228:231], v3, s[52:55], s80 offen offset:1024 sc1
    v_mfma_f32_16x16x32_bf16 a[196:199], a[208:211], v[52:55], a[196:199]
    v_mfma_f32_16x16x32_bf16 a[200:203], a[208:211], v[40:43], a[200:203]
    buffer_load_dwordx4 a[232:235], v3, s[52:55], s80 offen offset:2048 sc1
    v_mfma_f32_16x16x32_bf16 a[200:203], a[208:211], v[56:59], a[200:203]
    v_mfma_f32_16x16x32_bf16 a[204:207], a[208:211], v[44:47], a[204:207]
    buffer_load_dwordx4 a[236:239], v3, s[52:55], s80 offen offset:3072 sc1
    s_add_u32 s80, s80, 4096
    v_mfma_f32_16x16x32_bf16 a[204:207], a[208:211], v[60:63], a[204:207]
    s_waitcnt lgkmcnt(12)
    v_mfma_f32_16x16x32_bf16 v[192:195], a[64:67], v[32:35], v[192:195]
    buffer_load_dwordx4 a[240:243], v3, s[52:55], s80 offen offset:0 sc1
    v_mfma_f32_16x16x32_bf16 v[192:195], a[68:71], v[48:51], v[192:195]
    v_mfma_f32_16x16x32_bf16 v[196:199], a[68:71], v[52:55], v[196:199]
    buffer_load_dwordx4 a[244:247], v3, s[52:55], s80 offen offset:1024 sc1
    v_mfma_f32_16x16x32_bf16 v[196:199], a[64:67], v[36:39], v[196:199]
    v_mfma_f32_16x16x32_bf16 v[200:203], a[64:67], v[40:43], v[200:203]
    buffer_load_dwordx4 a[248:251], v3, s[52:55], s80 offen offset:2048 sc1
    v_mfma_f32_16x16x32_bf16 v[200:203], a[68:71], v[56:59], v[200:203]
    v_mfma_f32_16x16x32_bf16 v[204:207], a[68:71], v[60:63], v[204:207]
    buffer_load_dwordx4 a[252:255], v3, s[52:55], s80 offen offset:3072 sc1
    s_add_u32 s80, s80, 4096
    v_mfma_f32_16x16x32_bf16 v[204:207], a[64:67], v[44:47], v[204:207]
    v_mfma_f32_16x16x32_bf16 v[220:223], a[72:75], v[44:47], v[220:223]
    v_mfma_f32_16x16x32_bf16 v[220:223], a[76:79], v[60:63], v[220:223]
    v_accvgpr_read_b32 v26, a192
    v_accvgpr_read_b32 v27, a196
    v_mfma_f32_16x16x32_bf16 v[216:219], a[76:79], v[56:59], v[216:219]
    v_accvgpr_read_b32 v28, a200
    v_accvgpr_read_b32 v29, a204
    v_mfma_f32_16x16x32_bf16 v[216:219], a[72:75], v[40:43], v[216:219]
    ds_write_b128 v18, v[26:29]
    v_mfma_f32_16x16x32_bf16 v[212:215], a[72:75], v[36:39], v[212:215]
    v_mfma_f32_16x16x32_bf16 v[212:215], a[76:79], v[52:55], v[212:215]
    v_mfma_f32_16x16x32_bf16 v[208:211], a[76:79], v[48:51], v[208:211]
    v_mfma_f32_16x16x32_bf16 v[208:211], a[72:75], v[32:35], v[208:211]
    s_waitcnt lgkmcnt(9)
    ds_write_b128 v16, v[192:195] offset:0
    v_mfma_f32_16x16x32_bf16 v[224:227], a[80:83], v[32:35], v[224:227]
    v_mfma_f32_16x16x32_bf16 v[224:227], a[84:87], v[48:51], v[224:227]
    v_mfma_f32_16x16x32_bf16 v[228:231], a[84:87], v[52:55], v[228:231]
    ds_write_b128 v16, v[196:199] offset:1024
    v_mfma_f32_16x16x32_bf16 v[228:231], a[80:83], v[36:39], v[228:231]
    v_mfma_f32_16x16x32_bf16 v[232:235], a[80:83], v[40:43], v[232:235]
    v_mfma_f32_16x16x32_bf16 v[232:235], a[84:87], v[56:59], v[232:235]
    ds_write_b128 v16, v[200:203] offset:2048
    v_mfma_f32_16x16x32_bf16 v[236:239], a[84:87], v[60:63], v[236:239]
    v_mfma_f32_16x16x32_bf16 v[236:239], a[80:83], v[44:47], v[236:239]
    v_mfma_f32_16x16x32_bf16 v[252:255], a[88:91], v[44:47], v[252:255]
    ds_write_b128 v16, v[204:207] offset:3072
    v_mfma_f32_16x16x32_bf16 v[252:255], a[92:95], v[60:63], v[252:255]
    v_mfma_f32_16x16x32_bf16 v[248:251], a[92:95], v[56:59], v[248:251]
    v_mfma_f32_16x16x32_bf16 v[248:251], a[88:91], v[40:43], v[248:251]
    ds_write_b128 v16, v[208:211] offset:4096
    v_mfma_f32_16x16x32_bf16 v[244:247], a[88:91], v[36:39], v[244:247]
    v_mfma_f32_16x16x32_bf16 v[244:247], a[92:95], v[52:55], v[244:247]
    v_mfma_f32_16x16x32_bf16 v[240:243], a[92:95], v[48:51], v[240:243]
    ds_write_b128 v16, v[212:215] offset:5120
    v_mfma_f32_16x16x32_bf16 v[240:243], a[88:91], v[32:35], v[240:243]
    s_waitcnt lgkmcnt(11)
    v_mfma_f32_16x16x32_bf16 v[128:131], a[96:99], v[32:35], v[128:131]
    v_mfma_f32_16x16x32_bf16 v[128:131], a[100:103], v[48:51], v[128:131]
    ds_write_b128 v16, v[216:219] offset:6144
    v_mfma_f32_16x16x32_bf16 v[132:135], a[100:103], v[52:55], v[132:135]
    v_mfma_f32_16x16x32_bf16 v[132:135], a[96:99], v[36:39], v[132:135]
    v_mfma_f32_16x16x32_bf16 v[136:139], a[96:99], v[40:43], v[136:139]
    ds_write_b128 v16, v[220:223] offset:7168
    v_mfma_f32_16x16x32_bf16 v[136:139], a[100:103], v[56:59], v[136:139]
    buffer_load_dwordx4 a[64:67], v3, s[52:55], s80 offen offset:0 sc1
    v_mfma_f32_16x16x32_bf16 v[140:143], a[100:103], v[60:63], v[140:143]
    v_mfma_f32_16x16x32_bf16 v[140:143], a[96:99], v[44:47], v[140:143]
    ds_write_b128 v16, v[224:227] offset:8192
    v_mfma_f32_16x16x32_bf16 v[156:159], a[104:107], v[44:47], v[156:159]
    buffer_load_dwordx4 a[68:71], v3, s[52:55], s80 offen offset:1024 sc1
    v_mfma_f32_16x16x32_bf16 v[156:159], a[108:111], v[60:63], v[156:159]
    v_mfma_f32_16x16x32_bf16 v[152:155], a[108:111], v[56:59], v[152:155]
    ds_write_b128 v16, v[228:231] offset:9216
    v_mfma_f32_16x16x32_bf16 v[152:155], a[104:107], v[40:43], v[152:155]
    buffer_load_dwordx4 a[72:75], v3, s[52:55], s80 offen offset:2048 sc1
    v_mfma_f32_16x16x32_bf16 v[148:151], a[104:107], v[36:39], v[148:151]
    v_mfma_f32_16x16x32_bf16 v[148:151], a[108:111], v[52:55], v[148:151]
    ds_write_b128 v16, v[232:235] offset:10240
    v_mfma_f32_16x16x32_bf16 v[144:147], a[108:111], v[48:51], v[144:147]
    buffer_load_dwordx4 a[76:79], v3, s[52:55], s80 offen offset:3072 sc1
    s_add_u32 s80, s80, 4096
    v_mfma_f32_16x16x32_bf16 v[144:147], a[104:107], v[32:35], v[144:147]
    s_waitcnt lgkmcnt(12)
    v_mfma_f32_16x16x32_bf16 v[160:163], a[112:115], v[32:35], v[160:163]
    ds_write_b128 v16, v[236:239] offset:11264
    v_mfma_f32_16x16x32_bf16 v[160:163], a[116:119], v[48:51], v[160:163]
    buffer_load_dwordx4 a[80:83], v3, s[52:55], s80 offen offset:0 sc1
    v_mfma_f32_16x16x32_bf16 v[164:167], a[116:119], v[52:55], v[164:167]
    v_mfma_f32_16x16x32_bf16 v[164:167], a[112:115], v[36:39], v[164:167]
    ds_write_b128 v16, v[240:243] offset:12288
    v_mfma_f32_16x16x32_bf16 v[168:171], a[112:115], v[40:43], v[168:171]
    buffer_load_dwordx4 a[84:87], v3, s[52:55], s80 offen offset:1024 sc1
    v_mfma_f32_16x16x32_bf16 v[168:171], a[116:119], v[56:59], v[168:171]
    v_mfma_f32_16x16x32_bf16 v[172:175], a[116:119], v[60:63], v[172:175]
    ds_write_b128 v16, v[244:247] offset:13312
    v_mfma_f32_16x16x32_bf16 v[172:175], a[112:115], v[44:47], v[172:175]
    buffer_load_dwordx4 a[88:91], v3, s[52:55], s80 offen offset:2048 sc1
    v_mfma_f32_16x16x32_bf16 v[188:191], a[120:123], v[44:47], v[188:191]
    v_mfma_f32_16x16x32_bf16 v[188:191], a[124:127], v[60:63], v[188:191]
    ds_write_b128 v16, v[248:251] offset:14336
    v_mfma_f32_16x16x32_bf16 v[184:187], a[124:127], v[56:59], v[184:187]
    buffer_load_dwordx4 a[92:95], v3, s[52:55], s80 offen offset:3072 sc1
    s_add_u32 s80, s80, 4096
    v_mfma_f32_16x16x32_bf16 v[184:187], a[120:123], v[40:43], v[184:187]
    v_mfma_f32_16x16x32_bf16 v[180:183], a[120:123], v[36:39], v[180:183]
    ds_write_b128 v16, v[252:255] offset:15360
    v_mfma_f32_16x16x32_bf16 v[180:183], a[124:127], v[52:55], v[180:183]
    v_mfma_f32_16x16x32_bf16 v[176:179], a[124:127], v[48:51], v[176:179]
    v_mfma_f32_16x16x32_bf16 v[176:179], a[120:123], v[32:35], v[176:179]
    s_waitcnt lgkmcnt(0)
    s_barrier
    ds_read_b128 v[20:23], v19
    ds_read_b128 v[64:67], v17 offset:0
    ds_read_b128 v[68:71], v17 offset:1024
    buffer_load_dwordx4 a[208:211], v3, s[52:55], s80 offen offset:0 sc1
    ds_read_b128 v[72:75], v17 offset:2048
    ds_read_b128 v[76:79], v17 offset:3072
    buffer_load_dwordx4 a[212:215], v3, s[52:55], s80 offen offset:1024 sc1
    ds_read_b128 v[80:83], v17 offset:4096
    ds_read_b128 v[84:87], v17 offset:5120
    buffer_load_dwordx4 a[216:219], v3, s[52:55], s80 offen offset:2048 sc1
    ds_read_b128 v[88:91], v17 offset:6144
    ds_read_b128 v[92:95], v17 offset:7168
    buffer_load_dwordx4 a[220:223], v3, s[52:55], s80 offen offset:3072 sc1
    s_add_u32 s80, s80, 4096
    ds_read_b128 v[96:99], v17 offset:8192
    ds_read_b128 v[100:103], v17 offset:9216
    buffer_load_dwordx4 a[192:195], v3, s[52:55], s80 offen offset:0 sc1
    ds_read_b128 v[104:107], v17 offset:10240
    ds_read_b128 v[108:111], v17 offset:11264
    buffer_load_dwordx4 a[196:199], v3, s[52:55], s80 offen offset:1024 sc1
    ds_read_b128 v[112:115], v17 offset:12288
    ds_read_b128 v[116:119], v17 offset:13312
    buffer_load_dwordx4 a[200:203], v3, s[52:55], s80 offen offset:2048 sc1
    ds_read_b128 v[120:123], v17 offset:14336
    ds_read_b128 v[124:127], v17 offset:15360
    buffer_load_dwordx4 a[204:207], v3, s[52:55], s80 offen offset:3072 sc1
    s_add_u32 s80, s80, 4096
    s_waitcnt lgkmcnt(15)
    v_add_f32 v26, v26, v20
    v_add_f32 v27, v27, v21
    v_add_f32 v28, v28, v22
    v_add_f32 v29, v29, v23
    v_min3_f32 v25, v26, v27, v28
    v_add_f32 v24, v26, v27
    v_add_f32 v24, v24, v28
    v_min_f32 v25, v25, v29
    s_mov_b32 s100, 1
    v_add_f32 v24, v24, v29
    v_cmp_nle_f32 vcc, 0x17800000, v25
    s_mov_b64 s[6:7], vcc
    s_mov_b32 s101, s99
    v_cmp_nge_f32 vcc, 0x67800000, v24
    s_or_b64 vcc, vcc, s[6:7]
    s_cbranch_vccnz L_slow
    s_waitcnt lgkmcnt(12)
    v_pk_add_f32 v[128:129], v[128:129], v[64:65]
    v_pk_add_f32 v[130:131], v[130:131], v[66:67]
    v_pk_add_f32 v[132:133], v[132:133], v[68:69]
    v_pk_add_f32 v[134:135], v[134:135], v[70:71]
    v_pk_add_f32 v[136:137], v[136:137], v[72:73]
    v_pk_add_f32 v[138:139], v[138:139], v[74:75]
    v_pk_add_f32 v[140:141], v[140:141], v[76:77]
    v_pk_add_f32 v[142:143], v[142:143], v[78:79]
    s_waitcnt lgkmcnt(8)
    v_pk_add_f32 v[144:145], v[144:145], v[80:81]
    v_pk_add_f32 v[146:147], v[146:147], v[82:83]
    v_pk_add_f32 v[148:149], v[148:149], v[84:85]
    v_pk_add_f32 v[150:151], v[150:151], v[86:87]
    v_pk_add_f32 v[152:153], v[152:153], v[88:89]
    v_pk_add_f32 v[154:155], v[154:155], v[90:91]
    v_pk_add_f32 v[156:157], v[156:157], v[92:93]
    v_pk_add_f32 v[158:159], v[158:159], v[94:95]
    s_waitcnt lgkmcnt(4)
    v_pk_add_f32 v[160:161], v[160:161], v[96:97]
    v_pk_add_f32 v[162:163], v[162:163], v[98:99]
    v_pk_add_f32 v[164:165], v[164:165], v[100:101]
    v_pk_add_f32 v[166:167], v[166:167], v[102:103]
    v_pk_add_f32 v[168:169], v[168:169], v[104:105]
    v_pk_add_f32 v[170:171], v[170:171], v[106:107]
    v_pk_add_f32 v[172:173], v[172:173], v[108:109]
    v_pk_add_f32 v[174:175], v[174:175], v[110:111]
    s_waitcnt lgkmcnt(0)
    v_pk_add_f32 v[176:177], v[176:177], v[112:113]
    v_pk_add_f32 v[178:179], v[178:179], v[114:115]
    v_pk_add_f32 v[180:181], v[180:181], v[116:117]
    v_pk_add_f32 v[182:183], v[182:183], v[118:119]
    v_pk_add_f32 v[184:185], v[184:185], v[120:121]
    v_pk_add_f32 v[186:187], v[186:187], v[122:123]
    v_pk_add_f32 v[188:189], v[188:189], v[124:125]
    v_pk_add_f32 v[190:191], v[190:191], v[126:127]
L_ret1:
    buffer_load_dwordx4 a[96:99], v3, s[52:55], s80 offen offset:0 sc1
    buffer_load_dwordx4 a[100:103], v3, s[52:55], s80 offen offset:1024 sc1
    buffer_load_dwordx4 a[104:107], v3, s[52:55], s80 offen offset:2048 sc1
    buffer_load_dwordx4 a[108:111], v3, s[52:55], s80 offen offset:3072 sc1
    s_add_u32 s80, s80, 4096
    v_rcp_f32 v26, v26
    v_rcp_f32 v27, v27
    v_rcp_f32 v28, v28
    v_rcp_f32 v29, v29
    s_add_u32 s72, s87, 0
    v_pk_mul_f32 v[128:129], v[128:129], v[26:27] op_sel_hi:[1,0]
    v_pk_mul_f32 v[144:145], v[144:145], v[26:27] op_sel_hi:[1,0]
    v_pk_mul_f32 v[130:131], v[130:131], v[26:27] op_sel_hi:[1,0]
    v_pk_mul_f32 v[146:147], v[146:147], v[26:27] op_sel_hi:[1,0]
    v_cvt_pk_bf16_f32 v128, v128, v129
    v_cvt_pk_bf16_f32 v129, v130, v131
    v_cvt_pk_bf16_f32 v130, v144, v145
    v_cvt_pk_bf16_f32 v131, v146, v147
    buffer_store_dwordx4 v[128:131], v3, s[52:55], s72 offen offset:0 sc1
    v_pk_mul_f32 v[132:133], v[132:133], v[26:27] op_sel:[0,1] op_sel_hi:[1,1]
    v_pk_mul_f32 v[148:149], v[148:149], v[26:27] op_sel:[0,1] op_sel_hi:[1,1]
    v_pk_mul_f32 v[134:135], v[134:135], v[26:27] op_sel:[0,1] op_sel_hi:[1,1]
    v_pk_mul_f32 v[150:151], v[150:151], v[26:27] op_sel:[0,1] op_sel_hi:[1,1]
    v_cvt_pk_bf16_f32 v132, v132, v133
    v_cvt_pk_bf16_f32 v133, v134, v135
    v_cvt_pk_bf16_f32 v134, v148, v149
    v_cvt_pk_bf16_f32 v135, v150, v151
    buffer_store_dwordx4 v[132:135], v3, s[52:55], s72 offen offset:1024 sc1
    v_pk_mul_f32 v[136:137], v[136:137], v[28:29] op_sel_hi:[1,0]
    v_pk_mul_f32 v[152:153], v[152:153], v[28:29] op_sel_hi:[1,0]
    v_pk_mul_f32 v[138:139], v[138:139], v[28:29] op_sel_hi:[1,0]
    v_pk_mul_f32 v[154:155], v[154:155], v[28:29] op_sel_hi:[1,0]
    v_cvt_pk_bf16_f32 v136, v136, v137
    v_cvt_pk_bf16_f32 v137, v138, v139
    v_cvt_pk_bf16_f32 v138, v152, v153
    v_cvt_pk_bf16_f32 v139, v154, v155
    buffer_store_dwordx4 v[136:139], v3, s[52:55], s72 offen offset:2048 sc1
    v_pk_mul_f32 v[140:141], v[140:141], v[28:29] op_sel:[0,1] op_sel_hi:[1,1]
    v_pk_mul_f32 v[156:157], v[156:157], v[28:29] op_sel:[0,1] op_sel_hi:[1,1]
    v_pk_mul_f32 v[142:143], v[142:143], v[28:29] op_sel:[0,1] op_sel_hi:[1,1]
    v_pk_mul_f32 v[158:159], v[158:159], v[28:29] op_sel:[0,1] op_sel_hi:[1,1]
    v_cvt_pk_bf16_f32 v140, v140, v141
    v_cvt_pk_bf16_f32 v141, v142, v143
    v_cvt_pk_bf16_f32 v142, v156, v157
    v_cvt_pk_bf16_f32 v143, v158, v159
    buffer_store_dwordx4 v[140:143], v3, s[52:55], s72 offen offset:3072 sc1
    s_add_u32 s72, s87, 4096
    v_pk_mul_f32 v[160:161], v[160:161], v[26:27] op_sel_hi:[1,0]
    v_pk_mul_f32 v[176:177], v[176:177], v[26:27] op_sel_hi:[1,0]
    v_pk_mul_f32 v[162:163], v[162:163], v[26:27] op_sel_hi:[1,0]
    v_pk_mul_f32 v[178:179], v[178:179], v[26:27] op_sel_hi:[1,0]
    v_cvt_pk_bf16_f32 v160, v160, v161
    v_cvt_pk_bf16_f32 v161, v162, v163
    v_cvt_pk_bf16_f32 v162, v176, v177
    v_cvt_pk_bf16_f32 v163, v178, v179
    buffer_store_dwordx4 v[160:163], v3, s[52:55], s72 offen offset:0 sc1
    v_pk_mul_f32 v[164:165], v[164:165], v[26:27] op_sel:[0,1] op_sel_hi:[1,1]
    v_pk_mul_f32 v[180:181], v[180:181], v[26:27] op_sel:[0,1] op_sel_hi:[1,1]
    v_pk_mul_f32 v[166:167], v[166:167], v[26:27] op_sel:[0,1] op_sel_hi:[1,1]
    v_pk_mul_f32 v[182:183], v[182:183], v[26:27] op_sel:[0,1] op_sel_hi:[1,1]
    v_cvt_pk_bf16_f32 v164, v164, v165
    v_cvt_pk_bf16_f32 v165, v166, v167
    v_cvt_pk_bf16_f32 v166, v180, v181
    v_cvt_pk_bf16_f32 v167, v182, v183
    buffer_store_dwordx4 v[164:167], v3, s[52:55], s72 offen offset:1024 sc1
    v_pk_mul_f32 v[168:169], v[168:169], v[28:29] op_sel_hi:[1,0]
    v_pk_mul_f32 v[184:185], v[184:185], v[28:29] op_sel_hi:[1,0]
    v_pk_mul_f32 v[170:171], v[170:171], v[28:29] op_sel_hi:[1,0]
    v_pk_mul_f32 v[186:187], v[186:187], v[28:29] op_sel_hi:[1,0]
    v_cvt_pk_bf16_f32 v168, v168, v169
    v_cvt_pk_bf16_f32 v169, v170, v171
    v_cvt_pk_bf16_f32 v170, v184, v185
    v_cvt_pk_bf16_f32 v171, v186, v187
    buffer_store_dwordx4 v[168:171], v3, s[52:55], s72 offen offset:2048 sc1
    v_pk_mul_f32 v[172:173], v[172:173], v[28:29] op_sel:[0,1] op_sel_hi:[1,1]
    v_pk_mul_f32 v[188:189], v[188:189], v[28:29] op_sel:[0,1] op_sel_hi:[1,1]
    v_pk_mul_f32 v[174:175], v[174:175], v[28:29] op_sel:[0,1] op_sel_hi:[1,1]
    v_pk_mul_f32 v[190:191], v[190:191], v[28:29] op_sel:[0,1] op_sel_hi:[1,1]
    v_cvt_pk_bf16_f32 v172, v172, v173
    v_cvt_pk_bf16_f32 v173, v174, v175
    v_cvt_pk_bf16_f32 v174, v188, v189
    v_cvt_pk_bf16_f32 v175, v190, v191
    buffer_store_dwordx4 v[172:175], v3, s[52:55], s72 offen offset:3072 sc1
    s_branch L_attdone
L_mergeB:
    s_waitcnt lgkmcnt(0)
    ds_read_b128 a[64:67], v4 offset:16384
    ds_read_b128 a[68:71], v4 offset:24576
    ds_read_b128 a[72:75], v4 offset:17408
    ds_read_b128 a[76:79], v4 offset:25600
    ds_read_b128 a[80:83], v4 offset:18432
    ds_read_b128 a[84:87], v4 offset:26624
    ds_read_b128 a[88:91], v4 offset:19456
    ds_read_b128 a[92:95], v4 offset:27648
    v_cvt_pk_bf16_f32 v36, v68, v69
    v_cvt_pk_bf16_f32 v37, v70, v71
    v_cvt_pk_bf16_f32 v40, v72, v73
    v_cvt_pk_bf16_f32 v41, v74, v75
    v_cvt_pk_bf16_f32 v44, v76, v77
    v_cvt_pk_bf16_f32 v45, v78, v79
    v_cvt_pk_bf16_f32 v34, v80, v81
    v_cvt_pk_bf16_f32 v35, v82, v83
    v_cvt_pk_bf16_f32 v38, v84, v85
    v_cvt_pk_bf16_f32 v39, v86, v87
    v_cvt_pk_bf16_f32 v42, v88, v89
    v_cvt_pk_bf16_f32 v43, v90, v91
    v_cvt_pk_bf16_f32 v46, v92, v93
    v_cvt_pk_bf16_f32 v47, v94, v95
    v_cvt_pk_bf16_f32 v48, v96, v97
    v_cvt_pk_bf16_f32 v49, v98, v99
    v_cvt_pk_bf16_f32 v52, v100, v101
    v_cvt_pk_bf16_f32 v53, v102, v103
    v_cvt_pk_bf16_f32 v56, v104, v105
    v_cvt_pk_bf16_f32 v57, v106, v107
    v_cvt_pk_bf16_f32 v60, v108, v109
    v_cvt_pk_bf16_f32 v61, v110, v111
    v_cvt_pk_bf16_f32 v50, v112, v113
    v_cvt_pk_bf16_f32 v51, v114, v115
    v_cvt_pk_bf16_f32 v54, v116, v117
    v_cvt_pk_bf16_f32 v55, v118, v119
    v_cvt_pk_bf16_f32 v58, v120, v121
    v_cvt_pk_bf16_f32 v59, v122, v123
    v_cvt_pk_bf16_f32 v62, v124, v125
    v_cvt_pk_bf16_f32 v63, v126, v127
    ds_read_b128 a[96:99], v4 offset:20480
    ds_read_b128 a[100:103], v4 offset:28672
    ds_read_b128 a[104:107], v4 offset:21504
    ds_read_b128 a[108:111], v4 offset:29696
    ds_read_b128 a[112:115], v4 offset:22528
    ds_read_b128 a[116:119], v4 offset:30720
    ds_read_b128 a[120:123], v4 offset:23552
    ds_read_b128 a[124:127], v4 offset:31744
    v_mfma_f32_16x16x32_bf16 a[192:195], a[208:211], v[32:35], a[192:195]
    buffer_load_dwordx4 a[224:227], v3, s[52:55], s80 offen offset:0 sc1
    v_mfma_f32_16x16x32_bf16 a[192:195], a[208:211], v[48:51], a[192:195]
    v_mfma_f32_16x16x32_bf16 a[196:199], a[208:211], v[36:39], a[196:199]
    buffer_load_dwordx4 a[228:231], v3, s[52:55], s80 offen offset:1024 sc1
    v_mfma_f32_16x16x32_bf16 a[196:199], a[208:211], v[52:55], a[196:199]
    v_mfma_f32_16x16x32_bf16 a[200:203], a[208:211], v[40:43], a[200:203]
    buffer_load_dwordx4 a[232:235], v3, s[52:55], s80 offen offset:2048 sc1
    v_mfma_f32_16x16x32_bf16 a[200:203], a[208:211], v[56:59], a[200:203]
    v_mfma_f32_16x16x32_bf16 a[204:207], a[208:211], v[44:47], a[204:207]
    buffer_load_dwordx4 a[236:239], v3, s[52:55], s80 offen offset:3072 sc1
    s_add_u32 s80, s80, 4096
    v_mfma_f32_16x16x32_bf16 a[204:207], a[208:211], v[60:63], a[204:207]
    s_waitcnt lgkmcnt(12)
    v_mfma_f32_16x16x32_bf16 v[128:131], a[64:67], v[32:35], v[128:131]
    buffer_load_dwordx4 a[240:243], v3, s[52:55], s80 offen offset:0 sc1
    v_mfma_f32_16x16x32_bf16 v[128:131], a[68:71], v[48:51], v[128:131]
    v_mfma_f32_16x16x32_bf16 v[132:135], a[68:71], v[52:55], v[132:135]
    buffer_load_dwordx4 a[244:247], v3, s[52:55], s80 offen offset:1024 sc1
    v_mfma_f32_16x16x32_bf16 v[132:135], a[64:67], v[36:39], v[132:135]
    v_mfma_f32_16x16x32_bf16 v[136:139], a[64:67], v[40:43], v[136:139]
    buffer_load_dwordx4 a[248:251], v3, s[52:55], s80 offen offset:2048 sc1
    v_mfma_f32_16x16x32_bf16 v[136:139], a[68:71], v[56:59], v[136:139]
    v_mfma_f32_16x16x32_bf16 v[140:143], a[68:71], v[60:63], v[140:143]
    buffer_load_dwordx4 a[252:255], v3, s[52:55], s80 offen offset:3072 sc1
    s_add_u32 s80, s80, 4096
    v_mfma_f32_16x16x32_bf16 v[140:143], a[64:67], v[44:47], v[140:143]
    v_mfma_f32_16x16x32_bf16 v[156:159], a[72:75], v[44:47], v[156:159]
    v_mfma_f32_16x16x32_bf16 v[156:159], a[76:79], v[60:63], v[156:159]
    v_accvgpr_read_b32 v26, a192
    v_accvgpr_read_b32 v27, a196
    v_mfma_f32_16x16x32_bf16 v[152:155], a[76:79], v[56:59], v[152:155]
    v_accvgpr_read_b32 v28, a200
    v_accvgpr_read_b32 v29, a204
    v_mfma_f32_16x16x32_bf16 v[152:155], a[72:75], v[40:43], v[152:155]
    ds_write_b128 v18, v[26:29]
    v_mfma_f32_16x16x32_bf16 v[148:151], a[72:75], v[36:39], v[148:151]
    v_mfma_f32_16x16x32_bf16 v[148:151], a[76:79], v[52:55], v[148:151]
    v_mfma_f32_16x16x32_bf16 v[144:147], a[76:79], v[48:51], v[144:147]
    v_mfma_f32_16x16x32_bf16 v[144:147], a[72:75], v[32:35], v[144:147]
    s_waitcnt lgkmcnt(9)
    ds_write_b128 v16, v[128:131] offset:0
    v_mfma_f32_16x16x32_bf16 v[160:163], a[80:83], v[32:35], v[160:163]
    v_mfma_f32_16x16x32_bf16 v[160:163], a[84:87], v[48:51], v[160:163]
    v_mfma_f32_16x16x32_bf16 v[164:167], a[84:87], v[52:55], v[164:167]
    ds_write_b128 v16, v[132:135] offset:1024
    v_mfma_f32_16x16x32_bf16 v[164:167], a[80:83], v[36:39], v[164:167]
    v_mfma_f32_16x16x32_bf16 v[168:171], a[80:83], v[40:43], v[168:171]
    v_mfma_f32_16x16x32_bf16 v[168:171], a[84:87], v[56:59], v[168:171]
    ds_write_b128 v16, v[136:139] offset:2048
    v_mfma_f32_16x16x32_bf16 v[172:175], a[84:87], v[60:63], v[172:175]
    v_mfma_f32_16x16x32_bf16 v[172:175], a[80:83], v[44:47], v[172:175]
    v_mfma_f32_16x16x32_bf16 v[188:191], a[88:91], v[44:47], v[188:191]
    ds_write_b128 v16, v[140:143] offset:3072
    v_mfma_f32_16x16x32_bf16 v[188:191], a[92:95], v[60:63], v[188:191]
    v_mfma_f32_16x16x32_bf16 v[184:187], a[92:95], v[56:59], v[184:187]
    v_mfma_f32_16x16x32_bf16 v[184:187], a[88:91], v[40:43], v[184:187]
    ds_write_b128 v16, v[144:147] offset:4096
    v_mfma_f32_16x16x32_bf16 v[180:183], a[88:91], v[36:39], v[180:183]
    v_mfma_f32_16x16x32_bf16 v[180:183], a[92:95], v[52:55], v[180:183]
    v_mfma_f32_16x16x32_bf16 v[176:179], a[92:95], v[48:51], v[176:179]
    ds_write_b128 v16, v[148:151] offset:5120
    v_mfma_f32_16x16x32_bf16 v[176:179], a[88:91], v[32:35], v[176:179]
    s_waitcnt lgkmcnt(11)
    v_mfma_f32_16x16x32_bf16 v[192:195], a[96:99], v[32:35], v[192:195]
    v_mfma_f32_16x16x32_bf16 v[192:195], a[100:103], v[48:51], v[192:195]
    ds_write_b128 v16, v[152:155] offset:6144
    v_mfma_f32_16x16x32_bf16 v[196:199], a[100:103], v[52:55], v[196:199]
    v_mfma_f32_16x16x32_bf16 v[196:199], a[96:99], v[36:39], v[196:199]
    v_mfma_f32_16x16x32_bf16 v[200:203], a[96:99], v[40:43], v[200:203]
    ds_write_b128 v16, v[156:159] offset:7168
    v_mfma_f32_16x16x32_bf16 v[200:203], a[100:103], v[56:59], v[200:203]
    buffer_load_dwordx4 a[64:67], v3, s[52:55], s80 offen offset:0 sc1
    v_mfma_f32_16x16x32_bf16 v[204:207], a[100:103], v[60:63], v[204:207]
    v_mfma_f32_16x16x32_bf16 v[204:207], a[96:99], v[44:47], v[204:207]
    ds_write_b128 v16, v[160:163] offset:8192
    v_mfma_f32_16x16x32_bf16 v[220:223], a[104:107], v[44:47], v[220:223]
    buffer_load_dwordx4 a[68:71], v3, s[52:55], s80 offen offset:1024 sc1
    v_mfma_f32_16x16x32_bf16 v[220:223], a[108:111], v[60:63], v[220:223]
    v_mfma_f32_16x16x32_bf16 v[216:219], a[108:111], v[56:59], v[216:219]
    ds_write_b128 v16, v[164:167] offset:9216
    v_mfma_f32_16x16x32_bf16 v[216:219], a[104:107], v[40:43], v[216:219]
    buffer_load_dwordx4 a[72:75], v3, s[52:55], s80 offen offset:2048 sc1
    v_mfma_f32_16x16x32_bf16 v[212:215], a[104:107], v[36:39], v[212:215]
    v_mfma_f32_16x16x32_bf16 v[212:215], a[108:111], v[52:55], v[212:215]
    ds_write_b128 v16, v[168:171] offset:10240
    v_mfma_f32_16x16x32_bf16 v[208:211], a[108:111], v[48:51], v[208:211]
    buffer_load_dwordx4 a[76:79], v3, s[52:55], s80 offen offset:3072 sc1
    s_add_u32 s80, s80, 4096
    v_mfma_f32_16x16x32_bf16 v[208:211], a[104:107], v[32:35], v[208:211]
    s_waitcnt lgkmcnt(12)
    v_mfma_f32_16x16x32_bf16 v[224:227], a[112:115], v[32:35], v[224:227]
    ds_write_b128 v16, v[172:175] offset:11264
    v_mfma_f32_16x16x32_bf16 v[224:227], a[116:119], v[48:51], v[224:227]
    buffer_load_dwordx4 a[80:83], v3, s[52:55], s80 offen offset:0 sc1
    v_mfma_f32_16x16x32_bf16 v[228:231], a[116:119], v[52:55], v[228:231]
    v_mfma_f32_16x16x32_bf16 v[228:231], a[112:115], v[36:39], v[228:231]
    ds_write_b128 v16, v[176:179] offset:12288
    v_mfma_f32_16x16x32_bf16 v[232:235], a[112:115], v[40:43], v[232:235]
    buffer_load_dwordx4 a[84:87], v3, s[52:55], s80 offen offset:1024 sc1
    v_mfma_f32_16x16x32_bf16 v[232:235], a[116:119], v[56:59], v[232:235]
    v_mfma_f32_16x16x32_bf16 v[236:239], a[116:119], v[60:63], v[236:239]
    ds_write_b128 v16, v[180:183] offset:13312
    v_mfma_f32_16x16x32_bf16 v[236:239], a[112:115], v[44:47], v[236:239]
    buffer_load_dwordx4 a[88:91], v3, s[52:55], s80 offen offset:2048 sc1
    v_mfma_f32_16x16x32_bf16 v[252:255], a[120:123], v[44:47], v[252:255]
    v_mfma_f32_16x16x32_bf16 v[252:255], a[124:127], v[60:63], v[252:255]
    ds_write_b128 v16, v[184:187] offset:14336
    v_mfma_f32_16x16x32_bf16 v[248:251], a[124:127], v[56:59], v[248:251]
    buffer_load_dwordx4 a[92:95], v3, s[52:55], s80 offen offset:3072 sc1
    s_add_u32 s80, s80, 4096
    v_mfma_f32_16x16x32_bf16 v[248:251], a[120:123], v[40:43], v[248:251]
    v_mfma_f32_16x16x32_bf16 v[244:247], a[120:123], v[36:39], v[244:247]
    ds_write_b128 v16, v[188:191] offset:15360
    v_mfma_f32_16x16x32_bf16 v[244:247], a[124:127], v[52:55], v[244:247]
    v_mfma_f32_16x16x32_bf16 v[240:243], a[124:127], v[48:51], v[240:243]
    v_mfma_f32_16x16x32_bf16 v[240:243], a[120:123], v[32:35], v[240:243]
    s_waitcnt lgkmcnt(0)
    s_barrier
    ds_read_b128 v[20:23], v19
    ds_read_b128 v[64:67], v17 offset:0
    ds_read_b128 v[68:71], v17 offset:1024
    buffer_load_dwordx4 a[208:211], v3, s[52:55], s80 offen offset:0 sc1
    ds_read_b128 v[72:75], v17 offset:2048
    ds_read_b128 v[76:79], v17 offset:3072
    buffer_load_dwordx4 a[212:215], v3, s[52:55], s80 offen offset:1024 sc1
    ds_read_b128 v[80:83], v17 offset:4096
    ds_read_b128 v[84:87], v17 offset:5120
    buffer_load_dwordx4 a[216:219], v3, s[52:55], s80 offen offset:2048 sc1
    ds_read_b128 v[88:91], v17 offset:6144
    ds_read_b128 v[92:95], v17 offset:7168
    buffer_load_dwordx4 a[220:223], v3, s[52:55], s80 offen offset:3072 sc1
    s_add_u32 s80, s80, 4096
    ds_read_b128 v[96:99], v17 offset:8192
    ds_read_b128 v[100:103], v17 offset:9216
    buffer_load_dwordx4 a[192:195], v3, s[52:55], s80 offen offset:0 sc1
    ds_read_b128 v[104:107], v17 offset:10240
    ds_read_b128 v[108:111], v17 offset:11264
    buffer_load_dwordx4 a[196:199], v3, s[52:55], s80 offen offset:1024 sc1
    ds_read_b128 v[112:115], v17 offset:12288
    ds_read_b128 v[116:119], v17 offset:13312
    buffer_load_dwordx4 a[200:203], v3, s[52:55], s80 offen offset:2048 sc1
    ds_read_b128 v[120:123], v17 offset:14336
    ds_read_b128 v[124:127], v17 offset:15360
    buffer_load_dwordx4 a[204:207], v3, s[52:55], s80 offen offset:3072 sc1
    s_add_u32 s80, s80, 4096
    s_waitcnt lgkmcnt(15)
    v_add_f32 v26, v26, v20
    v_add_f32 v27, v27, v21
    v_add_f32 v28, v28, v22
    v_add_f32 v29, v29, v23
    v_min3_f32 v25, v26, v27, v28
    v_add_f32 v24, v26, v27
    v_add_f32 v24, v24, v28
    v_min_f32 v25, v25, v29
    s_mov_b32 s100, 2
    v_add_f32 v24, v24, v29
    v_cmp_nle_f32 vcc, 0x17800000, v25
    s_mov_b64 s[6:7], vcc
    s_mov_b32 s101, s99
    v_cmp_nge_f32 vcc, 0x67800000, v24
    s_or_b64 vcc, vcc, s[6:7]
    s_cbranch_vccnz L_slow
    s_waitcnt lgkmcnt(12)
    v_pk_add_f32 v[192:193], v[192:193], v[64:65]
    v_pk_add_f32 v[194:195], v[194:195], v[66:67]
    v_pk_add_f32 v[196:197], v[196:197], v[68:69]
    v_pk_add_f32 v[198:199], v[198:199], v[70:71]
    v_pk_add_f32 v[200:201], v[200:201], v[72:73]
    v_pk_add_f32 v[202:203], v[202:203], v[74:75]
    v_pk_add_f32 v[204:205], v[204:205], v[76:77]
    v_pk_add_f32 v[206:207], v[206:207], v[78:79]
    s_waitcnt lgkmcnt(8)
    v_pk_add_f32 v[208:209], v[208:209], v[80:81]
    v_pk_add_f32 v[210:211], v[210:211], v[82:83]
    v_pk_add_f32 v[212:213], v[212:213], v[84:85]
    v_pk_add_f32 v[214:215], v[214:215], v[86:87]
    v_pk_add_f32 v[216:217], v[216:217], v[88:89]
    v_pk_add_f32 v[218:219], v[218:219], v[90:91]
    v_pk_add_f32 v[220:221], v[220:221], v[92:93]
    v_pk_add_f32 v[222:223], v[222:223], v[94:95]
    s_waitcnt lgkmcnt(4)
    v_pk_add_f32 v[224:225], v[224:225], v[96:97]
    v_pk_add_f32 v[226:227], v[226:227], v[98:99]
    v_pk_add_f32 v[228:229], v[228:229], v[100:101]
    v_pk_add_f32 v[230:231], v[230:231], v[102:103]
    v_pk_add_f32 v[232:233], v[232:233], v[104:105]
    v_pk_add_f32 v[234:235], v[234:235], v[106:107]
    v_pk_add_f32 v[236:237], v[236:237], v[108:109]
    v_pk_add_f32 v[238:239], v[238:239], v[110:111]
    s_waitcnt lgkmcnt(0)
    v_pk_add_f32 v[240:241], v[240:241], v[112:113]
    v_pk_add_f32 v[242:243], v[242:243], v[114:115]
    v_pk_add_f32 v[244:245], v[244:245], v[116:117]
    v_pk_add_f32 v[246:247], v[246:247], v[118:119]
    v_pk_add_f32 v[248:249], v[248:249], v[120:121]
    v_pk_add_f32 v[250:251], v[250:251], v[122:123]
    v_pk_add_f32 v[252:253], v[252:253], v[124:125]
    v_pk_add_f32 v[254:255], v[254:255], v[126:127]
L_ret2:
    buffer_load_dwordx4 a[96:99], v3, s[52:55], s80 offen offset:0 sc1
    buffer_load_dwordx4 a[100:103], v3, s[52:55], s80 offen offset:1024 sc1
    buffer_load_dwordx4 a[104:107], v3, s[52:55], s80 offen offset:2048 sc1
    buffer_load_dwordx4 a[108:111], v3, s[52:55], s80 offen offset:3072 sc1
    s_add_u32 s80, s80, 4096
    v_rcp_f32 v26, v26
    v_rcp_f32 v27, v27
    v_rcp_f32 v28, v28
    v_rcp_f32 v29, v29
    s_add_u32 s72, s87, 8192
    v_pk_mul_f32 v[192:193], v[192:193], v[26:27] op_sel_hi:[1,0]
    v_pk_mul_f32 v[208:209], v[208:209], v[26:27] op_sel_hi:[1,0]
    v_pk_mul_f32 v[194:195], v[194:195], v[26:27] op_sel_hi:[1,0]
    v_pk_mul_f32 v[210:211], v[210:211], v[26:27] op_sel_hi:[1,0]
    v_cvt_pk_bf16_f32 v192, v192, v193
    v_cvt_pk_bf16_f32 v193, v194, v195
    v_cvt_pk_bf16_f32 v194, v208, v209
    v_cvt_pk_bf16_f32 v195, v210, v211
    buffer_store_dwordx4 v[192:195], v3, s[52:55], s72 offen offset:0 sc1
    v_pk_mul_f32 v[196:197], v[196:197], v[26:27] op_sel:[0,1] op_sel_hi:[1,1]
    v_pk_mul_f32 v[212:213], v[212:213], v[26:27] op_sel:[0,1] op_sel_hi:[1,1]
    v_pk_mul_f32 v[198:199], v[198:199], v[26:27] op_sel:[0,1] op_sel_hi:[1,1]
    v_pk_mul_f32 v[214:215], v[214:215], v[26:27] op_sel:[0,1] op_sel_hi:[1,1]
    v_cvt_pk_bf16_f32 v196, v196, v197
    v_cvt_pk_bf16_f32 v197, v198, v199
    v_cvt_pk_bf16_f32 v198, v212, v213
    v_cvt_pk_bf16_f32 v199, v214, v215
    buffer_store_dwordx4 v[196:199], v3, s[52:55], s72 offen offset:1024 sc1
    v_pk_mul_f32 v[200:201], v[200:201], v[28:29] op_sel_hi:[1,0]
    v_pk_mul_f32 v[216:217], v[216:217], v[28:29] op_sel_hi:[1,0]
    v_pk_mul_f32 v[202:203], v[202:203], v[28:29] op_sel_hi:[1,0]
    v_pk_mul_f32 v[218:219], v[218:219], v[28:29] op_sel_hi:[1,0]
    v_cvt_pk_bf16_f32 v200, v200, v201
    v_cvt_pk_bf16_f32 v201, v202, v203
    v_cvt_pk_bf16_f32 v202, v216, v217
    v_cvt_pk_bf16_f32 v203, v218, v219
    buffer_store_dwordx4 v[200:203], v3, s[52:55], s72 offen offset:2048 sc1
    v_pk_mul_f32 v[204:205], v[204:205], v[28:29] op_sel:[0,1] op_sel_hi:[1,1]
    v_pk_mul_f32 v[220:221], v[220:221], v[28:29] op_sel:[0,1] op_sel_hi:[1,1]
    v_pk_mul_f32 v[206:207], v[206:207], v[28:29] op_sel:[0,1] op_sel_hi:[1,1]
    v_pk_mul_f32 v[222:223], v[222:223], v[28:29] op_sel:[0,1] op_sel_hi:[1,1]
    v_cvt_pk_bf16_f32 v204, v204, v205
    v_cvt_pk_bf16_f32 v205, v206, v207
    v_cvt_pk_bf16_f32 v206, v220, v221
    v_cvt_pk_bf16_f32 v207, v222, v223
    buffer_store_dwordx4 v[204:207], v3, s[52:55], s72 offen offset:3072 sc1
    s_add_u32 s72, s87, 12288
    v_pk_mul_f32 v[224:225], v[224:225], v[26:27] op_sel_hi:[1,0]
    v_pk_mul_f32 v[240:241], v[240:241], v[26:27] op_sel_hi:[1,0]
    v_pk_mul_f32 v[226:227], v[226:227], v[26:27] op_sel_hi:[1,0]
    v_pk_mul_f32 v[242:243], v[242:243], v[26:27] op_sel_hi:[1,0]
    v_cvt_pk_bf16_f32 v224, v224, v225
    v_cvt_pk_bf16_f32 v225, v226, v227
    v_cvt_pk_bf16_f32 v226, v240, v241
    v_cvt_pk_bf16_f32 v227, v242, v243
    buffer_store_dwordx4 v[224:227], v3, s[52:55], s72 offen offset:0 sc1
    v_pk_mul_f32 v[228:229], v[228:229], v[26:27] op_sel:[0,1] op_sel_hi:[1,1]
    v_pk_mul_f32 v[244:245], v[244:245], v[26:27] op_sel:[0,1] op_sel_hi:[1,1]
    v_pk_mul_f32 v[230:231], v[230:231], v[26:27] op_sel:[0,1] op_sel_hi:[1,1]
    v_pk_mul_f32 v[246:247], v[246:247], v[26:27] op_sel:[0,1] op_sel_hi:[1,1]
    v_cvt_pk_bf16_f32 v228, v228, v229
    v_cvt_pk_bf16_f32 v229, v230, v231
    v_cvt_pk_bf16_f32 v230, v244, v245
    v_cvt_pk_bf16_f32 v231, v246, v247
    buffer_store_dwordx4 v[228:231], v3, s[52:55], s72 offen offset:1024 sc1
    v_pk_mul_f32 v[232:233], v[232:233], v[28:29] op_sel_hi:[1,0]
    v_pk_mul_f32 v[248:249], v[248:249], v[28:29] op_sel_hi:[1,0]
    v_pk_mul_f32 v[234:235], v[234:235], v[28:29] op_sel_hi:[1,0]
    v_pk_mul_f32 v[250:251], v[250:251], v[28:29] op_sel_hi:[1,0]
    v_cvt_pk_bf16_f32 v232, v232, v233
    v_cvt_pk_bf16_f32 v233, v234, v235
    v_cvt_pk_bf16_f32 v234, v248, v249
    v_cvt_pk_bf16_f32 v235, v250, v251
    buffer_store_dwordx4 v[232:235], v3, s[52:55], s72 offen offset:2048 sc1
    v_pk_mul_f32 v[236:237], v[236:237], v[28:29] op_sel:[0,1] op_sel_hi:[1,1]
    v_pk_mul_f32 v[252:253], v[252:253], v[28:29] op_sel:[0,1] op_sel_hi:[1,1]
    v_pk_mul_f32 v[238:239], v[238:239], v[28:29] op_sel:[0,1] op_sel_hi:[1,1]
    v_pk_mul_f32 v[254:255], v[254:255], v[28:29] op_sel:[0,1] op_sel_hi:[1,1]
    v_cvt_pk_bf16_f32 v236, v236, v237
    v_cvt_pk_bf16_f32 v237, v238, v239
    v_cvt_pk_bf16_f32 v238, v252, v253
    v_cvt_pk_bf16_f32 v239, v254, v255
    buffer_store_dwordx4 v[236:239], v3, s[52:55], s72 offen offset:3072 sc1
L_attdone:
    v_lshrrev_b32 v24, 5, v1
    v_lshlrev_b32 v24, 6, v24
    v_xor_b32 v16, v16, v24
    v_xor_b32 v18, 128, v16
    ds_write_b128 v16, a[128:131] offset:32768
    buffer_load_dwordx4 a[112:115], v3, s[52:55], s80 offen offset:0 sc1
    ds_write_b128 v16, a[132:135] offset:36864
    buffer_load_dwordx4 a[116:119], v3, s[52:55], s80 offen offset:1024 sc1
    ds_write_b128 v16, a[136:139] offset:40960
    buffer_load_dwordx4 a[120:123], v3, s[52:55], s80 offen offset:2048 sc1
    ds_write_b128 v16, a[140:143] offset:45056
    buffer_load_dwordx4 a[124:127], v3, s[52:55], s80 offen offset:3072 sc1
    s_add_u32 s80, s80, 4096
    ds_write_b128 v18, a[144:147] offset:33792
    buffer_load_dwordx4 a[0:3], v3, s[52:55], s80 offen offset:0 sc1
    ds_write_b128 v18, a[148:151] offset:37888
    buffer_load_dwordx4 a[4:7], v3, s[52:55], s80 offen offset:1024 sc1
    ds_write_b128 v18, a[152:155] offset:41984
    ds_write_b128 v18, a[156:159] offset:46080
    ds_write_b128 v16, a[160:163] offset:34816
    ds_write_b128 v16, a[164:167] offset:38912
    ds_write_b128 v16, a[168:171] offset:43008
    ds_write_b128 v16, a[172:175] offset:47104
    ds_write_b128 v18, a[176:179] offset:35840
    ds_write_b128 v18, a[180:183] offset:39936
    ds_write_b128 v18, a[184:187] offset:44032
    ds_write_b128 v18, a[188:191] offset:48128
    v_lshrrev_b32 v24, 3, v1
    v_and_b32 v25, 7, v1
    v_lshlrev_b32 v4, 10, v24
    v_lshl_add_u32 v4, v25, 4, v4
    v_lshlrev_b32 v24, 4, v24
    v_lshl_add_u32 v24, v25, 9, v24
    s_lshl_b32 s84, s69, 16
    s_lshl_b32 s72, s68, 14
    s_add_u32 s84, s84, s72
    s_lshl_b32 s73, s70, 7
    s_add_u32 s84, s84, s73
    s_add_u32 s85, s84, 8192
    v_and_b32 v25, 3, v1
    v_lshlrev_b32 v25, 6, v25
    v_xor_b32 v24, v24, v25
    s_lshl_b32 s72, s68, 12
    v_add_u32 v24, s72, v24
    v_xor_b32 v19, 128, v24
    v_add_u32 v17, 65536, v24
    v_add_u32 v20, 65536, v19
    s_lshr_b32 s72, s69, 1
    s_sub_u32 s73, 15, s72
    s_min_u32 s72, s72, s73
    s_lshl_b32 s72, s72, 9
    s_lshl_b32 s73, s68, 3
    s_add_u32 s72, s72, s73
    s_add_u32 s72, s72, 11550720
    v_and_b32 v31, 3, v1
    v_lshlrev_b32 v31, 7, v31
    v_and_or_b32 v31, v1, 4, v31
    v_add_u32 v31, s72, v31
    s_waitcnt vmcnt(6)
    s_waitcnt lgkmcnt(0)
    s_barrier
    s_lshr_b32 s101, s2, 3
    s_lshl_b32 s101, s101, 7
    s_and_b32 s6, s2, 7
    s_lshl_b32 s6, s6, 2
    s_add_u32 s101, s101, s6
    s_add_u32 s101, s101, 11550720
    v_mov_b32 v26, s3
    v_add_u32 v27, s78, v1
    v_min_u32 v27, 1, v27
    v_lshlrev_b32 v27, 30, v27
    buffer_store_dword v26, v27, s[52:55], s101 offen sc1
    ds_read_b128 v[192:195], v24 offset:32768
    ds_read_b128 v[196:199], v24 offset:33024
    ds_read_b128 v[200:203], v19 offset:32768
    ds_read_b128 v[204:207], v19 offset:33024
    ds_read_b128 v[208:211], v24 offset:49152
    ds_read_b128 v[212:215], v24 offset:49408
    ds_read_b128 v[216:219], v19 offset:49152
    ds_read_b128 v[220:223], v19 offset:49408
    ds_read_b128 v[224:227], v17 offset:32768
    ds_read_b128 v[228:231], v17 offset:33024
    ds_read_b128 v[232:235], v20 offset:32768
    ds_read_b128 v[236:239], v20 offset:33024
    ds_read_b128 v[240:243], v17 offset:49152
    ds_read_b128 v[244:247], v17 offset:49408
    ds_read_b128 v[248:251], v20 offset:49152
    ds_read_b128 v[252:255], v20 offset:49408
    buffer_load_dwordx4 v[8:11], v4, s[8:11], s84 offen
    buffer_load_dwordx4 v[12:15], v4, s[8:11], s85 offen
    s_waitcnt lgkmcnt(8)
    v_pk_add_f32 v[192:193], v[192:193], v[208:209]
    v_pk_add_f32 v[194:195], v[194:195], v[210:211]
    v_pk_add_f32 v[196:197], v[196:197], v[212:213]
    v_pk_add_f32 v[198:199], v[198:199], v[214:215]
    v_pk_add_f32 v[200:201], v[200:201], v[216:217]
    v_pk_add_f32 v[202:203], v[202:203], v[218:219]
    buffer_load_dwordx4 a[8:11], v3, s[52:55], s80 offen offset:2048 sc1
    v_pk_add_f32 v[204:205], v[204:205], v[220:221]
    v_pk_add_f32 v[206:207], v[206:207], v[222:223]
    s_waitcnt lgkmcnt(4)
    v_pk_add_f32 v[192:193], v[192:193], v[224:225]
    v_pk_add_f32 v[194:195], v[194:195], v[226:227]
    v_pk_add_f32 v[196:197], v[196:197], v[228:229]
    v_pk_add_f32 v[198:199], v[198:199], v[230:231]
    buffer_load_dwordx4 a[12:15], v3, s[52:55], s80 offen offset:3072 sc1
    s_add_u32 s80, s80, 4096
    v_pk_add_f32 v[200:201], v[200:201], v[232:233]
    v_pk_add_f32 v[202:203], v[202:203], v[234:235]
    v_pk_add_f32 v[204:205], v[204:205], v[236:237]
    v_pk_add_f32 v[206:207], v[206:207], v[238:239]
    s_waitcnt lgkmcnt(0)
    v_pk_add_f32 v[192:193], v[192:193], v[240:241]
    v_pk_add_f32 v[194:195], v[194:195], v[242:243]
    buffer_load_dwordx4 a[16:19], v3, s[52:55], s80 offen offset:0 sc1
    v_pk_add_f32 v[196:197], v[196:197], v[244:245]
    v_pk_add_f32 v[198:199], v[198:199], v[246:247]
    v_pk_add_f32 v[200:201], v[200:201], v[248:249]
    v_pk_add_f32 v[202:203], v[202:203], v[250:251]
    v_pk_add_f32 v[204:205], v[204:205], v[252:253]
    v_pk_add_f32 v[206:207], v[206:207], v[254:255]
    buffer_load_dwordx4 a[20:23], v3, s[52:55], s80 offen offset:1024 sc1
    v_cvt_pk_bf16_f32 v224, v192, v193
    v_cvt_pk_bf16_f32 v225, v194, v195
    v_cvt_pk_bf16_f32 v226, v196, v197
    v_cvt_pk_bf16_f32 v227, v198, v199
    v_cvt_pk_bf16_f32 v228, v200, v201
    v_cvt_pk_bf16_f32 v229, v202, v203
    buffer_load_dwordx4 a[24:27], v3, s[52:55], s80 offen offset:2048 sc1
    v_cvt_pk_bf16_f32 v230, v204, v205
    v_cvt_pk_bf16_f32 v231, v206, v207
    v_lshlrev_b32 v192, 16, v224
    v_and_b32 v193, 0xffff0000, v224
    v_lshlrev_b32 v194, 16, v225
    v_and_b32 v195, 0xffff0000, v225
    buffer_load_dwordx4 a[28:31], v3, s[52:55], s80 offen offset:3072 sc1
    s_add_u32 s80, s80, 4096
    v_lshlrev_b32 v196, 16, v226
    v_and_b32 v197, 0xffff0000, v226
    v_lshlrev_b32 v198, 16, v227
    v_and_b32 v199, 0xffff0000, v227
    v_lshlrev_b32 v200, 16, v228
    v_and_b32 v201, 0xffff0000, v228
    buffer_load_dwordx4 a[32:35], v3, s[52:55], s80 offen offset:0 sc1
    v_lshlrev_b32 v202, 16, v229
    v_and_b32 v203, 0xffff0000, v229
    v_lshlrev_b32 v204, 16, v230
    v_and_b32 v205, 0xffff0000, v230
    v_lshlrev_b32 v206, 16, v231
    v_and_b32 v207, 0xffff0000, v231
    buffer_load_dwordx4 a[36:39], v3, s[52:55], s80 offen offset:1024 sc1
    v_mul_f32 v208, 0xbfb8aa3b, v192
    v_mul_f32 v209, 0xbfb8aa3b, v193
    v_mul_f32 v210, 0xbfb8aa3b, v194
    v_mul_f32 v211, 0xbfb8aa3b, v195
    v_mul_f32 v212, 0xbfb8aa3b, v196
    v_mul_f32 v213, 0xbfb8aa3b, v197
    buffer_load_dwordx4 a[40:43], v3, s[52:55], s80 offen offset:2048 sc1
    v_mul_f32 v214, 0xbfb8aa3b, v198
    v_mul_f32 v215, 0xbfb8aa3b, v199
    v_mul_f32 v216, 0xbfb8aa3b, v200
    v_mul_f32 v217, 0xbfb8aa3b, v201
    v_mul_f32 v218, 0xbfb8aa3b, v202
    v_mul_f32 v219, 0xbfb8aa3b, v203
    buffer_load_dwordx4 a[44:47], v3, s[52:55], s80 offen offset:3072 sc1
    s_add_u32 s80, s80, 4096
    v_mul_f32 v220, 0xbfb8aa3b, v204
    v_mul_f32 v221, 0xbfb8aa3b, v205
    v_mul_f32 v222, 0xbfb8aa3b, v206
    v_mul_f32 v223, 0xbfb8aa3b, v207
    v_exp_f32 v208, v208
    v_exp_f32 v209, v209
    buffer_load_dwordx4 a[48:51], v3, s[52:55], s80 offen offset:0 sc1
    v_exp_f32 v210, v210
    v_exp_f32 v211, v211
    v_exp_f32 v212, v212
    v_exp_f32 v213, v213
    v_exp_f32 v214, v214
    v_exp_f32 v215, v215
    buffer_load_dwordx4 a[52:55], v3, s[52:55], s80 offen offset:1024 sc1
    v_exp_f32 v216, v216
    v_exp_f32 v217, v217
    v_exp_f32 v218, v218
    v_exp_f32 v219, v219
    v_exp_f32 v220, v220
    v_exp_f32 v221, v221
    buffer_load_dwordx4 a[56:59], v3, s[52:55], s80 offen offset:2048 sc1
    v_exp_f32 v222, v222
    v_exp_f32 v223, v223
    v_add_f32 v208, 1.0, v208
    v_add_f32 v209, 1.0, v209
    v_add_f32 v210, 1.0, v210
    v_add_f32 v211, 1.0, v211
    buffer_load_dwordx4 a[60:63], v3, s[52:55], s80 offen offset:3072 sc1
    s_add_u32 s80, s80, 4096
    v_add_f32 v212, 1.0, v212
    v_add_f32 v213, 1.0, v213
    v_add_f32 v214, 1.0, v214
    v_add_f32 v215, 1.0, v215
    v_add_f32 v216, 1.0, v216
    v_add_f32 v217, 1.0, v217
    buffer_load_dwordx4 v[32:35], v3, s[52:55], s80 offen offset:0 sc1
    v_add_f32 v218, 1.0, v218
    v_add_f32 v219, 1.0, v219
    v_add_f32 v220, 1.0, v220
    v_add_f32 v221, 1.0, v221
    v_add_f32 v222, 1.0, v222
    v_add_f32 v223, 1.0, v223
    buffer_load_dwordx4 v[36:39], v3, s[52:55], s80 offen offset:1024 sc1
    v_rcp_f32 v208, v208
    v_rcp_f32 v209, v209
    v_rcp_f32 v210, v210
    v_rcp_f32 v211, v211
    v_rcp_f32 v212, v212
    v_rcp_f32 v213, v213
    buffer_load_dwordx4 v[40:43], v3, s[52:55], s80 offen offset:2048 sc1
    v_rcp_f32 v214, v214
    v_rcp_f32 v215, v215
    v_rcp_f32 v216, v216
    v_rcp_f32 v217, v217
    v_rcp_f32 v218, v218
    v_rcp_f32 v219, v219
    buffer_load_dwordx4 v[44:47], v3, s[52:55], s80 offen offset:3072 sc1
    s_add_u32 s80, s80, 4096
    v_rcp_f32 v220, v220
    v_rcp_f32 v221, v221
    v_rcp_f32 v222, v222
    v_rcp_f32 v223, v223
    v_mul_f32 v192, v192, v208
    v_mul_f32 v193, v193, v209
    buffer_load_dwordx4 v[48:51], v3, s[52:55], s80 offen offset:0 sc1
    v_mul_f32 v194, v194, v210
    v_mul_f32 v195, v195, v211
    v_mul_f32 v196, v196, v212
    v_mul_f32 v197, v197, v213
    v_mul_f32 v198, v198, v214
    v_mul_f32 v199, v199, v215
    buffer_load_dwordx4 v[52:55], v3, s[52:55], s80 offen offset:1024 sc1
    v_mul_f32 v200, v200, v216
    v_mul_f32 v201, v201, v217
    v_mul_f32 v202, v202, v218
    v_mul_f32 v203, v203, v219
    v_mul_f32 v204, v204, v220
    v_mul_f32 v205, v205, v221
    buffer_load_dwordx4 v[56:59], v3, s[52:55], s80 offen offset:2048 sc1
    v_mul_f32 v206, v206, v222
    v_mul_f32 v207, v207, v223
    v_cvt_pk_bf16_f32 v224, v192, v193
    v_cvt_pk_bf16_f32 v225, v194, v195
    v_cvt_pk_bf16_f32 v226, v196, v197
    v_cvt_pk_bf16_f32 v227, v198, v199
    buffer_load_dwordx4 v[60:63], v3, s[52:55], s80 offen offset:3072 sc1
    s_add_u32 s80, s80, 4096
    v_cvt_pk_bf16_f32 v228, v200, v201
    v_cvt_pk_bf16_f32 v229, v202, v203
    v_cvt_pk_bf16_f32 v230, v204, v205
    v_cvt_pk_bf16_f32 v231, v206, v207
    v_lshlrev_b32 v192, 16, v224
    v_and_b32 v193, 0xffff0000, v224
    buffer_load_dwordx4 a[128:131], v3, s[52:55], s80 offen offset:0 sc1
    v_lshlrev_b32 v194, 16, v225
    v_and_b32 v195, 0xffff0000, v225
    v_lshlrev_b32 v196, 16, v226
    v_and_b32 v197, 0xffff0000, v226
    v_lshlrev_b32 v198, 16, v227
    v_and_b32 v199, 0xffff0000, v227
    buffer_load_dwordx4 a[132:135], v3, s[52:55], s80 offen offset:1024 sc1
    v_lshlrev_b32 v200, 16, v228
    v_and_b32 v201, 0xffff0000, v228
    v_lshlrev_b32 v202, 16, v229
    v_and_b32 v203, 0xffff0000, v229
    v_lshlrev_b32 v204, 16, v230
    v_and_b32 v205, 0xffff0000, v230
    buffer_load_dwordx4 a[136:139], v3, s[52:55], s80 offen offset:2048 sc1
    v_lshlrev_b32 v206, 16, v231
    v_and_b32 v207, 0xffff0000, v231
    buffer_load_dwordx4 a[140:143], v3, s[52:55], s80 offen offset:3072 sc1
    s_add_u32 s80, s80, 4096
    buffer_load_dwordx4 a[144:147], v3, s[52:55], s80 offen offset:0 sc1
    buffer_load_dwordx4 a[148:151], v3, s[52:55], s80 offen offset:1024 sc1
    buffer_load_dwordx4 a[152:155], v3, s[52:55], s80 offen offset:2048 sc1
    buffer_load_dwordx4 a[156:159], v3, s[52:55], s80 offen offset:3072 sc1
    s_add_u32 s80, s80, 4096
    buffer_load_dword v0, v31, s[52:55], 0 offen sc1
    buffer_load_dwordx4 a[160:163], v3, s[52:55], s80 offen offset:0 sc1
    buffer_load_dwordx4 a[164:167], v3, s[52:55], s80 offen offset:1024 sc1
    buffer_load_dwordx4 a[168:171], v3, s[52:55], s80 offen offset:2048 sc1
    buffer_load_dwordx4 a[172:175], v3, s[52:55], s80 offen offset:3072 sc1
    s_add_u32 s80, s80, 4096
    buffer_load_dwordx4 a[176:179], v3, s[52:55], s80 offen offset:0 sc1
    buffer_load_dwordx4 a[180:183], v3, s[52:55], s80 offen offset:1024 sc1
    buffer_load_dwordx4 a[184:187], v3, s[52:55], s80 offen offset:2048 sc1
    buffer_load_dwordx4 a[188:191], v3, s[52:55], s80 offen offset:3072 sc1
    s_add_u32 s80, s80, 4096
    s_waitcnt vmcnt(8)
    v_cmp_eq_u32 vcc, s3, v0
    s_cmp_eq_u64 vcc, exec
    s_cbranch_scc0 L_spin_c
L_ok_c:
    buffer_load_dwordx4 v[64:67], v3, s[52:55], s81 offen offset:0 sc1
    buffer_load_dwordx4 v[68:71], v3, s[52:55], s81 offen offset:1024 sc1
    buffer_load_dwordx4 v[72:75], v3, s[52:55], s81 offen offset:2048 sc1
    buffer_load_dwordx4 v[76:79], v3, s[52:55], s81 offen offset:3072 sc1
    s_add_u32 s81, s81, 4096
    buffer_load_dwordx4 v[80:83], v3, s[52:55], s81 offen offset:0 sc1
    buffer_load_dwordx4 v[84:87], v3, s[52:55], s81 offen offset:1024 sc1
    buffer_load_dwordx4 v[88:91], v3, s[52:55], s81 offen offset:2048 sc1
    buffer_load_dwordx4 v[92:95], v3, s[52:55], s81 offen offset:3072 sc1
    s_add_u32 s81, s81, 4096
    buffer_load_dwordx4 v[96:99], v3, s[52:55], s81 offen offset:0 sc1
    buffer_load_dwordx4 v[100:103], v3, s[52:55], s81 offen offset:1024 sc1
    buffer_load_dwordx4 v[104:107], v3, s[52:55], s81 offen offset:2048 sc1
    buffer_load_dwordx4 v[108:111], v3, s[52:55], s81 offen offset:3072 sc1
    s_add_u32 s81, s81, 4096
    buffer_load_dwordx4 v[112:115], v3, s[52:55], s81 offen offset:0 sc1
    buffer_load_dwordx4 v[116:119], v3, s[52:55], s81 offen offset:1024 sc1
    buffer_load_dwordx4 v[120:123], v3, s[52:55], s81 offen offset:2048 sc1
    buffer_load_dwordx4 v[124:127], v3, s[52:55], s81 offen offset:3072 sc1
    s_add_u32 s81, s81, 4096
    s_waitcnt vmcnt(12)
    v_mfma_f32_16x16x32_bf16 v[128:131], a[224:227], v[64:67], 0
    buffer_load_dwordx4 v[208:211], v3, s[52:55], s81 offen offset:0 sc1
    v_mfma_f32_16x16x32_bf16 v[132:135], a[224:227], v[68:71], 0
    v_mfma_f32_16x16x32_bf16 v[136:139], a[224:227], v[72:75], 0
    buffer_load_dwordx4 v[212:215], v3, s[52:55], s81 offen offset:1024 sc1
    v_mfma_f32_16x16x32_bf16 v[140:143], a[224:227], v[76:79], 0
    v_mfma_f32_16x16x32_bf16 v[144:147], a[228:231], v[64:67], 0
    buffer_load_dwordx4 v[216:219], v3, s[52:55], s81 offen offset:2048 sc1
    v_mfma_f32_16x16x32_bf16 v[148:151], a[228:231], v[68:71], 0
    v_mfma_f32_16x16x32_bf16 v[152:155], a[228:231], v[72:75], 0
    buffer_load_dwordx4 v[220:223], v3, s[52:55], s81 offen offset:3072 sc1
    s_add_u32 s81, s81, 4096
    v_mfma_f32_16x16x32_bf16 v[156:159], a[228:231], v[76:79], 0
    v_mfma_f32_16x16x32_bf16 v[160:163], a[232:235], v[64:67], 0
    v_mfma_f32_16x16x32_bf16 v[164:167], a[232:235], v[68:71], 0
    v_mfma_f32_16x16x32_bf16 v[168:171], a[232:235], v[72:75], 0
    v_mfma_f32_16x16x32_bf16 v[172:175], a[232:235], v[76:79], 0
    v_mfma_f32_16x16x32_bf16 v[176:179], a[236:239], v[64:67], 0
    v_mfma_f32_16x16x32_bf16 v[180:183], a[236:239], v[68:71], 0
    v_mfma_f32_16x16x32_bf16 v[184:187], a[236:239], v[72:75], 0
    v_mfma_f32_16x16x32_bf16 v[188:191], a[236:239], v[76:79], 0
    s_waitcnt vmcnt(12)
    v_mfma_f32_16x16x32_bf16 v[128:131], a[240:243], v[80:83], v[128:131]
    buffer_load_dwordx4 v[64:67], v3, s[52:55], s81 offen offset:0 sc1
    v_mfma_f32_16x16x32_bf16 v[132:135], a[240:243], v[84:87], v[132:135]
    v_mfma_f32_16x16x32_bf16 v[136:139], a[240:243], v[88:91], v[136:139]
    buffer_load_dwordx4 v[68:71], v3, s[52:55], s81 offen offset:1024 sc1
    v_mfma_f32_16x16x32_bf16 v[140:143], a[240:243], v[92:95], v[140:143]
    v_mfma_f32_16x16x32_bf16 v[144:147], a[244:247], v[80:83], v[144:147]
    buffer_load_dwordx4 v[72:75], v3, s[52:55], s81 offen offset:2048 sc1
    v_mfma_f32_16x16x32_bf16 v[148:151], a[244:247], v[84:87], v[148:151]
    v_mfma_f32_16x16x32_bf16 v[152:155], a[244:247], v[88:91], v[152:155]
    buffer_load_dwordx4 v[76:79], v3, s[52:55], s81 offen offset:3072 sc1
    s_add_u32 s81, s81, 4096
    v_mfma_f32_16x16x32_bf16 v[156:159], a[244:247], v[92:95], v[156:159]
    v_mfma_f32_16x16x32_bf16 v[160:163], a[248:251], v[80:83], v[160:163]
    buffer_load_dwordx4 a[224:227], v3, s[52:55], s80 offen offset:0 sc1
    v_mfma_f32_16x16x32_bf16 v[164:167], a[248:251], v[84:87], v[164:167]
    v_mfma_f32_16x16x32_bf16 v[168:171], a[248:251], v[88:91], v[168:171]
    buffer_load_dwordx4 a[228:231], v3, s[52:55], s80 offen offset:1024 sc1
    v_mfma_f32_16x16x32_bf16 v[172:175], a[248:251], v[92:95], v[172:175]
    v_mfma_f32_16x16x32_bf16 v[176:179], a[252:255], v[80:83], v[176:179]
    buffer_load_dwordx4 a[232:235], v3, s[52:55], s80 offen offset:2048 sc1
    v_mfma_f32_16x16x32_bf16 v[180:183], a[252:255], v[84:87], v[180:183]
    v_mfma_f32_16x16x32_bf16 v[184:187], a[252:255], v[88:91], v[184:187]
    buffer_load_dwordx4 a[236:239], v3, s[52:55], s80 offen offset:3072 sc1
    s_add_u32 s80, s80, 4096
    v_mfma_f32_16x16x32_bf16 v[188:191], a[252:255], v[92:95], v[188:191]
    s_waitcnt vmcnt(16)
    v_mfma_f32_16x16x32_bf16 v[128:131], a[64:67], v[96:99], v[128:131]
    buffer_load_dwordx4 v[80:83], v3, s[52:55], s81 offen offset:0 sc1
    v_mfma_f32_16x16x32_bf16 v[132:135], a[64:67], v[100:103], v[132:135]
    v_mfma_f32_16x16x32_bf16 v[136:139], a[64:67], v[104:107], v[136:139]
    buffer_load_dwordx4 v[84:87], v3, s[52:55], s81 offen offset:1024 sc1
    v_mfma_f32_16x16x32_bf16 v[140:143], a[64:67], v[108:111], v[140:143]
    v_mfma_f32_16x16x32_bf16 v[144:147], a[68:71], v[96:99], v[144:147]
    buffer_load_dwordx4 v[88:91], v3, s[52:55], s81 offen offset:2048 sc1
    v_mfma_f32_16x16x32_bf16 v[148:151], a[68:71], v[100:103], v[148:151]
    v_mfma_f32_16x16x32_bf16 v[152:155], a[68:71], v[104:107], v[152:155]
    buffer_load_dwordx4 v[92:95], v3, s[52:55], s81 offen offset:3072 sc1
    s_add_u32 s81, s81, 4096
    v_mfma_f32_16x16x32_bf16 v[156:159], a[68:71], v[108:111], v[156:159]
    v_mfma_f32_16x16x32_bf16 v[160:163], a[72:75], v[96:99], v[160:163]
    buffer_load_dwordx4 a[240:243], v3, s[52:55], s80 offen offset:0 sc1
    v_mfma_f32_16x16x32_bf16 v[164:167], a[72:75], v[100:103], v[164:167]
    v_mfma_f32_16x16x32_bf16 v[168:171], a[72:75], v[104:107], v[168:171]
    buffer_load_dwordx4 a[244:247], v3, s[52:55], s80 offen offset:1024 sc1
    v_mfma_f32_16x16x32_bf16 v[172:175], a[72:75], v[108:111], v[172:175]
    v_mfma_f32_16x16x32_bf16 v[176:179], a[76:79], v[96:99], v[176:179]
    buffer_load_dwordx4 a[248:251], v3, s[52:55], s80 offen offset:2048 sc1
    v_mfma_f32_16x16x32_bf16 v[180:183], a[76:79], v[100:103], v[180:183]
    v_mfma_f32_16x16x32_bf16 v[184:187], a[76:79], v[104:107], v[184:187]
    buffer_load_dwordx4 a[252:255], v3, s[52:55], s80 offen offset:3072 sc1
    s_add_u32 s80, s80, 4096
    v_mfma_f32_16x16x32_bf16 v[188:191], a[76:79], v[108:111], v[188:191]
    s_waitcnt vmcnt(20)
    v_mfma_f32_16x16x32_bf16 v[128:131], a[80:83], v[112:115], v[128:131]
    buffer_load_dwordx4 v[96:99], v3, s[52:55], s81 offen offset:0 sc1
    v_mfma_f32_16x16x32_bf16 v[132:135], a[80:83], v[116:119], v[132:135]
    v_mfma_f32_16x16x32_bf16 v[136:139], a[80:83], v[120:123], v[136:139]
    buffer_load_dwordx4 v[100:103], v3, s[52:55], s81 offen offset:1024 sc1
    v_mfma_f32_16x16x32_bf16 v[140:143], a[80:83], v[124:127], v[140:143]
    v_mfma_f32_16x16x32_bf16 v[144:147], a[84:87], v[112:115], v[144:147]
    buffer_load_dwordx4 v[104:107], v3, s[52:55], s81 offen offset:2048 sc1
    v_mfma_f32_16x16x32_bf16 v[148:151], a[84:87], v[116:119], v[148:151]
    v_mfma_f32_16x16x32_bf16 v[152:155], a[84:87], v[120:123], v[152:155]
    buffer_load_dwordx4 v[108:111], v3, s[52:55], s81 offen offset:3072 sc1
    s_add_u32 s81, s81, 4096
    v_mfma_f32_16x16x32_bf16 v[156:159], a[84:87], v[124:127], v[156:159]
    v_mfma_f32_16x16x32_bf16 v[160:163], a[88:91], v[112:115], v[160:163]
    buffer_load_dwordx4 a[64:67], v3, s[52:55], s80 offen offset:0 sc1
    v_mfma_f32_16x16x32_bf16 v[164:167], a[88:91], v[116:119], v[164:167]
    v_mfma_f32_16x16x32_bf16 v[168:171], a[88:91], v[120:123], v[168:171]
    buffer_load_dwordx4 a[68:71], v3, s[52:55], s80 offen offset:1024 sc1
    v_mfma_f32_16x16x32_bf16 v[172:175], a[88:91], v[124:127], v[172:175]
    v_mfma_f32_16x16x32_bf16 v[176:179], a[92:95], v[112:115], v[176:179]
    buffer_load_dwordx4 a[72:75], v3, s[52:55], s80 offen offset:2048 sc1
    v_mfma_f32_16x16x32_bf16 v[180:183], a[92:95], v[116:119], v[180:183]
    v_mfma_f32_16x16x32_bf16 v[184:187], a[92:95], v[120:123], v[184:187]
    buffer_load_dwordx4 a[76:79], v3, s[52:55], s80 offen offset:3072 sc1
    s_add_u32 s80, s80, 4096
    v_mfma_f32_16x16x32_bf16 v[188:191], a[92:95], v[124:127], v[188:191]
    s_waitcnt vmcnt(24)
    v_mfma_f32_16x16x32_bf16 v[128:131], a[208:211], v[208:211], v[128:131]
    buffer_load_dwordx4 v[112:115], v3, s[52:55], s81 offen offset:0 sc1
    v_mfma_f32_16x16x32_bf16 v[132:135], a[208:211], v[212:215], v[132:135]
    v_mfma_f32_16x16x32_bf16 v[136:139], a[208:211], v[216:219], v[136:139]
    buffer_load_dwordx4 v[116:119], v3, s[52:55], s81 offen offset:1024 sc1
    v_mfma_f32_16x16x32_bf16 v[140:143], a[208:211], v[220:223], v[140:143]
    v_mfma_f32_16x16x32_bf16 v[144:147], a[212:215], v[208:211], v[144:147]
    buffer_load_dwordx4 v[120:123], v3, s[52:55], s81 offen offset:2048 sc1
    v_mfma_f32_16x16x32_bf16 v[148:151], a[212:215], v[212:215], v[148:151]
    v_mfma_f32_16x16x32_bf16 v[152:155], a[212:215], v[216:219], v[152:155]
    buffer_load_dwordx4 v[124:127], v3, s[52:55], s81 offen offset:3072 sc1
    s_add_u32 s81, s81, 4096
    v_mfma_f32_16x16x32_bf16 v[156:159], a[212:215], v[220:223], v[156:159]
    v_mfma_f32_16x16x32_bf16 v[160:163], a[216:219], v[208:211], v[160:163]
    buffer_load_dwordx4 a[80:83], v3, s[52:55], s80 offen offset:0 sc1
    v_mfma_f32_16x16x32_bf16 v[164:167], a[216:219], v[212:215], v[164:167]
    v_mfma_f32_16x16x32_bf16 v[168:171], a[216:219], v[216:219], v[168:171]
    buffer_load_dwordx4 a[84:87], v3, s[52:55], s80 offen offset:1024 sc1
    v_mfma_f32_16x16x32_bf16 v[172:175], a[216:219], v[220:223], v[172:175]
    v_mfma_f32_16x16x32_bf16 v[176:179], a[220:223], v[208:211], v[176:179]
    buffer_load_dwordx4 a[88:91], v3, s[52:55], s80 offen offset:2048 sc1
    v_mfma_f32_16x16x32_bf16 v[180:183], a[220:223], v[212:215], v[180:183]
    v_mfma_f32_16x16x32_bf16 v[184:187], a[220:223], v[216:219], v[184:187]
    buffer_load_dwordx4 a[92:95], v3, s[52:55], s80 offen offset:3072 sc1
    s_add_u32 s80, s80, 4096
    v_mfma_f32_16x16x32_bf16 v[188:191], a[220:223], v[220:223], v[188:191]
    s_waitcnt vmcnt(28)
    v_mfma_f32_16x16x32_bf16 v[128:131], a[192:195], v[64:67], v[128:131]
    buffer_load_dwordx4 v[208:211], v3, s[52:55], s81 offen offset:0 sc1
    v_mfma_f32_16x16x32_bf16 v[132:135], a[192:195], v[68:71], v[132:135]
    v_mfma_f32_16x16x32_bf16 v[136:139], a[192:195], v[72:75], v[136:139]
    buffer_load_dwordx4 v[212:215], v3, s[52:55], s81 offen offset:1024 sc1
    v_mfma_f32_16x16x32_bf16 v[140:143], a[192:195], v[76:79], v[140:143]
    v_mfma_f32_16x16x32_bf16 v[144:147], a[196:199], v[64:67], v[144:147]
    buffer_load_dwordx4 v[216:219], v3, s[52:55], s81 offen offset:2048 sc1
    v_mfma_f32_16x16x32_bf16 v[148:151], a[196:199], v[68:71], v[148:151]
    v_mfma_f32_16x16x32_bf16 v[152:155], a[196:199], v[72:75], v[152:155]
    buffer_load_dwordx4 v[220:223], v3, s[52:55], s81 offen offset:3072 sc1
    s_add_u32 s81, s81, 4096
    v_mfma_f32_16x16x32_bf16 v[156:159], a[196:199], v[76:79], v[156:159]
    v_mfma_f32_16x16x32_bf16 v[160:163], a[200:203], v[64:67], v[160:163]
    buffer_load_dwordx4 a[208:211], v3, s[52:55], s80 offen offset:0 sc1
    v_mfma_f32_16x16x32_bf16 v[164:167], a[200:203], v[68:71], v[164:167]
    v_mfma_f32_16x16x32_bf16 v[168:171], a[200:203], v[72:75], v[168:171]
    buffer_load_dwordx4 a[212:215], v3, s[52:55], s80 offen offset:1024 sc1
    v_mfma_f32_16x16x32_bf16 v[172:175], a[200:203], v[76:79], v[172:175]
    v_mfma_f32_16x16x32_bf16 v[176:179], a[204:207], v[64:67], v[176:179]
    buffer_load_dwordx4 a[216:219], v3, s[52:55], s80 offen offset:2048 sc1
    v_mfma_f32_16x16x32_bf16 v[180:183], a[204:207], v[68:71], v[180:183]
    v_mfma_f32_16x16x32_bf16 v[184:187], a[204:207], v[72:75], v[184:187]
    buffer_load_dwordx4 a[220:223], v3, s[52:55], s80 offen offset:3072 sc1
    s_add_u32 s80, s80, 4096
    v_mfma_f32_16x16x32_bf16 v[188:191], a[204:207], v[76:79], v[188:191]
    s_waitcnt vmcnt(28)
    v_mfma_f32_16x16x32_bf16 v[128:131], a[96:99], v[80:83], v[128:131]
    buffer_load_dwordx4 v[64:67], v3, s[52:55], s81 offen offset:0 sc1
    v_mfma_f32_16x16x32_bf16 v[132:135], a[96:99], v[84:87], v[132:135]
    v_mfma_f32_16x16x32_bf16 v[136:139], a[96:99], v[88:91], v[136:139]
    buffer_load_dwordx4 v[68:71], v3, s[52:55], s81 offen offset:1024 sc1
    v_mfma_f32_16x16x32_bf16 v[140:143], a[96:99], v[92:95], v[140:143]
    v_mfma_f32_16x16x32_bf16 v[144:147], a[100:103], v[80:83], v[144:147]
    buffer_load_dwordx4 v[72:75], v3, s[52:55], s81 offen offset:2048 sc1
    v_mfma_f32_16x16x32_bf16 v[148:151], a[100:103], v[84:87], v[148:151]
    v_mfma_f32_16x16x32_bf16 v[152:155], a[100:103], v[88:91], v[152:155]
    buffer_load_dwordx4 v[76:79], v3, s[52:55], s81 offen offset:3072 sc1
    s_add_u32 s81, s81, 4096
    v_mfma_f32_16x16x32_bf16 v[156:159], a[100:103], v[92:95], v[156:159]
    v_mfma_f32_16x16x32_bf16 v[160:163], a[104:107], v[80:83], v[160:163]
    buffer_load_dwordx4 a[192:195], v3, s[52:55], s80 offen offset:0 sc1
    v_mfma_f32_16x16x32_bf16 v[164:167], a[104:107], v[84:87], v[164:167]
    v_mfma_f32_16x16x32_bf16 v[168:171], a[104:107], v[88:91], v[168:171]
    buffer_load_dwordx4 a[196:199], v3, s[52:55], s80 offen offset:1024 sc1
    v_mfma_f32_16x16x32_bf16 v[172:175], a[104:107], v[92:95], v[172:175]
    v_mfma_f32_16x16x32_bf16 v[176:179], a[108:111], v[80:83], v[176:179]
    buffer_load_dwordx4 a[200:203], v3, s[52:55], s80 offen offset:2048 sc1
    v_mfma_f32_16x16x32_bf16 v[180:183], a[108:111], v[84:87], v[180:183]
    v_mfma_f32_16x16x32_bf16 v[184:187], a[108:111], v[88:91], v[184:187]
    buffer_load_dwordx4 a[204:207], v3, s[52:55], s80 offen offset:3072 sc1
    s_add_u32 s80, s80, 4096
    v_mfma_f32_16x16x32_bf16 v[188:191], a[108:111], v[92:95], v[188:191]
    s_waitcnt vmcnt(28)
    v_mfma_f32_16x16x32_bf16 v[128:131], a[112:115], v[96:99], v[128:131]
    buffer_load_dwordx4 v[80:83], v3, s[52:55], s81 offen offset:0 sc1
    v_mfma_f32_16x16x32_bf16 v[132:135], a[112:115], v[100:103], v[132:135]
    v_mfma_f32_16x16x32_bf16 v[136:139], a[112:115], v[104:107], v[136:139]
    buffer_load_dwordx4 v[84:87], v3, s[52:55], s81 offen offset:1024 sc1
    v_mfma_f32_16x16x32_bf16 v[140:143], a[112:115], v[108:111], v[140:143]
    v_mfma_f32_16x16x32_bf16 v[144:147], a[116:119], v[96:99], v[144:147]
    buffer_load_dwordx4 v[88:91], v3, s[52:55], s81 offen offset:2048 sc1
    v_mfma_f32_16x16x32_bf16 v[148:151], a[116:119], v[100:103], v[148:151]
    v_mfma_f32_16x16x32_bf16 v[152:155], a[116:119], v[104:107], v[152:155]
    buffer_load_dwordx4 v[92:95], v3, s[52:55], s81 offen offset:3072 sc1
    s_add_u32 s81, s81, 4096
    v_mfma_f32_16x16x32_bf16 v[156:159], a[116:119], v[108:111], v[156:159]
    v_mfma_f32_16x16x32_bf16 v[160:163], a[120:123], v[96:99], v[160:163]
    buffer_load_dwordx4 a[96:99], v3, s[52:55], s80 offen offset:0 sc1
    v_mfma_f32_16x16x32_bf16 v[164:167], a[120:123], v[100:103], v[164:167]
    v_mfma_f32_16x16x32_bf16 v[168:171], a[120:123], v[104:107], v[168:171]
    buffer_load_dwordx4 a[100:103], v3, s[52:55], s80 offen offset:1024 sc1
    v_mfma_f32_16x16x32_bf16 v[172:175], a[120:123], v[108:111], v[172:175]
    v_mfma_f32_16x16x32_bf16 v[176:179], a[124:127], v[96:99], v[176:179]
    buffer_load_dwordx4 a[104:107], v3, s[52:55], s80 offen offset:2048 sc1
    v_mfma_f32_16x16x32_bf16 v[180:183], a[124:127], v[100:103], v[180:183]
    v_mfma_f32_16x16x32_bf16 v[184:187], a[124:127], v[104:107], v[184:187]
    buffer_load_dwordx4 a[108:111], v3, s[52:55], s80 offen offset:3072 sc1
    s_add_u32 s80, s80, 4096
    v_mfma_f32_16x16x32_bf16 v[188:191], a[124:127], v[108:111], v[188:191]
    s_waitcnt vmcnt(28)
    v_mfma_f32_16x16x32_bf16 v[128:131], a[0:3], v[112:115], v[128:131]
    buffer_load_dwordx4 v[96:99], v3, s[52:55], s81 offen offset:0 sc1
    v_mfma_f32_16x16x32_bf16 v[132:135], a[0:3], v[116:119], v[132:135]
    v_mfma_f32_16x16x32_bf16 v[136:139], a[0:3], v[120:123], v[136:139]
    buffer_load_dwordx4 v[100:103], v3, s[52:55], s81 offen offset:1024 sc1
    v_mfma_f32_16x16x32_bf16 v[140:143], a[0:3], v[124:127], v[140:143]
    v_mfma_f32_16x16x32_bf16 v[144:147], a[4:7], v[112:115], v[144:147]
    buffer_load_dwordx4 v[104:107], v3, s[52:55], s81 offen offset:2048 sc1
    v_mfma_f32_16x16x32_bf16 v[148:151], a[4:7], v[116:119], v[148:151]
    v_mfma_f32_16x16x32_bf16 v[152:155], a[4:7], v[120:123], v[152:155]
    buffer_load_dwordx4 v[108:111], v3, s[52:55], s81 offen offset:3072 sc1
    s_add_u32 s81, s81, 4096
    v_mfma_f32_16x16x32_bf16 v[156:159], a[4:7], v[124:127], v[156:159]
    v_mfma_f32_16x16x32_bf16 v[160:163], a[8:11], v[112:115], v[160:163]
    buffer_load_dwordx4 a[112:115], v3, s[52:55], s80 offen offset:0 sc1
    v_mfma_f32_16x16x32_bf16 v[164:167], a[8:11], v[116:119], v[164:167]
    v_mfma_f32_16x16x32_bf16 v[168:171], a[8:11], v[120:123], v[168:171]
    buffer_load_dwordx4 a[116:119], v3, s[52:55], s80 offen offset:1024 sc1
    v_mfma_f32_16x16x32_bf16 v[172:175], a[8:11], v[124:127], v[172:175]
    v_mfma_f32_16x16x32_bf16 v[176:179], a[12:15], v[112:115], v[176:179]
    buffer_load_dwordx4 a[120:123], v3, s[52:55], s80 offen offset:2048 sc1
    v_mfma_f32_16x16x32_bf16 v[180:183], a[12:15], v[116:119], v[180:183]
    v_mfma_f32_16x16x32_bf16 v[184:187], a[12:15], v[120:123], v[184:187]
    buffer_load_dwordx4 a[124:127], v3, s[52:55], s80 offen offset:3072 sc1
    s_add_u32 s80, s80, 4096
    v_mfma_f32_16x16x32_bf16 v[188:191], a[12:15], v[124:127], v[188:191]
    s_waitcnt vmcnt(28)
    v_mfma_f32_16x16x32_bf16 v[128:131], a[16:19], v[208:211], v[128:131]
    buffer_load_dwordx4 v[112:115], v3, s[52:55], s81 offen offset:0 sc1
    v_mfma_f32_16x16x32_bf16 v[132:135], a[16:19], v[212:215], v[132:135]
    v_mfma_f32_16x16x32_bf16 v[136:139], a[16:19], v[216:219], v[136:139]
    buffer_load_dwordx4 v[116:119], v3, s[52:55], s81 offen offset:1024 sc1
    v_mfma_f32_16x16x32_bf16 v[140:143], a[16:19], v[220:223], v[140:143]
    v_mfma_f32_16x16x32_bf16 v[144:147], a[20:23], v[208:211], v[144:147]
    buffer_load_dwordx4 v[120:123], v3, s[52:55], s81 offen offset:2048 sc1
    v_mfma_f32_16x16x32_bf16 v[148:151], a[20:23], v[212:215], v[148:151]
    v_mfma_f32_16x16x32_bf16 v[152:155], a[20:23], v[216:219], v[152:155]
    buffer_load_dwordx4 v[124:127], v3, s[52:55], s81 offen offset:3072 sc1
    s_add_u32 s81, s81, 4096
    v_mfma_f32_16x16x32_bf16 v[156:159], a[20:23], v[220:223], v[156:159]
    v_mfma_f32_16x16x32_bf16 v[160:163], a[24:27], v[208:211], v[160:163]
    buffer_load_dwordx4 a[0:3], v3, s[52:55], s80 offen offset:0 sc1
    v_mfma_f32_16x16x32_bf16 v[164:167], a[24:27], v[212:215], v[164:167]
    v_mfma_f32_16x16x32_bf16 v[168:171], a[24:27], v[216:219], v[168:171]
    buffer_load_dwordx4 a[4:7], v3, s[52:55], s80 offen offset:1024 sc1
    v_mfma_f32_16x16x32_bf16 v[172:175], a[24:27], v[220:223], v[172:175]
    v_mfma_f32_16x16x32_bf16 v[176:179], a[28:31], v[208:211], v[176:179]
    buffer_load_dwordx4 a[8:11], v3, s[52:55], s80 offen offset:2048 sc1
    v_mfma_f32_16x16x32_bf16 v[180:183], a[28:31], v[212:215], v[180:183]
    v_mfma_f32_16x16x32_bf16 v[184:187], a[28:31], v[216:219], v[184:187]
    buffer_load_dwordx4 a[12:15], v3, s[52:55], s80 offen offset:3072 sc1
    s_add_u32 s80, s80, 4096
    v_mfma_f32_16x16x32_bf16 v[188:191], a[28:31], v[220:223], v[188:191]
    s_waitcnt vmcnt(28)
    v_mfma_f32_16x16x32_bf16 v[128:131], a[32:35], v[64:67], v[128:131]
    buffer_load_dwordx4 v[208:211], v3, s[52:55], s81 offen offset:0 sc1
    v_mfma_f32_16x16x32_bf16 v[132:135], a[32:35], v[68:71], v[132:135]
    v_mfma_f32_16x16x32_bf16 v[136:139], a[32:35], v[72:75], v[136:139]
    buffer_load_dwordx4 v[212:215], v3, s[52:55], s81 offen offset:1024 sc1
    v_mfma_f32_16x16x32_bf16 v[140:143], a[32:35], v[76:79], v[140:143]
    v_mfma_f32_16x16x32_bf16 v[144:147], a[36:39], v[64:67], v[144:147]
    buffer_load_dwordx4 v[216:219], v3, s[52:55], s81 offen offset:2048 sc1
    v_mfma_f32_16x16x32_bf16 v[148:151], a[36:39], v[68:71], v[148:151]
    v_mfma_f32_16x16x32_bf16 v[152:155], a[36:39], v[72:75], v[152:155]
    buffer_load_dwordx4 v[220:223], v3, s[52:55], s81 offen offset:3072 sc1
    s_add_u32 s81, s81, 4096
    v_mfma_f32_16x16x32_bf16 v[156:159], a[36:39], v[76:79], v[156:159]
    v_mfma_f32_16x16x32_bf16 v[160:163], a[40:43], v[64:67], v[160:163]
    buffer_load_dwordx4 a[16:19], v3, s[52:55], s80 offen offset:0 sc1
    v_mfma_f32_16x16x32_bf16 v[164:167], a[40:43], v[68:71], v[164:167]
    v_mfma_f32_16x16x32_bf16 v[168:171], a[40:43], v[72:75], v[168:171]
    buffer_load_dwordx4 a[20:23], v3, s[52:55], s80 offen offset:1024 sc1
    v_mfma_f32_16x16x32_bf16 v[172:175], a[40:43], v[76:79], v[172:175]
    v_mfma_f32_16x16x32_bf16 v[176:179], a[44:47], v[64:67], v[176:179]
    buffer_load_dwordx4 a[24:27], v3, s[52:55], s80 offen offset:2048 sc1
    v_mfma_f32_16x16x32_bf16 v[180:183], a[44:47], v[68:71], v[180:183]
    v_mfma_f32_16x16x32_bf16 v[184:187], a[44:47], v[72:75], v[184:187]
    buffer_load_dwordx4 a[28:31], v3, s[52:55], s80 offen offset:3072 sc1
    s_add_u32 s80, s80, 4096
    v_mfma_f32_16x16x32_bf16 v[188:191], a[44:47], v[76:79], v[188:191]
    s_waitcnt vmcnt(28)
    v_mfma_f32_16x16x32_bf16 v[128:131], a[48:51], v[80:83], v[128:131]
    buffer_load_dwordx4 v[64:67], v3, s[52:55], s81 offen offset:0 sc1
    v_mfma_f32_16x16x32_bf16 v[132:135], a[48:51], v[84:87], v[132:135]
    v_mfma_f32_16x16x32_bf16 v[136:139], a[48:51], v[88:91], v[136:139]
    buffer_load_dwordx4 v[68:71], v3, s[52:55], s81 offen offset:1024 sc1
    v_mfma_f32_16x16x32_bf16 v[140:143], a[48:51], v[92:95], v[140:143]
    v_mfma_f32_16x16x32_bf16 v[144:147], a[52:55], v[80:83], v[144:147]
    buffer_load_dwordx4 v[72:75], v3, s[52:55], s81 offen offset:2048 sc1
    v_mfma_f32_16x16x32_bf16 v[148:151], a[52:55], v[84:87], v[148:151]
    v_mfma_f32_16x16x32_bf16 v[152:155], a[52:55], v[88:91], v[152:155]
    buffer_load_dwordx4 v[76:79], v3, s[52:55], s81 offen offset:3072 sc1
    s_add_u32 s81, s81, 4096
    v_mfma_f32_16x16x32_bf16 v[156:159], a[52:55], v[92:95], v[156:159]
    v_mfma_f32_16x16x32_bf16 v[160:163], a[56:59], v[80:83], v[160:163]
    buffer_load_dwordx4 a[32:35], v3, s[52:55], s80 offen offset:0 sc1
    v_mfma_f32_16x16x32_bf16 v[164:167], a[56:59], v[84:87], v[164:167]
    v_mfma_f32_16x16x32_bf16 v[168:171], a[56:59], v[88:91], v[168:171]
    buffer_load_dwordx4 a[36:39], v3, s[52:55], s80 offen offset:1024 sc1
    v_mfma_f32_16x16x32_bf16 v[172:175], a[56:59], v[92:95], v[172:175]
    v_mfma_f32_16x16x32_bf16 v[176:179], a[60:63], v[80:83], v[176:179]
    buffer_load_dwordx4 a[40:43], v3, s[52:55], s80 offen offset:2048 sc1
    v_mfma_f32_16x16x32_bf16 v[180:183], a[60:63], v[84:87], v[180:183]
    v_mfma_f32_16x16x32_bf16 v[184:187], a[60:63], v[88:91], v[184:187]
    buffer_load_dwordx4 a[44:47], v3, s[52:55], s80 offen offset:3072 sc1
    s_add_u32 s80, s80, 4096
    v_mfma_f32_16x16x32_bf16 v[188:191], a[60:63], v[92:95], v[188:191]
    s_waitcnt vmcnt(28)
    v_mfma_f32_16x16x32_bf16 v[128:131], v[32:35], v[96:99], v[128:131]
    buffer_load_dwordx4 v[80:83], v3, s[52:55], s81 offen offset:0 sc1
    v_mfma_f32_16x16x32_bf16 v[132:135], v[32:35], v[100:103], v[132:135]
    v_mfma_f32_16x16x32_bf16 v[136:139], v[32:35], v[104:107], v[136:139]
    buffer_load_dwordx4 v[84:87], v3, s[52:55], s81 offen offset:1024 sc1
    v_mfma_f32_16x16x32_bf16 v[140:143], v[32:35], v[108:111], v[140:143]
    v_mfma_f32_16x16x32_bf16 v[144:147], v[36:39], v[96:99], v[144:147]
    buffer_load_dwordx4 v[88:91], v3, s[52:55], s81 offen offset:2048 sc1
    v_mfma_f32_16x16x32_bf16 v[148:151], v[36:39], v[100:103], v[148:151]
    v_mfma_f32_16x16x32_bf16 v[152:155], v[36:39], v[104:107], v[152:155]
    buffer_load_dwordx4 v[92:95], v3, s[52:55], s81 offen offset:3072 sc1
    s_add_u32 s81, s81, 4096
    v_mfma_f32_16x16x32_bf16 v[156:159], v[36:39], v[108:111], v[156:159]
    v_mfma_f32_16x16x32_bf16 v[160:163], v[40:43], v[96:99], v[160:163]
    buffer_load_dwordx4 a[48:51], v3, s[52:55], s80 offen offset:0 sc1
    v_mfma_f32_16x16x32_bf16 v[164:167], v[40:43], v[100:103], v[164:167]
    v_mfma_f32_16x16x32_bf16 v[168:171], v[40:43], v[104:107], v[168:171]
    buffer_load_dwordx4 a[52:55], v3, s[52:55], s80 offen offset:1024 sc1
    v_mfma_f32_16x16x32_bf16 v[172:175], v[40:43], v[108:111], v[172:175]
    v_mfma_f32_16x16x32_bf16 v[176:179], v[44:47], v[96:99], v[176:179]
    buffer_load_dwordx4 a[56:59], v3, s[52:55], s80 offen offset:2048 sc1
    v_mfma_f32_16x16x32_bf16 v[180:183], v[44:47], v[100:103], v[180:183]
    v_mfma_f32_16x16x32_bf16 v[184:187], v[44:47], v[104:107], v[184:187]
    buffer_load_dwordx4 a[60:63], v3, s[52:55], s80 offen offset:3072 sc1
    s_add_u32 s80, s80, 4096
    v_mfma_f32_16x16x32_bf16 v[188:191], v[44:47], v[108:111], v[188:191]
    s_waitcnt vmcnt(28)
    v_mfma_f32_16x16x32_bf16 v[128:131], v[48:51], v[112:115], v[128:131]
    buffer_load_dwordx4 v[96:99], v3, s[52:55], s81 offen offset:0 sc1
    v_mfma_f32_16x16x32_bf16 v[132:135], v[48:51], v[116:119], v[132:135]
    v_mfma_f32_16x16x32_bf16 v[136:139], v[48:51], v[120:123], v[136:139]
    buffer_load_dwordx4 v[100:103], v3, s[52:55], s81 offen offset:1024 sc1
    v_mfma_f32_16x16x32_bf16 v[140:143], v[48:51], v[124:127], v[140:143]
    v_mfma_f32_16x16x32_bf16 v[144:147], v[52:55], v[112:115], v[144:147]
    buffer_load_dwordx4 v[104:107], v3, s[52:55], s81 offen offset:2048 sc1
    v_mfma_f32_16x16x32_bf16 v[148:151], v[52:55], v[116:119], v[148:151]
    v_mfma_f32_16x16x32_bf16 v[152:155], v[52:55], v[120:123], v[152:155]
    buffer_load_dwordx4 v[108:111], v3, s[52:55], s81 offen offset:3072 sc1
    s_add_u32 s81, s81, 4096
    v_mfma_f32_16x16x32_bf16 v[156:159], v[52:55], v[124:127], v[156:159]
    v_mfma_f32_16x16x32_bf16 v[160:163], v[56:59], v[112:115], v[160:163]
    buffer_load_dwordx4 v[32:35], v3, s[52:55], s80 offen offset:0 sc1
    v_mfma_f32_16x16x32_bf16 v[164:167], v[56:59], v[116:119], v[164:167]
    v_mfma_f32_16x16x32_bf16 v[168:171], v[56:59], v[120:123], v[168:171]
    buffer_load_dwordx4 v[36:39], v3, s[52:55], s80 offen offset:1024 sc1
    v_mfma_f32_16x16x32_bf16 v[172:175], v[56:59], v[124:127], v[172:175]
    v_mfma_f32_16x16x32_bf16 v[176:179], v[60:63], v[112:115], v[176:179]
    buffer_load_dwordx4 v[40:43], v3, s[52:55], s80 offen offset:2048 sc1
    v_mfma_f32_16x16x32_bf16 v[180:183], v[60:63], v[116:119], v[180:183]
    v_mfma_f32_16x16x32_bf16 v[184:187], v[60:63], v[120:123], v[184:187]
    buffer_load_dwordx4 v[44:47], v3, s[52:55], s80 offen offset:3072 sc1
    s_add_u32 s80, s80, 4096
    v_mfma_f32_16x16x32_bf16 v[188:191], v[60:63], v[124:127], v[188:191]
    s_waitcnt vmcnt(28)
    v_mfma_f32_16x16x32_bf16 v[128:131], a[128:131], v[208:211], v[128:131]
    buffer_load_dwordx4 v[112:115], v3, s[52:55], s81 offen offset:0 sc1
    v_mfma_f32_16x16x32_bf16 v[132:135], a[128:131], v[212:215], v[132:135]
    v_mfma_f32_16x16x32_bf16 v[136:139], a[128:131], v[216:219], v[136:139]
    buffer_load_dwordx4 v[116:119], v3, s[52:55], s81 offen offset:1024 sc1
    v_mfma_f32_16x16x32_bf16 v[140:143], a[128:131], v[220:223], v[140:143]
    v_mfma_f32_16x16x32_bf16 v[144:147], a[132:135], v[208:211], v[144:147]
    buffer_load_dwordx4 v[120:123], v3, s[52:55], s81 offen offset:2048 sc1
    v_mfma_f32_16x16x32_bf16 v[148:151], a[132:135], v[212:215], v[148:151]
    v_mfma_f32_16x16x32_bf16 v[152:155], a[132:135], v[216:219], v[152:155]
    buffer_load_dwordx4 v[124:127], v3, s[52:55], s81 offen offset:3072 sc1
    s_add_u32 s81, s81, 4096
    v_mfma_f32_16x16x32_bf16 v[156:159], a[132:135], v[220:223], v[156:159]
    v_mfma_f32_16x16x32_bf16 v[160:163], a[136:139], v[208:211], v[160:163]
    buffer_load_dwordx4 v[48:51], v3, s[52:55], s80 offen offset:0 sc1
    v_mfma_f32_16x16x32_bf16 v[164:167], a[136:139], v[212:215], v[164:167]
    v_mfma_f32_16x16x32_bf16 v[168:171], a[136:139], v[216:219], v[168:171]
    buffer_load_dwordx4 v[52:55], v3, s[52:55], s80 offen offset:1024 sc1
    v_mfma_f32_16x16x32_bf16 v[172:175], a[136:139], v[220:223], v[172:175]
    v_mfma_f32_16x16x32_bf16 v[176:179], a[140:143], v[208:211], v[176:179]
    buffer_load_dwordx4 v[56:59], v3, s[52:55], s80 offen offset:2048 sc1
    v_mfma_f32_16x16x32_bf16 v[180:183], a[140:143], v[212:215], v[180:183]
    v_mfma_f32_16x16x32_bf16 v[184:187], a[140:143], v[216:219], v[184:187]
    buffer_load_dwordx4 v[60:63], v3, s[52:55], s80 offen offset:3072 sc1
    s_add_u32 s80, s80, 4096
    v_mfma_f32_16x16x32_bf16 v[188:191], a[140:143], v[220:223], v[188:191]
    s_waitcnt vmcnt(28)
    v_mfma_f32_16x16x32_bf16 v[128:131], a[144:147], v[64:67], v[128:131]
    buffer_load_dwordx4 v[208:211], v3, s[52:55], s81 offen offset:0 sc1
    v_mfma_f32_16x16x32_bf16 v[132:135], a[144:147], v[68:71], v[132:135]
    v_mfma_f32_16x16x32_bf16 v[136:139], a[144:147], v[72:75], v[136:139]
    buffer_load_dwordx4 v[212:215], v3, s[52:55], s81 offen offset:1024 sc1
    v_mfma_f32_16x16x32_bf16 v[140:143], a[144:147], v[76:79], v[140:143]
    v_mfma_f32_16x16x32_bf16 v[144:147], a[148:151], v[64:67], v[144:147]
    buffer_load_dwordx4 v[216:219], v3, s[52:55], s81 offen offset:2048 sc1
    v_mfma_f32_16x16x32_bf16 v[148:151], a[148:151], v[68:71], v[148:151]
    v_mfma_f32_16x16x32_bf16 v[152:155], a[148:151], v[72:75], v[152:155]
    buffer_load_dwordx4 v[220:223], v3, s[52:55], s81 offen offset:3072 sc1
    s_add_u32 s81, s81, 4096
    v_mfma_f32_16x16x32_bf16 v[156:159], a[148:151], v[76:79], v[156:159]
    v_mfma_f32_16x16x32_bf16 v[160:163], a[152:155], v[64:67], v[160:163]
    v_mfma_f32_16x16x32_bf16 v[164:167], a[152:155], v[68:71], v[164:167]
    v_mfma_f32_16x16x32_bf16 v[168:171], a[152:155], v[72:75], v[168:171]
    v_mfma_f32_16x16x32_bf16 v[172:175], a[152:155], v[76:79], v[172:175]
    v_mfma_f32_16x16x32_bf16 v[176:179], a[156:159], v[64:67], v[176:179]
    v_mfma_f32_16x16x32_bf16 v[180:183], a[156:159], v[68:71], v[180:183]
    v_mfma_f32_16x16x32_bf16 v[184:187], a[156:159], v[72:75], v[184:187]
    v_mfma_f32_16x16x32_bf16 v[188:191], a[156:159], v[76:79], v[188:191]
    s_waitcnt vmcnt(24)
    v_mfma_f32_16x16x32_bf16 v[128:131], a[160:163], v[80:83], v[128:131]
    buffer_load_dwordx4 v[64:67], v3, s[52:55], s81 offen offset:0 sc1
    v_mfma_f32_16x16x32_bf16 v[132:135], a[160:163], v[84:87], v[132:135]
    v_mfma_f32_16x16x32_bf16 v[136:139], a[160:163], v[88:91], v[136:139]
    buffer_load_dwordx4 v[68:71], v3, s[52:55], s81 offen offset:1024 sc1
    v_mfma_f32_16x16x32_bf16 v[140:143], a[160:163], v[92:95], v[140:143]
    v_mfma_f32_16x16x32_bf16 v[144:147], a[164:167], v[80:83], v[144:147]
    buffer_load_dwordx4 v[72:75], v3, s[52:55], s81 offen offset:2048 sc1
    v_mfma_f32_16x16x32_bf16 v[148:151], a[164:167], v[84:87], v[148:151]
    v_mfma_f32_16x16x32_bf16 v[152:155], a[164:167], v[88:91], v[152:155]
    buffer_load_dwordx4 v[76:79], v3, s[52:55], s81 offen offset:3072 sc1
    s_add_u32 s81, s81, 4096
    v_mfma_f32_16x16x32_bf16 v[156:159], a[164:167], v[92:95], v[156:159]
    v_mfma_f32_16x16x32_bf16 v[160:163], a[168:171], v[80:83], v[160:163]
    v_mfma_f32_16x16x32_bf16 v[164:167], a[168:171], v[84:87], v[164:167]
    v_mfma_f32_16x16x32_bf16 v[168:171], a[168:171], v[88:91], v[168:171]
    v_mfma_f32_16x16x32_bf16 v[172:175], a[168:171], v[92:95], v[172:175]
    v_mfma_f32_16x16x32_bf16 v[176:179], a[172:175], v[80:83], v[176:179]
    v_mfma_f32_16x16x32_bf16 v[180:183], a[172:175], v[84:87], v[180:183]
    v_mfma_f32_16x16x32_bf16 v[184:187], a[172:175], v[88:91], v[184:187]
    v_mfma_f32_16x16x32_bf16 v[188:191], a[172:175], v[92:95], v[188:191]
    s_waitcnt vmcnt(20)
    v_mfma_f32_16x16x32_bf16 v[128:131], a[176:179], v[96:99], v[128:131]
    buffer_load_dwordx4 v[80:83], v3, s[52:55], s81 offen offset:0 sc1
    v_mfma_f32_16x16x32_bf16 v[132:135], a[176:179], v[100:103], v[132:135]
    v_mfma_f32_16x16x32_bf16 v[136:139], a[176:179], v[104:107], v[136:139]
    buffer_load_dwordx4 v[84:87], v3, s[52:55], s81 offen offset:1024 sc1
    v_mfma_f32_16x16x32_bf16 v[140:143], a[176:179], v[108:111], v[140:143]
    v_mfma_f32_16x16x32_bf16 v[144:147], a[180:183], v[96:99], v[144:147]
    buffer_load_dwordx4 v[88:91], v3, s[52:55], s81 offen offset:2048 sc1
    v_mfma_f32_16x16x32_bf16 v[148:151], a[180:183], v[100:103], v[148:151]
    v_mfma_f32_16x16x32_bf16 v[152:155], a[180:183], v[104:107], v[152:155]
    buffer_load_dwordx4 v[92:95], v3, s[52:55], s81 offen offset:3072 sc1
    s_add_u32 s81, s81, 4096
    v_mfma_f32_16x16x32_bf16 v[156:159], a[180:183], v[108:111], v[156:159]
    v_mfma_f32_16x16x32_bf16 v[160:163], a[184:187], v[96:99], v[160:163]
    v_mfma_f32_16x16x32_bf16 v[164:167], a[184:187], v[100:103], v[164:167]
    v_mfma_f32_16x16x32_bf16 v[168:171], a[184:187], v[104:107], v[168:171]
    v_mfma_f32_16x16x32_bf16 v[172:175], a[184:187], v[108:111], v[172:175]
    v_mfma_f32_16x16x32_bf16 v[176:179], a[188:191], v[96:99], v[176:179]
    v_mfma_f32_16x16x32_bf16 v[180:183], a[188:191], v[100:103], v[180:183]
    v_mfma_f32_16x16x32_bf16 v[184:187], a[188:191], v[104:107], v[184:187]
    v_mfma_f32_16x16x32_bf16 v[188:191], a[188:191], v[108:111], v[188:191]
    s_waitcnt vmcnt(16)
    v_mfma_f32_16x16x32_bf16 v[128:131], a[224:227], v[112:115], v[128:131]
    buffer_load_dwordx4 v[96:99], v3, s[52:55], s81 offen offset:0 sc1
    v_mfma_f32_16x16x32_bf16 v[132:135], a[224:227], v[116:119], v[132:135]
    v_mfma_f32_16x16x32_bf16 v[136:139], a[224:227], v[120:123], v[136:139]
    buffer_load_dwordx4 v[100:103], v3, s[52:55], s81 offen offset:1024 sc1
    v_mfma_f32_16x16x32_bf16 v[140:143], a[224:227], v[124:127], v[140:143]
    v_mfma_f32_16x16x32_bf16 v[144:147], a[228:231], v[112:115], v[144:147]
    buffer_load_dwordx4 v[104:107], v3, s[52:55], s81 offen offset:2048 sc1
    v_mfma_f32_16x16x32_bf16 v[148:151], a[228:231], v[116:119], v[148:151]
    v_mfma_f32_16x16x32_bf16 v[152:155], a[228:231], v[120:123], v[152:155]
    buffer_load_dwordx4 v[108:111], v3, s[52:55], s81 offen offset:3072 sc1
    s_add_u32 s81, s81, 4096
    v_mfma_f32_16x16x32_bf16 v[156:159], a[228:231], v[124:127], v[156:159]
    v_mfma_f32_16x16x32_bf16 v[160:163], a[232:235], v[112:115], v[160:163]
    v_mfma_f32_16x16x32_bf16 v[164:167], a[232:235], v[116:119], v[164:167]
    v_mfma_f32_16x16x32_bf16 v[168:171], a[232:235], v[120:123], v[168:171]
    v_mfma_f32_16x16x32_bf16 v[172:175], a[232:235], v[124:127], v[172:175]
    v_mfma_f32_16x16x32_bf16 v[176:179], a[236:239], v[112:115], v[176:179]
    v_mfma_f32_16x16x32_bf16 v[180:183], a[236:239], v[116:119], v[180:183]
    v_mfma_f32_16x16x32_bf16 v[184:187], a[236:239], v[120:123], v[184:187]
    v_mfma_f32_16x16x32_bf16 v[188:191], a[236:239], v[124:127], v[188:191]
    s_waitcnt vmcnt(12)
    v_mfma_f32_16x16x32_bf16 v[128:131], a[240:243], v[208:211], v[128:131]
    buffer_load_dwordx4 v[112:115], v3, s[52:55], s81 offen offset:0 sc1
    v_mfma_f32_16x16x32_bf16 v[132:135], a[240:243], v[212:215], v[132:135]
    v_mfma_f32_16x16x32_bf16 v[136:139], a[240:243], v[216:219], v[136:139]
    buffer_load_dwordx4 v[116:119], v3, s[52:55], s81 offen offset:1024 sc1
    v_mfma_f32_16x16x32_bf16 v[140:143], a[240:243], v[220:223], v[140:143]
    v_mfma_f32_16x16x32_bf16 v[144:147], a[244:247], v[208:211], v[144:147]
    buffer_load_dwordx4 v[120:123], v3, s[52:55], s81 offen offset:2048 sc1
    v_mfma_f32_16x16x32_bf16 v[148:151], a[244:247], v[212:215], v[148:151]
    v_mfma_f32_16x16x32_bf16 v[152:155], a[244:247], v[216:219], v[152:155]
    buffer_load_dwordx4 v[124:127], v3, s[52:55], s81 offen offset:3072 sc1
    s_add_u32 s81, s81, 4096
    v_mfma_f32_16x16x32_bf16 v[156:159], a[244:247], v[220:223], v[156:159]
    v_mfma_f32_16x16x32_bf16 v[160:163], a[248:251], v[208:211], v[160:163]
    v_mfma_f32_16x16x32_bf16 v[164:167], a[248:251], v[212:215], v[164:167]
    v_mfma_f32_16x16x32_bf16 v[168:171], a[248:251], v[216:219], v[168:171]
    v_mfma_f32_16x16x32_bf16 v[172:175], a[248:251], v[220:223], v[172:175]
    v_mfma_f32_16x16x32_bf16 v[176:179], a[252:255], v[208:211], v[176:179]
    v_mfma_f32_16x16x32_bf16 v[180:183], a[252:255], v[212:215], v[180:183]
    v_mfma_f32_16x16x32_bf16 v[184:187], a[252:255], v[216:219], v[184:187]
    v_mfma_f32_16x16x32_bf16 v[188:191], a[252:255], v[220:223], v[188:191]
    s_waitcnt vmcnt(12)
    v_mfma_f32_16x16x32_bf16 v[128:131], a[64:67], v[64:67], v[128:131]
    buffer_load_dwordx4 v[208:211], v3, s[52:55], s81 offen offset:0 sc1
    v_mfma_f32_16x16x32_bf16 v[132:135], a[64:67], v[68:71], v[132:135]
    v_mfma_f32_16x16x32_bf16 v[136:139], a[64:67], v[72:75], v[136:139]
    buffer_load_dwordx4 v[212:215], v3, s[52:55], s81 offen offset:1024 sc1
    v_mfma_f32_16x16x32_bf16 v[140:143], a[64:67], v[76:79], v[140:143]
    v_mfma_f32_16x16x32_bf16 v[144:147], a[68:71], v[64:67], v[144:147]
    buffer_load_dwordx4 v[216:219], v3, s[52:55], s81 offen offset:2048 sc1
    v_mfma_f32_16x16x32_bf16 v[148:151], a[68:71], v[68:71], v[148:151]
    v_mfma_f32_16x16x32_bf16 v[152:155], a[68:71], v[72:75], v[152:155]
    buffer_load_dwordx4 v[220:223], v3, s[52:55], s81 offen offset:3072 sc1
    s_add_u32 s81, s81, 4096
    v_mfma_f32_16x16x32_bf16 v[156:159], a[68:71], v[76:79], v[156:159]
    v_mfma_f32_16x16x32_bf16 v[160:163], a[72:75], v[64:67], v[160:163]
    v_mfma_f32_16x16x32_bf16 v[164:167], a[72:75], v[68:71], v[164:167]
    v_mfma_f32_16x16x32_bf16 v[168:171], a[72:75], v[72:75], v[168:171]
    v_mfma_f32_16x16x32_bf16 v[172:175], a[72:75], v[76:79], v[172:175]
    v_mfma_f32_16x16x32_bf16 v[176:179], a[76:79], v[64:67], v[176:179]
    v_mfma_f32_16x16x32_bf16 v[180:183], a[76:79], v[68:71], v[180:183]
    v_mfma_f32_16x16x32_bf16 v[184:187], a[76:79], v[72:75], v[184:187]
    v_mfma_f32_16x16x32_bf16 v[188:191], a[76:79], v[76:79], v[188:191]
    s_waitcnt vmcnt(12)
    v_mfma_f32_16x16x32_bf16 v[128:131], a[80:83], v[80:83], v[128:131]
    buffer_load_dwordx4 v[64:67], v3, s[52:55], s81 offen offset:0 sc1
    v_mfma_f32_16x16x32_bf16 v[132:135], a[80:83], v[84:87], v[132:135]
    v_mfma_f32_16x16x32_bf16 v[136:139], a[80:83], v[88:91], v[136:139]
    buffer_load_dwordx4 v[68:71], v3, s[52:55], s81 offen offset:1024 sc1
    v_mfma_f32_16x16x32_bf16 v[140:143], a[80:83], v[92:95], v[140:143]
    v_mfma_f32_16x16x32_bf16 v[144:147], a[84:87], v[80:83], v[144:147]
    buffer_load_dwordx4 v[72:75], v3, s[52:55], s81 offen offset:2048 sc1
    v_mfma_f32_16x16x32_bf16 v[148:151], a[84:87], v[84:87], v[148:151]
    v_mfma_f32_16x16x32_bf16 v[152:155], a[84:87], v[88:91], v[152:155]
    buffer_load_dwordx4 v[76:79], v3, s[52:55], s81 offen offset:3072 sc1
    s_add_u32 s81, s81, 4096
    v_mfma_f32_16x16x32_bf16 v[156:159], a[84:87], v[92:95], v[156:159]
    v_mfma_f32_16x16x32_bf16 v[160:163], a[88:91], v[80:83], v[160:163]
    v_mfma_f32_16x16x32_bf16 v[164:167], a[88:91], v[84:87], v[164:167]
    v_mfma_f32_16x16x32_bf16 v[168:171], a[88:91], v[88:91], v[168:171]
    v_mfma_f32_16x16x32_bf16 v[172:175], a[88:91], v[92:95], v[172:175]
    v_mfma_f32_16x16x32_bf16 v[176:179], a[92:95], v[80:83], v[176:179]
    v_mfma_f32_16x16x32_bf16 v[180:183], a[92:95], v[84:87], v[180:183]
    v_mfma_f32_16x16x32_bf16 v[184:187], a[92:95], v[88:91], v[184:187]
    v_mfma_f32_16x16x32_bf16 v[188:191], a[92:95], v[92:95], v[188:191]
    s_waitcnt vmcnt(12)
    v_mfma_f32_16x16x32_bf16 v[128:131], a[208:211], v[96:99], v[128:131]
    buffer_load_dwordx4 v[80:83], v3, s[52:55], s81 offen offset:0 sc1
    v_mfma_f32_16x16x32_bf16 v[132:135], a[208:211], v[100:103], v[132:135]
    v_mfma_f32_16x16x32_bf16 v[136:139], a[208:211], v[104:107], v[136:139]
    buffer_load_dwordx4 v[84:87], v3, s[52:55], s81 offen offset:1024 sc1
    v_mfma_f32_16x16x32_bf16 v[140:143], a[208:211], v[108:111], v[140:143]
    v_mfma_f32_16x16x32_bf16 v[144:147], a[212:215], v[96:99], v[144:147]
    buffer_load_dwordx4 v[88:91], v3, s[52:55], s81 offen offset:2048 sc1
    v_mfma_f32_16x16x32_bf16 v[148:151], a[212:215], v[100:103], v[148:151]
    v_mfma_f32_16x16x32_bf16 v[152:155], a[212:215], v[104:107], v[152:155]
    buffer_load_dwordx4 v[92:95], v3, s[52:55], s81 offen offset:3072 sc1
    s_add_u32 s81, s81, 4096
    v_mfma_f32_16x16x32_bf16 v[156:159], a[212:215], v[108:111], v[156:159]
    v_mfma_f32_16x16x32_bf16 v[160:163], a[216:219], v[96:99], v[160:163]
    v_mfma_f32_16x16x32_bf16 v[164:167], a[216:219], v[100:103], v[164:167]
    v_mfma_f32_16x16x32_bf16 v[168:171], a[216:219], v[104:107], v[168:171]
    v_mfma_f32_16x16x32_bf16 v[172:175], a[216:219], v[108:111], v[172:175]
    v_mfma_f32_16x16x32_bf16 v[176:179], a[220:223], v[96:99], v[176:179]
    v_mfma_f32_16x16x32_bf16 v[180:183], a[220:223], v[100:103], v[180:183]
    v_mfma_f32_16x16x32_bf16 v[184:187], a[220:223], v[104:107], v[184:187]
    v_mfma_f32_16x16x32_bf16 v[188:191], a[220:223], v[108:111], v[188:191]
    s_waitcnt vmcnt(12)
    v_mfma_f32_16x16x32_bf16 v[128:131], a[192:195], v[112:115], v[128:131]
    buffer_load_dwordx4 v[96:99], v3, s[52:55], s81 offen offset:0 sc1
    v_mfma_f32_16x16x32_bf16 v[132:135], a[192:195], v[116:119], v[132:135]
    v_mfma_f32_16x16x32_bf16 v[136:139], a[192:195], v[120:123], v[136:139]
    buffer_load_dwordx4 v[100:103], v3, s[52:55], s81 offen offset:1024 sc1
    v_mfma_f32_16x16x32_bf16 v[140:143], a[192:195], v[124:127], v[140:143]
    v_mfma_f32_16x16x32_bf16 v[144:147], a[196:199], v[112:115], v[144:147]
    buffer_load_dwordx4 v[104:107], v3, s[52:55], s81 offen offset:2048 sc1
    v_mfma_f32_16x16x32_bf16 v[148:151], a[196:199], v[116:119], v[148:151]
    v_mfma_f32_16x16x32_bf16 v[152:155], a[196:199], v[120:123], v[152:155]
    buffer_load_dwordx4 v[108:111], v3, s[52:55], s81 offen offset:3072 sc1
    s_add_u32 s81, s81, 4096
    v_mfma_f32_16x16x32_bf16 v[156:159], a[196:199], v[124:127], v[156:159]
    v_mfma_f32_16x16x32_bf16 v[160:163], a[200:203], v[112:115], v[160:163]
    v_mfma_f32_16x16x32_bf16 v[164:167], a[200:203], v[116:119], v[164:167]
    v_mfma_f32_16x16x32_bf16 v[168:171], a[200:203], v[120:123], v[168:171]
    v_mfma_f32_16x16x32_bf16 v[172:175], a[200:203], v[124:127], v[172:175]
    v_mfma_f32_16x16x32_bf16 v[176:179], a[204:207], v[112:115], v[176:179]
    v_mfma_f32_16x16x32_bf16 v[180:183], a[204:207], v[116:119], v[180:183]
    v_mfma_f32_16x16x32_bf16 v[184:187], a[204:207], v[120:123], v[184:187]
    v_mfma_f32_16x16x32_bf16 v[188:191], a[204:207], v[124:127], v[188:191]
    s_waitcnt vmcnt(12)
    v_mfma_f32_16x16x32_bf16 v[128:131], a[96:99], v[208:211], v[128:131]
    buffer_load_dwordx4 v[112:115], v3, s[52:55], s81 offen offset:0 sc1
    v_mfma_f32_16x16x32_bf16 v[132:135], a[96:99], v[212:215], v[132:135]
    v_mfma_f32_16x16x32_bf16 v[136:139], a[96:99], v[216:219], v[136:139]
    buffer_load_dwordx4 v[116:119], v3, s[52:55], s81 offen offset:1024 sc1
    v_mfma_f32_16x16x32_bf16 v[140:143], a[96:99], v[220:223], v[140:143]
    v_mfma_f32_16x16x32_bf16 v[144:147], a[100:103], v[208:211], v[144:147]
    buffer_load_dwordx4 v[120:123], v3, s[52:55], s81 offen offset:2048 sc1
    v_mfma_f32_16x16x32_bf16 v[148:151], a[100:103], v[212:215], v[148:151]
    v_mfma_f32_16x16x32_bf16 v[152:155], a[100:103], v[216:219], v[152:155]
    buffer_load_dwordx4 v[124:127], v3, s[52:55], s81 offen offset:3072 sc1
    s_add_u32 s81, s81, 4096
    v_mfma_f32_16x16x32_bf16 v[156:159], a[100:103], v[220:223], v[156:159]
    v_mfma_f32_16x16x32_bf16 v[160:163], a[104:107], v[208:211], v[160:163]
    v_mfma_f32_16x16x32_bf16 v[164:167], a[104:107], v[212:215], v[164:167]
    v_mfma_f32_16x16x32_bf16 v[168:171], a[104:107], v[216:219], v[168:171]
    v_mfma_f32_16x16x32_bf16 v[172:175], a[104:107], v[220:223], v[172:175]
    v_mfma_f32_16x16x32_bf16 v[176:179], a[108:111], v[208:211], v[176:179]
    v_mfma_f32_16x16x32_bf16 v[180:183], a[108:111], v[212:215], v[180:183]
    v_mfma_f32_16x16x32_bf16 v[184:187], a[108:111], v[216:219], v[184:187]
    v_mfma_f32_16x16x32_bf16 v[188:191], a[108:111], v[220:223], v[188:191]
    s_waitcnt vmcnt(12)
    v_mfma_f32_16x16x32_bf16 v[128:131], a[112:115], v[64:67], v[128:131]
    buffer_load_dwordx4 v[208:211], v3, s[52:55], s81 offen offset:0 sc1
    v_mfma_f32_16x16x32_bf16 v[132:135], a[112:115], v[68:71], v[132:135]
    v_mfma_f32_16x16x32_bf16 v[136:139], a[112:115], v[72:75], v[136:139]
    buffer_load_dwordx4 v[212:215], v3, s[52:55], s81 offen offset:1024 sc1
    v_mfma_f32_16x16x32_bf16 v[140:143], a[112:115], v[76:79], v[140:143]
    v_mfma_f32_16x16x32_bf16 v[144:147], a[116:119], v[64:67], v[144:147]
    buffer_load_dwordx4 v[216:219], v3, s[52:55], s81 offen offset:2048 sc1
    v_mfma_f32_16x16x32_bf16 v[148:151], a[116:119], v[68:71], v[148:151]
    v_mfma_f32_16x16x32_bf16 v[152:155], a[116:119], v[72:75], v[152:155]
    buffer_load_dwordx4 v[220:223], v3, s[52:55], s81 offen offset:3072 sc1
    s_add_u32 s81, s81, 4096
    v_mfma_f32_16x16x32_bf16 v[156:159], a[116:119], v[76:79], v[156:159]
    v_mfma_f32_16x16x32_bf16 v[160:163], a[120:123], v[64:67], v[160:163]
    v_mfma_f32_16x16x32_bf16 v[164:167], a[120:123], v[68:71], v[164:167]
    v_mfma_f32_16x16x32_bf16 v[168:171], a[120:123], v[72:75], v[168:171]
    v_mfma_f32_16x16x32_bf16 v[172:175], a[120:123], v[76:79], v[172:175]
    v_mfma_f32_16x16x32_bf16 v[176:179], a[124:127], v[64:67], v[176:179]
    v_mfma_f32_16x16x32_bf16 v[180:183], a[124:127], v[68:71], v[180:183]
    v_mfma_f32_16x16x32_bf16 v[184:187], a[124:127], v[72:75], v[184:187]
    v_mfma_f32_16x16x32_bf16 v[188:191], a[124:127], v[76:79], v[188:191]
    s_waitcnt vmcnt(12)
    v_mfma_f32_16x16x32_bf16 v[128:131], a[0:3], v[80:83], v[128:131]
    buffer_load_dwordx4 v[64:67], v3, s[52:55], s81 offen offset:0 sc1
    v_mfma_f32_16x16x32_bf16 v[132:135], a[0:3], v[84:87], v[132:135]
    v_mfma_f32_16x16x32_bf16 v[136:139], a[0:3], v[88:91], v[136:139]
    buffer_load_dwordx4 v[68:71], v3, s[52:55], s81 offen offset:1024 sc1
    v_mfma_f32_16x16x32_bf16 v[140:143], a[0:3], v[92:95], v[140:143]
    v_mfma_f32_16x16x32_bf16 v[144:147], a[4:7], v[80:83], v[144:147]
    buffer_load_dwordx4 v[72:75], v3, s[52:55], s81 offen offset:2048 sc1
    v_mfma_f32_16x16x32_bf16 v[148:151], a[4:7], v[84:87], v[148:151]
    v_mfma_f32_16x16x32_bf16 v[152:155], a[4:7], v[88:91], v[152:155]
    buffer_load_dwordx4 v[76:79], v3, s[52:55], s81 offen offset:3072 sc1
    s_add_u32 s81, s81, 4096
    v_mfma_f32_16x16x32_bf16 v[156:159], a[4:7], v[92:95], v[156:159]
    v_mfma_f32_16x16x32_bf16 v[160:163], a[8:11], v[80:83], v[160:163]
    v_mfma_f32_16x16x32_bf16 v[164:167], a[8:11], v[84:87], v[164:167]
    v_mfma_f32_16x16x32_bf16 v[168:171], a[8:11], v[88:91], v[168:171]
    v_mfma_f32_16x16x32_bf16 v[172:175], a[8:11], v[92:95], v[172:175]
    v_mfma_f32_16x16x32_bf16 v[176:179], a[12:15], v[80:83], v[176:179]
    v_mfma_f32_16x16x32_bf16 v[180:183], a[12:15], v[84:87], v[180:183]
    v_mfma_f32_16x16x32_bf16 v[184:187], a[12:15], v[88:91], v[184:187]
    v_mfma_f32_16x16x32_bf16 v[188:191], a[12:15], v[92:95], v[188:191]
    s_waitcnt vmcnt(12)
    v_mfma_f32_16x16x32_bf16 v[128:131], a[16:19], v[96:99], v[128:131]
    buffer_load_dwordx4 v[80:83], v3, s[52:55], s81 offen offset:0 sc1
    v_mfma_f32_16x16x32_bf16 v[132:135], a[16:19], v[100:103], v[132:135]
    v_mfma_f32_16x16x32_bf16 v[136:139], a[16:19], v[104:107], v[136:139]
    buffer_load_dwordx4 v[84:87], v3, s[52:55], s81 offen offset:1024 sc1
    v_mfma_f32_16x16x32_bf16 v[140:143], a[16:19], v[108:111], v[140:143]
    v_mfma_f32_16x16x32_bf16 v[144:147], a[20:23], v[96:99], v[144:147]
    buffer_load_dwordx4 v[88:91], v3, s[52:55], s81 offen offset:2048 sc1
    v_mfma_f32_16x16x32_bf16 v[148:151], a[20:23], v[100:103], v[148:151]
    v_mfma_f32_16x16x32_bf16 v[152:155], a[20:23], v[104:107], v[152:155]
    buffer_load_dwordx4 v[92:95], v3, s[52:55], s81 offen offset:3072 sc1
    s_add_u32 s81, s81, 4096
    v_mfma_f32_16x16x32_bf16 v[156:159], a[20:23], v[108:111], v[156:159]
    v_mfma_f32_16x16x32_bf16 v[160:163], a[24:27], v[96:99], v[160:163]
    v_mfma_f32_16x16x32_bf16 v[164:167], a[24:27], v[100:103], v[164:167]
    v_mfma_f32_16x16x32_bf16 v[168:171], a[24:27], v[104:107], v[168:171]
    v_mfma_f32_16x16x32_bf16 v[172:175], a[24:27], v[108:111], v[172:175]
    v_mfma_f32_16x16x32_bf16 v[176:179], a[28:31], v[96:99], v[176:179]
    v_mfma_f32_16x16x32_bf16 v[180:183], a[28:31], v[100:103], v[180:183]
    v_mfma_f32_16x16x32_bf16 v[184:187], a[28:31], v[104:107], v[184:187]
    v_mfma_f32_16x16x32_bf16 v[188:191], a[28:31], v[108:111], v[188:191]
    s_waitcnt vmcnt(12)
    v_mfma_f32_16x16x32_bf16 v[128:131], a[32:35], v[112:115], v[128:131]
    v_mfma_f32_16x16x32_bf16 v[132:135], a[32:35], v[116:119], v[132:135]
    v_mfma_f32_16x16x32_bf16 v[136:139], a[32:35], v[120:123], v[136:139]
    v_mfma_f32_16x16x32_bf16 v[140:143], a[32:35], v[124:127], v[140:143]
    v_mfma_f32_16x16x32_bf16 v[144:147], a[36:39], v[112:115], v[144:147]
    v_mfma_f32_16x16x32_bf16 v[148:151], a[36:39], v[116:119], v[148:151]
    v_mfma_f32_16x16x32_bf16 v[152:155], a[36:39], v[120:123], v[152:155]
    v_mfma_f32_16x16x32_bf16 v[156:159], a[36:39], v[124:127], v[156:159]
    v_mfma_f32_16x16x32_bf16 v[160:163], a[40:43], v[112:115], v[160:163]
    v_mfma_f32_16x16x32_bf16 v[164:167], a[40:43], v[116:119], v[164:167]
    v_mfma_f32_16x16x32_bf16 v[168:171], a[40:43], v[120:123], v[168:171]
    v_mfma_f32_16x16x32_bf16 v[172:175], a[40:43], v[124:127], v[172:175]
    v_mfma_f32_16x16x32_bf16 v[176:179], a[44:47], v[112:115], v[176:179]
    v_mfma_f32_16x16x32_bf16 v[180:183], a[44:47], v[116:119], v[180:183]
    v_mfma_f32_16x16x32_bf16 v[184:187], a[44:47], v[120:123], v[184:187]
    v_mfma_f32_16x16x32_bf16 v[188:191], a[44:47], v[124:127], v[188:191]
    s_waitcnt vmcnt(8)
    v_mfma_f32_16x16x32_bf16 v[128:131], a[48:51], v[208:211], v[128:131]
    v_mfma_f32_16x16x32_bf16 v[132:135], a[48:51], v[212:215], v[132:135]
    v_mfma_f32_16x16x32_bf16 v[136:139], a[48:51], v[216:219], v[136:139]
    v_mfma_f32_16x16x32_bf16 v[140:143], a[48:51], v[220:223], v[140:143]
    v_mfma_f32_16x16x32_bf16 v[144:147], a[52:55], v[208:211], v[144:147]
    v_mfma_f32_16x16x32_bf16 v[148:151], a[52:55], v[212:215], v[148:151]
    v_mfma_f32_16x16x32_bf16 v[152:155], a[52:55], v[216:219], v[152:155]
    v_mfma_f32_16x16x32_bf16 v[156:159], a[52:55], v[220:223], v[156:159]
    v_mfma_f32_16x16x32_bf16 v[160:163], a[56:59], v[208:211], v[160:163]
    v_mfma_f32_16x16x32_bf16 v[164:167], a[56:59], v[212:215], v[164:167]
    v_mfma_f32_16x16x32_bf16 v[168:171], a[56:59], v[216:219], v[168:171]
    v_mfma_f32_16x16x32_bf16 v[172:175], a[56:59], v[220:223], v[172:175]
    v_mfma_f32_16x16x32_bf16 v[176:179], a[60:63], v[208:211], v[176:179]
    v_mfma_f32_16x16x32_bf16 v[180:183], a[60:63], v[212:215], v[180:183]
    v_mfma_f32_16x16x32_bf16 v[184:187], a[60:63], v[216:219], v[184:187]
    v_mfma_f32_16x16x32_bf16 v[188:191], a[60:63], v[220:223], v[188:191]
    s_waitcnt vmcnt(4)
    v_mfma_f32_16x16x32_bf16 v[128:131], v[32:35], v[64:67], v[128:131]
    v_mfma_f32_16x16x32_bf16 v[132:135], v[32:35], v[68:71], v[132:135]
    v_mfma_f32_16x16x32_bf16 v[136:139], v[32:35], v[72:75], v[136:139]
    v_mfma_f32_16x16x32_bf16 v[140:143], v[32:35], v[76:79], v[140:143]
    v_mfma_f32_16x16x32_bf16 v[144:147], v[36:39], v[64:67], v[144:147]
    v_mfma_f32_16x16x32_bf16 v[148:151], v[36:39], v[68:71], v[148:151]
    v_mfma_f32_16x16x32_bf16 v[152:155], v[36:39], v[72:75], v[152:155]
    v_mfma_f32_16x16x32_bf16 v[156:159], v[36:39], v[76:79], v[156:159]
    v_mfma_f32_16x16x32_bf16 v[160:163], v[40:43], v[64:67], v[160:163]
    v_mfma_f32_16x16x32_bf16 v[164:167], v[40:43], v[68:71], v[164:167]
    v_mfma_f32_16x16x32_bf16 v[168:171], v[40:43], v[72:75], v[168:171]
    v_mfma_f32_16x16x32_bf16 v[172:175], v[40:43], v[76:79], v[172:175]
    v_mfma_f32_16x16x32_bf16 v[176:179], v[44:47], v[64:67], v[176:179]
    v_mfma_f32_16x16x32_bf16 v[180:183], v[44:47], v[68:71], v[180:183]
    v_mfma_f32_16x16x32_bf16 v[184:187], v[44:47], v[72:75], v[184:187]
    v_mfma_f32_16x16x32_bf16 v[188:191], v[44:47], v[76:79], v[188:191]
    s_waitcnt vmcnt(0)
    v_mfma_f32_16x16x32_bf16 v[128:131], v[48:51], v[80:83], v[128:131]
    v_mfma_f32_16x16x32_bf16 v[132:135], v[48:51], v[84:87], v[132:135]
    v_mfma_f32_16x16x32_bf16 v[136:139], v[48:51], v[88:91], v[136:139]
    v_mfma_f32_16x16x32_bf16 v[140:143], v[48:51], v[92:95], v[140:143]
    v_mfma_f32_16x16x32_bf16 v[144:147], v[52:55], v[80:83], v[144:147]
    v_mfma_f32_16x16x32_bf16 v[148:151], v[52:55], v[84:87], v[148:151]
    v_mfma_f32_16x16x32_bf16 v[152:155], v[52:55], v[88:91], v[152:155]
    v_mfma_f32_16x16x32_bf16 v[156:159], v[52:55], v[92:95], v[156:159]
    v_mfma_f32_16x16x32_bf16 v[160:163], v[56:59], v[80:83], v[160:163]
    ds_write_b128 v16, v[128:131] offset:0
    v_mfma_f32_16x16x32_bf16 v[164:167], v[56:59], v[84:87], v[164:167]
    ds_write_b128 v16, v[132:135] offset:4096
    v_mfma_f32_16x16x32_bf16 v[168:171], v[56:59], v[88:91], v[168:171]
    ds_write_b128 v16, v[136:139] offset:8192
    v_mfma_f32_16x16x32_bf16 v[172:175], v[56:59], v[92:95], v[172:175]
    ds_write_b128 v16, v[140:143] offset:12288
    v_mfma_f32_16x16x32_bf16 v[176:179], v[60:63], v[80:83], v[176:179]
    ds_write_b128 v18, v[144:147] offset:1024
    v_mfma_f32_16x16x32_bf16 v[180:183], v[60:63], v[84:87], v[180:183]
    ds_write_b128 v18, v[148:151] offset:5120
    v_mfma_f32_16x16x32_bf16 v[184:187], v[60:63], v[88:91], v[184:187]
    ds_write_b128 v18, v[152:155] offset:9216
    v_mfma_f32_16x16x32_bf16 v[188:191], v[60:63], v[92:95], v[188:191]
    ds_write_b128 v18, v[156:159] offset:13312
    ds_write_b128 v16, v[160:163] offset:2048
    ds_write_b128 v16, v[164:167] offset:6144
    ds_write_b128 v16, v[168:171] offset:10240
    ds_write_b128 v16, v[172:175] offset:14336
    s_nop 1
    ds_write_b128 v18, v[176:179] offset:3072
    s_nop 1
    ds_write_b128 v18, v[180:183] offset:7168
    s_nop 1
    ds_write_b128 v18, v[184:187] offset:11264
    s_nop 1
    ds_write_b128 v18, v[188:191] offset:15360
    v_lshlrev_b32 v208, 16, v8
    v_and_b32 v209, 0xffff0000, v8
    v_lshlrev_b32 v210, 16, v9
    v_and_b32 v211, 0xffff0000, v9
    v_lshlrev_b32 v212, 16, v10
    v_and_b32 v213, 0xffff0000, v10
    v_lshlrev_b32 v214, 16, v11
    v_and_b32 v215, 0xffff0000, v11
    v_lshlrev_b32 v216, 16, v12
    v_and_b32 v217, 0xffff0000, v12
    v_lshlrev_b32 v218, 16, v13
    v_and_b32 v219, 0xffff0000, v13
    v_lshlrev_b32 v220, 16, v14
    v_and_b32 v221, 0xffff0000, v14
    v_lshlrev_b32 v222, 16, v15
    v_and_b32 v223, 0xffff0000, v15
    s_waitcnt lgkmcnt(0)
    s_barrier
    ds_read_b128 v[128:131], v24 offset:0
    ds_read_b128 v[132:135], v24 offset:256
    ds_read_b128 v[136:139], v19 offset:0
    ds_read_b128 v[140:143], v19 offset:256
    ds_read_b128 v[144:147], v24 offset:16384
    ds_read_b128 v[148:151], v24 offset:16640
    ds_read_b128 v[152:155], v19 offset:16384
    ds_read_b128 v[156:159], v19 offset:16640
    ds_read_b128 v[160:163], v17 offset:0
    ds_read_b128 v[164:167], v17 offset:256
    ds_read_b128 v[168:171], v20 offset:0
    ds_read_b128 v[172:175], v20 offset:256
    ds_read_b128 v[176:179], v17 offset:16384
    ds_read_b128 v[180:183], v17 offset:16640
    ds_read_b128 v[184:187], v20 offset:16384
    ds_read_b128 v[188:191], v20 offset:16640
    s_waitcnt lgkmcnt(8)
    v_pk_add_f32 v[128:129], v[128:129], v[144:145]
    v_pk_add_f32 v[130:131], v[130:131], v[146:147]
    v_pk_add_f32 v[132:133], v[132:133], v[148:149]
    v_pk_add_f32 v[134:135], v[134:135], v[150:151]
    v_pk_add_f32 v[136:137], v[136:137], v[152:153]
    v_pk_add_f32 v[138:139], v[138:139], v[154:155]
    v_pk_add_f32 v[140:141], v[140:141], v[156:157]
    v_pk_add_f32 v[142:143], v[142:143], v[158:159]
    s_waitcnt lgkmcnt(4)
    v_pk_add_f32 v[128:129], v[128:129], v[160:161]
    v_pk_add_f32 v[130:131], v[130:131], v[162:163]
    v_pk_add_f32 v[132:133], v[132:133], v[164:165]
    v_pk_add_f32 v[134:135], v[134:135], v[166:167]
    v_pk_add_f32 v[136:137], v[136:137], v[168:169]
    v_pk_add_f32 v[138:139], v[138:139], v[170:171]
    v_pk_add_f32 v[140:141], v[140:141], v[172:173]
    v_pk_add_f32 v[142:143], v[142:143], v[174:175]
    s_waitcnt lgkmcnt(0)
    v_pk_add_f32 v[128:129], v[128:129], v[176:177]
    v_pk_add_f32 v[130:131], v[130:131], v[178:179]
    v_pk_add_f32 v[132:133], v[132:133], v[180:181]
    v_pk_add_f32 v[134:135], v[134:135], v[182:183]
    v_pk_add_f32 v[136:137], v[136:137], v[184:185]
    v_pk_add_f32 v[138:139], v[138:139], v[186:187]
    v_pk_add_f32 v[140:141], v[140:141], v[188:189]
    v_pk_add_f32 v[142:143], v[142:143], v[190:191]
    v_pk_fma_f32 v[128:129], v[128:129], v[192:193], v[208:209]
    v_pk_fma_f32 v[130:131], v[130:131], v[194:195], v[210:211]
    v_pk_fma_f32 v[132:133], v[132:133], v[196:197], v[212:213]
    v_pk_fma_f32 v[134:135], v[134:135], v[198:199], v[214:215]
    v_pk_fma_f32 v[136:137], v[136:137], v[200:201], v[216:217]
    v_pk_fma_f32 v[138:139], v[138:139], v[202:203], v[218:219]
    v_pk_fma_f32 v[140:141], v[140:141], v[204:205], v[220:221]
    v_pk_fma_f32 v[142:143], v[142:143], v[206:207], v[222:223]
    v_cvt_pk_bf16_f32 v224, v128, v129
    v_cvt_pk_bf16_f32 v225, v130, v131
    v_cvt_pk_bf16_f32 v226, v132, v133
    v_cvt_pk_bf16_f32 v227, v134, v135
    v_cvt_pk_bf16_f32 v228, v136, v137
    v_cvt_pk_bf16_f32 v229, v138, v139
    v_cvt_pk_bf16_f32 v230, v140, v141
    v_cvt_pk_bf16_f32 v231, v142, v143
    buffer_store_dwordx4 v[224:227], v4, s[44:47], s84 offen sc1
    buffer_store_dwordx4 v[228:231], v4, s[44:47], s85 offen sc1
    s_cmp_lg_u32 s2, 0
    s_cbranch_scc1 L_nobump
    s_mov_b32 s101, 11534336
    v_mov_b32 v26, s3
    v_add_u32 v27, s78, v1
    v_min_u32 v27, 1, v27
    v_lshlrev_b32 v27, 30, v27
    buffer_store_dword v26, v27, s[52:55], s101 offen sc1
L_nobump:
    s_branch L_end
L_trans:
    s_waitcnt lgkmcnt(0)
    ds_read_b128 a[64:67], v4 offset:16384
    ds_read_b128 a[68:71], v4 offset:24576
    ds_read_b128 a[72:75], v4 offset:17408
    ds_read_b128 a[76:79], v4 offset:25600
    ds_read_b128 a[80:83], v4 offset:18432
    ds_read_b128 a[84:87], v4 offset:26624
    ds_read_b128 a[88:91], v4 offset:19456
    ds_read_b128 a[92:95], v4 offset:27648
    v_cvt_pk_bf16_f32 v36, v68, v69
    v_cvt_pk_bf16_f32 v37, v70, v71
    v_cvt_pk_bf16_f32 v40, v72, v73
    v_cvt_pk_bf16_f32 v41, v74, v75
    v_cvt_pk_bf16_f32 v44, v76, v77
    v_cvt_pk_bf16_f32 v45, v78, v79
    v_cvt_pk_bf16_f32 v34, v80, v81
    v_cvt_pk_bf16_f32 v35, v82, v83
    v_cvt_pk_bf16_f32 v38, v84, v85
    v_cvt_pk_bf16_f32 v39, v86, v87
    v_cvt_pk_bf16_f32 v42, v88, v89
    v_cvt_pk_bf16_f32 v43, v90, v91
    v_cvt_pk_bf16_f32 v46, v92, v93
    v_cvt_pk_bf16_f32 v47, v94, v95
    v_cvt_pk_bf16_f32 v48, v96, v97
    v_cvt_pk_bf16_f32 v49, v98, v99
    v_cvt_pk_bf16_f32 v52, v100, v101
    v_cvt_pk_bf16_f32 v53, v102, v103
    v_cvt_pk_bf16_f32 v56, v104, v105
    v_cvt_pk_bf16_f32 v57, v106, v107
    v_cvt_pk_bf16_f32 v60, v108, v109
    v_cvt_pk_bf16_f32 v61, v110, v111
    v_cvt_pk_bf16_f32 v50, v112, v113
    v_cvt_pk_bf16_f32 v51, v114, v115
    v_cvt_pk_bf16_f32 v54, v116, v117
    v_cvt_pk_bf16_f32 v55, v118, v119
    v_cvt_pk_bf16_f32 v58, v120, v121
    v_cvt_pk_bf16_f32 v59, v122, v123
    v_cvt_pk_bf16_f32 v62, v124, v125
    v_cvt_pk_bf16_f32 v63, v126, v127
    ds_read_b128 a[96:99], v4 offset:20480
    ds_read_b128 a[100:103], v4 offset:28672
    ds_read_b128 a[104:107], v4 offset:21504
    ds_read_b128 a[108:111], v4 offset:29696
    ds_read_b128 a[112:115], v4 offset:22528
    ds_read_b128 a[116:119], v4 offset:30720
    ds_read_b128 a[120:123], v4 offset:23552
    ds_read_b128 a[124:127], v4 offset:31744
    v_mfma_f32_16x16x32_bf16 a[192:195], a[208:211], v[32:35], a[192:195]
    buffer_load_dwordx4 v3, s[64:67], s76 offen offset:0 sc1 lds
    v_mfma_f32_16x16x32_bf16 a[192:195], a[208:211], v[48:51], a[192:195]
    buffer_load_dwordx4 v3, s[64:67], s76 offen offset:1024 sc1 lds
    v_mfma_f32_16x16x32_bf16 a[196:199], a[208:211], v[36:39], a[196:199]
    buffer_load_dwordx4 v3, s[64:67], s76 offen offset:2048 sc1 lds
    v_mfma_f32_16x16x32_bf16 a[196:199], a[208:211], v[52:55], a[196:199]
    buffer_load_dwordx4 v3, s[64:67], s76 offen offset:3072 sc1 lds
    s_sub_u32 s92, s92, 16384
    s_min_u32 s89, s92, s93
    v_mfma_f32_16x16x32_bf16 a[200:203], a[208:211], v[40:43], a[200:203]
    buffer_load_dwordx4 a[224:227], v3, s[56:59], s49 offen offset:0 sc1
    v_mfma_f32_16x16x32_bf16 a[200:203], a[208:211], v[56:59], a[200:203]
    buffer_load_dwordx4 a[228:231], v3, s[56:59], s49 offen offset:1024 sc1
    v_mfma_f32_16x16x32_bf16 a[204:207], a[208:211], v[44:47], a[204:207]
    buffer_load_dwordx4 a[232:235], v3, s[56:59], s49 offen offset:2048 sc1
    v_mfma_f32_16x16x32_bf16 a[204:207], a[208:211], v[60:63], a[204:207]
    s_waitcnt lgkmcnt(12)
    buffer_load_dwordx4 a[236:239], v3, s[56:59], s49 offen offset:3072 sc1
    s_add_u32 s49, s49, s51
    v_mfma_f32_16x16x32_bf16 v[128:131], a[64:67], v[32:35], v[128:131]
    buffer_load_dwordx4 a[240:243], v3, s[56:59], s50 offen offset:0 sc1
    v_mfma_f32_16x16x32_bf16 v[128:131], a[68:71], v[48:51], v[128:131]
    buffer_load_dwordx4 a[244:247], v3, s[56:59], s50 offen offset:1024 sc1
    v_mfma_f32_16x16x32_bf16 v[132:135], a[68:71], v[52:55], v[132:135]
    buffer_load_dwordx4 a[248:251], v3, s[56:59], s50 offen offset:2048 sc1
    v_mfma_f32_16x16x32_bf16 v[132:135], a[64:67], v[36:39], v[132:135]
    buffer_load_dwordx4 a[252:255], v3, s[56:59], s50 offen offset:3072 sc1
    s_add_u32 s50, s50, s51
    v_mfma_f32_16x16x32_bf16 v[136:139], a[64:67], v[40:43], v[136:139]
    buffer_load_dword v0, v31, s[52:55], 0 offen sc1
    v_mfma_f32_16x16x32_bf16 v[136:139], a[68:71], v[56:59], v[136:139]
    v_accvgpr_read_b32 v26, a192
    v_accvgpr_read_b32 v27, a196
    v_mfma_f32_16x16x32_bf16 v[140:143], a[68:71], v[60:63], v[140:143]
    v_accvgpr_read_b32 v28, a200
    v_accvgpr_read_b32 v29, a204
    v_mfma_f32_16x16x32_bf16 v[140:143], a[64:67], v[44:47], v[140:143]
    v_min3_f32 v25, v26, v27, v28
    v_add_f32 v24, v26, v27
    v_mfma_f32_16x16x32_bf16 v[156:159], a[72:75], v[44:47], v[156:159]
    v_add_f32 v24, v24, v28
    v_min_f32 v25, v25, v29
    v_mfma_f32_16x16x32_bf16 v[156:159], a[76:79], v[60:63], v[156:159]
    s_mov_b32 s100, 0
    v_add_f32 v24, v24, v29
    v_cmp_nle_f32 vcc, 0x17800000, v25
    v_mfma_f32_16x16x32_bf16 v[152:155], a[76:79], v[56:59], v[152:155]
    s_mov_b64 s[6:7], vcc
    s_mov_b32 s101, s98
    v_cmp_nge_f32 vcc, 0x67800000, v24
    v_mfma_f32_16x16x32_bf16 v[152:155], a[72:75], v[40:43], v[152:155]
    s_or_b64 vcc, vcc, s[6:7]
    s_cbranch_vccnz L_slow
    v_mfma_f32_16x16x32_bf16 v[148:151], a[72:75], v[36:39], v[148:151]
    v_rcp_f32 v26, v26
    v_mfma_f32_16x16x32_bf16 v[148:151], a[76:79], v[52:55], v[148:151]
    v_rcp_f32 v27, v27
    v_mfma_f32_16x16x32_bf16 v[144:147], a[76:79], v[48:51], v[144:147]
    v_rcp_f32 v28, v28
    v_mfma_f32_16x16x32_bf16 v[144:147], a[72:75], v[32:35], v[144:147]
    s_waitcnt lgkmcnt(8)
    v_rcp_f32 v29, v29
    v_mfma_f32_16x16x32_bf16 v[160:163], a[80:83], v[32:35], v[160:163]
    v_xor_b32 v4, 98304, v4
    v_mfma_f32_16x16x32_bf16 v[160:163], a[84:87], v[48:51], v[160:163]
    v_mfma_f32_16x16x32_bf16 v[164:167], a[84:87], v[52:55], v[164:167]
    v_mfma_f32_16x16x32_bf16 v[164:167], a[80:83], v[36:39], v[164:167]
    v_mfma_f32_16x16x32_bf16 v[168:171], a[80:83], v[40:43], v[168:171]
    s_add_u32 s72, s86, 0
    v_mul_f32 v128, v128, v26
    v_mul_f32 v144, v144, v26
    v_mfma_f32_16x16x32_bf16 v[168:171], a[84:87], v[56:59], v[168:171]
    v_mul_f32 v129, v129, v26
    v_mul_f32 v145, v145, v26
    v_mfma_f32_16x16x32_bf16 v[172:175], a[84:87], v[60:63], v[172:175]
    v_mul_f32 v130, v130, v26
    v_mul_f32 v146, v146, v26
    v_mfma_f32_16x16x32_bf16 v[172:175], a[80:83], v[44:47], v[172:175]
    v_mul_f32 v131, v131, v26
    v_mul_f32 v147, v147, v26
    v_mfma_f32_16x16x32_bf16 v[188:191], a[88:91], v[44:47], v[188:191]
    v_cvt_pk_bf16_f32 v128, v128, v129
    v_cvt_pk_bf16_f32 v129, v130, v131
    v_mfma_f32_16x16x32_bf16 v[188:191], a[92:95], v[60:63], v[188:191]
    v_cvt_pk_bf16_f32 v130, v144, v145
    v_cvt_pk_bf16_f32 v131, v146, v147
    v_mfma_f32_16x16x32_bf16 v[184:187], a[92:95], v[56:59], v[184:187]
    buffer_store_dwordx4 v[128:131], v3, s[52:55], s72 offen offset:0 sc1
    v_mfma_f32_16x16x32_bf16 v[184:187], a[88:91], v[40:43], v[184:187]
    v_mul_f32 v132, v132, v27
    v_mul_f32 v148, v148, v27
    v_mfma_f32_16x16x32_bf16 v[180:183], a[88:91], v[36:39], v[180:183]
    v_mul_f32 v133, v133, v27
    v_mul_f32 v149, v149, v27
    v_mfma_f32_16x16x32_bf16 v[180:183], a[92:95], v[52:55], v[180:183]
    v_mul_f32 v134, v134, v27
    v_mul_f32 v150, v150, v27
    v_mfma_f32_16x16x32_bf16 v[176:179], a[92:95], v[48:51], v[176:179]
    v_mul_f32 v135, v135, v27
    v_mul_f32 v151, v151, v27
    v_mfma_f32_16x16x32_bf16 v[176:179], a[88:91], v[32:35], v[176:179]
    s_waitcnt lgkmcnt(4)
    v_cvt_pk_bf16_f32 v132, v132, v133
    v_cvt_pk_bf16_f32 v133, v134, v135
    v_mfma_f32_16x16x32_bf16 v[192:195], a[96:99], v[32:35], v[192:195]
    v_cvt_pk_bf16_f32 v134, v148, v149
    v_cvt_pk_bf16_f32 v135, v150, v151
    v_mfma_f32_16x16x32_bf16 v[192:195], a[100:103], v[48:51], v[192:195]
    buffer_store_dwordx4 v[132:135], v3, s[52:55], s72 offen offset:1024 sc1
    v_mfma_f32_16x16x32_bf16 v[196:199], a[100:103], v[52:55], v[196:199]
    v_mul_f32 v136, v136, v28
    v_mul_f32 v152, v152, v28
    v_mfma_f32_16x16x32_bf16 v[196:199], a[96:99], v[36:39], v[196:199]
    v_mul_f32 v137, v137, v28
    v_mul_f32 v153, v153, v28
    v_mfma_f32_16x16x32_bf16 v[200:203], a[96:99], v[40:43], v[200:203]
    v_mul_f32 v138, v138, v28
    v_mul_f32 v154, v154, v28
    v_mfma_f32_16x16x32_bf16 v[200:203], a[100:103], v[56:59], v[200:203]
    v_mul_f32 v139, v139, v28
    v_mul_f32 v155, v155, v28
    v_mfma_f32_16x16x32_bf16 v[204:207], a[100:103], v[60:63], v[204:207]
    v_cvt_pk_bf16_f32 v136, v136, v137
    v_cvt_pk_bf16_f32 v137, v138, v139
    v_mfma_f32_16x16x32_bf16 v[204:207], a[96:99], v[44:47], v[204:207]
    v_cvt_pk_bf16_f32 v138, v152, v153
    v_cvt_pk_bf16_f32 v139, v154, v155
    v_mfma_f32_16x16x32_bf16 v[220:223], a[104:107], v[44:47], v[220:223]
    buffer_store_dwordx4 v[136:139], v3, s[52:55], s72 offen offset:2048 sc1
    v_mfma_f32_16x16x32_bf16 v[220:223], a[108:111], v[60:63], v[220:223]
    v_mul_f32 v140, v140, v29
    v_mul_f32 v156, v156, v29
    v_mfma_f32_16x16x32_bf16 v[216:219], a[108:111], v[56:59], v[216:219]
    v_mul_f32 v141, v141, v29
    v_mul_f32 v157, v157, v29
    v_mfma_f32_16x16x32_bf16 v[216:219], a[104:107], v[40:43], v[216:219]
    v_mul_f32 v142, v142, v29
    v_mul_f32 v158, v158, v29
    v_mfma_f32_16x16x32_bf16 v[212:215], a[104:107], v[36:39], v[212:215]
    v_mul_f32 v143, v143, v29
    v_mul_f32 v159, v159, v29
    v_mfma_f32_16x16x32_bf16 v[212:215], a[108:111], v[52:55], v[212:215]
    v_cvt_pk_bf16_f32 v140, v140, v141
    v_cvt_pk_bf16_f32 v141, v142, v143
    v_mfma_f32_16x16x32_bf16 v[208:211], a[108:111], v[48:51], v[208:211]
    v_cvt_pk_bf16_f32 v142, v156, v157
    v_cvt_pk_bf16_f32 v143, v158, v159
    v_mfma_f32_16x16x32_bf16 v[208:211], a[104:107], v[32:35], v[208:211]
    s_waitcnt lgkmcnt(0)
    buffer_store_dwordx4 v[140:143], v3, s[52:55], s72 offen offset:3072 sc1
    s_add_u32 s72, s86, 4096
    v_mfma_f32_16x16x32_bf16 v[224:227], a[112:115], v[32:35], v[224:227]
    v_mul_f32 v160, v160, v26
    v_mul_f32 v176, v176, v26
    v_mfma_f32_16x16x32_bf16 v[224:227], a[116:119], v[48:51], v[224:227]
    v_mul_f32 v161, v161, v26
    v_mul_f32 v177, v177, v26
    v_mfma_f32_16x16x32_bf16 v[228:231], a[116:119], v[52:55], v[228:231]
    v_mul_f32 v162, v162, v26
    v_mul_f32 v178, v178, v26
    v_mfma_f32_16x16x32_bf16 v[228:231], a[112:115], v[36:39], v[228:231]
    v_mul_f32 v163, v163, v26
    v_mul_f32 v179, v179, v26
    v_mfma_f32_16x16x32_bf16 v[232:235], a[112:115], v[40:43], v[232:235]
    v_cvt_pk_bf16_f32 v160, v160, v161
    v_cvt_pk_bf16_f32 v161, v162, v163
    v_mfma_f32_16x16x32_bf16 v[232:235], a[116:119], v[56:59], v[232:235]
    v_cvt_pk_bf16_f32 v162, v176, v177
    v_cvt_pk_bf16_f32 v163, v178, v179
    v_mfma_f32_16x16x32_bf16 v[236:239], a[116:119], v[60:63], v[236:239]
    buffer_store_dwordx4 v[160:163], v3, s[52:55], s72 offen offset:0 sc1
    v_mfma_f32_16x16x32_bf16 v[236:239], a[112:115], v[44:47], v[236:239]
    v_mul_f32 v164, v164, v27
    v_mul_f32 v180, v180, v27
    v_mfma_f32_16x16x32_bf16 v[252:255], a[120:123], v[44:47], v[252:255]
    v_mul_f32 v165, v165, v27
    v_mul_f32 v181, v181, v27
    v_mfma_f32_16x16x32_bf16 v[252:255], a[124:127], v[60:63], v[252:255]
    v_mul_f32 v166, v166, v27
    v_mul_f32 v182, v182, v27
    v_mfma_f32_16x16x32_bf16 v[248:251], a[124:127], v[56:59], v[248:251]
    v_mul_f32 v167, v167, v27
    v_mul_f32 v183, v183, v27
    v_mfma_f32_16x16x32_bf16 v[248:251], a[120:123], v[40:43], v[248:251]
    v_cvt_pk_bf16_f32 v164, v164, v165
    v_cvt_pk_bf16_f32 v165, v166, v167
    v_mfma_f32_16x16x32_bf16 v[244:247], a[120:123], v[36:39], v[244:247]
    v_cvt_pk_bf16_f32 v166, v180, v181
    v_cvt_pk_bf16_f32 v167, v182, v183
    v_mfma_f32_16x16x32_bf16 v[244:247], a[124:127], v[52:55], v[244:247]
    buffer_store_dwordx4 v[164:167], v3, s[52:55], s72 offen offset:1024 sc1
    v_mfma_f32_16x16x32_bf16 v[240:243], a[124:127], v[48:51], v[240:243]
    v_mul_f32 v168, v168, v28
    v_mul_f32 v184, v184, v28
    v_mfma_f32_16x16x32_bf16 v[240:243], a[120:123], v[32:35], v[240:243]
    v_mul_f32 v169, v169, v28
    v_mul_f32 v185, v185, v28
    s_mov_b32 s73, 0x30000
    s_cmp_le_u32 s94, 15
    s_cselect_b32 s77, 32768, s73
    s_cmp_le_u32 s94, s25
    s_cselect_b32 s62, 67108864, 0
    s_add_u32 s75, s94, 2
    s_xor_b32 s91, s91, s77
    s_cmp_ge_u32 s75, s97
    s_cselect_b32 s66, s62, 0
    s_xor_b32 s90, s90, s77
    s_mov_b32 m0, s90
    s_waitcnt vmcnt(6)
    s_barrier
    v_mfma_f32_16x16x32_bf16 a[128:131], a[224:227], a[240:243], a[128:131]
    buffer_load_dwordx4 v3, s[60:63], s88 offen offset:0 sc1 lds
    v_mfma_f32_16x16x32_bf16 a[132:135], a[224:227], a[244:247], a[132:135]
    ds_read_b128 a[0:3], v14 offset:0
    ds_read_b128 a[4:7], v14 offset:1024
    v_mfma_f32_16x16x32_bf16 a[136:139], a[224:227], a[248:251], a[136:139]
    ds_read_b128 a[8:11], v14 offset:2048
    ds_read_b128 a[12:15], v14 offset:3072
    v_mfma_f32_16x16x32_bf16 a[140:143], a[224:227], a[252:255], a[140:143]
    ds_read_b128 a[16:19], v14 offset:4096
    ds_read_b128 a[20:23], v14 offset:5120
    v_mfma_f32_16x16x32_bf16 a[156:159], a[228:231], a[252:255], a[156:159]
    buffer_load_dwordx4 v3, s[60:63], s88 offen offset:1024 sc1 lds
    v_mfma_f32_16x16x32_bf16 a[152:155], a[228:231], a[248:251], a[152:155]
    ds_read_b128 a[24:27], v14 offset:6144
    ds_read_b128 a[28:31], v14 offset:7168
    v_mfma_f32_16x16x32_bf16 a[148:151], a[228:231], a[244:247], a[148:151]
    ds_read_b128 a[32:35], v14 offset:8192
    ds_read_b128 a[36:39], v14 offset:9216
    v_mfma_f32_16x16x32_bf16 a[144:147], a[228:231], a[240:243], a[144:147]
    ds_read_b128 a[40:43], v14 offset:10240
    ds_read_b128 a[44:47], v14 offset:11264
    v_mfma_f32_16x16x32_bf16 a[160:163], a[232:235], a[240:243], a[160:163]
    buffer_load_dwordx4 v3, s[60:63], s88 offen offset:2048 sc1 lds
    v_mfma_f32_16x16x32_bf16 a[164:167], a[232:235], a[244:247], a[164:167]
    ds_read_b128 a[48:51], v14 offset:12288
    ds_read_b128 a[52:55], v14 offset:13312
    v_mfma_f32_16x16x32_bf16 a[168:171], a[232:235], a[248:251], a[168:171]
    ds_read_b128 a[56:59], v14 offset:14336
    ds_read_b128 a[60:63], v14 offset:15360
    v_mfma_f32_16x16x32_bf16 a[172:175], a[232:235], a[252:255], a[172:175]
    ds_read_b128 a[64:67], v4 offset:0
    ds_read_b128 a[68:71], v4 offset:1024
    v_mfma_f32_16x16x32_bf16 a[188:191], a[236:239], a[252:255], a[188:191]
    buffer_load_dwordx4 v3, s[60:63], s88 offen offset:3072 sc1 lds
    s_add_u32 m0, s90, 4096
    s_add_u32 s76, s88, 4096
    v_mfma_f32_16x16x32_bf16 a[184:187], a[236:239], a[248:251], a[184:187]
    ds_read_b128 a[72:75], v4 offset:2048
    ds_read_b128 a[76:79], v4 offset:3072
    v_mfma_f32_16x16x32_bf16 a[180:183], a[236:239], a[244:247], a[180:183]
    ds_read_b128 a[80:83], v4 offset:4096
    ds_read_b128 a[84:87], v4 offset:5120
    v_mfma_f32_16x16x32_bf16 a[176:179], a[236:239], a[240:243], a[176:179]
    ds_read_b128 a[88:91], v4 offset:6144
    ds_read_b128 a[92:95], v4 offset:7168
    v_mul_f32 v170, v170, v28
    v_mul_f32 v186, v186, v28
    v_mul_f32 v171, v171, v28
    v_mul_f32 v187, v187, v28
    v_cvt_pk_bf16_f32 v168, v168, v169
    v_cvt_pk_bf16_f32 v169, v170, v171
    v_cvt_pk_bf16_f32 v170, v184, v185
    v_cvt_pk_bf16_f32 v171, v186, v187
    buffer_store_dwordx4 v[168:171], v3, s[52:55], s72 offen offset:2048 sc1
    buffer_load_dwordx4 v3, s[60:63], s76 offen offset:0 sc1 lds
    v_mul_f32 v172, v172, v29
    v_mul_f32 v188, v188, v29
    v_mul_f32 v173, v173, v29
    v_mul_f32 v189, v189, v29
    v_mul_f32 v174, v174, v29
    v_mul_f32 v190, v190, v29
    v_mul_f32 v175, v175, v29
    v_mul_f32 v191, v191, v29
    v_cvt_pk_bf16_f32 v172, v172, v173
    v_cvt_pk_bf16_f32 v173, v174, v175
    v_cvt_pk_bf16_f32 v174, v188, v189
    v_cvt_pk_bf16_f32 v175, v190, v191
    buffer_store_dwordx4 v[172:175], v3, s[52:55], s72 offen offset:3072 sc1
    buffer_load_dwordx4 v3, s[60:63], s76 offen offset:1024 sc1 lds
    s_add_u32 s72, s86, 8192
    v_mul_f32 v192, v192, v26
    v_mul_f32 v208, v208, v26
    v_mul_f32 v193, v193, v26
    v_mul_f32 v209, v209, v26
    v_mul_f32 v194, v194, v26
    v_mul_f32 v210, v210, v26
    v_mul_f32 v195, v195, v26
    v_mul_f32 v211, v211, v26
    v_cvt_pk_bf16_f32 v192, v192, v193
    v_cvt_pk_bf16_f32 v193, v194, v195
    v_cvt_pk_bf16_f32 v194, v208, v209
    v_cvt_pk_bf16_f32 v195, v210, v211
    buffer_store_dwordx4 v[192:195], v3, s[52:55], s72 offen offset:0 sc1
    buffer_load_dwordx4 v3, s[60:63], s76 offen offset:2048 sc1 lds
    v_mul_f32 v196, v196, v27
    v_mul_f32 v212, v212, v27
    v_mul_f32 v197, v197, v27
    v_mul_f32 v213, v213, v27
    v_mul_f32 v198, v198, v27
    v_mul_f32 v214, v214, v27
    v_mul_f32 v199, v199, v27
    v_mul_f32 v215, v215, v27
    v_cvt_pk_bf16_f32 v196, v196, v197
    v_cvt_pk_bf16_f32 v197, v198, v199
    v_cvt_pk_bf16_f32 v198, v212, v213
    v_cvt_pk_bf16_f32 v199, v214, v215
    buffer_store_dwordx4 v[196:199], v3, s[52:55], s72 offen offset:1024 sc1
    buffer_load_dwordx4 v3, s[60:63], s76 offen offset:3072 sc1 lds
    s_mov_b32 m0, s91
    s_add_u32 s88, s88, 16384
    v_mul_f32 v200, v200, v28
    v_mul_f32 v216, v216, v28
    v_mul_f32 v201, v201, v28
    v_mul_f32 v217, v217, v28
    v_mul_f32 v202, v202, v28
    v_mul_f32 v218, v218, v28
    v_mul_f32 v203, v203, v28
    v_mul_f32 v219, v219, v28
    v_cvt_pk_bf16_f32 v200, v200, v201
    v_cvt_pk_bf16_f32 v201, v202, v203
    v_cvt_pk_bf16_f32 v202, v216, v217
    v_cvt_pk_bf16_f32 v203, v218, v219
    buffer_store_dwordx4 v[200:203], v3, s[52:55], s72 offen offset:2048 sc1
    buffer_load_dwordx4 v3, s[64:67], s89 offen offset:0 sc1 lds
    v_mul_f32 v204, v204, v29
    v_mul_f32 v220, v220, v29
    v_mul_f32 v205, v205, v29
    v_mul_f32 v221, v221, v29
    v_mul_f32 v206, v206, v29
    v_mul_f32 v222, v222, v29
    v_mul_f32 v207, v207, v29
    v_mul_f32 v223, v223, v29
    v_cvt_pk_bf16_f32 v204, v204, v205
    v_cvt_pk_bf16_f32 v205, v206, v207
    v_cvt_pk_bf16_f32 v206, v220, v221
    v_cvt_pk_bf16_f32 v207, v222, v223
    buffer_store_dwordx4 v[204:207], v3, s[52:55], s72 offen offset:3072 sc1
    buffer_load_dwordx4 v3, s[64:67], s89 offen offset:1024 sc1 lds
    s_add_u32 s72, s86, 12288
    v_mul_f32 v224, v224, v26
    v_mul_f32 v240, v240, v26
    v_mul_f32 v225, v225, v26
    v_mul_f32 v241, v241, v26
    v_mul_f32 v226, v226, v26
    v_mul_f32 v242, v242, v26
    v_mul_f32 v227, v227, v26
    v_mul_f32 v243, v243, v26
    v_cvt_pk_bf16_f32 v224, v224, v225
    v_cvt_pk_bf16_f32 v225, v226, v227
    v_cvt_pk_bf16_f32 v226, v240, v241
    v_cvt_pk_bf16_f32 v227, v242, v243
    buffer_store_dwordx4 v[224:227], v3, s[52:55], s72 offen offset:0 sc1
    buffer_load_dwordx4 v3, s[64:67], s89 offen offset:2048 sc1 lds
    v_mul_f32 v228, v228, v27
    v_mul_f32 v244, v244, v27
    v_mul_f32 v229, v229, v27
    v_mul_f32 v245, v245, v27
    v_mul_f32 v230, v230, v27
    v_mul_f32 v246, v246, v27
    v_mul_f32 v231, v231, v27
    v_mul_f32 v247, v247, v27
    v_cvt_pk_bf16_f32 v228, v228, v229
    v_cvt_pk_bf16_f32 v229, v230, v231
    v_cvt_pk_bf16_f32 v230, v244, v245
    v_cvt_pk_bf16_f32 v231, v246, v247
    buffer_store_dwordx4 v[228:231], v3, s[52:55], s72 offen offset:1024 sc1
    buffer_load_dwordx4 v3, s[64:67], s89 offen offset:3072 sc1 lds
    s_add_u32 m0, s91, 4096
    s_add_u32 s76, s89, 4096
    v_mul_f32 v232, v232, v28
    v_mul_f32 v248, v248, v28
    v_mul_f32 v233, v233, v28
    v_mul_f32 v249, v249, v28
    v_mul_f32 v234, v234, v28
    v_mul_f32 v250, v250, v28
    v_mul_f32 v235, v235, v28
    v_mul_f32 v251, v251, v28
    v_cvt_pk_bf16_f32 v232, v232, v233
    v_cvt_pk_bf16_f32 v233, v234, v235
    v_cvt_pk_bf16_f32 v234, v248, v249
    v_cvt_pk_bf16_f32 v235, v250, v251
    buffer_store_dwordx4 v[232:235], v3, s[52:55], s72 offen offset:2048 sc1
    v_mul_f32 v236, v236, v29
    v_mul_f32 v252, v252, v29
    v_mul_f32 v237, v237, v29
    v_mul_f32 v253, v253, v29
    v_mul_f32 v238, v238, v29
    v_mul_f32 v254, v254, v29
    v_mul_f32 v239, v239, v29
    v_mul_f32 v255, v255, v29
    v_cvt_pk_bf16_f32 v236, v236, v237
    v_cvt_pk_bf16_f32 v237, v238, v239
    v_cvt_pk_bf16_f32 v238, v252, v253
    v_cvt_pk_bf16_f32 v239, v254, v255
    buffer_store_dwordx4 v[236:239], v3, s[52:55], s72 offen offset:3072 sc1
    s_add_u32 s94, s94, 1
    s_cmp_eq_u32 s94, s22
    s_cselect_b32 s21, -1, 0
    s_cmp_eq_u32 s94, s20
    s_cselect_b32 s21, -1, s21
    v_and_b32 v16, s21, v9
    v_and_b32 v17, s21, v10
    v_and_b32 v18, s21, v11
    v_and_b32 v19, s21, v30
    s_and_b32 s21, s21, 0xff800000
    v_mov_b32 v20, s21
    v_mov_b32 v21, s21
    v_mov_b32 v22, s21
    v_mov_b32 v23, s21
    s_mov_b32 s96, 17
    s_waitcnt lgkmcnt(4)
    s_branch L_special
L_first:
    s_cmp_eq_u32 s94, 17
    s_cbranch_scc1 L_fzero
    v_mfma_f32_16x16x32_bf16 v[64:67], a[64:67], a[0:3], v[16:19]
    ds_read_b128 a[96:99], v4 offset:8192
    v_mfma_f32_16x16x32_bf16 v[64:67], a[68:71], a[4:7], v[64:67]
    v_mfma_f32_16x16x32_bf16 v[64:67], a[72:75], a[8:11], v[64:67]
    buffer_load_dwordx4 v3, s[64:67], s76 offen offset:0 sc1 lds
    v_mfma_f32_16x16x32_bf16 v[64:67], a[76:79], a[12:15], v[64:67]
    v_mfma_f32_16x16x32_bf16 v[68:71], a[76:79], a[28:31], 0
    ds_read_b128 a[100:103], v4 offset:9216
    v_mfma_f32_16x16x32_bf16 v[68:71], a[72:75], a[24:27], v[68:71]
    v_mfma_f32_16x16x32_bf16 v[68:71], a[68:71], a[20:23], v[68:71]
    buffer_load_dwordx4 v3, s[64:67], s76 offen offset:1024 sc1 lds
    v_mfma_f32_16x16x32_bf16 v[68:71], a[64:67], a[16:19], v[68:71]
    v_mfma_f32_16x16x32_bf16 v[72:75], a[64:67], a[32:35], 0
    ds_read_b128 a[104:107], v4 offset:10240
    v_mfma_f32_16x16x32_bf16 v[72:75], a[68:71], a[36:39], v[72:75]
    v_mfma_f32_16x16x32_bf16 v[72:75], a[72:75], a[40:43], v[72:75]
    buffer_load_dwordx4 v3, s[64:67], s76 offen offset:2048 sc1 lds
    v_mfma_f32_16x16x32_bf16 v[72:75], a[76:79], a[44:47], v[72:75]
    v_mfma_f32_16x16x32_bf16 v[76:79], a[76:79], a[60:63], 0
    ds_read_b128 a[108:111], v4 offset:11264
    v_mfma_f32_16x16x32_bf16 v[76:79], a[72:75], a[56:59], v[76:79]
    v_mfma_f32_16x16x32_bf16 v[76:79], a[68:71], a[52:55], v[76:79]
    buffer_load_dwordx4 v3, s[64:67], s76 offen offset:3072 sc1 lds
    s_sub_u32 s92, s92, 16384
    v_mfma_f32_16x16x32_bf16 v[76:79], a[64:67], a[48:51], v[76:79]
    s_waitcnt lgkmcnt(4)
    v_mfma_f32_16x16x32_bf16 v[80:83], a[80:83], a[0:3], v[20:23]
    s_min_u32 s89, s92, s93
    ds_read_b128 a[112:115], v4 offset:12288
    v_mfma_f32_16x16x32_bf16 v[80:83], a[84:87], a[4:7], v[80:83]
    v_exp_f32 v64, v64
    v_mfma_f32_16x16x32_bf16 v[80:83], a[88:91], a[8:11], v[80:83]
    buffer_load_dwordx4 a[224:227], v3, s[56:59], s49 offen offset:0 sc1
    v_mfma_f32_16x16x32_bf16 v[80:83], a[92:95], a[12:15], v[80:83]
    v_exp_f32 v65, v65
    v_mfma_f32_16x16x32_bf16 v[84:87], a[92:95], a[28:31], v[16:19]
    ds_read_b128 a[116:119], v4 offset:13312
    v_mfma_f32_16x16x32_bf16 v[84:87], a[88:91], a[24:27], v[84:87]
    v_exp_f32 v66, v66
    v_mfma_f32_16x16x32_bf16 v[84:87], a[84:87], a[20:23], v[84:87]
    buffer_load_dwordx4 a[228:231], v3, s[56:59], s49 offen offset:1024 sc1
    v_mfma_f32_16x16x32_bf16 v[84:87], a[80:83], a[16:19], v[84:87]
    v_exp_f32 v67, v67
    v_mfma_f32_16x16x32_bf16 v[88:91], a[80:83], a[32:35], 0
    ds_read_b128 a[120:123], v4 offset:14336
    v_mfma_f32_16x16x32_bf16 v[88:91], a[84:87], a[36:39], v[88:91]
    v_exp_f32 v68, v68
    v_mfma_f32_16x16x32_bf16 v[88:91], a[88:91], a[40:43], v[88:91]
    buffer_load_dwordx4 a[232:235], v3, s[56:59], s49 offen offset:2048 sc1
    v_mfma_f32_16x16x32_bf16 v[88:91], a[92:95], a[44:47], v[88:91]
    v_exp_f32 v69, v69
    v_mfma_f32_16x16x32_bf16 v[92:95], a[92:95], a[60:63], 0
    ds_read_b128 a[124:127], v4 offset:15360
    v_mfma_f32_16x16x32_bf16 v[92:95], a[88:91], a[56:59], v[92:95]
    v_exp_f32 v70, v70
    v_mfma_f32_16x16x32_bf16 v[92:95], a[84:87], a[52:55], v[92:95]
    buffer_load_dwordx4 a[236:239], v3, s[56:59], s49 offen offset:3072 sc1
    s_add_u32 s49, s49, s51
    v_mfma_f32_16x16x32_bf16 v[92:95], a[80:83], a[48:51], v[92:95]
    s_waitcnt lgkmcnt(4)
    v_exp_f32 v71, v71
    v_mfma_f32_16x16x32_bf16 v[96:99], a[96:99], a[0:3], v[20:23]
    v_mfma_f32_16x16x32_bf16 v[96:99], a[100:103], a[4:7], v[96:99]
    v_exp_f32 v72, v72
    v_mfma_f32_16x16x32_bf16 v[96:99], a[104:107], a[8:11], v[96:99]
    buffer_load_dwordx4 a[240:243], v3, s[56:59], s50 offen offset:0 sc1
    v_mfma_f32_16x16x32_bf16 v[96:99], a[108:111], a[12:15], v[96:99]
    v_exp_f32 v73, v73
    v_mfma_f32_16x16x32_bf16 v[100:103], a[108:111], a[28:31], v[20:23]
    v_mfma_f32_16x16x32_bf16 v[100:103], a[104:107], a[24:27], v[100:103]
    v_exp_f32 v74, v74
    v_mfma_f32_16x16x32_bf16 v[100:103], a[100:103], a[20:23], v[100:103]
    buffer_load_dwordx4 a[244:247], v3, s[56:59], s50 offen offset:1024 sc1
    v_mfma_f32_16x16x32_bf16 v[100:103], a[96:99], a[16:19], v[100:103]
    v_exp_f32 v75, v75
    v_mfma_f32_16x16x32_bf16 v[104:107], a[96:99], a[32:35], v[16:19]
    v_mfma_f32_16x16x32_bf16 v[104:107], a[100:103], a[36:39], v[104:107]
    v_exp_f32 v76, v76
    v_mfma_f32_16x16x32_bf16 v[104:107], a[104:107], a[40:43], v[104:107]
    buffer_load_dwordx4 a[248:251], v3, s[56:59], s50 offen offset:2048 sc1
    v_mfma_f32_16x16x32_bf16 v[104:107], a[108:111], a[44:47], v[104:107]
    v_exp_f32 v77, v77
    v_mfma_f32_16x16x32_bf16 v[108:111], a[108:111], a[60:63], 0
    v_mfma_f32_16x16x32_bf16 v[108:111], a[104:107], a[56:59], v[108:111]
    v_exp_f32 v78, v78
    v_mfma_f32_16x16x32_bf16 v[108:111], a[100:103], a[52:55], v[108:111]
    buffer_load_dwordx4 a[252:255], v3, s[56:59], s50 offen offset:3072 sc1
    s_add_u32 s50, s50, s51
    v_mfma_f32_16x16x32_bf16 v[108:111], a[96:99], a[48:51], v[108:111]
    s_waitcnt lgkmcnt(0)
    v_exp_f32 v79, v79
    v_mfma_f32_16x16x32_bf16 v[112:115], a[112:115], a[0:3], v[20:23]
    v_mfma_f32_16x16x32_bf16 v[112:115], a[116:119], a[4:7], v[112:115]
    v_exp_f32 v80, v80
    v_mfma_f32_16x16x32_bf16 v[112:115], a[120:123], a[8:11], v[112:115]
    v_mfma_f32_16x16x32_bf16 v[112:115], a[124:127], a[12:15], v[112:115]
    v_exp_f32 v81, v81
    v_mfma_f32_16x16x32_bf16 v[116:119], a[124:127], a[28:31], v[20:23]
    v_mfma_f32_16x16x32_bf16 v[116:119], a[120:123], a[24:27], v[116:119]
    v_exp_f32 v82, v82
    v_mfma_f32_16x16x32_bf16 v[116:119], a[116:119], a[20:23], v[116:119]
    v_mfma_f32_16x16x32_bf16 v[116:119], a[112:115], a[16:19], v[116:119]
    v_exp_f32 v83, v83
    v_mfma_f32_16x16x32_bf16 v[120:123], a[112:115], a[32:35], v[20:23]
    v_mfma_f32_16x16x32_bf16 v[120:123], a[116:119], a[36:39], v[120:123]
    v_exp_f32 v84, v84
    v_mfma_f32_16x16x32_bf16 v[120:123], a[120:123], a[40:43], v[120:123]
    buffer_load_dword v0, v31, s[52:55], 0 offen sc1
    v_mfma_f32_16x16x32_bf16 v[120:123], a[124:127], a[44:47], v[120:123]
    v_exp_f32 v85, v85
    v_mfma_f32_16x16x32_bf16 v[124:127], a[124:127], a[60:63], v[16:19]
    v_mfma_f32_16x16x32_bf16 v[124:127], a[120:123], a[56:59], v[124:127]
    v_exp_f32 v86, v86
    v_mfma_f32_16x16x32_bf16 v[124:127], a[116:119], a[52:55], v[124:127]
    s_mov_b32 s73, 0x30000
    v_mfma_f32_16x16x32_bf16 v[124:127], a[112:115], a[48:51], v[124:127]
    v_exp_f32 v87, v87
    v_exp_f32 v88, v88
    v_exp_f32 v89, v89
    v_exp_f32 v90, v90
    v_exp_f32 v91, v91
    v_exp_f32 v92, v92
    v_exp_f32 v93, v93
    v_exp_f32 v94, v94
    v_exp_f32 v95, v95
    s_cmp_le_u32 s94, 15
    s_cselect_b32 s72, 32768, s73
    v_exp_f32 v96, v96
    s_cmp_le_u32 s94, s25
    s_cselect_b32 s62, 67108864, 0
    v_exp_f32 v97, v97
    s_add_u32 s75, s94, 2
    s_xor_b32 s91, s91, s72
    v_exp_f32 v98, v98
    s_cmp_ge_u32 s75, s97
    s_cselect_b32 s66, s62, 0
    v_exp_f32 v99, v99
    s_xor_b32 s90, s90, s72
    s_mov_b32 m0, s90
    v_exp_f32 v100, v100
    v_xor_b32 v4, 32768, v4
    s_add_u32 s94, s94, 1
    v_exp_f32 v101, v101
    s_cmp_eq_u32 s94, s22
    s_cselect_b32 s21, -1, 0
    v_exp_f32 v102, v102
    s_cmp_eq_u32 s94, s20
    s_cselect_b32 s21, -1, s21
    s_waitcnt vmcnt(0) lgkmcnt(0)
    s_barrier
    v_mfma_f32_16x16x32_bf16 v[128:131], a[212:215], a[212:215], 0
    v_exp_f32 v103, v103
    v_mfma_f32_16x16x32_bf16 v[132:135], a[212:215], a[212:215], 0
    v_exp_f32 v104, v104
    v_mfma_f32_16x16x32_bf16 v[136:139], a[212:215], a[212:215], 0
    buffer_load_dwordx4 v3, s[60:63], s88 offen offset:0 sc1 lds
    v_mfma_f32_16x16x32_bf16 v[140:143], a[212:215], a[212:215], 0
    v_exp_f32 v105, v105
    v_mfma_f32_16x16x32_bf16 v[156:159], a[212:215], a[212:215], 0
    ds_read_b128 a[64:67], v4 offset:0
    v_mfma_f32_16x16x32_bf16 v[152:155], a[212:215], a[212:215], 0
    v_exp_f32 v106, v106
    v_mfma_f32_16x16x32_bf16 v[148:151], a[212:215], a[212:215], 0
    buffer_load_dwordx4 v3, s[60:63], s88 offen offset:1024 sc1 lds
    v_mfma_f32_16x16x32_bf16 v[144:147], a[212:215], a[212:215], 0
    v_exp_f32 v107, v107
    v_mfma_f32_16x16x32_bf16 v[160:163], a[212:215], a[212:215], 0
    ds_read_b128 a[68:71], v4 offset:1024
    v_mfma_f32_16x16x32_bf16 v[164:167], a[212:215], a[212:215], 0
    v_exp_f32 v108, v108
    v_mfma_f32_16x16x32_bf16 v[168:171], a[212:215], a[212:215], 0
    buffer_load_dwordx4 v3, s[60:63], s88 offen offset:2048 sc1 lds
    v_mfma_f32_16x16x32_bf16 v[172:175], a[212:215], a[212:215], 0
    v_exp_f32 v109, v109
    v_mfma_f32_16x16x32_bf16 v[188:191], a[212:215], a[212:215], 0
    ds_read_b128 a[72:75], v4 offset:2048
    v_mfma_f32_16x16x32_bf16 v[184:187], a[212:215], a[212:215], 0
    v_exp_f32 v110, v110
    v_mfma_f32_16x16x32_bf16 v[180:183], a[212:215], a[212:215], 0
    buffer_load_dwordx4 v3, s[60:63], s88 offen offset:3072 sc1 lds
    s_add_u32 m0, s90, 4096
    v_mfma_f32_16x16x32_bf16 v[176:179], a[212:215], a[212:215], 0
    s_add_u32 s76, s88, 4096
    v_exp_f32 v111, v111
    v_mfma_f32_16x16x32_bf16 v[192:195], a[212:215], a[212:215], 0
    ds_read_b128 a[76:79], v4 offset:3072
    v_mfma_f32_16x16x32_bf16 v[196:199], a[212:215], a[212:215], 0
    v_exp_f32 v112, v112
    v_mfma_f32_16x16x32_bf16 v[200:203], a[212:215], a[212:215], 0
    buffer_load_dwordx4 v3, s[60:63], s76 offen offset:0 sc1 lds
    v_mfma_f32_16x16x32_bf16 v[204:207], a[212:215], a[212:215], 0
    v_exp_f32 v113, v113
    v_mfma_f32_16x16x32_bf16 v[220:223], a[212:215], a[212:215], 0
    ds_read_b128 a[80:83], v4 offset:4096
    v_mfma_f32_16x16x32_bf16 v[216:219], a[212:215], a[212:215], 0
    v_exp_f32 v114, v114
    v_mfma_f32_16x16x32_bf16 v[212:215], a[212:215], a[212:215], 0
    buffer_load_dwordx4 v3, s[60:63], s76 offen offset:1024 sc1 lds
    v_mfma_f32_16x16x32_bf16 v[208:211], a[212:215], a[212:215], 0
    v_exp_f32 v115, v115
    v_mfma_f32_16x16x32_bf16 v[224:227], a[212:215], a[212:215], 0
    ds_read_b128 a[84:87], v4 offset:5120
    v_mfma_f32_16x16x32_bf16 v[228:231], a[212:215], a[212:215], 0
    v_exp_f32 v116, v116
    v_mfma_f32_16x16x32_bf16 v[232:235], a[212:215], a[212:215], 0
    buffer_load_dwordx4 v3, s[60:63], s76 offen offset:2048 sc1 lds
    v_mfma_f32_16x16x32_bf16 v[236:239], a[212:215], a[212:215], 0
    v_exp_f32 v117, v117
    v_mfma_f32_16x16x32_bf16 v[252:255], a[212:215], a[212:215], 0
    ds_read_b128 a[88:91], v4 offset:6144
    v_mfma_f32_16x16x32_bf16 v[248:251], a[212:215], a[212:215], 0
    v_exp_f32 v118, v118
    v_mfma_f32_16x16x32_bf16 v[244:247], a[212:215], a[212:215], 0
    buffer_load_dwordx4 v3, s[60:63], s76 offen offset:3072 sc1 lds
    s_mov_b32 m0, s91
    v_mfma_f32_16x16x32_bf16 v[240:243], a[212:215], a[212:215], 0
    s_add_u32 s88, s88, 16384
    v_exp_f32 v119, v119
    v_mfma_f32_16x16x32_bf16 a[192:195], a[212:215], a[212:215], 0
    ds_read_b128 a[92:95], v4 offset:7168
    v_mfma_f32_16x16x32_bf16 a[196:199], a[212:215], a[212:215], 0
    v_exp_f32 v120, v120
    v_mfma_f32_16x16x32_bf16 a[200:203], a[212:215], a[212:215], 0
    buffer_load_dwordx4 v3, s[64:67], s89 offen offset:0 sc1 lds
    v_mfma_f32_16x16x32_bf16 a[204:207], a[212:215], a[212:215], 0
    v_exp_f32 v121, v121
    v_and_b32 v16, s21, v9
    v_and_b32 v17, s21, v10
    v_exp_f32 v122, v122
    buffer_load_dwordx4 v3, s[64:67], s89 offen offset:1024 sc1 lds
    v_exp_f32 v123, v123
    v_mfma_f32_16x16x32_bf16 a[128:131], a[224:227], a[240:243], a[128:131]
    v_and_b32 v18, s21, v11
    v_and_b32 v19, s21, v30
    v_mfma_f32_16x16x32_bf16 a[132:135], a[224:227], a[244:247], a[132:135]
    v_exp_f32 v124, v124
    v_mfma_f32_16x16x32_bf16 a[136:139], a[224:227], a[248:251], a[136:139]
    buffer_load_dwordx4 v3, s[64:67], s89 offen offset:2048 sc1 lds
    v_mfma_f32_16x16x32_bf16 a[140:143], a[224:227], a[252:255], a[140:143]
    v_exp_f32 v125, v125
    v_mfma_f32_16x16x32_bf16 a[156:159], a[228:231], a[252:255], a[156:159]
    s_and_b32 s21, s21, 0xff800000
    v_mov_b32 v20, s21
    v_mov_b32 v21, s21
    v_mfma_f32_16x16x32_bf16 a[152:155], a[228:231], a[248:251], a[152:155]
    v_exp_f32 v126, v126
    v_mfma_f32_16x16x32_bf16 a[148:151], a[228:231], a[244:247], a[148:151]
    buffer_load_dwordx4 v3, s[64:67], s89 offen offset:3072 sc1 lds
    s_add_u32 m0, s91, 4096
    v_mfma_f32_16x16x32_bf16 a[144:147], a[228:231], a[240:243], a[144:147]
    s_add_u32 s76, s89, 4096
    v_exp_f32 v127, v127
    v_mfma_f32_16x16x32_bf16 a[160:163], a[232:235], a[240:243], a[160:163]
    v_mov_b32 v22, s21
    v_mov_b32 v23, s21
    v_mfma_f32_16x16x32_bf16 a[164:167], a[232:235], a[244:247], a[164:167]
    v_mfma_f32_16x16x32_bf16 a[168:171], a[232:235], a[248:251], a[168:171]
    v_cvt_pk_bf16_f32 v32, v64, v65
    v_cvt_pk_bf16_f32 v33, v66, v67
    v_mfma_f32_16x16x32_bf16 a[172:175], a[232:235], a[252:255], a[172:175]
    v_mfma_f32_16x16x32_bf16 a[188:191], a[236:239], a[252:255], a[188:191]
    v_mfma_f32_16x16x32_bf16 a[184:187], a[236:239], a[248:251], a[184:187]
    v_mfma_f32_16x16x32_bf16 a[180:183], a[236:239], a[244:247], a[180:183]
    s_cmp_eq_u32 s94, s74
    v_mfma_f32_16x16x32_bf16 a[176:179], a[236:239], a[240:243], a[176:179]
    s_waitcnt lgkmcnt(4)
    s_cbranch_scc0 L_body
    s_branch L_special
L_fzero:
    v_mov_b32 v128, 0
    v_mov_b32 v129, 0
    v_mov_b32 v130, 0
    v_mov_b32 v131, 0
    v_mov_b32 v132, 0
    v_mov_b32 v133, 0
    v_mov_b32 v134, 0
    v_mov_b32 v135, 0
    v_mov_b32 v136, 0
    v_mov_b32 v137, 0
    v_mov_b32 v138, 0
    v_mov_b32 v139, 0
    v_mov_b32 v140, 0
    v_mov_b32 v141, 0
    v_mov_b32 v142, 0
    v_mov_b32 v143, 0
    v_mov_b32 v144, 0
    v_mov_b32 v145, 0
    v_mov_b32 v146, 0
    v_mov_b32 v147, 0
    v_mov_b32 v148, 0
    v_mov_b32 v149, 0
    v_mov_b32 v150, 0
    v_mov_b32 v151, 0
    v_mov_b32 v152, 0
    v_mov_b32 v153, 0
    v_mov_b32 v154, 0
    v_mov_b32 v155, 0
    v_mov_b32 v156, 0
    v_mov_b32 v157, 0
    v_mov_b32 v158, 0
    v_mov_b32 v159, 0
    v_mov_b32 v160, 0
    v_mov_b32 v161, 0
    v_mov_b32 v162, 0
    v_mov_b32 v163, 0
    v_mov_b32 v164, 0
    v_mov_b32 v165, 0
    v_mov_b32 v166, 0
    v_mov_b32 v167, 0
    v_mov_b32 v168, 0
    v_mov_b32 v169, 0
    v_mov_b32 v170, 0
    v_mov_b32 v171, 0
    v_mov_b32 v172, 0
    v_mov_b32 v173, 0
    v_mov_b32 v174, 0
    v_mov_b32 v175, 0
    v_mov_b32 v176, 0
    v_mov_b32 v177, 0
    v_mov_b32 v178, 0
    v_mov_b32 v179, 0
    v_mov_b32 v180, 0
    v_mov_b32 v181, 0
    v_mov_b32 v182, 0
    v_mov_b32 v183, 0
    v_mov_b32 v184, 0
    v_mov_b32 v185, 0
    v_mov_b32 v186, 0
    v_mov_b32 v187, 0
    v_mov_b32 v188, 0
    v_mov_b32 v189, 0
    v_mov_b32 v190, 0
    v_mov_b32 v191, 0
    v_mov_b32 v192, 0
    v_mov_b32 v193, 0
    v_mov_b32 v194, 0
    v_mov_b32 v195, 0
    v_mov_b32 v196, 0
    v_mov_b32 v197, 0
    v_mov_b32 v198, 0
    v_mov_b32 v199, 0
    v_mov_b32 v200, 0
    v_mov_b32 v201, 0
    v_mov_b32 v202, 0
    v_mov_b32 v203, 0
    v_mov_b32 v204, 0
    v_mov_b32 v205, 0
    v_mov_b32 v206, 0
    v_mov_b32 v207, 0
    v_mov_b32 v208, 0
    v_mov_b32 v209, 0
    v_mov_b32 v210, 0
    v_mov_b32 v211, 0
    v_mov_b32 v212, 0
    v_mov_b32 v213, 0
    v_mov_b32 v214, 0
    v_mov_b32 v215, 0
    v_mov_b32 v216, 0
    v_mov_b32 v217, 0
    v_mov_b32 v218, 0
    v_mov_b32 v219, 0
    v_mov_b32 v220, 0
    v_mov_b32 v221, 0
    v_mov_b32 v222, 0
    v_mov_b32 v223, 0
    v_mov_b32 v224, 0
    v_mov_b32 v225, 0
    v_mov_b32 v226, 0
    v_mov_b32 v227, 0
    v_mov_b32 v228, 0
    v_mov_b32 v229, 0
    v_mov_b32 v230, 0
    v_mov_b32 v231, 0
    v_mov_b32 v232, 0
    v_mov_b32 v233, 0
    v_mov_b32 v234, 0
    v_mov_b32 v235, 0
    v_mov_b32 v236, 0
    v_mov_b32 v237, 0
    v_mov_b32 v238, 0
    v_mov_b32 v239, 0
    v_mov_b32 v240, 0
    v_mov_b32 v241, 0
    v_mov_b32 v242, 0
    v_mov_b32 v243, 0
    v_mov_b32 v244, 0
    v_mov_b32 v245, 0
    v_mov_b32 v246, 0
    v_mov_b32 v247, 0
    v_mov_b32 v248, 0
    v_mov_b32 v249, 0
    v_mov_b32 v250, 0
    v_mov_b32 v251, 0
    v_mov_b32 v252, 0
    v_mov_b32 v253, 0
    v_mov_b32 v254, 0
    v_mov_b32 v255, 0
    v_mov_b32 v64, 0
    v_mov_b32 v65, 0
    v_mov_b32 v66, 0
    v_mov_b32 v67, 0
    v_mov_b32 v68, 0
    v_mov_b32 v69, 0
    v_mov_b32 v70, 0
    v_mov_b32 v71, 0
    v_mov_b32 v72, 0
    v_mov_b32 v73, 0
    v_mov_b32 v74, 0
    v_mov_b32 v75, 0
    v_mov_b32 v76, 0
    v_mov_b32 v77, 0
    v_mov_b32 v78, 0
    v_mov_b32 v79, 0
    v_mov_b32 v80, 0
    v_mov_b32 v81, 0
    v_mov_b32 v82, 0
    v_mov_b32 v83, 0
    v_mov_b32 v84, 0
    v_mov_b32 v85, 0
    v_mov_b32 v86, 0
    v_mov_b32 v87, 0
    v_mov_b32 v88, 0
    v_mov_b32 v89, 0
    v_mov_b32 v90, 0
    v_mov_b32 v91, 0
    v_mov_b32 v92, 0
    v_mov_b32 v93, 0
    v_mov_b32 v94, 0
    v_mov_b32 v95, 0
    v_mov_b32 v96, 0
    v_mov_b32 v97, 0
    v_mov_b32 v98, 0
    v_mov_b32 v99, 0
    v_mov_b32 v100, 0
    v_mov_b32 v101, 0
    v_mov_b32 v102, 0
    v_mov_b32 v103, 0
    v_mov_b32 v104, 0
    v_mov_b32 v105, 0
    v_mov_b32 v106, 0
    v_mov_b32 v107, 0
    v_mov_b32 v108, 0
    v_mov_b32 v109, 0
    v_mov_b32 v110, 0
    v_mov_b32 v111, 0
    v_mov_b32 v112, 0
    v_mov_b32 v113, 0
    v_mov_b32 v114, 0
    v_mov_b32 v115, 0
    v_mov_b32 v116, 0
    v_mov_b32 v117, 0
    v_mov_b32 v118, 0
    v_mov_b32 v119, 0
    v_mov_b32 v120, 0
    v_mov_b32 v121, 0
    v_mov_b32 v122, 0
    v_mov_b32 v123, 0
    v_mov_b32 v124, 0
    v_mov_b32 v125, 0
    v_mov_b32 v126, 0
    v_mov_b32 v127, 0
    v_mov_b32 v32, 0
    v_mov_b32 v33, 0
    v_accvgpr_write_b32 a192, 0
    v_accvgpr_write_b32 a193, 0
    v_accvgpr_write_b32 a194, 0
    v_accvgpr_write_b32 a195, 0
    v_accvgpr_write_b32 a196, 0
    v_accvgpr_write_b32 a197, 0
    v_accvgpr_write_b32 a198, 0
    v_accvgpr_write_b32 a199, 0
    v_accvgpr_write_b32 a200, 0
    v_accvgpr_write_b32 a201, 0
    v_accvgpr_write_b32 a202, 0
    v_accvgpr_write_b32 a203, 0
    v_accvgpr_write_b32 a204, 0
    v_accvgpr_write_b32 a205, 0
    v_accvgpr_write_b32 a206, 0
    v_accvgpr_write_b32 a207, 0
    s_branch L_final
L_ret0:
    v_rcp_f32 v26, v26
    v_rcp_f32 v27, v27
    v_rcp_f32 v28, v28
    v_rcp_f32 v29, v29
    v_xor_b32 v4, 98304, v4
    s_add_u32 s72, s86, 0
    v_mul_f32 v128, v128, v26
    v_mul_f32 v144, v144, v26
    v_mul_f32 v129, v129, v26
    v_mul_f32 v145, v145, v26
    v_mul_f32 v130, v130, v26
    v_mul_f32 v146, v146, v26
    v_mul_f32 v131, v131, v26
    v_mul_f32 v147, v147, v26
    v_cvt_pk_bf16_f32 v128, v128, v129
    v_cvt_pk_bf16_f32 v129, v130, v131
    v_cvt_pk_bf16_f32 v130, v144, v145
    v_cvt_pk_bf16_f32 v131, v146, v147
    buffer_store_dwordx4 v[128:131], v3, s[52:55], s72 offen offset:0 sc1
    v_mul_f32 v132, v132, v27
    v_mul_f32 v148, v148, v27
    v_mul_f32 v133, v133, v27
    v_mul_f32 v149, v149, v27
    v_mul_f32 v134, v134, v27
    v_mul_f32 v150, v150, v27
    v_mul_f32 v135, v135, v27
    v_mul_f32 v151, v151, v27
    v_cvt_pk_bf16_f32 v132, v132, v133
    v_cvt_pk_bf16_f32 v133, v134, v135
    v_cvt_pk_bf16_f32 v134, v148, v149
    v_cvt_pk_bf16_f32 v135, v150, v151
    buffer_store_dwordx4 v[132:135], v3, s[52:55], s72 offen offset:1024 sc1
    v_mul_f32 v136, v136, v28
    v_mul_f32 v152, v152, v28
    v_mul_f32 v137, v137, v28
    v_mul_f32 v153, v153, v28
    v_mul_f32 v138, v138, v28
    v_mul_f32 v154, v154, v28
    v_mul_f32 v139, v139, v28
    v_mul_f32 v155, v155, v28
    v_cvt_pk_bf16_f32 v136, v136, v137
    v_cvt_pk_bf16_f32 v137, v138, v139
    v_cvt_pk_bf16_f32 v138, v152, v153
    v_cvt_pk_bf16_f32 v139, v154, v155
    buffer_store_dwordx4 v[136:139], v3, s[52:55], s72 offen offset:2048 sc1
    v_mul_f32 v140, v140, v29
    v_mul_f32 v156, v156, v29
    v_mul_f32 v141, v141, v29
    v_mul_f32 v157, v157, v29
    v_mul_f32 v142, v142, v29
    v_mul_f32 v158, v158, v29
    v_mul_f32 v143, v143, v29
    v_mul_f32 v159, v159, v29
    v_cvt_pk_bf16_f32 v140, v140, v141
    v_cvt_pk_bf16_f32 v141, v142, v143
    v_cvt_pk_bf16_f32 v142, v156, v157
    v_cvt_pk_bf16_f32 v143, v158, v159
    buffer_store_dwordx4 v[140:143], v3, s[52:55], s72 offen offset:3072 sc1
    s_add_u32 s72, s86, 4096
    v_mul_f32 v160, v160, v26
    v_mul_f32 v176, v176, v26
    v_mul_f32 v161, v161, v26
    v_mul_f32 v177, v177, v26
    v_mul_f32 v162, v162, v26
    v_mul_f32 v178, v178, v26
    v_mul_f32 v163, v163, v26
    v_mul_f32 v179, v179, v26
    v_cvt_pk_bf16_f32 v160, v160, v161
    v_cvt_pk_bf16_f32 v161, v162, v163
    v_cvt_pk_bf16_f32 v162, v176, v177
    v_cvt_pk_bf16_f32 v163, v178, v179
    buffer_store_dwordx4 v[160:163], v3, s[52:55], s72 offen offset:0 sc1
    v_mul_f32 v164, v164, v27
    v_mul_f32 v180, v180, v27
    v_mul_f32 v165, v165, v27
    v_mul_f32 v181, v181, v27
    v_mul_f32 v166, v166, v27
    v_mul_f32 v182, v182, v27
    v_mul_f32 v167, v167, v27
    v_mul_f32 v183, v183, v27
    v_cvt_pk_bf16_f32 v164, v164, v165
    v_cvt_pk_bf16_f32 v165, v166, v167
    v_cvt_pk_bf16_f32 v166, v180, v181
    v_cvt_pk_bf16_f32 v167, v182, v183
    buffer_store_dwordx4 v[164:167], v3, s[52:55], s72 offen offset:1024 sc1
    v_mul_f32 v168, v168, v28
    v_mul_f32 v184, v184, v28
    v_mul_f32 v169, v169, v28
    v_mul_f32 v185, v185, v28
    v_mul_f32 v170, v170, v28
    v_mul_f32 v186, v186, v28
    v_mul_f32 v171, v171, v28
    v_mul_f32 v187, v187, v28
    v_cvt_pk_bf16_f32 v168, v168, v169
    v_cvt_pk_bf16_f32 v169, v170, v171
    v_cvt_pk_bf16_f32 v170, v184, v185
    v_cvt_pk_bf16_f32 v171, v186, v187
    buffer_store_dwordx4 v[168:171], v3, s[52:55], s72 offen offset:2048 sc1
    v_mul_f32 v172, v172, v29
    v_mul_f32 v188, v188, v29
    v_mul_f32 v173, v173, v29
    v_mul_f32 v189, v189, v29
    v_mul_f32 v174, v174, v29
    v_mul_f32 v190, v190, v29
    v_mul_f32 v175, v175, v29
    v_mul_f32 v191, v191, v29
    v_cvt_pk_bf16_f32 v172, v172, v173
    v_cvt_pk_bf16_f32 v173, v174, v175
    v_cvt_pk_bf16_f32 v174, v188, v189
    v_cvt_pk_bf16_f32 v175, v190, v191
    buffer_store_dwordx4 v[172:175], v3, s[52:55], s72 offen offset:3072 sc1
    s_add_u32 s72, s86, 8192
    v_mul_f32 v192, v192, v26
    v_mul_f32 v208, v208, v26
    v_mul_f32 v193, v193, v26
    v_mul_f32 v209, v209, v26
    v_mul_f32 v194, v194, v26
    v_mul_f32 v210, v210, v26
    v_mul_f32 v195, v195, v26
    v_mul_f32 v211, v211, v26
    v_cvt_pk_bf16_f32 v192, v192, v193
    v_cvt_pk_bf16_f32 v193, v194, v195
    v_cvt_pk_bf16_f32 v194, v208, v209
    v_cvt_pk_bf16_f32 v195, v210, v211
    buffer_store_dwordx4 v[192:195], v3, s[52:55], s72 offen offset:0 sc1
    v_mul_f32 v196, v196, v27
    v_mul_f32 v212, v212, v27
    v_mul_f32 v197, v197, v27
    v_mul_f32 v213, v213, v27
    v_mul_f32 v198, v198, v27
    v_mul_f32 v214, v214, v27
    v_mul_f32 v199, v199, v27
    v_mul_f32 v215, v215, v27
    v_cvt_pk_bf16_f32 v196, v196, v197
    v_cvt_pk_bf16_f32 v197, v198, v199
    v_cvt_pk_bf16_f32 v198, v212, v213
    v_cvt_pk_bf16_f32 v199, v214, v215
    buffer_store_dwordx4 v[196:199], v3, s[52:55], s72 offen offset:1024 sc1
    v_mul_f32 v200, v200, v28
    v_mul_f32 v216, v216, v28
    v_mul_f32 v201, v201, v28
    v_mul_f32 v217, v217, v28
    v_mul_f32 v202, v202, v28
    v_mul_f32 v218, v218, v28
    v_mul_f32 v203, v203, v28
    v_mul_f32 v219, v219, v28
    v_cvt_pk_bf16_f32 v200, v200, v201
    v_cvt_pk_bf16_f32 v201, v202, v203
    v_cvt_pk_bf16_f32 v202, v216, v217
    v_cvt_pk_bf16_f32 v203, v218, v219
    buffer_store_dwordx4 v[200:203], v3, s[52:55], s72 offen offset:2048 sc1
    v_mul_f32 v204, v204, v29
    v_mul_f32 v220, v220, v29
    v_mul_f32 v205, v205, v29
    v_mul_f32 v221, v221, v29
    v_mul_f32 v206, v206, v29
    v_mul_f32 v222, v222, v29
    v_mul_f32 v207, v207, v29
    v_mul_f32 v223, v223, v29
    v_cvt_pk_bf16_f32 v204, v204, v205
    v_cvt_pk_bf16_f32 v205, v206, v207
    v_cvt_pk_bf16_f32 v206, v220, v221
    v_cvt_pk_bf16_f32 v207, v222, v223
    buffer_store_dwordx4 v[204:207], v3, s[52:55], s72 offen offset:3072 sc1
    s_add_u32 s72, s86, 12288
    v_mul_f32 v224, v224, v26
    v_mul_f32 v240, v240, v26
    v_mul_f32 v225, v225, v26
    v_mul_f32 v241, v241, v26
    v_mul_f32 v226, v226, v26
    v_mul_f32 v242, v242, v26
    v_mul_f32 v227, v227, v26
    v_mul_f32 v243, v243, v26
    v_cvt_pk_bf16_f32 v224, v224, v225
    v_cvt_pk_bf16_f32 v225, v226, v227
    v_cvt_pk_bf16_f32 v226, v240, v241
    v_cvt_pk_bf16_f32 v227, v242, v243
    buffer_store_dwordx4 v[224:227], v3, s[52:55], s72 offen offset:0 sc1
    v_mul_f32 v228, v228, v27
    v_mul_f32 v244, v244, v27
    v_mul_f32 v229, v229, v27
    v_mul_f32 v245, v245, v27
    v_mul_f32 v230, v230, v27
    v_mul_f32 v246, v246, v27
    v_mul_f32 v231, v231, v27
    v_mul_f32 v247, v247, v27
    v_cvt_pk_bf16_f32 v228, v228, v229
    v_cvt_pk_bf16_f32 v229, v230, v231
    v_cvt_pk_bf16_f32 v230, v244, v245
    v_cvt_pk_bf16_f32 v231, v246, v247
    buffer_store_dwordx4 v[228:231], v3, s[52:55], s72 offen offset:1024 sc1
    v_mul_f32 v232, v232, v28
    v_mul_f32 v248, v248, v28
    v_mul_f32 v233, v233, v28
    v_mul_f32 v249, v249, v28
    v_mul_f32 v234, v234, v28
    v_mul_f32 v250, v250, v28
    v_mul_f32 v235, v235, v28
    v_mul_f32 v251, v251, v28
    v_cvt_pk_bf16_f32 v232, v232, v233
    v_cvt_pk_bf16_f32 v233, v234, v235
    v_cvt_pk_bf16_f32 v234, v248, v249
    v_cvt_pk_bf16_f32 v235, v250, v251
    buffer_store_dwordx4 v[232:235], v3, s[52:55], s72 offen offset:2048 sc1
    v_mul_f32 v236, v236, v29
    v_mul_f32 v252, v252, v29
    v_mul_f32 v237, v237, v29
    v_mul_f32 v253, v253, v29
    v_mul_f32 v238, v238, v29
    v_mul_f32 v254, v254, v29
    v_mul_f32 v239, v239, v29
    v_mul_f32 v255, v255, v29
    v_cvt_pk_bf16_f32 v236, v236, v237
    v_cvt_pk_bf16_f32 v237, v238, v239
    v_cvt_pk_bf16_f32 v238, v252, v253
    v_cvt_pk_bf16_f32 v239, v254, v255
    buffer_store_dwordx4 v[236:239], v3, s[52:55], s72 offen offset:3072 sc1
    s_mov_b32 s73, 0x30000
    s_cmp_le_u32 s94, 15
    s_cselect_b32 s77, 32768, s73
    s_cmp_le_u32 s94, s25
    s_cselect_b32 s62, 67108864, 0
    s_add_u32 s75, s94, 2
    s_xor_b32 s91, s91, s77
    s_cmp_ge_u32 s75, s97
    s_cselect_b32 s66, s62, 0
    s_xor_b32 s90, s90, s77
    s_mov_b32 m0, s90
    s_barrier
    v_mfma_f32_16x16x32_bf16 a[128:131], a[224:227], a[240:243], a[128:131]
    buffer_load_dwordx4 v3, s[60:63], s88 offen offset:0 sc1 lds
    v_mfma_f32_16x16x32_bf16 a[132:135], a[224:227], a[244:247], a[132:135]
    ds_read_b128 a[0:3], v14 offset:0
    ds_read_b128 a[4:7], v14 offset:1024
    v_mfma_f32_16x16x32_bf16 a[136:139], a[224:227], a[248:251], a[136:139]
    ds_read_b128 a[8:11], v14 offset:2048
    ds_read_b128 a[12:15], v14 offset:3072
    v_mfma_f32_16x16x32_bf16 a[140:143], a[224:227], a[252:255], a[140:143]
    ds_read_b128 a[16:19], v14 offset:4096
    ds_read_b128 a[20:23], v14 offset:5120
    v_mfma_f32_16x16x32_bf16 a[156:159], a[228:231], a[252:255], a[156:159]
    buffer_load_dwordx4 v3, s[60:63], s88 offen offset:1024 sc1 lds
    v_mfma_f32_16x16x32_bf16 a[152:155], a[228:231], a[248:251], a[152:155]
    ds_read_b128 a[24:27], v14 offset:6144
    ds_read_b128 a[28:31], v14 offset:7168
    v_mfma_f32_16x16x32_bf16 a[148:151], a[228:231], a[244:247], a[148:151]
    ds_read_b128 a[32:35], v14 offset:8192
    ds_read_b128 a[36:39], v14 offset:9216
    v_mfma_f32_16x16x32_bf16 a[144:147], a[228:231], a[240:243], a[144:147]
    ds_read_b128 a[40:43], v14 offset:10240
    ds_read_b128 a[44:47], v14 offset:11264
    v_mfma_f32_16x16x32_bf16 a[160:163], a[232:235], a[240:243], a[160:163]
    buffer_load_dwordx4 v3, s[60:63], s88 offen offset:2048 sc1 lds
    v_mfma_f32_16x16x32_bf16 a[164:167], a[232:235], a[244:247], a[164:167]
    ds_read_b128 a[48:51], v14 offset:12288
    ds_read_b128 a[52:55], v14 offset:13312
    v_mfma_f32_16x16x32_bf16 a[168:171], a[232:235], a[248:251], a[168:171]
    ds_read_b128 a[56:59], v14 offset:14336
    ds_read_b128 a[60:63], v14 offset:15360
    v_mfma_f32_16x16x32_bf16 a[172:175], a[232:235], a[252:255], a[172:175]
    ds_read_b128 a[64:67], v4 offset:0
    ds_read_b128 a[68:71], v4 offset:1024
    v_mfma_f32_16x16x32_bf16 a[188:191], a[236:239], a[252:255], a[188:191]
    buffer_load_dwordx4 v3, s[60:63], s88 offen offset:3072 sc1 lds
    s_add_u32 m0, s90, 4096
    s_add_u32 s76, s88, 4096
    v_mfma_f32_16x16x32_bf16 a[184:187], a[236:239], a[248:251], a[184:187]
    ds_read_b128 a[72:75], v4 offset:2048
    ds_read_b128 a[76:79], v4 offset:3072
    v_mfma_f32_16x16x32_bf16 a[180:183], a[236:239], a[244:247], a[180:183]
    ds_read_b128 a[80:83], v4 offset:4096
    ds_read_b128 a[84:87], v4 offset:5120
    v_mfma_f32_16x16x32_bf16 a[176:179], a[236:239], a[240:243], a[176:179]
    ds_read_b128 a[88:91], v4 offset:6144
    ds_read_b128 a[92:95], v4 offset:7168
    buffer_load_dwordx4 v3, s[60:63], s76 offen offset:0 sc1 lds
    s_nop 0
    buffer_load_dwordx4 v3, s[60:63], s76 offen offset:1024 sc1 lds
    s_nop 0
    buffer_load_dwordx4 v3, s[60:63], s76 offen offset:2048 sc1 lds
    s_nop 0
    buffer_load_dwordx4 v3, s[60:63], s76 offen offset:3072 sc1 lds
    s_mov_b32 m0, s91
    s_add_u32 s88, s88, 16384
    s_nop 0
    buffer_load_dwordx4 v3, s[64:67], s89 offen offset:0 sc1 lds
    s_nop 0
    buffer_load_dwordx4 v3, s[64:67], s89 offen offset:1024 sc1 lds
    s_nop 0
    buffer_load_dwordx4 v3, s[64:67], s89 offen offset:2048 sc1 lds
    s_nop 0
    buffer_load_dwordx4 v3, s[64:67], s89 offen offset:3072 sc1 lds
    s_add_u32 m0, s91, 4096
    s_add_u32 s76, s89, 4096
    s_nop 0
    s_add_u32 s94, s94, 1
    s_cmp_eq_u32 s94, s22
    s_cselect_b32 s21, -1, 0
    s_cmp_eq_u32 s94, s20
    s_cselect_b32 s21, -1, s21
    v_and_b32 v16, s21, v9
    v_and_b32 v17, s21, v10
    v_and_b32 v18, s21, v11
    v_and_b32 v19, s21, v30
    s_and_b32 s21, s21, 0xff800000
    v_mov_b32 v20, s21
    v_mov_b32 v21, s21
    v_mov_b32 v22, s21
    v_mov_b32 v23, s21
    s_mov_b32 s96, 17
    s_waitcnt lgkmcnt(4)
    s_branch L_special
L_spin_xn:
    s_mov_b32 s101, 0x40000
L_spinl_xn:
    s_sleep 2
    buffer_load_dword v0, v29, s[52:55], 0 offen sc1
    s_waitcnt vmcnt(0)
    v_cmp_eq_u32 vcc, s3, v0
    s_cmp_eq_u64 vcc, exec
    s_cbranch_scc1 L_ok_xn
    s_sub_u32 s101, s101, 1
    s_cmp_lg_u32 s101, 0
    s_cbranch_scc1 L_spinl_xn
    s_branch L_ok_xn
L_spin_kv:
    s_mov_b32 s101, 0x40000
L_spinl_kv:
    s_sleep 2
    buffer_load_dword v0, v29, s[52:55], 0 offen sc1
    s_waitcnt vmcnt(0)
    v_cmp_eq_u32 vcc, s3, v0
    s_cmp_eq_u64 vcc, exec
    s_cbranch_scc1 L_ok_kv
    s_sub_u32 s101, s101, 1
    s_cmp_lg_u32 s101, 0
    s_cbranch_scc1 L_spinl_kv
    s_branch L_ok_kv
L_spin_b:
    s_mov_b32 s101, 0x40000
L_spinl_b:
    s_sleep 2
    buffer_load_dword v0, v31, s[52:55], 0 offen sc1
    s_waitcnt vmcnt(0)
    v_cmp_eq_u32 vcc, s3, v0
    s_cmp_eq_u64 vcc, exec
    s_cbranch_scc1 L_ok_b
    s_sub_u32 s101, s101, 1
    s_cmp_lg_u32 s101, 0
    s_cbranch_scc1 L_spinl_b
    s_branch L_ok_b
L_spin_c:
    s_mov_b32 s101, 0x40000
L_spinl_c:
    s_sleep 2
    buffer_load_dword v0, v31, s[52:55], 0 offen sc1
    s_waitcnt vmcnt(0)
    v_cmp_eq_u32 vcc, s3, v0
    s_cmp_eq_u64 vcc, exec
    s_cbranch_scc1 L_ok_c
    s_sub_u32 s101, s101, 1
    s_cmp_lg_u32 s101, 0
    s_cbranch_scc1 L_spinl_c
    s_branch L_ok_c
L_slow:
    s_waitcnt vmcnt(0) lgkmcnt(0)
    s_lshl_b32 s73, s101, 1
    s_add_u32 s73, s73, 2
    s_lshl_b32 s75, s69, 19
    s_add_u32 s77, s75, 50331648
    s_add_u32 s75, s75, 33554432
    s_lshl_b32 s101, s101, 6
    v_lshrrev_b32 v56, 4, v1
    v_lshlrev_b32 v56, 2, v56
    v_and_b32 v60, 15, v1
    v_sub_u32 v60, v60, v56
    v_add_u32 v60, s101, v60
    v_mov_b32 v61, 0xff800000
    s_mov_b32 s72, 0
    v_mov_b32 v128, 0
    v_mov_b32 v129, 0
    v_mov_b32 v130, 0
    v_mov_b32 v131, 0
    v_mov_b32 v132, 0
    v_mov_b32 v133, 0
    v_mov_b32 v134, 0
    v_mov_b32 v135, 0
    v_mov_b32 v136, 0
    v_mov_b32 v137, 0
    v_mov_b32 v138, 0
    v_mov_b32 v139, 0
    v_mov_b32 v140, 0
    v_mov_b32 v141, 0
    v_mov_b32 v142, 0
    v_mov_b32 v143, 0
    v_mov_b32 v144, 0
    v_mov_b32 v145, 0
    v_mov_b32 v146, 0
    v_mov_b32 v147, 0
    v_mov_b32 v148, 0
    v_mov_b32 v149, 0
    v_mov_b32 v150, 0
    v_mov_b32 v151, 0
    v_mov_b32 v152, 0
    v_mov_b32 v153, 0
    v_mov_b32 v154, 0
    v_mov_b32 v155, 0
    v_mov_b32 v156, 0
    v_mov_b32 v157, 0
    v_mov_b32 v158, 0
    v_mov_b32 v159, 0
    v_mov_b32 v160, 0
    v_mov_b32 v161, 0
    v_mov_b32 v162, 0
    v_mov_b32 v163, 0
    v_mov_b32 v164, 0
    v_mov_b32 v165, 0
    v_mov_b32 v166, 0
    v_mov_b32 v167, 0
    v_mov_b32 v168, 0
    v_mov_b32 v169, 0
    v_mov_b32 v170, 0
    v_mov_b32 v171, 0
    v_mov_b32 v172, 0
    v_mov_b32 v173, 0
    v_mov_b32 v174, 0
    v_mov_b32 v175, 0
    v_mov_b32 v176, 0
    v_mov_b32 v177, 0
    v_mov_b32 v178, 0
    v_mov_b32 v179, 0
    v_mov_b32 v180, 0
    v_mov_b32 v181, 0
    v_mov_b32 v182, 0
    v_mov_b32 v183, 0
    v_mov_b32 v184, 0
    v_mov_b32 v185, 0
    v_mov_b32 v186, 0
    v_mov_b32 v187, 0
    v_mov_b32 v188, 0
    v_mov_b32 v189, 0
    v_mov_b32 v190, 0
    v_mov_b32 v191, 0
    v_mov_b32 v192, 0
    v_mov_b32 v193, 0
    v_mov_b32 v194, 0
    v_mov_b32 v195, 0
    v_mov_b32 v196, 0
    v_mov_b32 v197, 0
    v_mov_b32 v198, 0
    v_mov_b32 v199, 0
    v_mov_b32 v200, 0
    v_mov_b32 v201, 0
    v_mov_b32 v202, 0
    v_mov_b32 v203, 0
    v_mov_b32 v204, 0
    v_mov_b32 v205, 0
    v_mov_b32 v206, 0
    v_mov_b32 v207, 0
    v_mov_b32 v208, 0
    v_mov_b32 v209, 0
    v_mov_b32 v210, 0
    v_mov_b32 v211, 0
    v_mov_b32 v212, 0
    v_mov_b32 v213, 0
    v_mov_b32 v214, 0
    v_mov_b32 v215, 0
    v_mov_b32 v216, 0
    v_mov_b32 v217, 0
    v_mov_b32 v218, 0
    v_mov_b32 v219, 0
    v_mov_b32 v220, 0
    v_mov_b32 v221, 0
    v_mov_b32 v222, 0
    v_mov_b32 v223, 0
    v_mov_b32 v224, 0
    v_mov_b32 v225, 0
    v_mov_b32 v226, 0
    v_mov_b32 v227, 0
    v_mov_b32 v228, 0
    v_mov_b32 v229, 0
    v_mov_b32 v230, 0
    v_mov_b32 v231, 0
    v_mov_b32 v232, 0
    v_mov_b32 v233, 0
    v_mov_b32 v234, 0
    v_mov_b32 v235, 0
    v_mov_b32 v236, 0
    v_mov_b32 v237, 0
    v_mov_b32 v238, 0
    v_mov_b32 v239, 0
    v_mov_b32 v240, 0
    v_mov_b32 v241, 0
    v_mov_b32 v242, 0
    v_mov_b32 v243, 0
    v_mov_b32 v244, 0
    v_mov_b32 v245, 0
    v_mov_b32 v246, 0
    v_mov_b32 v247, 0
    v_mov_b32 v248, 0
    v_mov_b32 v249, 0
    v_mov_b32 v250, 0
    v_mov_b32 v251, 0
    v_mov_b32 v252, 0
    v_mov_b32 v253, 0
    v_mov_b32 v254, 0
    v_mov_b32 v255, 0
    v_mov_b32 v48, v61
    v_mov_b32 v26, 0
    v_mov_b32 v49, v61
    v_mov_b32 v27, 0
    v_mov_b32 v50, v61
    v_mov_b32 v28, 0
    v_mov_b32 v51, v61
    v_mov_b32 v29, 0
L_slowl:
    buffer_load_dwordx4 a[96:99], v3, s[52:55], s75 offen offset:0 sc1
    buffer_load_dwordx4 a[100:103], v3, s[52:55], s75 offen offset:1024 sc1
    buffer_load_dwordx4 a[104:107], v3, s[52:55], s75 offen offset:2048 sc1
    buffer_load_dwordx4 a[108:111], v3, s[52:55], s75 offen offset:3072 sc1
    s_add_u32 s75, s75, 4096
    buffer_load_dwordx4 a[112:115], v3, s[52:55], s75 offen offset:0 sc1
    buffer_load_dwordx4 a[116:119], v3, s[52:55], s75 offen offset:1024 sc1
    buffer_load_dwordx4 a[120:123], v3, s[52:55], s75 offen offset:2048 sc1
    buffer_load_dwordx4 a[124:127], v3, s[52:55], s75 offen offset:3072 sc1
    s_add_u32 s75, s75, 4096
    s_waitcnt vmcnt(0) lgkmcnt(0)
    v_mfma_f32_16x16x32_bf16 v[64:67], a[96:99], a[0:3], 0
    v_mfma_f32_16x16x32_bf16 v[68:71], a[96:99], a[16:19], 0
    v_mfma_f32_16x16x32_bf16 v[72:75], a[96:99], a[32:35], 0
    v_mfma_f32_16x16x32_bf16 v[76:79], a[96:99], a[48:51], 0
    v_mfma_f32_16x16x32_bf16 v[64:67], a[100:103], a[4:7], v[64:67]
    v_mfma_f32_16x16x32_bf16 v[68:71], a[100:103], a[20:23], v[68:71]
    v_mfma_f32_16x16x32_bf16 v[72:75], a[100:103], a[36:39], v[72:75]
    v_mfma_f32_16x16x32_bf16 v[76:79], a[100:103], a[52:55], v[76:79]
    v_mfma_f32_16x16x32_bf16 v[64:67], a[104:107], a[8:11], v[64:67]
    v_mfma_f32_16x16x32_bf16 v[68:71], a[104:107], a[24:27], v[68:71]
    v_mfma_f32_16x16x32_bf16 v[72:75], a[104:107], a[40:43], v[72:75]
    v_mfma_f32_16x16x32_bf16 v[76:79], a[104:107], a[56:59], v[76:79]
    v_mfma_f32_16x16x32_bf16 v[64:67], a[108:111], a[12:15], v[64:67]
    v_mfma_f32_16x16x32_bf16 v[68:71], a[108:111], a[28:31], v[68:71]
    v_mfma_f32_16x16x32_bf16 v[72:75], a[108:111], a[44:47], v[72:75]
    v_mfma_f32_16x16x32_bf16 v[76:79], a[108:111], a[60:63], v[76:79]
    v_mfma_f32_16x16x32_bf16 v[80:83], a[112:115], a[0:3], 0
    v_mfma_f32_16x16x32_bf16 v[84:87], a[112:115], a[16:19], 0
    v_mfma_f32_16x16x32_bf16 v[88:91], a[112:115], a[32:35], 0
    v_mfma_f32_16x16x32_bf16 v[92:95], a[112:115], a[48:51], 0
    v_mfma_f32_16x16x32_bf16 v[80:83], a[116:119], a[4:7], v[80:83]
    v_mfma_f32_16x16x32_bf16 v[84:87], a[116:119], a[20:23], v[84:87]
    v_mfma_f32_16x16x32_bf16 v[88:91], a[116:119], a[36:39], v[88:91]
    v_mfma_f32_16x16x32_bf16 v[92:95], a[116:119], a[52:55], v[92:95]
    v_mfma_f32_16x16x32_bf16 v[80:83], a[120:123], a[8:11], v[80:83]
    v_mfma_f32_16x16x32_bf16 v[84:87], a[120:123], a[24:27], v[84:87]
    v_mfma_f32_16x16x32_bf16 v[88:91], a[120:123], a[40:43], v[88:91]
    v_mfma_f32_16x16x32_bf16 v[92:95], a[120:123], a[56:59], v[92:95]
    v_mfma_f32_16x16x32_bf16 v[80:83], a[124:127], a[12:15], v[80:83]
    v_mfma_f32_16x16x32_bf16 v[84:87], a[124:127], a[28:31], v[84:87]
    v_mfma_f32_16x16x32_bf16 v[88:91], a[124:127], a[44:47], v[88:91]
    v_mfma_f32_16x16x32_bf16 v[92:95], a[124:127], a[60:63], v[92:95]
    s_nop 7
    buffer_load_dwordx4 a[96:99], v3, s[52:55], s77 offen offset:0 sc1
    buffer_load_dwordx4 a[100:103], v3, s[52:55], s77 offen offset:1024 sc1
    buffer_load_dwordx4 a[104:107], v3, s[52:55], s77 offen offset:2048 sc1
    buffer_load_dwordx4 a[108:111], v3, s[52:55], s77 offen offset:3072 sc1
    s_add_u32 s77, s77, 4096
    buffer_load_dwordx4 a[112:115], v3, s[52:55], s77 offen offset:0 sc1
    buffer_load_dwordx4 a[116:119], v3, s[52:55], s77 offen offset:1024 sc1
    buffer_load_dwordx4 a[120:123], v3, s[52:55], s77 offen offset:2048 sc1
    buffer_load_dwordx4 a[124:127], v3, s[52:55], s77 offen offset:3072 sc1
    s_add_u32 s77, s77, 4096
    v_cmp_gt_i32 vcc, 0, v60
    s_nop 1
    v_cndmask_b32 v64, v64, v61, vcc
    v_cmp_gt_i32 vcc, 1, v60
    s_nop 1
    v_cndmask_b32 v65, v65, v61, vcc
    v_cmp_gt_i32 vcc, 2, v60
    s_nop 1
    v_cndmask_b32 v66, v66, v61, vcc
    v_cmp_gt_i32 vcc, 3, v60
    s_nop 1
    v_cndmask_b32 v67, v67, v61, vcc
    v_cmp_gt_i32 vcc, -16, v60
    s_nop 1
    v_cndmask_b32 v68, v68, v61, vcc
    v_cmp_gt_i32 vcc, -15, v60
    s_nop 1
    v_cndmask_b32 v69, v69, v61, vcc
    v_cmp_gt_i32 vcc, -14, v60
    s_nop 1
    v_cndmask_b32 v70, v70, v61, vcc
    v_cmp_gt_i32 vcc, -13, v60
    s_nop 1
    v_cndmask_b32 v71, v71, v61, vcc
    v_cmp_gt_i32 vcc, -32, v60
    s_nop 1
    v_cndmask_b32 v72, v72, v61, vcc
    v_cmp_gt_i32 vcc, -31, v60
    s_nop 1
    v_cndmask_b32 v73, v73, v61, vcc
    v_cmp_gt_i32 vcc, -30, v60
    s_nop 1
    v_cndmask_b32 v74, v74, v61, vcc
    v_cmp_gt_i32 vcc, -29, v60
    s_nop 1
    v_cndmask_b32 v75, v75, v61, vcc
    v_cmp_gt_i32 vcc, -48, v60
    s_nop 1
    v_cndmask_b32 v76, v76, v61, vcc
    v_cmp_gt_i32 vcc, -47, v60
    s_nop 1
    v_cndmask_b32 v77, v77, v61, vcc
    v_cmp_gt_i32 vcc, -46, v60
    s_nop 1
    v_cndmask_b32 v78, v78, v61, vcc
    v_cmp_gt_i32 vcc, -45, v60
    s_nop 1
    v_cndmask_b32 v79, v79, v61, vcc
    v_cmp_gt_i32 vcc, 16, v60
    s_nop 1
    v_cndmask_b32 v80, v80, v61, vcc
    v_cmp_gt_i32 vcc, 17, v60
    s_nop 1
    v_cndmask_b32 v81, v81, v61, vcc
    v_cmp_gt_i32 vcc, 18, v60
    s_nop 1
    v_cndmask_b32 v82, v82, v61, vcc
    v_cmp_gt_i32 vcc, 19, v60
    s_nop 1
    v_cndmask_b32 v83, v83, v61, vcc
    v_cmp_gt_i32 vcc, 0, v60
    s_nop 1
    v_cndmask_b32 v84, v84, v61, vcc
    v_cmp_gt_i32 vcc, 1, v60
    s_nop 1
    v_cndmask_b32 v85, v85, v61, vcc
    v_cmp_gt_i32 vcc, 2, v60
    s_nop 1
    v_cndmask_b32 v86, v86, v61, vcc
    v_cmp_gt_i32 vcc, 3, v60
    s_nop 1
    v_cndmask_b32 v87, v87, v61, vcc
    v_cmp_gt_i32 vcc, -16, v60
    s_nop 1
    v_cndmask_b32 v88, v88, v61, vcc
    v_cmp_gt_i32 vcc, -15, v60
    s_nop 1
    v_cndmask_b32 v89, v89, v61, vcc
    v_cmp_gt_i32 vcc, -14, v60
    s_nop 1
    v_cndmask_b32 v90, v90, v61, vcc
    v_cmp_gt_i32 vcc, -13, v60
    s_nop 1
    v_cndmask_b32 v91, v91, v61, vcc
    v_cmp_gt_i32 vcc, -32, v60
    s_nop 1
    v_cndmask_b32 v92, v92, v61, vcc
    v_cmp_gt_i32 vcc, -31, v60
    s_nop 1
    v_cndmask_b32 v93, v93, v61, vcc
    v_cmp_gt_i32 vcc, -30, v60
    s_nop 1
    v_cndmask_b32 v94, v94, v61, vcc
    v_cmp_gt_i32 vcc, -29, v60
    s_nop 1
    v_cndmask_b32 v95, v95, v61, vcc
    v_subrev_u32 v60, 32, v60
    v_max3_f32 v56, v64, v65, v66
    v_max3_f32 v56, v56, v67, v80
    v_max3_f32 v56, v56, v81, v82
    v_max3_f32 v56, v56, v83, v48
    v_mov_b32 v57, v56
    s_nop 1
    v_permlane32_swap_b32 v56, v57
    v_max_f32 v56, v56, v57
    v_mov_b32 v57, v56
    s_nop 1
    v_permlane16_swap_b32 v56, v57
    v_max_f32 v56, v56, v57
    v_sub_f32 v52, v48, v56
    v_mov_b32 v48, v56
    v_exp_f32 v52, v52
    v_sub_f32 v64, v64, v56
    v_sub_f32 v65, v65, v56
    v_sub_f32 v66, v66, v56
    v_sub_f32 v67, v67, v56
    v_sub_f32 v80, v80, v56
    v_sub_f32 v81, v81, v56
    v_sub_f32 v82, v82, v56
    v_sub_f32 v83, v83, v56
    v_exp_f32 v64, v64
    v_exp_f32 v65, v65
    v_exp_f32 v66, v66
    v_exp_f32 v67, v67
    v_exp_f32 v80, v80
    v_exp_f32 v81, v81
    v_exp_f32 v82, v82
    v_exp_f32 v83, v83
    v_mul_f32 v26, v26, v52
    v_add_f32 v26, v26, v64
    v_add_f32 v26, v26, v65
    v_add_f32 v26, v26, v66
    v_add_f32 v26, v26, v67
    v_add_f32 v26, v26, v80
    v_add_f32 v26, v26, v81
    v_add_f32 v26, v26, v82
    v_add_f32 v26, v26, v83
    v_cvt_pk_bf16_f32 v32, v64, v65
    v_cvt_pk_bf16_f32 v33, v66, v67
    v_cvt_pk_bf16_f32 v34, v80, v81
    v_cvt_pk_bf16_f32 v35, v82, v83
    v_mul_f32 v128, v128, v52
    v_mul_f32 v129, v129, v52
    v_mul_f32 v130, v130, v52
    v_mul_f32 v131, v131, v52
    v_mul_f32 v144, v144, v52
    v_mul_f32 v145, v145, v52
    v_mul_f32 v146, v146, v52
    v_mul_f32 v147, v147, v52
    v_mul_f32 v160, v160, v52
    v_mul_f32 v161, v161, v52
    v_mul_f32 v162, v162, v52
    v_mul_f32 v163, v163, v52
    v_mul_f32 v176, v176, v52
    v_mul_f32 v177, v177, v52
    v_mul_f32 v178, v178, v52
    v_mul_f32 v179, v179, v52
    v_mul_f32 v192, v192, v52
    v_mul_f32 v193, v193, v52
    v_mul_f32 v194, v194, v52
    v_mul_f32 v195, v195, v52
    v_mul_f32 v208, v208, v52
    v_mul_f32 v209, v209, v52
    v_mul_f32 v210, v210, v52
    v_mul_f32 v211, v211, v52
    v_mul_f32 v224, v224, v52
    v_mul_f32 v225, v225, v52
    v_mul_f32 v226, v226, v52
    v_mul_f32 v227, v227, v52
    v_mul_f32 v240, v240, v52
    v_mul_f32 v241, v241, v52
    v_mul_f32 v242, v242, v52
    v_mul_f32 v243, v243, v52
    v_max3_f32 v56, v68, v69, v70
    v_max3_f32 v56, v56, v71, v84
    v_max3_f32 v56, v56, v85, v86
    v_max3_f32 v56, v56, v87, v49
    v_mov_b32 v57, v56
    s_nop 1
    v_permlane32_swap_b32 v56, v57
    v_max_f32 v56, v56, v57
    v_mov_b32 v57, v56
    s_nop 1
    v_permlane16_swap_b32 v56, v57
    v_max_f32 v56, v56, v57
    v_sub_f32 v53, v49, v56
    v_mov_b32 v49, v56
    v_exp_f32 v53, v53
    v_sub_f32 v68, v68, v56
    v_sub_f32 v69, v69, v56
    v_sub_f32 v70, v70, v56
    v_sub_f32 v71, v71, v56
    v_sub_f32 v84, v84, v56
    v_sub_f32 v85, v85, v56
    v_sub_f32 v86, v86, v56
    v_sub_f32 v87, v87, v56
    v_exp_f32 v68, v68
    v_exp_f32 v69, v69
    v_exp_f32 v70, v70
    v_exp_f32 v71, v71
    v_exp_f32 v84, v84
    v_exp_f32 v85, v85
    v_exp_f32 v86, v86
    v_exp_f32 v87, v87
    v_mul_f32 v27, v27, v53
    v_add_f32 v27, v27, v68
    v_add_f32 v27, v27, v69
    v_add_f32 v27, v27, v70
    v_add_f32 v27, v27, v71
    v_add_f32 v27, v27, v84
    v_add_f32 v27, v27, v85
    v_add_f32 v27, v27, v86
    v_add_f32 v27, v27, v87
    v_cvt_pk_bf16_f32 v36, v68, v69
    v_cvt_pk_bf16_f32 v37, v70, v71
    v_cvt_pk_bf16_f32 v38, v84, v85
    v_cvt_pk_bf16_f32 v39, v86, v87
    v_mul_f32 v132, v132, v53
    v_mul_f32 v133, v133, v53
    v_mul_f32 v134, v134, v53
    v_mul_f32 v135, v135, v53
    v_mul_f32 v148, v148, v53
    v_mul_f32 v149, v149, v53
    v_mul_f32 v150, v150, v53
    v_mul_f32 v151, v151, v53
    v_mul_f32 v164, v164, v53
    v_mul_f32 v165, v165, v53
    v_mul_f32 v166, v166, v53
    v_mul_f32 v167, v167, v53
    v_mul_f32 v180, v180, v53
    v_mul_f32 v181, v181, v53
    v_mul_f32 v182, v182, v53
    v_mul_f32 v183, v183, v53
    v_mul_f32 v196, v196, v53
    v_mul_f32 v197, v197, v53
    v_mul_f32 v198, v198, v53
    v_mul_f32 v199, v199, v53
    v_mul_f32 v212, v212, v53
    v_mul_f32 v213, v213, v53
    v_mul_f32 v214, v214, v53
    v_mul_f32 v215, v215, v53
    v_mul_f32 v228, v228, v53
    v_mul_f32 v229, v229, v53
    v_mul_f32 v230, v230, v53
    v_mul_f32 v231, v231, v53
    v_mul_f32 v244, v244, v53
    v_mul_f32 v245, v245, v53
    v_mul_f32 v246, v246, v53
    v_mul_f32 v247, v247, v53
    v_max3_f32 v56, v72, v73, v74
    v_max3_f32 v56, v56, v75, v88
    v_max3_f32 v56, v56, v89, v90
    v_max3_f32 v56, v56, v91, v50
    v_mov_b32 v57, v56
    s_nop 1
    v_permlane32_swap_b32 v56, v57
    v_max_f32 v56, v56, v57
    v_mov_b32 v57, v56
    s_nop 1
    v_permlane16_swap_b32 v56, v57
    v_max_f32 v56, v56, v57
    v_sub_f32 v54, v50, v56
    v_mov_b32 v50, v56
    v_exp_f32 v54, v54
    v_sub_f32 v72, v72, v56
    v_sub_f32 v73, v73, v56
    v_sub_f32 v74, v74, v56
    v_sub_f32 v75, v75, v56
    v_sub_f32 v88, v88, v56
    v_sub_f32 v89, v89, v56
    v_sub_f32 v90, v90, v56
    v_sub_f32 v91, v91, v56
    v_exp_f32 v72, v72
    v_exp_f32 v73, v73
    v_exp_f32 v74, v74
    v_exp_f32 v75, v75
    v_exp_f32 v88, v88
    v_exp_f32 v89, v89
    v_exp_f32 v90, v90
    v_exp_f32 v91, v91
    v_mul_f32 v28, v28, v54
    v_add_f32 v28, v28, v72
    v_add_f32 v28, v28, v73
    v_add_f32 v28, v28, v74
    v_add_f32 v28, v28, v75
    v_add_f32 v28, v28, v88
    v_add_f32 v28, v28, v89
    v_add_f32 v28, v28, v90
    v_add_f32 v28, v28, v91
    v_cvt_pk_bf16_f32 v40, v72, v73
    v_cvt_pk_bf16_f32 v41, v74, v75
    v_cvt_pk_bf16_f32 v42, v88, v89
    v_cvt_pk_bf16_f32 v43, v90, v91
    v_mul_f32 v136, v136, v54
    v_mul_f32 v137, v137, v54
    v_mul_f32 v138, v138, v54
    v_mul_f32 v139, v139, v54
    v_mul_f32 v152, v152, v54
    v_mul_f32 v153, v153, v54
    v_mul_f32 v154, v154, v54
    v_mul_f32 v155, v155, v54
    v_mul_f32 v168, v168, v54
    v_mul_f32 v169, v169, v54
    v_mul_f32 v170, v170, v54
    v_mul_f32 v171, v171, v54
    v_mul_f32 v184, v184, v54
    v_mul_f32 v185, v185, v54
    v_mul_f32 v186, v186, v54
    v_mul_f32 v187, v187, v54
    v_mul_f32 v200, v200, v54
    v_mul_f32 v201, v201, v54
    v_mul_f32 v202, v202, v54
    v_mul_f32 v203, v203, v54
    v_mul_f32 v216, v216, v54
    v_mul_f32 v217, v217, v54
    v_mul_f32 v218, v218, v54
    v_mul_f32 v219, v219, v54
    v_mul_f32 v232, v232, v54
    v_mul_f32 v233, v233, v54
    v_mul_f32 v234, v234, v54
    v_mul_f32 v235, v235, v54
    v_mul_f32 v248, v248, v54
    v_mul_f32 v249, v249, v54
    v_mul_f32 v250, v250, v54
    v_mul_f32 v251, v251, v54
    v_max3_f32 v56, v76, v77, v78
    v_max3_f32 v56, v56, v79, v92
    v_max3_f32 v56, v56, v93, v94
    v_max3_f32 v56, v56, v95, v51
    v_mov_b32 v57, v56
    s_nop 1
    v_permlane32_swap_b32 v56, v57
    v_max_f32 v56, v56, v57
    v_mov_b32 v57, v56
    s_nop 1
    v_permlane16_swap_b32 v56, v57
    v_max_f32 v56, v56, v57
    v_sub_f32 v55, v51, v56
    v_mov_b32 v51, v56
    v_exp_f32 v55, v55
    v_sub_f32 v76, v76, v56
    v_sub_f32 v77, v77, v56
    v_sub_f32 v78, v78, v56
    v_sub_f32 v79, v79, v56
    v_sub_f32 v92, v92, v56
    v_sub_f32 v93, v93, v56
    v_sub_f32 v94, v94, v56
    v_sub_f32 v95, v95, v56
    v_exp_f32 v76, v76
    v_exp_f32 v77, v77
    v_exp_f32 v78, v78
    v_exp_f32 v79, v79
    v_exp_f32 v92, v92
    v_exp_f32 v93, v93
    v_exp_f32 v94, v94
    v_exp_f32 v95, v95
    v_mul_f32 v29, v29, v55
    v_add_f32 v29, v29, v76
    v_add_f32 v29, v29, v77
    v_add_f32 v29, v29, v78
    v_add_f32 v29, v29, v79
    v_add_f32 v29, v29, v92
    v_add_f32 v29, v29, v93
    v_add_f32 v29, v29, v94
    v_add_f32 v29, v29, v95
    v_cvt_pk_bf16_f32 v44, v76, v77
    v_cvt_pk_bf16_f32 v45, v78, v79
    v_cvt_pk_bf16_f32 v46, v92, v93
    v_cvt_pk_bf16_f32 v47, v94, v95
    v_mul_f32 v140, v140, v55
    v_mul_f32 v141, v141, v55
    v_mul_f32 v142, v142, v55
    v_mul_f32 v143, v143, v55
    v_mul_f32 v156, v156, v55
    v_mul_f32 v157, v157, v55
    v_mul_f32 v158, v158, v55
    v_mul_f32 v159, v159, v55
    v_mul_f32 v172, v172, v55
    v_mul_f32 v173, v173, v55
    v_mul_f32 v174, v174, v55
    v_mul_f32 v175, v175, v55
    v_mul_f32 v188, v188, v55
    v_mul_f32 v189, v189, v55
    v_mul_f32 v190, v190, v55
    v_mul_f32 v191, v191, v55
    v_mul_f32 v204, v204, v55
    v_mul_f32 v205, v205, v55
    v_mul_f32 v206, v206, v55
    v_mul_f32 v207, v207, v55
    v_mul_f32 v220, v220, v55
    v_mul_f32 v221, v221, v55
    v_mul_f32 v222, v222, v55
    v_mul_f32 v223, v223, v55
    v_mul_f32 v236, v236, v55
    v_mul_f32 v237, v237, v55
    v_mul_f32 v238, v238, v55
    v_mul_f32 v239, v239, v55
    v_mul_f32 v252, v252, v55
    v_mul_f32 v253, v253, v55
    v_mul_f32 v254, v254, v55
    v_mul_f32 v255, v255, v55
    s_waitcnt vmcnt(0) lgkmcnt(0)
    s_nop 1
    v_mfma_f32_16x16x32_bf16 v[128:131], a[96:99], v[32:35], v[128:131]
    v_mfma_f32_16x16x32_bf16 v[132:135], a[96:99], v[36:39], v[132:135]
    v_mfma_f32_16x16x32_bf16 v[136:139], a[96:99], v[40:43], v[136:139]
    v_mfma_f32_16x16x32_bf16 v[140:143], a[96:99], v[44:47], v[140:143]
    v_mfma_f32_16x16x32_bf16 v[144:147], a[100:103], v[32:35], v[144:147]
    v_mfma_f32_16x16x32_bf16 v[148:151], a[100:103], v[36:39], v[148:151]
    v_mfma_f32_16x16x32_bf16 v[152:155], a[100:103], v[40:43], v[152:155]
    v_mfma_f32_16x16x32_bf16 v[156:159], a[100:103], v[44:47], v[156:159]
    v_mfma_f32_16x16x32_bf16 v[160:163], a[104:107], v[32:35], v[160:163]
    v_mfma_f32_16x16x32_bf16 v[164:167], a[104:107], v[36:39], v[164:167]
    v_mfma_f32_16x16x32_bf16 v[168:171], a[104:107], v[40:43], v[168:171]
    v_mfma_f32_16x16x32_bf16 v[172:175], a[104:107], v[44:47], v[172:175]
    v_mfma_f32_16x16x32_bf16 v[176:179], a[108:111], v[32:35], v[176:179]
    v_mfma_f32_16x16x32_bf16 v[180:183], a[108:111], v[36:39], v[180:183]
    v_mfma_f32_16x16x32_bf16 v[184:187], a[108:111], v[40:43], v[184:187]
    v_mfma_f32_16x16x32_bf16 v[188:191], a[108:111], v[44:47], v[188:191]
    v_mfma_f32_16x16x32_bf16 v[192:195], a[112:115], v[32:35], v[192:195]
    v_mfma_f32_16x16x32_bf16 v[196:199], a[112:115], v[36:39], v[196:199]
    v_mfma_f32_16x16x32_bf16 v[200:203], a[112:115], v[40:43], v[200:203]
    v_mfma_f32_16x16x32_bf16 v[204:207], a[112:115], v[44:47], v[204:207]
    v_mfma_f32_16x16x32_bf16 v[208:211], a[116:119], v[32:35], v[208:211]
    v_mfma_f32_16x16x32_bf16 v[212:215], a[116:119], v[36:39], v[212:215]
    v_mfma_f32_16x16x32_bf16 v[216:219], a[116:119], v[40:43], v[216:219]
    v_mfma_f32_16x16x32_bf16 v[220:223], a[116:119], v[44:47], v[220:223]
    v_mfma_f32_16x16x32_bf16 v[224:227], a[120:123], v[32:35], v[224:227]
    v_mfma_f32_16x16x32_bf16 v[228:231], a[120:123], v[36:39], v[228:231]
    v_mfma_f32_16x16x32_bf16 v[232:235], a[120:123], v[40:43], v[232:235]
    v_mfma_f32_16x16x32_bf16 v[236:239], a[120:123], v[44:47], v[236:239]
    v_mfma_f32_16x16x32_bf16 v[240:243], a[124:127], v[32:35], v[240:243]
    v_mfma_f32_16x16x32_bf16 v[244:247], a[124:127], v[36:39], v[244:247]
    v_mfma_f32_16x16x32_bf16 v[248:251], a[124:127], v[40:43], v[248:251]
    v_mfma_f32_16x16x32_bf16 v[252:255], a[124:127], v[44:47], v[252:255]
    s_add_u32 s72, s72, 1
    s_cmp_lt_u32 s72, s73
    s_nop 7
    s_cbranch_scc1 L_slowl
    v_mov_b32 v56, v26
    s_nop 1
    v_permlane32_swap_b32 v26, v56
    v_add_f32 v26, v26, v56
    v_mov_b32 v56, v26
    s_nop 1
    v_permlane16_swap_b32 v26, v56
    v_add_f32 v26, v26, v56
    v_mov_b32 v56, v27
    s_nop 1
    v_permlane32_swap_b32 v27, v56
    v_add_f32 v27, v27, v56
    v_mov_b32 v56, v27
    s_nop 1
    v_permlane16_swap_b32 v27, v56
    v_add_f32 v27, v27, v56
    v_mov_b32 v56, v28
    s_nop 1
    v_permlane32_swap_b32 v28, v56
    v_add_f32 v28, v28, v56
    v_mov_b32 v56, v28
    s_nop 1
    v_permlane16_swap_b32 v28, v56
    v_add_f32 v28, v28, v56
    v_mov_b32 v56, v29
    s_nop 1
    v_permlane32_swap_b32 v29, v56
    v_add_f32 v29, v29, v56
    v_mov_b32 v56, v29
    s_nop 1
    v_permlane16_swap_b32 v29, v56
    v_add_f32 v29, v29, v56
    s_cmp_eq_u32 s100, 0
    s_cbranch_scc1 L_ret0
    s_cmp_eq_u32 s100, 1
    s_cbranch_scc1 L_ret1
    s_branch L_ret2
L_end:
    s_endpgm

.section .rodata,"a"
.p2align 6
.amdhsa_kernel recurrent_scan__compressed_kv_cla__glu_gated_geglu__prompt_kernel
  .amdhsa_next_free_vgpr 512
  .amdhsa_next_free_sgpr 102
  .amdhsa_accum_offset 256
  .amdhsa_group_segment_fixed_size 0
  .amdhsa_kernarg_size 104
  .amdhsa_user_sgpr_count 2
  .amdhsa_user_sgpr_kernarg_segment_ptr 1
  .amdhsa_system_sgpr_workgroup_id_x 1
.end_amdhsa_kernel
```
